```python
import torch

def _softmax(x, axis=-1):
    return torch.softmax(x, dim=axis)

def _gelu(x):
    return torch.nn.functional.gelu(x, approximate='tanh')

def _silu(x):
    return torch.nn.functional.silu(x)

def _sigmoid(x):
    return torch.sigmoid(x)

def _layernorm(x, axis=-1, eps=1e-05):
    m = x.mean(dim=axis, keepdim=True)
    v = x.var(dim=axis, keepdim=True, unbiased=False)
    return (x - m) / torch.sqrt(v + eps)

def _scatter_add(tgt, idx, src, axis=0):
    return tgt.clone().index_add_(axis, idx, src)

def _segment_sum(src, seg, n):
    out = torch.zeros((n,) + src.shape[1:], dtype=src.dtype)
    return out.index_add_(0, seg, src)

def _pad(x, pw):
    flat = tuple((v for pair in reversed(pw) for v in pair))
    return torch.nn.functional.pad(x, flat)
kernel_name = 'adaLN_cond__linear_kernel_hedgehog__mixer_gmlp__prompt'

def setup_inputs():

    _w = lambda a: (lambda t: t.to(torch.bfloat16) if t.is_floating_point() else t)(torch.as_tensor(a))

    def _A_setup():
        B, S, D, H = (1, 2048, 1024, 32)
        Dh = D // H
        return {'x': _w((lambda *s: torch.randn(*s, dtype=torch.bfloat16) * 0.05)(B, S, D)), 'wqkv': _w((lambda *s: torch.randn(*s, dtype=torch.bfloat16) * 0.4)(D, 3 * D)), 'w_phi': _w((lambda *s: torch.randn(*s, dtype=torch.bfloat16) * 0.4)(H, Dh, Dh) * Dh ** (-0.5)), 'wo': _w((lambda *s: torch.randn(*s, dtype=torch.bfloat16) * 0.05)(D, D))}
    _A_in = _A_setup()

    def _B_setup():
        B, S, D, F = (1, 2048, 1024, 3584)
        Fh = F // 2
        return {'x': _w((lambda *s: torch.randn(*s, dtype=torch.bfloat16) * 0.05)(B, S, D)), 'w_in': _w((lambda *s: torch.randn(*s, dtype=torch.bfloat16) * 0.2)(D, 2 * Fh)), 'w_sp': _w(0.01 * (lambda *s: torch.randn(*s, dtype=torch.bfloat16) * 0.2)(S, S)), 'b_sp': _w(1.0 + 0.01 * (lambda *s: torch.randn(*s, dtype=torch.bfloat16) * 0.05)(S)), 'w_out': _w((lambda *s: torch.randn(*s, dtype=torch.bfloat16) * 0.05)(Fh, D))}
    _B_in = _B_setup()
    return {'A_x': _A_in['x'], 'A_wqkv': _A_in['wqkv'], 'A_w_phi': _A_in['w_phi'], 'A_wo': _A_in['wo'], 'B_x': _B_in['x'], 'B_w_in': _B_in['w_in'], 'B_w_sp': _B_in['w_sp'], 'B_b_sp': _B_in['b_sp'], 'B_w_out': _B_in['w_out'], 'c': _w((lambda *s: torch.randn(*s, dtype=torch.bfloat16) * 0.1)(1, 1024) * 8.0), 'w_mod': _w((lambda *s: torch.randn(*s, dtype=torch.bfloat16) * 0.1)(1024, 6 * 1024) * 1024 ** (-0.5) * 8.0)}

def reference(A_x, A_wqkv, A_w_phi, A_wo, B_x, B_w_in, B_w_sp, B_b_sp, B_w_out, c, w_mod):

    def _A_ref(x, wqkv, w_phi, wo):
        B, S, D = x.shape
        H = 32
        Dh = D // H
        qkv = (lambda x, *d: x.permute(*d))((x @ wqkv).reshape(B, S, 3, H, Dh), 2, 0, 3, 1, 4)
        q, k, v = (qkv[0], qkv[1], qkv[2])
        pq = torch.einsum('bhsd,hdf->bhsf', q, w_phi)
        pk = torch.einsum('bhsd,hdf->bhsf', k, w_phi)
        phi_q = torch.concatenate([_softmax(pq, axis=-1), _softmax(-pq, axis=-1)], axis=-1)
        phi_k = torch.concatenate([_softmax(pk, axis=-1), _softmax(-pk, axis=-1)], axis=-1)
        kv = torch.einsum('bhsf,bhsd->bhfd', phi_k, v)
        z = torch.einsum('bhsf->bhf', phi_k)
        num = torch.einsum('bhqf,bhfd->bhqd', phi_q, kv)
        den = torch.einsum('bhqf,bhf->bhq', phi_q, z)[..., None] + 1e-06
        o = num / den
        return (lambda x, *d: x.permute(*d))(o, 0, 2, 1, 3).reshape(B, S, D) @ wo

    def _B_ref(x, w_in, w_sp, b_sp, w_out):
        B, S, D = x.shape
        F = w_in.shape[-1]
        Fh = F // 2
        z = _gelu(torch.einsum('bsd,df->bsf', x, w_in))
        z1 = z[..., :Fh].clone()
        z2 = _layernorm(z[..., Fh:], axis=-1)
        g = torch.einsum('ts,bsf->btf', w_sp, z2) + b_sp[None, :, None]
        return torch.einsum('bsf,fd->bsd', z1 * g, w_out)
    x = A_x
    mod = (_silu(c) @ w_mod).reshape(c.shape[0], 6, 1, -1)
    sa, ca, ga, sb, cb, gb = (mod[:, 0].clone(), mod[:, 1].clone(), mod[:, 2].clone(), mod[:, 3].clone(), mod[:, 4].clone(), mod[:, 5].clone())
    h = _layernorm(x, axis=-1) * (1 + ca) + sa
    x = x + ga * _A_ref(h, A_wqkv, A_w_phi, A_wo)
    h = _layernorm(x, axis=-1) * (1 + cb) + sb
    x = x + gb * _B_ref(h, B_w_in, B_w_sp, B_b_sp, B_w_out)
    return x
```

```asm
; @launch kernel=k0_kernel grid=(256,1,1) block=(256,1,1) lds=1024
; @launch kernel=k0b_kernel grid=(256,1,1) block=(256,1,1) lds=1024
; @launch kernel=k1_kernel grid=(256,1,1) block=(512,1,1) lds=163840
; @launch kernel=k1b_kernel grid=(480,1,1) block=(512,1,1) lds=8704
; @launch kernel=k2_kernel grid=(256,1,1) block=(512,1,1) lds=147456
; @launch kernel=k3_kernel grid=(256,1,1) block=(512,1,1) lds=163840
; @launch kernel=k4_kernel grid=(256,1,1) block=(512,1,1) lds=135168
; @launch kernel=k5_kernel grid=(256,1,1) block=(512,1,1) lds=147456
.amdgcn_target "amdgcn-amd-amdhsa--gfx950"
.text
.globl k0_kernel
.p2align 8
.type k0_kernel,@function
k0_kernel:
    s_load_dwordx4 s[8:11], s[0:1], 72
    s_load_dwordx2 s[6:7], s[0:1], 0
    s_cmp_ge_u32 s2, 256
    s_cbranch_scc1 k0_end
    v_and_b32 v1, 63, v0
    v_lshrrev_b32 v2, 6, v0
    s_nop 0
    v_readfirstlane_b32 s40, v2
    s_load_dwordx2 s[4:5], s[0:1], 104
    s_load_dwordx2 s[36:37], s[0:1], 8
    s_load_dwordx2 s[48:49], s[0:1], 24
    s_load_dwordx2 s[50:51], s[0:1], 64
    s_and_b32 s3, s2, 7
    s_lshr_b32 s24, s2, 3
    s_cmp_ge_u32 s2, 128
    s_cbranch_scc1 k0_stats
    s_lshl_b32 s3, s3, 2
    s_and_b32 s25, s24, 3
    s_add_u32 s3, s3, s25
    s_lshr_b32 s24, s24, 2
    v_and_b32 v3, 0xf8, v0
    s_lshl_b32 s25, s24, 8
    v_add_u32 v3, s25, v3
    v_lshlrev_b32 v4, 1, v3
    s_movk_i32 s25, 12288
    v_mul_lo_u32 v5, v3, s25
    v_and_b32 v6, 7, v0
    v_lshl_add_u32 v5, v6, 4, v5
    s_lshl_b32 s26, s3, 7
    s_mov_b32 s14, 2048
    s_mov_b32 s15, 0x00020000
    s_mov_b32 s18, 12582912
    s_mov_b32 s19, 0x00020000
    s_waitcnt lgkmcnt(0)
    s_mov_b32 s16, s10
    s_and_b32 s17, s11, 0xffff
    buffer_load_dwordx4 v[64:67], v5, s[16:19], s26 offen nt
    s_mov_b32 s12, s8
    s_and_b32 s13, s9, 0xffff
    buffer_load_dwordx4 v[8:11], v4, s[12:15], 0 offen
    s_add_u32 s26, s26, s25
    buffer_load_dwordx4 v[68:71], v5, s[16:19], s26 offen nt
    s_add_u32 s26, s26, s25
    buffer_load_dwordx4 v[72:75], v5, s[16:19], s26 offen nt
    s_add_u32 s26, s26, s25
    buffer_load_dwordx4 v[76:79], v5, s[16:19], s26 offen nt
    s_add_u32 s26, s26, s25
    buffer_load_dwordx4 v[80:83], v5, s[16:19], s26 offen nt
    s_add_u32 s26, s26, s25
    buffer_load_dwordx4 v[84:87], v5, s[16:19], s26 offen nt
    s_add_u32 s26, s26, s25
    buffer_load_dwordx4 v[88:91], v5, s[16:19], s26 offen nt
    s_add_u32 s26, s26, s25
    buffer_load_dwordx4 v[92:95], v5, s[16:19], s26 offen nt
    s_lshl_b32 s41, s2, 2
    s_add_u32 s41, s41, s40
    s_lshr_b32 s42, s41, 7
    s_and_b32 s43, s41, 127
    s_lshl_b32 s43, s43, 3
    v_lshrrev_b32 v133, 3, v1
    v_add_u32 v134, s43, v133
    s_cmp_ge_u32 s42, 6
    s_cselect_b32 s44, s48, s36
    s_cselect_b32 s45, s49, s37
    s_mov_b32 s46, 6291456
    s_cmov_b32 s46, 2097152
    s_mov_b32 s47, 0x00020000
    s_movk_i32 s43, 6144
    s_cmovk_i32 s43, 2048
    v_mul_lo_u32 v134, v134, s43
    s_cselect_b32 s43, 6, 0
    s_and_b32 s45, s45, 0xffff
    s_sub_u32 s43, s42, s43
    s_lshl_b32 s52, s43, 10
    s_lshl_b32 s43, s43, 11
    s_cmp_ge_u32 s42, 3
    s_cselect_b32 s56, 5120, 0
    s_sub_u32 s43, s43, s56
    s_cmp_ge_u32 s42, 6
    s_cselect_b32 s43, s52, s43
    v_and_b32 v136, 7, v1
    v_lshlrev_b32 v136, 4, v136
    v_add_u32 v134, v134, v136
    v_lshl_add_u32 v133, v133, 11, v136
    buffer_load_dwordx4 v[136:139], v134, s[44:47], s43 offen offset:384
    s_mov_b32 s44, s50
    s_and_b32 s45, s51, 0xffff
    s_mov_b32 s46, 3670016
    s_mov_b32 s47, 0x00020000
    s_cmpk_ge_u32 s41, 224
    s_cselect_b32 s42, 224, 0
    s_cselect_b32 s43, 0x400, 0
    s_sub_u32 s42, s41, s42
    s_lshl_b32 s42, s42, 14
    s_add_u32 s42, s42, s43
    buffer_load_dwordx4 v[140:143], v133, s[44:47], s42 offen offset:384
    s_mov_b32 s44, s36
    s_and_b32 s45, s37, 0xffff
    s_mov_b32 s46, 4194304
    s_mov_b32 s47, 0x00020000
    v_lshlrev_b32 v130, 6, v1
    s_lshl_b32 s41, s2, 2
    s_add_u32 s41, s41, s40
    s_lshl_b32 s41, s41, 12
    buffer_load_dword v132, v130, s[44:47], s41 offen
    s_add_u32 s41, s41, 4194304
    buffer_load_dword v132, v130, s[44:47], s41 offen
    s_getpc_b64 s[42:43]
pfc_1:
    s_add_u32 s42, s42, k0b_kernel-pfc_1
    s_addc_u32 s43, s43, 0
    s_lshr_b32 s44, s2, 3
    s_lshl_b32 s44, s44, 2
    s_add_u32 s44, s44, s40
    s_lshl_b32 s44, s44, 8
    v_and_b32 v131, 3, v1
    v_lshlrev_b32 v131, 6, v131
    v_add_u32 v131, s44, v131
    v_min_u32 v131, k1_kernel_end-k0b_kernel, v131
    global_load_dword v132, v131, s[42:43]
    s_mov_b32 s28, 0xffff0000
    s_add_u32 s20, s4, 327680
    s_addc_u32 s21, s5, 0
    s_and_b32 s21, s21, 0xffff
    s_mov_b32 s22, 32768
    s_mov_b32 s23, 0x00020000
    v_and_b32 v7, 7, v1
    v_lshlrev_b32 v7, 5, v7
    v_bfe_u32 v12, v1, 3, 1
    v_lshl_add_u32 v7, v12, 4, v7
    v_bfe_u32 v12, v1, 4, 1
    v_lshl_add_u32 v7, v12, 3, v7
    v_bfe_u32 v12, v1, 5, 1
    v_lshl_add_u32 v7, v12, 2, v7
    v_lshl_add_u32 v7, v2, 8, v7
    s_waitcnt vmcnt(12)
    v_lshlrev_b32 v16, 16, v8
    v_and_b32 v17, s28, v8
    v_lshlrev_b32 v18, 16, v9
    v_and_b32 v19, s28, v9
    v_lshlrev_b32 v20, 16, v10
    v_and_b32 v21, s28, v10
    v_lshlrev_b32 v22, 16, v11
    v_and_b32 v23, s28, v11
    v_mul_f32 v24, 0xbfb8aa3b, v16
    v_mul_f32 v25, 0xbfb8aa3b, v17
    v_mul_f32 v26, 0xbfb8aa3b, v18
    v_mul_f32 v27, 0xbfb8aa3b, v19
    v_mul_f32 v28, 0xbfb8aa3b, v20
    v_mul_f32 v29, 0xbfb8aa3b, v21
    v_mul_f32 v30, 0xbfb8aa3b, v22
    v_mul_f32 v31, 0xbfb8aa3b, v23
    v_exp_f32 v24, v24
    v_exp_f32 v25, v25
    v_exp_f32 v26, v26
    v_exp_f32 v27, v27
    v_exp_f32 v28, v28
    v_exp_f32 v29, v29
    v_exp_f32 v30, v30
    v_exp_f32 v31, v31
    v_add_f32 v24, 1.0, v24
    v_add_f32 v25, 1.0, v25
    v_add_f32 v26, 1.0, v26
    v_add_f32 v27, 1.0, v27
    v_add_f32 v28, 1.0, v28
    v_add_f32 v29, 1.0, v29
    v_add_f32 v30, 1.0, v30
    v_add_f32 v31, 1.0, v31
    v_rcp_f32 v24, v24
    v_rcp_f32 v25, v25
    v_rcp_f32 v26, v26
    v_rcp_f32 v27, v27
    v_rcp_f32 v28, v28
    v_rcp_f32 v29, v29
    v_rcp_f32 v30, v30
    v_rcp_f32 v31, v31
    v_mul_f32 v16, v16, v24
    v_mul_f32 v17, v17, v25
    v_mul_f32 v18, v18, v26
    v_mul_f32 v19, v19, v27
    v_mul_f32 v20, v20, v28
    v_mul_f32 v21, v21, v29
    v_mul_f32 v22, v22, v30
    v_mul_f32 v23, v23, v31
    v_cvt_pk_bf16_f32 v24, v16, v17
    v_cvt_pk_bf16_f32 v26, v18, v19
    v_cvt_pk_bf16_f32 v28, v20, v21
    v_cvt_pk_bf16_f32 v30, v22, v23
    v_lshlrev_b32 v16, 16, v24
    v_and_b32 v17, s28, v24
    v_lshlrev_b32 v18, 16, v26
    v_and_b32 v19, s28, v26
    v_lshlrev_b32 v20, 16, v28
    v_and_b32 v21, s28, v28
    v_lshlrev_b32 v22, 16, v30
    v_and_b32 v23, s28, v30
    s_waitcnt vmcnt(12)
    v_lshlrev_b32 v56, 16, v64
    v_and_b32 v57, s28, v64
    v_lshlrev_b32 v58, 16, v65
    v_and_b32 v59, s28, v65
    v_lshlrev_b32 v60, 16, v66
    v_and_b32 v61, s28, v66
    v_lshlrev_b32 v62, 16, v67
    v_and_b32 v63, s28, v67
    v_mul_f32 v48, v56, v16
    v_mul_f32 v49, v57, v16
    v_mul_f32 v50, v58, v16
    v_mul_f32 v51, v59, v16
    v_mul_f32 v52, v60, v16
    v_mul_f32 v53, v61, v16
    v_mul_f32 v54, v62, v16
    v_mul_f32 v55, v63, v16
    s_waitcnt vmcnt(11)
    v_lshlrev_b32 v56, 16, v68
    v_and_b32 v57, s28, v68
    v_lshlrev_b32 v58, 16, v69
    v_and_b32 v59, s28, v69
    v_lshlrev_b32 v60, 16, v70
    v_and_b32 v61, s28, v70
    v_lshlrev_b32 v62, 16, v71
    v_and_b32 v63, s28, v71
    v_fmac_f32 v48, v56, v17
    v_fmac_f32 v49, v57, v17
    v_fmac_f32 v50, v58, v17
    v_fmac_f32 v51, v59, v17
    v_fmac_f32 v52, v60, v17
    v_fmac_f32 v53, v61, v17
    v_fmac_f32 v54, v62, v17
    v_fmac_f32 v55, v63, v17
    s_waitcnt vmcnt(10)
    v_lshlrev_b32 v56, 16, v72
    v_and_b32 v57, s28, v72
    v_lshlrev_b32 v58, 16, v73
    v_and_b32 v59, s28, v73
    v_lshlrev_b32 v60, 16, v74
    v_and_b32 v61, s28, v74
    v_lshlrev_b32 v62, 16, v75
    v_and_b32 v63, s28, v75
    v_fmac_f32 v48, v56, v18
    v_fmac_f32 v49, v57, v18
    v_fmac_f32 v50, v58, v18
    v_fmac_f32 v51, v59, v18
    v_fmac_f32 v52, v60, v18
    v_fmac_f32 v53, v61, v18
    v_fmac_f32 v54, v62, v18
    v_fmac_f32 v55, v63, v18
    s_waitcnt vmcnt(9)
    v_lshlrev_b32 v56, 16, v76
    v_and_b32 v57, s28, v76
    v_lshlrev_b32 v58, 16, v77
    v_and_b32 v59, s28, v77
    v_lshlrev_b32 v60, 16, v78
    v_and_b32 v61, s28, v78
    v_lshlrev_b32 v62, 16, v79
    v_and_b32 v63, s28, v79
    v_fmac_f32 v48, v56, v19
    v_fmac_f32 v49, v57, v19
    v_fmac_f32 v50, v58, v19
    v_fmac_f32 v51, v59, v19
    v_fmac_f32 v52, v60, v19
    v_fmac_f32 v53, v61, v19
    v_fmac_f32 v54, v62, v19
    v_fmac_f32 v55, v63, v19
    s_waitcnt vmcnt(8)
    v_lshlrev_b32 v56, 16, v80
    v_and_b32 v57, s28, v80
    v_lshlrev_b32 v58, 16, v81
    v_and_b32 v59, s28, v81
    v_lshlrev_b32 v60, 16, v82
    v_and_b32 v61, s28, v82
    v_lshlrev_b32 v62, 16, v83
    v_and_b32 v63, s28, v83
    v_fmac_f32 v48, v56, v20
    v_fmac_f32 v49, v57, v20
    v_fmac_f32 v50, v58, v20
    v_fmac_f32 v51, v59, v20
    v_fmac_f32 v52, v60, v20
    v_fmac_f32 v53, v61, v20
    v_fmac_f32 v54, v62, v20
    v_fmac_f32 v55, v63, v20
    s_waitcnt vmcnt(7)
    v_lshlrev_b32 v56, 16, v84
    v_and_b32 v57, s28, v84
    v_lshlrev_b32 v58, 16, v85
    v_and_b32 v59, s28, v85
    v_lshlrev_b32 v60, 16, v86
    v_and_b32 v61, s28, v86
    v_lshlrev_b32 v62, 16, v87
    v_and_b32 v63, s28, v87
    v_fmac_f32 v48, v56, v21
    v_fmac_f32 v49, v57, v21
    v_fmac_f32 v50, v58, v21
    v_fmac_f32 v51, v59, v21
    v_fmac_f32 v52, v60, v21
    v_fmac_f32 v53, v61, v21
    v_fmac_f32 v54, v62, v21
    v_fmac_f32 v55, v63, v21
    s_waitcnt vmcnt(6)
    v_lshlrev_b32 v56, 16, v88
    v_and_b32 v57, s28, v88
    v_lshlrev_b32 v58, 16, v89
    v_and_b32 v59, s28, v89
    v_lshlrev_b32 v60, 16, v90
    v_and_b32 v61, s28, v90
    v_lshlrev_b32 v62, 16, v91
    v_and_b32 v63, s28, v91
    v_fmac_f32 v48, v56, v22
    v_fmac_f32 v49, v57, v22
    v_fmac_f32 v50, v58, v22
    v_fmac_f32 v51, v59, v22
    v_fmac_f32 v52, v60, v22
    v_fmac_f32 v53, v61, v22
    v_fmac_f32 v54, v62, v22
    v_fmac_f32 v55, v63, v22
    s_waitcnt vmcnt(5)
    v_lshlrev_b32 v56, 16, v92
    v_and_b32 v57, s28, v92
    v_lshlrev_b32 v58, 16, v93
    v_and_b32 v59, s28, v93
    v_lshlrev_b32 v60, 16, v94
    v_and_b32 v61, s28, v94
    v_lshlrev_b32 v62, 16, v95
    v_and_b32 v63, s28, v95
    v_fmac_f32 v48, v56, v23
    v_fmac_f32 v49, v57, v23
    v_fmac_f32 v50, v58, v23
    v_fmac_f32 v51, v59, v23
    v_fmac_f32 v52, v60, v23
    v_fmac_f32 v53, v61, v23
    v_fmac_f32 v54, v62, v23
    v_fmac_f32 v55, v63, v23
    v_permlane32_swap_b32 v48, v49
    v_permlane32_swap_b32 v50, v51
    v_permlane32_swap_b32 v52, v53
    v_permlane32_swap_b32 v54, v55
    v_add_f32 v48, v48, v49
    v_add_f32 v50, v50, v51
    v_add_f32 v52, v52, v53
    v_add_f32 v54, v54, v55
    v_permlane16_swap_b32 v48, v50
    s_nop 0
    v_permlane16_swap_b32 v52, v54
    v_add_f32 v48, v48, v50
    v_add_f32 v52, v52, v54
    s_nop 0
    v_add_f32_dpp v48, v48, v48 row_ror:8 row_mask:0xf bank_mask:0xf
    s_nop 1
    v_add_f32_dpp v48, v52, v52 row_ror:8 row_mask:0xf bank_mask:0xc
    ds_write_b32 v7, v48
    s_waitcnt vmcnt(3) lgkmcnt(0)
    s_barrier
    s_add_u32 s44, s4, 55574528
    s_addc_u32 s45, s5, 0
    s_and_b32 s45, s45, 0xffff
    s_mov_b32 s46, 1507328
    s_mov_b32 s47, 0x00020000
    v_lshlrev_b32 v133, 4, v1
    s_lshl_b32 s42, s2, 2
    s_add_u32 s42, s42, s40
    s_lshl_b32 s42, s42, 10
    s_add_u32 s43, s42, 0x100000
    buffer_store_dwordx4 v[136:139], v133, s[44:47], s42 offen
    buffer_store_dwordx4 v[140:143], v133, s[44:47], s43 offen
    s_add_u32 s44, s4, 524288
    s_addc_u32 s45, s5, 0
    s_and_b32 s45, s45, 0xffff
    s_mov_b32 s46, 524288
    s_mov_b32 s47, 0x00020000
    v_lshlrev_b32 v133, 3, v1
    v_mov_b32 v134, -1
    v_mov_b32 v135, -1
    s_lshr_b32 s42, s42, 1
    buffer_store_dwordx2 v[134:135], v133, s[44:47], s42 offen
    s_cmp_lg_u32 s40, 0
    s_cbranch_scc1 k0_fin
    v_lshlrev_b32 v7, 2, v1
    ds_read2st64_b32 v[8:9], v7 offset0:0 offset1:1
    ds_read2st64_b32 v[10:11], v7 offset0:2 offset1:3
    s_lshl_b32 s26, s3, 8
    s_lshl_b32 s24, s24, 13
    s_add_u32 s26, s26, s24
    s_waitcnt lgkmcnt(0)
    v_add_f32 v8, v8, v9
    v_add_f32 v10, v10, v11
    v_add_f32 v8, v8, v10
    buffer_store_dword v8, v7, s[20:23], s26 offen
    s_branch k0_fin
k0_stats:
    s_sub_u32 s24, s24, 16
    s_lshl_b32 s24, s24, 2
    s_lshr_b32 s25, s3, 1
    s_add_u32 s24, s24, s25
    s_and_b32 s25, s3, 1
    s_lshl_b32 s25, s25, 6
    s_add_u32 s3, s24, s25
    s_lshl_b32 s24, s3, 2
    s_add_u32 s24, s24, s40
    s_lshl_b32 s24, s24, 2
    s_lshl_b32 s26, s24, 11
    s_add_u32 s27, s26, 4096
    v_lshlrev_b32 v4, 4, v1
    s_mov_b32 s14, 4194304
    s_mov_b32 s15, 0x00020000
    s_waitcnt lgkmcnt(0)
    s_mov_b32 s12, s6
    s_and_b32 s13, s7, 0xffff
    buffer_load_dwordx4 v[64:67], v4, s[12:15], s26 offen offset:0
    buffer_load_dwordx4 v[68:71], v4, s[12:15], s26 offen offset:1024
    buffer_load_dwordx4 v[72:75], v4, s[12:15], s26 offen offset:2048
    buffer_load_dwordx4 v[76:79], v4, s[12:15], s26 offen offset:3072
    buffer_load_dwordx4 v[80:83], v4, s[12:15], s27 offen offset:0
    buffer_load_dwordx4 v[84:87], v4, s[12:15], s27 offen offset:1024
    buffer_load_dwordx4 v[88:91], v4, s[12:15], s27 offen offset:2048
    buffer_load_dwordx4 v[92:95], v4, s[12:15], s27 offen offset:3072
    s_lshl_b32 s41, s2, 2
    s_add_u32 s41, s41, s40
    s_lshr_b32 s42, s41, 7
    s_and_b32 s43, s41, 127
    s_lshl_b32 s43, s43, 3
    v_lshrrev_b32 v53, 3, v1
    v_add_u32 v54, s43, v53
    s_cmp_ge_u32 s42, 6
    s_cselect_b32 s44, s48, s36
    s_cselect_b32 s45, s49, s37
    s_mov_b32 s46, 6291456
    s_cmov_b32 s46, 2097152
    s_mov_b32 s47, 0x00020000
    s_movk_i32 s43, 6144
    s_cmovk_i32 s43, 2048
    v_mul_lo_u32 v54, v54, s43
    s_cselect_b32 s43, 6, 0
    s_and_b32 s45, s45, 0xffff
    s_sub_u32 s43, s42, s43
    s_lshl_b32 s52, s43, 10
    s_lshl_b32 s43, s43, 11
    s_cmp_ge_u32 s42, 3
    s_cselect_b32 s56, 5120, 0
    s_sub_u32 s43, s43, s56
    s_cmp_ge_u32 s42, 6
    s_cselect_b32 s43, s52, s43
    v_and_b32 v56, 7, v1
    v_lshlrev_b32 v56, 4, v56
    v_add_u32 v54, v54, v56
    v_lshl_add_u32 v53, v53, 11, v56
    buffer_load_dwordx4 v[56:59], v54, s[44:47], s43 offen offset:384
    s_mov_b32 s44, s50
    s_and_b32 s45, s51, 0xffff
    s_mov_b32 s46, 3670016
    s_mov_b32 s47, 0x00020000
    s_cmpk_ge_u32 s41, 224
    s_cselect_b32 s42, 224, 0
    s_cselect_b32 s43, 0x400, 0
    s_sub_u32 s42, s41, s42
    s_lshl_b32 s42, s42, 14
    s_add_u32 s42, s42, s43
    buffer_load_dwordx4 v[60:63], v53, s[44:47], s42 offen offset:384
    s_mov_b32 s44, s36
    s_and_b32 s45, s37, 0xffff
    s_mov_b32 s46, 4194304
    s_mov_b32 s47, 0x00020000
    v_lshlrev_b32 v50, 6, v1
    s_lshl_b32 s41, s2, 2
    s_add_u32 s41, s41, s40
    s_lshl_b32 s41, s41, 12
    buffer_load_dword v52, v50, s[44:47], s41 offen
    s_add_u32 s41, s41, 4194304
    buffer_load_dword v52, v50, s[44:47], s41 offen
    s_getpc_b64 s[42:43]
pfc_2:
    s_add_u32 s42, s42, k0b_kernel-pfc_2
    s_addc_u32 s43, s43, 0
    s_lshr_b32 s44, s2, 3
    s_lshl_b32 s44, s44, 2
    s_add_u32 s44, s44, s40
    s_lshl_b32 s44, s44, 8
    v_and_b32 v51, 3, v1
    v_lshlrev_b32 v51, 6, v51
    v_add_u32 v51, s44, v51
    v_min_u32 v51, k1_kernel_end-k0b_kernel, v51
    global_load_dword v52, v51, s[42:43]
    s_mov_b32 s28, 0xffff0000
    s_add_u32 s16, s4, 32768
    s_addc_u32 s17, s5, 0
    s_and_b32 s17, s17, 0xffff
    s_mov_b32 s18, 16384
    s_mov_b32 s19, 0x00020000
    s_mov_b32 s20, s4
    s_and_b32 s21, s5, 0xffff
    s_mov_b32 s22, 1048576
    s_mov_b32 s23, 0x00020000
    v_mov_b32 v8, 0
    v_lshlrev_b32 v5, 2, v1
    s_mov_b32 s25, 65536
    s_cmp_eq_u32 s40, 1
    s_cmov_b32 s25, 0x40000
    s_cmp_eq_u32 s40, 2
    s_cmov_b32 s25, 360448
    s_cmp_eq_u32 s40, 3
    s_cmov_b32 s25, 98304
    s_lshl_b32 s26, s3, 8
    s_add_u32 s26, s26, s25
    buffer_store_dword v8, v5, s[20:23], s26 offen
    s_waitcnt vmcnt(12)
    v_lshlrev_b32 v128, 16, v64
    v_and_b32 v129, s28, v64
    v_lshlrev_b32 v130, 16, v65
    v_and_b32 v131, s28, v65
    v_lshlrev_b32 v132, 16, v66
    v_and_b32 v133, s28, v66
    v_lshlrev_b32 v134, 16, v67
    v_and_b32 v135, s28, v67
    v_lshlrev_b32 v136, 16, v68
    v_and_b32 v137, s28, v68
    v_lshlrev_b32 v138, 16, v69
    v_and_b32 v139, s28, v69
    v_lshlrev_b32 v140, 16, v70
    v_and_b32 v141, s28, v70
    v_lshlrev_b32 v142, 16, v71
    v_and_b32 v143, s28, v71
    v_pk_add_f32 v[8:9], v[128:129], v[130:131]
    v_pk_add_f32 v[8:9], v[8:9], v[132:133]
    v_pk_add_f32 v[8:9], v[8:9], v[134:135]
    v_pk_add_f32 v[8:9], v[8:9], v[136:137]
    v_pk_add_f32 v[8:9], v[8:9], v[138:139]
    v_pk_add_f32 v[8:9], v[8:9], v[140:141]
    v_pk_add_f32 v[8:9], v[8:9], v[142:143]
    v_add_f32 v16, v8, v9
    s_waitcnt vmcnt(10)
    v_lshlrev_b32 v144, 16, v72
    v_and_b32 v145, s28, v72
    v_lshlrev_b32 v146, 16, v73
    v_and_b32 v147, s28, v73
    v_lshlrev_b32 v148, 16, v74
    v_and_b32 v149, s28, v74
    v_lshlrev_b32 v150, 16, v75
    v_and_b32 v151, s28, v75
    v_lshlrev_b32 v152, 16, v76
    v_and_b32 v153, s28, v76
    v_lshlrev_b32 v154, 16, v77
    v_and_b32 v155, s28, v77
    v_lshlrev_b32 v156, 16, v78
    v_and_b32 v157, s28, v78
    v_lshlrev_b32 v158, 16, v79
    v_and_b32 v159, s28, v79
    v_pk_add_f32 v[8:9], v[144:145], v[146:147]
    v_pk_add_f32 v[8:9], v[8:9], v[148:149]
    v_pk_add_f32 v[8:9], v[8:9], v[150:151]
    v_pk_add_f32 v[8:9], v[8:9], v[152:153]
    v_pk_add_f32 v[8:9], v[8:9], v[154:155]
    v_pk_add_f32 v[8:9], v[8:9], v[156:157]
    v_pk_add_f32 v[8:9], v[8:9], v[158:159]
    v_add_f32 v18, v8, v9
    s_waitcnt vmcnt(8)
    v_lshlrev_b32 v160, 16, v80
    v_and_b32 v161, s28, v80
    v_lshlrev_b32 v162, 16, v81
    v_and_b32 v163, s28, v81
    v_lshlrev_b32 v164, 16, v82
    v_and_b32 v165, s28, v82
    v_lshlrev_b32 v166, 16, v83
    v_and_b32 v167, s28, v83
    v_lshlrev_b32 v168, 16, v84
    v_and_b32 v169, s28, v84
    v_lshlrev_b32 v170, 16, v85
    v_and_b32 v171, s28, v85
    v_lshlrev_b32 v172, 16, v86
    v_and_b32 v173, s28, v86
    v_lshlrev_b32 v174, 16, v87
    v_and_b32 v175, s28, v87
    v_pk_add_f32 v[8:9], v[160:161], v[162:163]
    v_pk_add_f32 v[8:9], v[8:9], v[164:165]
    v_pk_add_f32 v[8:9], v[8:9], v[166:167]
    v_pk_add_f32 v[8:9], v[8:9], v[168:169]
    v_pk_add_f32 v[8:9], v[8:9], v[170:171]
    v_pk_add_f32 v[8:9], v[8:9], v[172:173]
    v_pk_add_f32 v[8:9], v[8:9], v[174:175]
    v_add_f32 v20, v8, v9
    s_waitcnt vmcnt(6)
    v_lshlrev_b32 v176, 16, v88
    v_and_b32 v177, s28, v88
    v_lshlrev_b32 v178, 16, v89
    v_and_b32 v179, s28, v89
    v_lshlrev_b32 v180, 16, v90
    v_and_b32 v181, s28, v90
    v_lshlrev_b32 v182, 16, v91
    v_and_b32 v183, s28, v91
    v_lshlrev_b32 v184, 16, v92
    v_and_b32 v185, s28, v92
    v_lshlrev_b32 v186, 16, v93
    v_and_b32 v187, s28, v93
    v_lshlrev_b32 v188, 16, v94
    v_and_b32 v189, s28, v94
    v_lshlrev_b32 v190, 16, v95
    v_and_b32 v191, s28, v95
    v_pk_add_f32 v[8:9], v[176:177], v[178:179]
    v_pk_add_f32 v[8:9], v[8:9], v[180:181]
    v_pk_add_f32 v[8:9], v[8:9], v[182:183]
    v_pk_add_f32 v[8:9], v[8:9], v[184:185]
    v_pk_add_f32 v[8:9], v[8:9], v[186:187]
    v_pk_add_f32 v[8:9], v[8:9], v[188:189]
    v_pk_add_f32 v[8:9], v[8:9], v[190:191]
    v_add_f32 v22, v8, v9
    v_add_f32_dpp v16, v16, v16 quad_perm:[1,0,3,2] row_mask:0xf bank_mask:0xf
    v_add_f32_dpp v18, v18, v18 quad_perm:[1,0,3,2] row_mask:0xf bank_mask:0xf
    v_add_f32_dpp v20, v20, v20 quad_perm:[1,0,3,2] row_mask:0xf bank_mask:0xf
    v_add_f32_dpp v22, v22, v22 quad_perm:[1,0,3,2] row_mask:0xf bank_mask:0xf
    v_add_f32_dpp v16, v16, v16 quad_perm:[2,3,0,1] row_mask:0xf bank_mask:0xf
    v_add_f32_dpp v18, v18, v18 quad_perm:[2,3,0,1] row_mask:0xf bank_mask:0xf
    v_add_f32_dpp v20, v20, v20 quad_perm:[2,3,0,1] row_mask:0xf bank_mask:0xf
    v_add_f32_dpp v22, v22, v22 quad_perm:[2,3,0,1] row_mask:0xf bank_mask:0xf
    v_add_f32_dpp v16, v16, v16 row_ror:4 row_mask:0xf bank_mask:0xf
    v_add_f32_dpp v18, v18, v18 row_ror:4 row_mask:0xf bank_mask:0xf
    v_add_f32_dpp v20, v20, v20 row_ror:4 row_mask:0xf bank_mask:0xf
    v_add_f32_dpp v22, v22, v22 row_ror:4 row_mask:0xf bank_mask:0xf
    v_add_f32_dpp v16, v16, v16 row_ror:8 row_mask:0xf bank_mask:0xf
    v_add_f32_dpp v18, v18, v18 row_ror:8 row_mask:0xf bank_mask:0xf
    v_add_f32_dpp v20, v20, v20 row_ror:8 row_mask:0xf bank_mask:0xf
    v_add_f32_dpp v22, v22, v22 row_ror:8 row_mask:0xf bank_mask:0xf
    v_mov_b32 v32, v16
    v_mov_b32 v34, v18
    v_mov_b32 v36, v20
    v_mov_b32 v38, v22
    v_permlane16_swap_b32 v16, v32
    v_permlane16_swap_b32 v18, v34
    v_permlane16_swap_b32 v20, v36
    v_permlane16_swap_b32 v22, v38
    v_add_f32 v16, v16, v32
    v_add_f32 v18, v18, v34
    v_add_f32 v20, v20, v36
    v_add_f32 v22, v22, v38
    v_mov_b32 v32, v16
    v_mov_b32 v34, v18
    v_mov_b32 v36, v20
    v_mov_b32 v38, v22
    v_permlane32_swap_b32 v16, v32
    v_permlane32_swap_b32 v18, v34
    v_permlane32_swap_b32 v20, v36
    v_permlane32_swap_b32 v22, v38
    v_add_f32 v16, v16, v32
    v_add_f32 v18, v18, v34
    v_add_f32 v20, v20, v36
    v_add_f32 v22, v22, v38
    v_mul_f32 v16, 0x3a800000, v16
    v_mul_f32 v18, 0x3a800000, v18
    v_mul_f32 v20, 0x3a800000, v20
    v_mul_f32 v22, 0x3a800000, v22
    v_pk_add_f32 v[128:129], v[128:129], v[16:17] op_sel_hi:[1,0] neg_lo:[0,1] neg_hi:[0,1]
    v_pk_add_f32 v[130:131], v[130:131], v[16:17] op_sel_hi:[1,0] neg_lo:[0,1] neg_hi:[0,1]
    v_pk_add_f32 v[132:133], v[132:133], v[16:17] op_sel_hi:[1,0] neg_lo:[0,1] neg_hi:[0,1]
    v_pk_add_f32 v[134:135], v[134:135], v[16:17] op_sel_hi:[1,0] neg_lo:[0,1] neg_hi:[0,1]
    v_pk_add_f32 v[136:137], v[136:137], v[16:17] op_sel_hi:[1,0] neg_lo:[0,1] neg_hi:[0,1]
    v_pk_add_f32 v[138:139], v[138:139], v[16:17] op_sel_hi:[1,0] neg_lo:[0,1] neg_hi:[0,1]
    v_pk_add_f32 v[140:141], v[140:141], v[16:17] op_sel_hi:[1,0] neg_lo:[0,1] neg_hi:[0,1]
    v_pk_add_f32 v[142:143], v[142:143], v[16:17] op_sel_hi:[1,0] neg_lo:[0,1] neg_hi:[0,1]
    v_pk_mul_f32 v[8:9], v[128:129], v[128:129]
    v_pk_fma_f32 v[8:9], v[130:131], v[130:131], v[8:9]
    v_pk_fma_f32 v[8:9], v[132:133], v[132:133], v[8:9]
    v_pk_fma_f32 v[8:9], v[134:135], v[134:135], v[8:9]
    v_pk_fma_f32 v[8:9], v[136:137], v[136:137], v[8:9]
    v_pk_fma_f32 v[8:9], v[138:139], v[138:139], v[8:9]
    v_pk_fma_f32 v[8:9], v[140:141], v[140:141], v[8:9]
    v_pk_fma_f32 v[8:9], v[142:143], v[142:143], v[8:9]
    v_add_f32 v24, v8, v9
    v_pk_add_f32 v[144:145], v[144:145], v[18:19] op_sel_hi:[1,0] neg_lo:[0,1] neg_hi:[0,1]
    v_pk_add_f32 v[146:147], v[146:147], v[18:19] op_sel_hi:[1,0] neg_lo:[0,1] neg_hi:[0,1]
    v_pk_add_f32 v[148:149], v[148:149], v[18:19] op_sel_hi:[1,0] neg_lo:[0,1] neg_hi:[0,1]
    v_pk_add_f32 v[150:151], v[150:151], v[18:19] op_sel_hi:[1,0] neg_lo:[0,1] neg_hi:[0,1]
    v_pk_add_f32 v[152:153], v[152:153], v[18:19] op_sel_hi:[1,0] neg_lo:[0,1] neg_hi:[0,1]
    v_pk_add_f32 v[154:155], v[154:155], v[18:19] op_sel_hi:[1,0] neg_lo:[0,1] neg_hi:[0,1]
    v_pk_add_f32 v[156:157], v[156:157], v[18:19] op_sel_hi:[1,0] neg_lo:[0,1] neg_hi:[0,1]
    v_pk_add_f32 v[158:159], v[158:159], v[18:19] op_sel_hi:[1,0] neg_lo:[0,1] neg_hi:[0,1]
    v_pk_mul_f32 v[8:9], v[144:145], v[144:145]
    v_pk_fma_f32 v[8:9], v[146:147], v[146:147], v[8:9]
    v_pk_fma_f32 v[8:9], v[148:149], v[148:149], v[8:9]
    v_pk_fma_f32 v[8:9], v[150:151], v[150:151], v[8:9]
    v_pk_fma_f32 v[8:9], v[152:153], v[152:153], v[8:9]
    v_pk_fma_f32 v[8:9], v[154:155], v[154:155], v[8:9]
    v_pk_fma_f32 v[8:9], v[156:157], v[156:157], v[8:9]
    v_pk_fma_f32 v[8:9], v[158:159], v[158:159], v[8:9]
    v_add_f32 v25, v8, v9
    v_pk_add_f32 v[160:161], v[160:161], v[20:21] op_sel_hi:[1,0] neg_lo:[0,1] neg_hi:[0,1]
    v_pk_add_f32 v[162:163], v[162:163], v[20:21] op_sel_hi:[1,0] neg_lo:[0,1] neg_hi:[0,1]
    v_pk_add_f32 v[164:165], v[164:165], v[20:21] op_sel_hi:[1,0] neg_lo:[0,1] neg_hi:[0,1]
    v_pk_add_f32 v[166:167], v[166:167], v[20:21] op_sel_hi:[1,0] neg_lo:[0,1] neg_hi:[0,1]
    v_pk_add_f32 v[168:169], v[168:169], v[20:21] op_sel_hi:[1,0] neg_lo:[0,1] neg_hi:[0,1]
    v_pk_add_f32 v[170:171], v[170:171], v[20:21] op_sel_hi:[1,0] neg_lo:[0,1] neg_hi:[0,1]
    v_pk_add_f32 v[172:173], v[172:173], v[20:21] op_sel_hi:[1,0] neg_lo:[0,1] neg_hi:[0,1]
    v_pk_add_f32 v[174:175], v[174:175], v[20:21] op_sel_hi:[1,0] neg_lo:[0,1] neg_hi:[0,1]
    v_pk_mul_f32 v[8:9], v[160:161], v[160:161]
    v_pk_fma_f32 v[8:9], v[162:163], v[162:163], v[8:9]
    v_pk_fma_f32 v[8:9], v[164:165], v[164:165], v[8:9]
    v_pk_fma_f32 v[8:9], v[166:167], v[166:167], v[8:9]
    v_pk_fma_f32 v[8:9], v[168:169], v[168:169], v[8:9]
    v_pk_fma_f32 v[8:9], v[170:171], v[170:171], v[8:9]
    v_pk_fma_f32 v[8:9], v[172:173], v[172:173], v[8:9]
    v_pk_fma_f32 v[8:9], v[174:175], v[174:175], v[8:9]
    v_add_f32 v26, v8, v9
    v_pk_add_f32 v[176:177], v[176:177], v[22:23] op_sel_hi:[1,0] neg_lo:[0,1] neg_hi:[0,1]
    v_pk_add_f32 v[178:179], v[178:179], v[22:23] op_sel_hi:[1,0] neg_lo:[0,1] neg_hi:[0,1]
    v_pk_add_f32 v[180:181], v[180:181], v[22:23] op_sel_hi:[1,0] neg_lo:[0,1] neg_hi:[0,1]
    v_pk_add_f32 v[182:183], v[182:183], v[22:23] op_sel_hi:[1,0] neg_lo:[0,1] neg_hi:[0,1]
    v_pk_add_f32 v[184:185], v[184:185], v[22:23] op_sel_hi:[1,0] neg_lo:[0,1] neg_hi:[0,1]
    v_pk_add_f32 v[186:187], v[186:187], v[22:23] op_sel_hi:[1,0] neg_lo:[0,1] neg_hi:[0,1]
    v_pk_add_f32 v[188:189], v[188:189], v[22:23] op_sel_hi:[1,0] neg_lo:[0,1] neg_hi:[0,1]
    v_pk_add_f32 v[190:191], v[190:191], v[22:23] op_sel_hi:[1,0] neg_lo:[0,1] neg_hi:[0,1]
    v_pk_mul_f32 v[8:9], v[176:177], v[176:177]
    v_pk_fma_f32 v[8:9], v[178:179], v[178:179], v[8:9]
    v_pk_fma_f32 v[8:9], v[180:181], v[180:181], v[8:9]
    v_pk_fma_f32 v[8:9], v[182:183], v[182:183], v[8:9]
    v_pk_fma_f32 v[8:9], v[184:185], v[184:185], v[8:9]
    v_pk_fma_f32 v[8:9], v[186:187], v[186:187], v[8:9]
    v_pk_fma_f32 v[8:9], v[188:189], v[188:189], v[8:9]
    v_pk_fma_f32 v[8:9], v[190:191], v[190:191], v[8:9]
    v_add_f32 v27, v8, v9
    v_add_f32_dpp v24, v24, v24 quad_perm:[1,0,3,2] row_mask:0xf bank_mask:0xf
    v_add_f32_dpp v25, v25, v25 quad_perm:[1,0,3,2] row_mask:0xf bank_mask:0xf
    v_add_f32_dpp v26, v26, v26 quad_perm:[1,0,3,2] row_mask:0xf bank_mask:0xf
    v_add_f32_dpp v27, v27, v27 quad_perm:[1,0,3,2] row_mask:0xf bank_mask:0xf
    v_add_f32_dpp v24, v24, v24 quad_perm:[2,3,0,1] row_mask:0xf bank_mask:0xf
    v_add_f32_dpp v25, v25, v25 quad_perm:[2,3,0,1] row_mask:0xf bank_mask:0xf
    v_add_f32_dpp v26, v26, v26 quad_perm:[2,3,0,1] row_mask:0xf bank_mask:0xf
    v_add_f32_dpp v27, v27, v27 quad_perm:[2,3,0,1] row_mask:0xf bank_mask:0xf
    v_add_f32_dpp v24, v24, v24 row_ror:4 row_mask:0xf bank_mask:0xf
    v_add_f32_dpp v25, v25, v25 row_ror:4 row_mask:0xf bank_mask:0xf
    v_add_f32_dpp v26, v26, v26 row_ror:4 row_mask:0xf bank_mask:0xf
    v_add_f32_dpp v27, v27, v27 row_ror:4 row_mask:0xf bank_mask:0xf
    v_add_f32_dpp v24, v24, v24 row_ror:8 row_mask:0xf bank_mask:0xf
    v_add_f32_dpp v25, v25, v25 row_ror:8 row_mask:0xf bank_mask:0xf
    v_add_f32_dpp v26, v26, v26 row_ror:8 row_mask:0xf bank_mask:0xf
    v_add_f32_dpp v27, v27, v27 row_ror:8 row_mask:0xf bank_mask:0xf
    v_mov_b32 v40, v24
    v_mov_b32 v41, v25
    v_mov_b32 v42, v26
    v_mov_b32 v43, v27
    v_permlane16_swap_b32 v24, v40
    v_permlane16_swap_b32 v25, v41
    v_permlane16_swap_b32 v26, v42
    v_permlane16_swap_b32 v27, v43
    v_add_f32 v24, v24, v40
    v_add_f32 v25, v25, v41
    v_add_f32 v26, v26, v42
    v_add_f32 v27, v27, v43
    v_mov_b32 v40, v24
    v_mov_b32 v41, v25
    v_mov_b32 v42, v26
    v_mov_b32 v43, v27
    v_permlane32_swap_b32 v24, v40
    v_permlane32_swap_b32 v25, v41
    v_permlane32_swap_b32 v26, v42
    v_permlane32_swap_b32 v27, v43
    v_add_f32 v24, v24, v40
    v_add_f32 v25, v25, v41
    v_add_f32 v26, v26, v42
    v_add_f32 v27, v27, v43
    v_and_b32 v5, 3, v1
    v_mov_b32 v8, v16
    v_mov_b32 v9, v24
    v_cmp_eq_u32 vcc, 1, v5
    s_nop 1
    v_cndmask_b32 v8, v8, v18, vcc
    v_cndmask_b32 v9, v9, v25, vcc
    v_cmp_eq_u32 vcc, 2, v5
    s_nop 1
    v_cndmask_b32 v8, v8, v20, vcc
    v_cndmask_b32 v9, v9, v26, vcc
    v_cmp_eq_u32 vcc, 3, v5
    s_nop 1
    v_cndmask_b32 v8, v8, v22, vcc
    v_cndmask_b32 v9, v9, v27, vcc
    v_mul_f32 v9, 0x3a800000, v9
    v_max_f32 v9, 0, v9
    v_cvt_pk_bf16_f32 v9, v9, v9
    v_and_b32 v9, 0xffff0000, v9
    v_add_f32 v9, 0x3727c5ac, v9
    v_cvt_pk_bf16_f32 v9, v9, v9
    v_and_b32 v9, 0xffff0000, v9
    v_sqrt_f32 v9, v9
    s_nop 0
    v_cvt_pk_bf16_f32 v9, v9, v9
    v_and_b32 v9, 0xffff0000, v9
    v_rcp_f32 v10, v9
    v_cvt_pk_bf16_f32 v8, v8, v8
    v_and_b32 v8, 0xffff0000, v8
    v_mul_f32 v11, v8, v10
    v_sub_f32 v11, 0, v11
    v_lshlrev_b32 v5, 3, v5
    s_lshl_b32 s24, s24, 3
    buffer_store_dwordx2 v[10:11], v5, s[16:19], s24 offen
    s_waitcnt vmcnt(5)
    s_add_u32 s44, s4, 55574528
    s_addc_u32 s45, s5, 0
    s_and_b32 s45, s45, 0xffff
    s_mov_b32 s46, 1507328
    s_mov_b32 s47, 0x00020000
    v_lshlrev_b32 v53, 4, v1
    s_lshl_b32 s42, s2, 2
    s_add_u32 s42, s42, s40
    s_lshl_b32 s42, s42, 10
    s_add_u32 s43, s42, 0x100000
    buffer_store_dwordx4 v[56:59], v53, s[44:47], s42 offen
    buffer_store_dwordx4 v[60:63], v53, s[44:47], s43 offen
    s_add_u32 s44, s4, 524288
    s_addc_u32 s45, s5, 0
    s_and_b32 s45, s45, 0xffff
    s_mov_b32 s46, 524288
    s_mov_b32 s47, 0x00020000
    v_lshlrev_b32 v53, 3, v1
    v_mov_b32 v54, -1
    v_mov_b32 v55, -1
    s_lshr_b32 s42, s42, 1
    buffer_store_dwordx2 v[54:55], v53, s[44:47], s42 offen
k0_fin:
k0_end:
    s_endpgm
.text
.globl k0b_kernel
.p2align 8
.type k0b_kernel,@function
k0b_kernel:
    s_load_dwordx2 s[4:5], s[0:1], 104
    s_load_dwordx2 s[6:7], s[0:1], 0
    s_load_dwordx2 s[10:11], s[0:1], 8
    s_cmp_ge_u32 s2, 256
    s_cbranch_scc1 k0b_x
    s_and_b32 s3, s2, 1
    s_lshl_b32 s3, s3, 6
    s_lshr_b32 s17, s2, 2
    s_add_u32 s3, s3, s17
    s_bfe_u32 s18, s2, 0x10001
    s_lshl_b32 s19, s3, 15
    s_lshl_b32 s20, s18, 10
    s_add_u32 s19, s19, s20
    s_add_u32 s21, s19, 4096
    s_lshl_b32 s20, s18, 11
    s_add_u32 s22, s20, 4096
    s_lshl_b32 s23, s3, 7
    v_bfe_u32 v1, v0, 4, 2
    v_lshrrev_b32 v4, 6, v0
    v_and_b32 v5, 15, v0
    v_lshl_add_u32 v4, v4, 4, v5
    v_lshlrev_b32 v2, 13, v1
    v_lshl_add_u32 v3, v4, 5, v2
    v_lshl_add_u32 v2, v4, 4, v2
    v_lshlrev_b32 v4, 5, v1
    s_mov_b32 s27, 0x00020000
    s_mov_b32 s31, 0x00020000
    s_mov_b32 s35, 0x00020000
    s_mov_b32 s39, 0x00020000
    s_mov_b32 s26, 4194304
    s_mov_b32 s30, 32768
    s_mov_b32 s34, 4194304
    s_mov_b32 s38, 16384
    s_waitcnt lgkmcnt(0)
    s_mov_b32 s24, s6
    s_and_b32 s25, s7, 0xffff
    s_and_b32 s5, s5, 0xffff
    s_add_u32 s28, s4, 327680
    s_addc_u32 s29, s5, 0
    buffer_load_dwordx4 v[24:27], v3, s[28:31], s20 offen
    buffer_load_dwordx4 v[28:31], v3, s[28:31], s20 offen offset:16
    buffer_load_dwordx4 v[32:35], v3, s[28:31], s22 offen
    buffer_load_dwordx4 v[36:39], v3, s[28:31], s22 offen offset:16
    s_add_u32 s36, s4, 32768
    s_addc_u32 s37, s5, 0
    buffer_load_dwordx4 v[40:43], v4, s[36:39], s23 offen
    buffer_load_dwordx4 v[44:47], v4, s[36:39], s23 offen offset:16
    buffer_load_dwordx4 v[8:11], v2, s[24:27], s19 offen offset:0
    buffer_load_dwordx4 v[12:15], v2, s[24:27], s19 offen offset:2048
    buffer_load_dwordx4 v[16:19], v2, s[24:27], s21 offen offset:0
    buffer_load_dwordx4 v[20:23], v2, s[24:27], s21 offen offset:2048
    s_add_u32 s32, s4, 39845888
    s_addc_u32 s33, s5, 0
    s_mov_b32 s23, 0xffff0000
    s_waitcnt vmcnt(8)
    v_permlane32_swap_b32 v24, v25
    v_permlane32_swap_b32 v26, v27
    v_permlane32_swap_b32 v28, v29
    v_permlane32_swap_b32 v30, v31
    v_add_f32 v24, v24, v25
    v_add_f32 v26, v26, v27
    v_add_f32 v28, v28, v29
    v_add_f32 v30, v30, v31
    v_permlane16_swap_b32 v24, v26
    s_nop 0
    v_permlane16_swap_b32 v28, v30
    s_waitcnt vmcnt(6)
    v_permlane32_swap_b32 v32, v33
    v_permlane32_swap_b32 v34, v35
    v_permlane32_swap_b32 v36, v37
    v_permlane32_swap_b32 v38, v39
    v_add_f32 v32, v32, v33
    v_add_f32 v34, v34, v35
    v_add_f32 v36, v36, v37
    v_add_f32 v38, v38, v39
    v_permlane16_swap_b32 v32, v34
    s_nop 0
    v_permlane16_swap_b32 v36, v38
    v_add_f32 v24, v24, v26
    v_add_f32 v28, v28, v30
    v_add_f32 v32, v32, v34
    v_add_f32 v36, v36, v38
    v_cvt_pk_bf16_f32 v24, v24, v24
    v_and_b32 v24, 0xffff0000, v24
    v_cvt_pk_bf16_f32 v28, v28, v28
    v_and_b32 v28, 0xffff0000, v28
    v_cvt_pk_bf16_f32 v32, v32, v32
    v_and_b32 v32, 0xffff0000, v32
    v_cvt_pk_bf16_f32 v36, v36, v36
    v_and_b32 v36, 0xffff0000, v36
    v_add_f32 v32, 1.0, v32
    v_add_f32 v36, 1.0, v36
    v_cvt_pk_bf16_f32 v32, v32, v32
    v_and_b32 v32, 0xffff0000, v32
    v_cvt_pk_bf16_f32 v36, v36, v36
    v_and_b32 v36, 0xffff0000, v36
    v_mov_b32 v26, v24
    v_mov_b32 v30, v28
    v_mov_b32 v34, v32
    v_mov_b32 v38, v36
    v_permlane16_swap_b32 v24, v26
    v_permlane16_swap_b32 v28, v30
    v_permlane16_swap_b32 v32, v34
    v_permlane16_swap_b32 v36, v38
    v_mov_b32 v25, v24
    v_mov_b32 v27, v26
    v_mov_b32 v29, v28
    v_mov_b32 v31, v30
    v_mov_b32 v33, v32
    v_mov_b32 v35, v34
    v_mov_b32 v37, v36
    v_mov_b32 v39, v38
    v_permlane32_swap_b32 v24, v25
    v_permlane32_swap_b32 v26, v27
    v_permlane32_swap_b32 v28, v29
    v_permlane32_swap_b32 v30, v31
    v_permlane32_swap_b32 v32, v33
    v_permlane32_swap_b32 v34, v35
    v_permlane32_swap_b32 v36, v37
    v_permlane32_swap_b32 v38, v39
    s_waitcnt vmcnt(3)
    v_lshlrev_b32 v48, 16, v8
    v_and_b32 v49, s23, v8
    v_lshlrev_b32 v50, 16, v9
    v_and_b32 v51, s23, v9
    v_lshlrev_b32 v52, 16, v10
    v_and_b32 v53, s23, v10
    v_lshlrev_b32 v54, 16, v11
    v_and_b32 v55, s23, v11
    v_pk_fma_f32 v[48:49], v[48:49], v[40:41], v[40:41] op_sel:[0,0,1] op_sel_hi:[1,0,1]
    v_pk_fma_f32 v[50:51], v[50:51], v[40:41], v[40:41] op_sel:[0,0,1] op_sel_hi:[1,0,1]
    v_pk_fma_f32 v[52:53], v[52:53], v[40:41], v[40:41] op_sel:[0,0,1] op_sel_hi:[1,0,1]
    v_pk_fma_f32 v[54:55], v[54:55], v[40:41], v[40:41] op_sel:[0,0,1] op_sel_hi:[1,0,1]
    v_pk_fma_f32 v[48:49], v[48:49], v[32:33], v[24:25]
    v_pk_fma_f32 v[50:51], v[50:51], v[34:35], v[26:27]
    v_pk_fma_f32 v[52:53], v[52:53], v[36:37], v[28:29]
    v_pk_fma_f32 v[54:55], v[54:55], v[38:39], v[30:31]
    v_cvt_pk_bf16_f32 v8, v48, v49
    v_cvt_pk_bf16_f32 v9, v50, v51
    v_cvt_pk_bf16_f32 v10, v52, v53
    v_cvt_pk_bf16_f32 v11, v54, v55
    buffer_store_dwordx4 v[8:11], v2, s[32:35], s19 offen offset:0 sc0 sc1
    s_waitcnt vmcnt(3)
    v_lshlrev_b32 v56, 16, v12
    v_and_b32 v57, s23, v12
    v_lshlrev_b32 v58, 16, v13
    v_and_b32 v59, s23, v13
    v_lshlrev_b32 v60, 16, v14
    v_and_b32 v61, s23, v14
    v_lshlrev_b32 v62, 16, v15
    v_and_b32 v63, s23, v15
    v_pk_fma_f32 v[56:57], v[56:57], v[42:43], v[42:43] op_sel:[0,0,1] op_sel_hi:[1,0,1]
    v_pk_fma_f32 v[58:59], v[58:59], v[42:43], v[42:43] op_sel:[0,0,1] op_sel_hi:[1,0,1]
    v_pk_fma_f32 v[60:61], v[60:61], v[42:43], v[42:43] op_sel:[0,0,1] op_sel_hi:[1,0,1]
    v_pk_fma_f32 v[62:63], v[62:63], v[42:43], v[42:43] op_sel:[0,0,1] op_sel_hi:[1,0,1]
    v_pk_fma_f32 v[56:57], v[56:57], v[32:33], v[24:25]
    v_pk_fma_f32 v[58:59], v[58:59], v[34:35], v[26:27]
    v_pk_fma_f32 v[60:61], v[60:61], v[36:37], v[28:29]
    v_pk_fma_f32 v[62:63], v[62:63], v[38:39], v[30:31]
    v_cvt_pk_bf16_f32 v12, v56, v57
    v_cvt_pk_bf16_f32 v13, v58, v59
    v_cvt_pk_bf16_f32 v14, v60, v61
    v_cvt_pk_bf16_f32 v15, v62, v63
    buffer_store_dwordx4 v[12:15], v2, s[32:35], s19 offen offset:2048 sc0 sc1
    s_waitcnt vmcnt(3)
    v_lshlrev_b32 v64, 16, v16
    v_and_b32 v65, s23, v16
    v_lshlrev_b32 v66, 16, v17
    v_and_b32 v67, s23, v17
    v_lshlrev_b32 v68, 16, v18
    v_and_b32 v69, s23, v18
    v_lshlrev_b32 v70, 16, v19
    v_and_b32 v71, s23, v19
    v_pk_fma_f32 v[64:65], v[64:65], v[44:45], v[44:45] op_sel:[0,0,1] op_sel_hi:[1,0,1]
    v_pk_fma_f32 v[66:67], v[66:67], v[44:45], v[44:45] op_sel:[0,0,1] op_sel_hi:[1,0,1]
    v_pk_fma_f32 v[68:69], v[68:69], v[44:45], v[44:45] op_sel:[0,0,1] op_sel_hi:[1,0,1]
    v_pk_fma_f32 v[70:71], v[70:71], v[44:45], v[44:45] op_sel:[0,0,1] op_sel_hi:[1,0,1]
    v_pk_fma_f32 v[64:65], v[64:65], v[32:33], v[24:25]
    v_pk_fma_f32 v[66:67], v[66:67], v[34:35], v[26:27]
    v_pk_fma_f32 v[68:69], v[68:69], v[36:37], v[28:29]
    v_pk_fma_f32 v[70:71], v[70:71], v[38:39], v[30:31]
    v_cvt_pk_bf16_f32 v16, v64, v65
    v_cvt_pk_bf16_f32 v17, v66, v67
    v_cvt_pk_bf16_f32 v18, v68, v69
    v_cvt_pk_bf16_f32 v19, v70, v71
    buffer_store_dwordx4 v[16:19], v2, s[32:35], s21 offen offset:0 sc0 sc1
    s_waitcnt vmcnt(3)
    v_lshlrev_b32 v72, 16, v20
    v_and_b32 v73, s23, v20
    v_lshlrev_b32 v74, 16, v21
    v_and_b32 v75, s23, v21
    v_lshlrev_b32 v76, 16, v22
    v_and_b32 v77, s23, v22
    v_lshlrev_b32 v78, 16, v23
    v_and_b32 v79, s23, v23
    v_pk_fma_f32 v[72:73], v[72:73], v[46:47], v[46:47] op_sel:[0,0,1] op_sel_hi:[1,0,1]
    v_pk_fma_f32 v[74:75], v[74:75], v[46:47], v[46:47] op_sel:[0,0,1] op_sel_hi:[1,0,1]
    v_pk_fma_f32 v[76:77], v[76:77], v[46:47], v[46:47] op_sel:[0,0,1] op_sel_hi:[1,0,1]
    v_pk_fma_f32 v[78:79], v[78:79], v[46:47], v[46:47] op_sel:[0,0,1] op_sel_hi:[1,0,1]
    v_pk_fma_f32 v[72:73], v[72:73], v[32:33], v[24:25]
    v_pk_fma_f32 v[74:75], v[74:75], v[34:35], v[26:27]
    v_pk_fma_f32 v[76:77], v[76:77], v[36:37], v[28:29]
    v_pk_fma_f32 v[78:79], v[78:79], v[38:39], v[30:31]
    v_cvt_pk_bf16_f32 v20, v72, v73
    v_cvt_pk_bf16_f32 v21, v74, v75
    v_cvt_pk_bf16_f32 v22, v76, v77
    v_cvt_pk_bf16_f32 v23, v78, v79
    buffer_store_dwordx4 v[20:23], v2, s[32:35], s21 offen offset:2048 sc0 sc1
    s_endpgm
k0b_x:
    s_cmp_ge_u32 s2, 256
    s_cbranch_scc1 k0b_kernel_end
    s_load_dwordx4 s[12:15], s[0:1], 72
    s_sub_u32 s3, s2, 256
    s_lshr_b32 s24, s3, 3
    s_and_b32 s3, s3, 7
    s_lshl_b32 s3, s3, 2
    s_and_b32 s25, s24, 3
    s_add_u32 s3, s3, s25
    s_lshr_b32 s24, s24, 2
    v_and_b32 v1, 63, v0
    v_lshrrev_b32 v3, 3, v0
    v_lshlrev_b32 v3, 3, v3
    s_lshl_b32 s25, s24, 8
    v_add_u32 v3, s25, v3
    v_lshlrev_b32 v4, 1, v3
    s_movk_i32 s25, 12288
    v_mul_lo_u32 v5, v3, s25
    v_and_b32 v6, 7, v0
    v_lshl_add_u32 v5, v6, 4, v5
    s_lshl_b32 s26, s3, 7
    s_add_u32 s26, s26, 6144
    s_mov_b32 s18, 12582912
    s_mov_b32 s19, 0x00020000
    s_waitcnt lgkmcnt(0)
    s_mov_b32 s16, s14
    s_and_b32 s17, s15, 0xffff
    buffer_load_dwordx4 v[64:67], v5, s[16:19], s26 offen nt
    global_load_dwordx4 v[8:11], v4, s[12:13]
    s_add_u32 s26, s26, s25
    buffer_load_dwordx4 v[68:71], v5, s[16:19], s26 offen nt
    s_add_u32 s26, s26, s25
    buffer_load_dwordx4 v[72:75], v5, s[16:19], s26 offen nt
    s_add_u32 s26, s26, s25
    buffer_load_dwordx4 v[76:79], v5, s[16:19], s26 offen nt
    s_add_u32 s26, s26, s25
    buffer_load_dwordx4 v[80:83], v5, s[16:19], s26 offen nt
    s_add_u32 s26, s26, s25
    buffer_load_dwordx4 v[84:87], v5, s[16:19], s26 offen nt
    s_add_u32 s26, s26, s25
    buffer_load_dwordx4 v[88:91], v5, s[16:19], s26 offen nt
    s_add_u32 s26, s26, s25
    buffer_load_dwordx4 v[92:95], v5, s[16:19], s26 offen nt
    s_mov_b32 s28, 0xffff0000
    s_add_u32 s20, s4, 393216
    s_addc_u32 s21, s5, 0
    s_and_b32 s21, s21, 0xffff
    s_mov_b32 s22, 32768
    s_mov_b32 s23, 0x00020000
    v_and_b32 v7, 7, v1
    v_lshlrev_b32 v7, 5, v7
    v_bfe_u32 v12, v1, 3, 1
    v_lshl_add_u32 v7, v12, 4, v7
    v_bfe_u32 v12, v1, 4, 1
    v_lshl_add_u32 v7, v12, 3, v7
    v_bfe_u32 v12, v1, 5, 1
    v_lshl_add_u32 v7, v12, 2, v7
    v_lshrrev_b32 v2, 6, v0
    v_lshl_add_u32 v7, v2, 8, v7
    s_waitcnt vmcnt(7)
    v_lshlrev_b32 v16, 16, v8
    v_and_b32 v17, s28, v8
    v_lshlrev_b32 v18, 16, v9
    v_and_b32 v19, s28, v9
    v_lshlrev_b32 v20, 16, v10
    v_and_b32 v21, s28, v10
    v_lshlrev_b32 v22, 16, v11
    v_and_b32 v23, s28, v11
    v_mul_f32 v24, 0xbfb8aa3b, v16
    v_mul_f32 v25, 0xbfb8aa3b, v17
    v_mul_f32 v26, 0xbfb8aa3b, v18
    v_mul_f32 v27, 0xbfb8aa3b, v19
    v_mul_f32 v28, 0xbfb8aa3b, v20
    v_mul_f32 v29, 0xbfb8aa3b, v21
    v_mul_f32 v30, 0xbfb8aa3b, v22
    v_mul_f32 v31, 0xbfb8aa3b, v23
    v_exp_f32 v24, v24
    v_exp_f32 v25, v25
    v_exp_f32 v26, v26
    v_exp_f32 v27, v27
    v_exp_f32 v28, v28
    v_exp_f32 v29, v29
    v_exp_f32 v30, v30
    v_exp_f32 v31, v31
    v_add_f32 v24, 1.0, v24
    v_add_f32 v25, 1.0, v25
    v_add_f32 v26, 1.0, v26
    v_add_f32 v27, 1.0, v27
    v_add_f32 v28, 1.0, v28
    v_add_f32 v29, 1.0, v29
    v_add_f32 v30, 1.0, v30
    v_add_f32 v31, 1.0, v31
    v_rcp_f32 v24, v24
    v_rcp_f32 v25, v25
    v_rcp_f32 v26, v26
    v_rcp_f32 v27, v27
    v_rcp_f32 v28, v28
    v_rcp_f32 v29, v29
    v_rcp_f32 v30, v30
    v_rcp_f32 v31, v31
    v_mul_f32 v16, v16, v24
    v_mul_f32 v17, v17, v25
    v_mul_f32 v18, v18, v26
    v_mul_f32 v19, v19, v27
    v_mul_f32 v20, v20, v28
    v_mul_f32 v21, v21, v29
    v_mul_f32 v22, v22, v30
    v_mul_f32 v23, v23, v31
    v_cvt_pk_bf16_f32 v24, v16, v17
    v_cvt_pk_bf16_f32 v26, v18, v19
    v_cvt_pk_bf16_f32 v28, v20, v21
    v_cvt_pk_bf16_f32 v30, v22, v23
    v_lshlrev_b32 v16, 16, v24
    v_and_b32 v17, s28, v24
    v_lshlrev_b32 v18, 16, v26
    v_and_b32 v19, s28, v26
    v_lshlrev_b32 v20, 16, v28
    v_and_b32 v21, s28, v28
    v_lshlrev_b32 v22, 16, v30
    v_and_b32 v23, s28, v30
    s_waitcnt vmcnt(7)
    v_lshlrev_b32 v56, 16, v64
    v_and_b32 v57, s28, v64
    v_lshlrev_b32 v58, 16, v65
    v_and_b32 v59, s28, v65
    v_lshlrev_b32 v60, 16, v66
    v_and_b32 v61, s28, v66
    v_lshlrev_b32 v62, 16, v67
    v_and_b32 v63, s28, v67
    v_mul_f32 v48, v56, v16
    v_mul_f32 v49, v57, v16
    v_mul_f32 v50, v58, v16
    v_mul_f32 v51, v59, v16
    v_mul_f32 v52, v60, v16
    v_mul_f32 v53, v61, v16
    v_mul_f32 v54, v62, v16
    v_mul_f32 v55, v63, v16
    s_waitcnt vmcnt(6)
    v_lshlrev_b32 v56, 16, v68
    v_and_b32 v57, s28, v68
    v_lshlrev_b32 v58, 16, v69
    v_and_b32 v59, s28, v69
    v_lshlrev_b32 v60, 16, v70
    v_and_b32 v61, s28, v70
    v_lshlrev_b32 v62, 16, v71
    v_and_b32 v63, s28, v71
    v_fmac_f32 v48, v56, v17
    v_fmac_f32 v49, v57, v17
    v_fmac_f32 v50, v58, v17
    v_fmac_f32 v51, v59, v17
    v_fmac_f32 v52, v60, v17
    v_fmac_f32 v53, v61, v17
    v_fmac_f32 v54, v62, v17
    v_fmac_f32 v55, v63, v17
    s_waitcnt vmcnt(5)
    v_lshlrev_b32 v56, 16, v72
    v_and_b32 v57, s28, v72
    v_lshlrev_b32 v58, 16, v73
    v_and_b32 v59, s28, v73
    v_lshlrev_b32 v60, 16, v74
    v_and_b32 v61, s28, v74
    v_lshlrev_b32 v62, 16, v75
    v_and_b32 v63, s28, v75
    v_fmac_f32 v48, v56, v18
    v_fmac_f32 v49, v57, v18
    v_fmac_f32 v50, v58, v18
    v_fmac_f32 v51, v59, v18
    v_fmac_f32 v52, v60, v18
    v_fmac_f32 v53, v61, v18
    v_fmac_f32 v54, v62, v18
    v_fmac_f32 v55, v63, v18
    s_waitcnt vmcnt(4)
    v_lshlrev_b32 v56, 16, v76
    v_and_b32 v57, s28, v76
    v_lshlrev_b32 v58, 16, v77
    v_and_b32 v59, s28, v77
    v_lshlrev_b32 v60, 16, v78
    v_and_b32 v61, s28, v78
    v_lshlrev_b32 v62, 16, v79
    v_and_b32 v63, s28, v79
    v_fmac_f32 v48, v56, v19
    v_fmac_f32 v49, v57, v19
    v_fmac_f32 v50, v58, v19
    v_fmac_f32 v51, v59, v19
    v_fmac_f32 v52, v60, v19
    v_fmac_f32 v53, v61, v19
    v_fmac_f32 v54, v62, v19
    v_fmac_f32 v55, v63, v19
    s_waitcnt vmcnt(3)
    v_lshlrev_b32 v56, 16, v80
    v_and_b32 v57, s28, v80
    v_lshlrev_b32 v58, 16, v81
    v_and_b32 v59, s28, v81
    v_lshlrev_b32 v60, 16, v82
    v_and_b32 v61, s28, v82
    v_lshlrev_b32 v62, 16, v83
    v_and_b32 v63, s28, v83
    v_fmac_f32 v48, v56, v20
    v_fmac_f32 v49, v57, v20
    v_fmac_f32 v50, v58, v20
    v_fmac_f32 v51, v59, v20
    v_fmac_f32 v52, v60, v20
    v_fmac_f32 v53, v61, v20
    v_fmac_f32 v54, v62, v20
    v_fmac_f32 v55, v63, v20
    s_waitcnt vmcnt(2)
    v_lshlrev_b32 v56, 16, v84
    v_and_b32 v57, s28, v84
    v_lshlrev_b32 v58, 16, v85
    v_and_b32 v59, s28, v85
    v_lshlrev_b32 v60, 16, v86
    v_and_b32 v61, s28, v86
    v_lshlrev_b32 v62, 16, v87
    v_and_b32 v63, s28, v87
    v_fmac_f32 v48, v56, v21
    v_fmac_f32 v49, v57, v21
    v_fmac_f32 v50, v58, v21
    v_fmac_f32 v51, v59, v21
    v_fmac_f32 v52, v60, v21
    v_fmac_f32 v53, v61, v21
    v_fmac_f32 v54, v62, v21
    v_fmac_f32 v55, v63, v21
    s_waitcnt vmcnt(1)
    v_lshlrev_b32 v56, 16, v88
    v_and_b32 v57, s28, v88
    v_lshlrev_b32 v58, 16, v89
    v_and_b32 v59, s28, v89
    v_lshlrev_b32 v60, 16, v90
    v_and_b32 v61, s28, v90
    v_lshlrev_b32 v62, 16, v91
    v_and_b32 v63, s28, v91
    v_fmac_f32 v48, v56, v22
    v_fmac_f32 v49, v57, v22
    v_fmac_f32 v50, v58, v22
    v_fmac_f32 v51, v59, v22
    v_fmac_f32 v52, v60, v22
    v_fmac_f32 v53, v61, v22
    v_fmac_f32 v54, v62, v22
    v_fmac_f32 v55, v63, v22
    s_waitcnt vmcnt(0)
    v_lshlrev_b32 v56, 16, v92
    v_and_b32 v57, s28, v92
    v_lshlrev_b32 v58, 16, v93
    v_and_b32 v59, s28, v93
    v_lshlrev_b32 v60, 16, v94
    v_and_b32 v61, s28, v94
    v_lshlrev_b32 v62, 16, v95
    v_and_b32 v63, s28, v95
    v_fmac_f32 v48, v56, v23
    v_fmac_f32 v49, v57, v23
    v_fmac_f32 v50, v58, v23
    v_fmac_f32 v51, v59, v23
    v_fmac_f32 v52, v60, v23
    v_fmac_f32 v53, v61, v23
    v_fmac_f32 v54, v62, v23
    v_fmac_f32 v55, v63, v23
    v_permlane32_swap_b32 v48, v49
    v_permlane32_swap_b32 v50, v51
    v_permlane32_swap_b32 v52, v53
    v_permlane32_swap_b32 v54, v55
    v_add_f32 v48, v48, v49
    v_add_f32 v50, v50, v51
    v_add_f32 v52, v52, v53
    v_add_f32 v54, v54, v55
    v_permlane16_swap_b32 v48, v50
    s_nop 0
    v_permlane16_swap_b32 v52, v54
    v_add_f32 v48, v48, v50
    v_add_f32 v52, v52, v54
    s_nop 0
    v_add_f32_dpp v48, v48, v48 row_ror:8 row_mask:0xf bank_mask:0xf
    s_nop 1
    v_add_f32_dpp v48, v52, v52 row_ror:8 row_mask:0xf bank_mask:0xc
    ds_write_b32 v7, v48
    s_waitcnt lgkmcnt(0)
    s_barrier
    v_cmp_gt_u32 vcc, 64, v0
    s_nop 4
    s_cbranch_vccz k0b_kernel_end
    v_lshlrev_b32 v7, 2, v1
    ds_read2st64_b32 v[8:9], v7 offset0:0 offset1:1
    ds_read2st64_b32 v[10:11], v7 offset0:2 offset1:3
    s_lshl_b32 s26, s3, 8
    s_lshl_b32 s24, s24, 13
    s_add_u32 s26, s26, s24
    s_waitcnt lgkmcnt(0)
    v_add_f32 v8, v8, v9
    v_add_f32 v10, v10, v11
    v_add_f32 v8, v8, v10
    buffer_store_dword v8, v7, s[20:23], s26 offen
    s_endpgm
k0b_kernel_end:
    s_endpgm
.text
.globl k1_kernel
.p2align 8
.type k1_kernel,@function
k1_kernel:
    s_cmp_ge_u32 s2, 256
    s_cbranch_scc1 k1_kernel_end
    v_lshrrev_b32 v1, 6, v0
    s_nop 0
    v_readfirstlane_b32 s16, v1
    s_load_dwordx4 s[8:11], s[0:1], 8
    s_load_dwordx2 s[4:5], s[0:1], 104
    s_load_dwordx2 s[12:13], s[0:1], 24
    s_load_dwordx2 s[34:35], s[0:1], 40
    s_and_b32 s3, s2, 7
    s_lshr_b32 s6, s2, 3
    s_and_b32 s14, s3, 1
    s_lshl_b32 s14, s14, 3
    s_and_b32 s7, s6, 7
    s_add_u32 s14, s14, s7
    s_lshr_b32 s15, s3, 1
    s_lshl_b32 s15, s15, 2
    s_lshr_b32 s7, s6, 3
    s_add_u32 s15, s15, s7
    s_cmp_ge_u32 s16, 4
    s_cbranch_scc1 k1_prod
    v_and_b32 v2, 63, v0
    v_and_b32 v3, 15, v0
    v_bfe_u32 v4, v0, 4, 2
    v_bfe_u32 v5, v0, 2, 2
    v_and_b32 v6, 3, v0
    s_lshr_b32 s17, s16, 1
    s_and_b32 s18, s16, 1
    v_lshrrev_b32 v7, 1, v3
    v_xor_b32 v7, v7, v4
    v_lshlrev_b32 v10, 4, v7
    v_lshl_add_u32 v10, v3, 7, v10
    s_lshl_b32 s60, s17, 13
    v_add_u32 v10, s60, v10
    v_xor_b32 v11, 64, v10
    v_lshl_add_u32 v12, v4, 3, v5
    v_lshlrev_b32 v12, 7, v12
    v_lshl_add_u32 v12, v6, 3, v12
    v_lshrrev_b32 v7, 1, v5
    v_xor_b32 v7, s18, v7
    v_lshl_add_u32 v12, v7, 6, v12
    v_and_b32 v7, 1, v4
    v_lshl_add_u32 v12, v7, 5, v12
    v_add_u32 v12, 65536, v12
    v_xor_b32 v13, 32, v12
    v_add_u32 v14, 49152, v12
    v_add_u32 v15, 49152, v13
    v_mov_b32 v96, 0
    v_mov_b32 v97, 0
    v_mov_b32 v98, 0
    v_mov_b32 v99, 0
    v_mov_b32 v100, 0
    v_mov_b32 v101, 0
    v_mov_b32 v102, 0
    v_mov_b32 v103, 0
    v_mov_b32 v104, 0
    v_mov_b32 v105, 0
    v_mov_b32 v106, 0
    v_mov_b32 v107, 0
    v_mov_b32 v108, 0
    v_mov_b32 v109, 0
    v_mov_b32 v110, 0
    v_mov_b32 v111, 0
    v_mov_b32 v112, 0
    v_mov_b32 v113, 0
    v_mov_b32 v114, 0
    v_mov_b32 v115, 0
    v_mov_b32 v116, 0
    v_mov_b32 v117, 0
    v_mov_b32 v118, 0
    v_mov_b32 v119, 0
    v_mov_b32 v120, 0
    v_mov_b32 v121, 0
    v_mov_b32 v122, 0
    v_mov_b32 v123, 0
    v_mov_b32 v124, 0
    v_mov_b32 v125, 0
    v_mov_b32 v126, 0
    v_mov_b32 v127, 0
    v_mov_b32 v128, 0
    v_mov_b32 v129, 0
    v_mov_b32 v130, 0
    v_mov_b32 v131, 0
    v_mov_b32 v132, 0
    v_mov_b32 v133, 0
    v_mov_b32 v134, 0
    v_mov_b32 v135, 0
    v_mov_b32 v136, 0
    v_mov_b32 v137, 0
    v_mov_b32 v138, 0
    v_mov_b32 v139, 0
    v_mov_b32 v140, 0
    v_mov_b32 v141, 0
    v_mov_b32 v142, 0
    v_mov_b32 v143, 0
    v_mov_b32 v144, 0
    v_mov_b32 v145, 0
    v_mov_b32 v146, 0
    v_mov_b32 v147, 0
    v_mov_b32 v148, 0
    v_mov_b32 v149, 0
    v_mov_b32 v150, 0
    v_mov_b32 v151, 0
    v_mov_b32 v152, 0
    v_mov_b32 v153, 0
    v_mov_b32 v154, 0
    v_mov_b32 v155, 0
    v_mov_b32 v156, 0
    v_mov_b32 v157, 0
    v_mov_b32 v158, 0
    v_mov_b32 v159, 0
    v_mov_b32 v160, 0
    v_mov_b32 v161, 0
    v_mov_b32 v162, 0
    v_mov_b32 v163, 0
    v_mov_b32 v164, 0
    v_mov_b32 v165, 0
    v_mov_b32 v166, 0
    v_mov_b32 v167, 0
    v_mov_b32 v168, 0
    v_mov_b32 v169, 0
    v_mov_b32 v170, 0
    v_mov_b32 v171, 0
    v_mov_b32 v172, 0
    v_mov_b32 v173, 0
    v_mov_b32 v174, 0
    v_mov_b32 v175, 0
    v_mov_b32 v176, 0
    v_mov_b32 v177, 0
    v_mov_b32 v178, 0
    v_mov_b32 v179, 0
    v_mov_b32 v180, 0
    v_mov_b32 v181, 0
    v_mov_b32 v182, 0
    v_mov_b32 v183, 0
    v_mov_b32 v184, 0
    v_mov_b32 v185, 0
    v_mov_b32 v186, 0
    v_mov_b32 v187, 0
    v_mov_b32 v188, 0
    v_mov_b32 v189, 0
    v_mov_b32 v190, 0
    v_mov_b32 v191, 0
    v_mov_b32 v56, 0
    v_mov_b32 v57, 0
    v_mov_b32 v58, 0
    v_mov_b32 v59, 0
    v_mov_b32 v60, 0
    v_mov_b32 v61, 0
    v_mov_b32 v62, 0
    v_mov_b32 v63, 0
    v_mov_b32 v64, 0
    v_mov_b32 v65, 0
    v_mov_b32 v66, 0
    v_mov_b32 v67, 0
    v_mov_b32 v68, 0
    v_mov_b32 v69, 0
    v_mov_b32 v70, 0
    v_mov_b32 v71, 0
    v_mov_b32 v72, 0
    v_mov_b32 v73, 0
    v_mov_b32 v74, 0
    v_mov_b32 v75, 0
    v_mov_b32 v76, 0
    v_mov_b32 v77, 0
    v_mov_b32 v78, 0
    v_mov_b32 v79, 0
    v_mov_b32 v80, 0
    v_mov_b32 v81, 0
    v_mov_b32 v82, 0
    v_mov_b32 v83, 0
    v_mov_b32 v84, 0
    v_mov_b32 v85, 0
    v_mov_b32 v86, 0
    v_mov_b32 v87, 0
    v_mov_b32 v88, 0
    v_mov_b32 v89, 0
    v_mov_b32 v90, 0
    v_mov_b32 v91, 0
    v_mov_b32 v92, 0
    v_mov_b32 v93, 0
    v_mov_b32 v94, 0
    v_mov_b32 v95, 0
    s_waitcnt lgkmcnt(0)
    s_add_u32 s36, s4, 5242880
    s_addc_u32 s37, s5, 0
    s_and_b32 s37, s37, 0xffff
    s_mov_b32 s38, 4194304
    s_mov_b32 s39, 0x00020000
    s_add_u32 s40, s4, 1048576
    s_addc_u32 s41, s5, 0
    s_and_b32 s41, s41, 0xffff
    s_mov_b32 s42, 4194304
    s_mov_b32 s43, 0x00020000
    s_add_u32 s44, s4, 131072
    s_addc_u32 s45, s5, 0
    s_and_b32 s45, s45, 0xffff
    s_mov_b32 s46, 131072
    s_mov_b32 s47, 0x00020000
    s_mov_b32 s48, 4
    s_barrier
k1_cloop:
    v_mfma_f32_16x16x32_bf16 v[96:99], v[72:75], v[56:59], v[96:99]
    ds_read_b128 v[16:19], v10 offset:0
    v_mfma_f32_16x16x32_bf16 v[104:107], v[72:75], v[60:63], v[104:107]
    ds_read_b64_tr_b16 v[32:33], v12 offset:0
    v_mfma_f32_16x16x32_bf16 v[112:115], v[72:75], v[64:67], v[112:115]
    ds_read_b64_tr_b16 v[34:35], v12 offset:512
    v_mfma_f32_16x16x32_bf16 v[120:123], v[72:75], v[68:71], v[120:123]
    ds_read_b128 v[20:23], v10 offset:2048
    v_mfma_f32_16x16x32_bf16 v[100:103], v[76:79], v[56:59], v[100:103]
    ds_read_b128 v[24:27], v10 offset:4096
    v_mfma_f32_16x16x32_bf16 v[108:111], v[76:79], v[60:63], v[108:111]
    ds_read_b128 v[28:31], v10 offset:6144
    v_mfma_f32_16x16x32_bf16 v[116:119], v[76:79], v[64:67], v[116:119]
    ds_read_b64_tr_b16 v[36:37], v13 offset:0
    v_mfma_f32_16x16x32_bf16 v[124:127], v[76:79], v[68:71], v[124:127]
    ds_read_b64_tr_b16 v[38:39], v13 offset:512
    v_mfma_f32_16x16x32_bf16 v[128:131], v[80:83], v[56:59], v[128:131]
    ds_read_b64_tr_b16 v[40:41], v12 offset:8192
    v_mfma_f32_16x16x32_bf16 v[136:139], v[80:83], v[60:63], v[136:139]
    ds_read_b64_tr_b16 v[42:43], v12 offset:8704
    v_mfma_f32_16x16x32_bf16 v[144:147], v[80:83], v[64:67], v[144:147]
    ds_read_b64_tr_b16 v[44:45], v13 offset:8192
    v_mfma_f32_16x16x32_bf16 v[152:155], v[80:83], v[68:71], v[152:155]
    ds_read_b64_tr_b16 v[46:47], v13 offset:8704
    v_mfma_f32_16x16x32_bf16 v[132:135], v[84:87], v[56:59], v[132:135]
    ds_read_b64_tr_b16 v[48:49], v12 offset:16384
    v_mfma_f32_16x16x32_bf16 v[140:143], v[84:87], v[60:63], v[140:143]
    ds_read_b64_tr_b16 v[50:51], v12 offset:16896
    v_mfma_f32_16x16x32_bf16 v[148:151], v[84:87], v[64:67], v[148:151]
    ds_read_b64_tr_b16 v[52:53], v13 offset:16384
    v_mfma_f32_16x16x32_bf16 v[156:159], v[84:87], v[68:71], v[156:159]
    ds_read_b64_tr_b16 v[54:55], v13 offset:16896
    v_mfma_f32_16x16x32_bf16 v[160:163], v[56:59], v[88:91], v[160:163]
    v_mfma_f32_16x16x32_bf16 v[168:171], v[60:63], v[88:91], v[168:171]
    v_mfma_f32_16x16x32_bf16 v[176:179], v[64:67], v[88:91], v[176:179]
    v_mfma_f32_16x16x32_bf16 v[184:187], v[68:71], v[88:91], v[184:187]
    v_mfma_f32_16x16x32_bf16 v[164:167], v[56:59], v[92:95], v[164:167]
    v_mfma_f32_16x16x32_bf16 v[172:175], v[60:63], v[92:95], v[172:175]
    v_mfma_f32_16x16x32_bf16 v[180:183], v[64:67], v[92:95], v[180:183]
    v_mfma_f32_16x16x32_bf16 v[188:191], v[68:71], v[92:95], v[188:191]
    s_waitcnt lgkmcnt(13)
    v_mfma_f32_16x16x32_bf16 v[96:99], v[32:35], v[16:19], v[96:99]
    ds_read_b128 v[56:59], v11 offset:0
    ds_read_b64_tr_b16 v[72:73], v12 offset:4096
    s_waitcnt lgkmcnt(14)
    v_mfma_f32_16x16x32_bf16 v[104:107], v[32:35], v[20:23], v[104:107]
    ds_read_b64_tr_b16 v[74:75], v12 offset:4608
    s_waitcnt lgkmcnt(14)
    v_mfma_f32_16x16x32_bf16 v[112:115], v[32:35], v[24:27], v[112:115]
    ds_read_b128 v[60:63], v11 offset:2048
    s_waitcnt lgkmcnt(14)
    v_mfma_f32_16x16x32_bf16 v[120:123], v[32:35], v[28:31], v[120:123]
    ds_read_b128 v[64:67], v11 offset:4096
    s_waitcnt lgkmcnt(13)
    v_mfma_f32_16x16x32_bf16 v[100:103], v[36:39], v[16:19], v[100:103]
    ds_read_b128 v[68:71], v11 offset:6144
    v_mfma_f32_16x16x32_bf16 v[108:111], v[36:39], v[20:23], v[108:111]
    ds_read_b64_tr_b16 v[76:77], v13 offset:4096
    v_mfma_f32_16x16x32_bf16 v[116:119], v[36:39], v[24:27], v[116:119]
    ds_read_b64_tr_b16 v[78:79], v13 offset:4608
    v_mfma_f32_16x16x32_bf16 v[124:127], v[36:39], v[28:31], v[124:127]
    ds_read_b64_tr_b16 v[80:81], v12 offset:12288
    s_waitcnt lgkmcnt(15)
    v_mfma_f32_16x16x32_bf16 v[128:131], v[40:43], v[16:19], v[128:131]
    ds_read_b64_tr_b16 v[82:83], v12 offset:12800
    v_mfma_f32_16x16x32_bf16 v[136:139], v[40:43], v[20:23], v[136:139]
    ds_read_b64_tr_b16 v[84:85], v13 offset:12288
    v_mfma_f32_16x16x32_bf16 v[144:147], v[40:43], v[24:27], v[144:147]
    ds_read_b64_tr_b16 v[86:87], v13 offset:12800
    v_mfma_f32_16x16x32_bf16 v[152:155], v[40:43], v[28:31], v[152:155]
    ds_read_b64_tr_b16 v[88:89], v12 offset:20480
    s_waitcnt lgkmcnt(15)
    v_mfma_f32_16x16x32_bf16 v[132:135], v[44:47], v[16:19], v[132:135]
    ds_read_b64_tr_b16 v[90:91], v12 offset:20992
    v_mfma_f32_16x16x32_bf16 v[140:143], v[44:47], v[20:23], v[140:143]
    ds_read_b64_tr_b16 v[92:93], v13 offset:20480
    v_mfma_f32_16x16x32_bf16 v[148:151], v[44:47], v[24:27], v[148:151]
    ds_read_b64_tr_b16 v[94:95], v13 offset:20992
    v_mfma_f32_16x16x32_bf16 v[156:159], v[44:47], v[28:31], v[156:159]
    v_mfma_f32_16x16x32_bf16 v[160:163], v[16:19], v[48:51], v[160:163]
    v_mfma_f32_16x16x32_bf16 v[168:171], v[20:23], v[48:51], v[168:171]
    v_mfma_f32_16x16x32_bf16 v[176:179], v[24:27], v[48:51], v[176:179]
    v_mfma_f32_16x16x32_bf16 v[184:187], v[28:31], v[48:51], v[184:187]
    s_waitcnt lgkmcnt(15)
    v_mfma_f32_16x16x32_bf16 v[164:167], v[16:19], v[52:55], v[164:167]
    v_mfma_f32_16x16x32_bf16 v[172:175], v[20:23], v[52:55], v[172:175]
    v_mfma_f32_16x16x32_bf16 v[180:183], v[24:27], v[52:55], v[180:183]
    v_mfma_f32_16x16x32_bf16 v[188:191], v[28:31], v[52:55], v[188:191]
    s_waitcnt lgkmcnt(0)
    s_barrier
    v_mfma_f32_16x16x32_bf16 v[96:99], v[72:75], v[56:59], v[96:99]
    ds_read_b128 v[16:19], v10 offset:16384
    v_mfma_f32_16x16x32_bf16 v[104:107], v[72:75], v[60:63], v[104:107]
    ds_read_b64_tr_b16 v[32:33], v12 offset:24576
    v_mfma_f32_16x16x32_bf16 v[112:115], v[72:75], v[64:67], v[112:115]
    ds_read_b64_tr_b16 v[34:35], v12 offset:25088
    v_mfma_f32_16x16x32_bf16 v[120:123], v[72:75], v[68:71], v[120:123]
    ds_read_b128 v[20:23], v10 offset:18432
    v_mfma_f32_16x16x32_bf16 v[100:103], v[76:79], v[56:59], v[100:103]
    ds_read_b128 v[24:27], v10 offset:20480
    v_mfma_f32_16x16x32_bf16 v[108:111], v[76:79], v[60:63], v[108:111]
    ds_read_b128 v[28:31], v10 offset:22528
    v_mfma_f32_16x16x32_bf16 v[116:119], v[76:79], v[64:67], v[116:119]
    ds_read_b64_tr_b16 v[36:37], v13 offset:24576
    v_mfma_f32_16x16x32_bf16 v[124:127], v[76:79], v[68:71], v[124:127]
    ds_read_b64_tr_b16 v[38:39], v13 offset:25088
    v_mfma_f32_16x16x32_bf16 v[128:131], v[80:83], v[56:59], v[128:131]
    ds_read_b64_tr_b16 v[40:41], v12 offset:32768
    v_mfma_f32_16x16x32_bf16 v[136:139], v[80:83], v[60:63], v[136:139]
    ds_read_b64_tr_b16 v[42:43], v12 offset:33280
    v_mfma_f32_16x16x32_bf16 v[144:147], v[80:83], v[64:67], v[144:147]
    ds_read_b64_tr_b16 v[44:45], v13 offset:32768
    v_mfma_f32_16x16x32_bf16 v[152:155], v[80:83], v[68:71], v[152:155]
    ds_read_b64_tr_b16 v[46:47], v13 offset:33280
    v_mfma_f32_16x16x32_bf16 v[132:135], v[84:87], v[56:59], v[132:135]
    ds_read_b64_tr_b16 v[48:49], v12 offset:40960
    v_mfma_f32_16x16x32_bf16 v[140:143], v[84:87], v[60:63], v[140:143]
    ds_read_b64_tr_b16 v[50:51], v12 offset:41472
    v_mfma_f32_16x16x32_bf16 v[148:151], v[84:87], v[64:67], v[148:151]
    ds_read_b64_tr_b16 v[52:53], v13 offset:40960
    v_mfma_f32_16x16x32_bf16 v[156:159], v[84:87], v[68:71], v[156:159]
    ds_read_b64_tr_b16 v[54:55], v13 offset:41472
    v_mfma_f32_16x16x32_bf16 v[160:163], v[56:59], v[88:91], v[160:163]
    v_mfma_f32_16x16x32_bf16 v[168:171], v[60:63], v[88:91], v[168:171]
    v_mfma_f32_16x16x32_bf16 v[176:179], v[64:67], v[88:91], v[176:179]
    v_mfma_f32_16x16x32_bf16 v[184:187], v[68:71], v[88:91], v[184:187]
    v_mfma_f32_16x16x32_bf16 v[164:167], v[56:59], v[92:95], v[164:167]
    v_mfma_f32_16x16x32_bf16 v[172:175], v[60:63], v[92:95], v[172:175]
    v_mfma_f32_16x16x32_bf16 v[180:183], v[64:67], v[92:95], v[180:183]
    v_mfma_f32_16x16x32_bf16 v[188:191], v[68:71], v[92:95], v[188:191]
    s_waitcnt lgkmcnt(13)
    v_mfma_f32_16x16x32_bf16 v[96:99], v[32:35], v[16:19], v[96:99]
    ds_read_b128 v[56:59], v11 offset:16384
    ds_read_b64_tr_b16 v[72:73], v12 offset:28672
    s_waitcnt lgkmcnt(14)
    v_mfma_f32_16x16x32_bf16 v[104:107], v[32:35], v[20:23], v[104:107]
    ds_read_b64_tr_b16 v[74:75], v12 offset:29184
    s_waitcnt lgkmcnt(14)
    v_mfma_f32_16x16x32_bf16 v[112:115], v[32:35], v[24:27], v[112:115]
    ds_read_b128 v[60:63], v11 offset:18432
    s_waitcnt lgkmcnt(14)
    v_mfma_f32_16x16x32_bf16 v[120:123], v[32:35], v[28:31], v[120:123]
    ds_read_b128 v[64:67], v11 offset:20480
    s_waitcnt lgkmcnt(13)
    v_mfma_f32_16x16x32_bf16 v[100:103], v[36:39], v[16:19], v[100:103]
    ds_read_b128 v[68:71], v11 offset:22528
    v_mfma_f32_16x16x32_bf16 v[108:111], v[36:39], v[20:23], v[108:111]
    ds_read_b64_tr_b16 v[76:77], v13 offset:28672
    v_mfma_f32_16x16x32_bf16 v[116:119], v[36:39], v[24:27], v[116:119]
    ds_read_b64_tr_b16 v[78:79], v13 offset:29184
    v_mfma_f32_16x16x32_bf16 v[124:127], v[36:39], v[28:31], v[124:127]
    ds_read_b64_tr_b16 v[80:81], v12 offset:36864
    s_waitcnt lgkmcnt(15)
    v_mfma_f32_16x16x32_bf16 v[128:131], v[40:43], v[16:19], v[128:131]
    ds_read_b64_tr_b16 v[82:83], v12 offset:37376
    v_mfma_f32_16x16x32_bf16 v[136:139], v[40:43], v[20:23], v[136:139]
    ds_read_b64_tr_b16 v[84:85], v13 offset:36864
    v_mfma_f32_16x16x32_bf16 v[144:147], v[40:43], v[24:27], v[144:147]
    ds_read_b64_tr_b16 v[86:87], v13 offset:37376
    v_mfma_f32_16x16x32_bf16 v[152:155], v[40:43], v[28:31], v[152:155]
    ds_read_b64_tr_b16 v[88:89], v12 offset:45056
    s_waitcnt lgkmcnt(15)
    v_mfma_f32_16x16x32_bf16 v[132:135], v[44:47], v[16:19], v[132:135]
    ds_read_b64_tr_b16 v[90:91], v12 offset:45568
    v_mfma_f32_16x16x32_bf16 v[140:143], v[44:47], v[20:23], v[140:143]
    ds_read_b64_tr_b16 v[92:93], v13 offset:45056
    v_mfma_f32_16x16x32_bf16 v[148:151], v[44:47], v[24:27], v[148:151]
    ds_read_b64_tr_b16 v[94:95], v13 offset:45568
    v_mfma_f32_16x16x32_bf16 v[156:159], v[44:47], v[28:31], v[156:159]
    v_mfma_f32_16x16x32_bf16 v[160:163], v[16:19], v[48:51], v[160:163]
    v_mfma_f32_16x16x32_bf16 v[168:171], v[20:23], v[48:51], v[168:171]
    v_mfma_f32_16x16x32_bf16 v[176:179], v[24:27], v[48:51], v[176:179]
    v_mfma_f32_16x16x32_bf16 v[184:187], v[28:31], v[48:51], v[184:187]
    s_waitcnt lgkmcnt(15)
    v_mfma_f32_16x16x32_bf16 v[164:167], v[16:19], v[52:55], v[164:167]
    v_mfma_f32_16x16x32_bf16 v[172:175], v[20:23], v[52:55], v[172:175]
    v_mfma_f32_16x16x32_bf16 v[180:183], v[24:27], v[52:55], v[180:183]
    v_mfma_f32_16x16x32_bf16 v[188:191], v[28:31], v[52:55], v[188:191]
    s_waitcnt lgkmcnt(0)
    s_barrier
    v_mfma_f32_16x16x32_bf16 v[96:99], v[72:75], v[56:59], v[96:99]
    ds_read_b128 v[16:19], v10 offset:32768
    v_mfma_f32_16x16x32_bf16 v[104:107], v[72:75], v[60:63], v[104:107]
    ds_read_b64_tr_b16 v[32:33], v14 offset:0
    v_mfma_f32_16x16x32_bf16 v[112:115], v[72:75], v[64:67], v[112:115]
    ds_read_b64_tr_b16 v[34:35], v14 offset:512
    v_mfma_f32_16x16x32_bf16 v[120:123], v[72:75], v[68:71], v[120:123]
    ds_read_b128 v[20:23], v10 offset:34816
    v_mfma_f32_16x16x32_bf16 v[100:103], v[76:79], v[56:59], v[100:103]
    ds_read_b128 v[24:27], v10 offset:36864
    v_mfma_f32_16x16x32_bf16 v[108:111], v[76:79], v[60:63], v[108:111]
    ds_read_b128 v[28:31], v10 offset:38912
    v_mfma_f32_16x16x32_bf16 v[116:119], v[76:79], v[64:67], v[116:119]
    ds_read_b64_tr_b16 v[36:37], v15 offset:0
    v_mfma_f32_16x16x32_bf16 v[124:127], v[76:79], v[68:71], v[124:127]
    ds_read_b64_tr_b16 v[38:39], v15 offset:512
    v_mfma_f32_16x16x32_bf16 v[128:131], v[80:83], v[56:59], v[128:131]
    ds_read_b64_tr_b16 v[40:41], v14 offset:8192
    v_mfma_f32_16x16x32_bf16 v[136:139], v[80:83], v[60:63], v[136:139]
    ds_read_b64_tr_b16 v[42:43], v14 offset:8704
    v_mfma_f32_16x16x32_bf16 v[144:147], v[80:83], v[64:67], v[144:147]
    ds_read_b64_tr_b16 v[44:45], v15 offset:8192
    v_mfma_f32_16x16x32_bf16 v[152:155], v[80:83], v[68:71], v[152:155]
    ds_read_b64_tr_b16 v[46:47], v15 offset:8704
    v_mfma_f32_16x16x32_bf16 v[132:135], v[84:87], v[56:59], v[132:135]
    ds_read_b64_tr_b16 v[48:49], v14 offset:16384
    v_mfma_f32_16x16x32_bf16 v[140:143], v[84:87], v[60:63], v[140:143]
    ds_read_b64_tr_b16 v[50:51], v14 offset:16896
    v_mfma_f32_16x16x32_bf16 v[148:151], v[84:87], v[64:67], v[148:151]
    ds_read_b64_tr_b16 v[52:53], v15 offset:16384
    v_mfma_f32_16x16x32_bf16 v[156:159], v[84:87], v[68:71], v[156:159]
    ds_read_b64_tr_b16 v[54:55], v15 offset:16896
    v_mfma_f32_16x16x32_bf16 v[160:163], v[56:59], v[88:91], v[160:163]
    v_mfma_f32_16x16x32_bf16 v[168:171], v[60:63], v[88:91], v[168:171]
    v_mfma_f32_16x16x32_bf16 v[176:179], v[64:67], v[88:91], v[176:179]
    v_mfma_f32_16x16x32_bf16 v[184:187], v[68:71], v[88:91], v[184:187]
    v_mfma_f32_16x16x32_bf16 v[164:167], v[56:59], v[92:95], v[164:167]
    v_mfma_f32_16x16x32_bf16 v[172:175], v[60:63], v[92:95], v[172:175]
    v_mfma_f32_16x16x32_bf16 v[180:183], v[64:67], v[92:95], v[180:183]
    v_mfma_f32_16x16x32_bf16 v[188:191], v[68:71], v[92:95], v[188:191]
    s_waitcnt lgkmcnt(13)
    v_mfma_f32_16x16x32_bf16 v[96:99], v[32:35], v[16:19], v[96:99]
    ds_read_b128 v[56:59], v11 offset:32768
    ds_read_b64_tr_b16 v[72:73], v14 offset:4096
    s_waitcnt lgkmcnt(14)
    v_mfma_f32_16x16x32_bf16 v[104:107], v[32:35], v[20:23], v[104:107]
    ds_read_b64_tr_b16 v[74:75], v14 offset:4608
    s_waitcnt lgkmcnt(14)
    v_mfma_f32_16x16x32_bf16 v[112:115], v[32:35], v[24:27], v[112:115]
    ds_read_b128 v[60:63], v11 offset:34816
    s_waitcnt lgkmcnt(14)
    v_mfma_f32_16x16x32_bf16 v[120:123], v[32:35], v[28:31], v[120:123]
    ds_read_b128 v[64:67], v11 offset:36864
    s_waitcnt lgkmcnt(13)
    v_mfma_f32_16x16x32_bf16 v[100:103], v[36:39], v[16:19], v[100:103]
    ds_read_b128 v[68:71], v11 offset:38912
    v_mfma_f32_16x16x32_bf16 v[108:111], v[36:39], v[20:23], v[108:111]
    ds_read_b64_tr_b16 v[76:77], v15 offset:4096
    v_mfma_f32_16x16x32_bf16 v[116:119], v[36:39], v[24:27], v[116:119]
    ds_read_b64_tr_b16 v[78:79], v15 offset:4608
    v_mfma_f32_16x16x32_bf16 v[124:127], v[36:39], v[28:31], v[124:127]
    ds_read_b64_tr_b16 v[80:81], v14 offset:12288
    s_waitcnt lgkmcnt(15)
    v_mfma_f32_16x16x32_bf16 v[128:131], v[40:43], v[16:19], v[128:131]
    ds_read_b64_tr_b16 v[82:83], v14 offset:12800
    v_mfma_f32_16x16x32_bf16 v[136:139], v[40:43], v[20:23], v[136:139]
    ds_read_b64_tr_b16 v[84:85], v15 offset:12288
    v_mfma_f32_16x16x32_bf16 v[144:147], v[40:43], v[24:27], v[144:147]
    ds_read_b64_tr_b16 v[86:87], v15 offset:12800
    v_mfma_f32_16x16x32_bf16 v[152:155], v[40:43], v[28:31], v[152:155]
    ds_read_b64_tr_b16 v[88:89], v14 offset:20480
    s_waitcnt lgkmcnt(15)
    v_mfma_f32_16x16x32_bf16 v[132:135], v[44:47], v[16:19], v[132:135]
    ds_read_b64_tr_b16 v[90:91], v14 offset:20992
    v_mfma_f32_16x16x32_bf16 v[140:143], v[44:47], v[20:23], v[140:143]
    ds_read_b64_tr_b16 v[92:93], v15 offset:20480
    v_mfma_f32_16x16x32_bf16 v[148:151], v[44:47], v[24:27], v[148:151]
    ds_read_b64_tr_b16 v[94:95], v15 offset:20992
    v_mfma_f32_16x16x32_bf16 v[156:159], v[44:47], v[28:31], v[156:159]
    v_mfma_f32_16x16x32_bf16 v[160:163], v[16:19], v[48:51], v[160:163]
    v_mfma_f32_16x16x32_bf16 v[168:171], v[20:23], v[48:51], v[168:171]
    v_mfma_f32_16x16x32_bf16 v[176:179], v[24:27], v[48:51], v[176:179]
    v_mfma_f32_16x16x32_bf16 v[184:187], v[28:31], v[48:51], v[184:187]
    s_waitcnt lgkmcnt(15)
    v_mfma_f32_16x16x32_bf16 v[164:167], v[16:19], v[52:55], v[164:167]
    v_mfma_f32_16x16x32_bf16 v[172:175], v[20:23], v[52:55], v[172:175]
    v_mfma_f32_16x16x32_bf16 v[180:183], v[24:27], v[52:55], v[180:183]
    v_mfma_f32_16x16x32_bf16 v[188:191], v[28:31], v[52:55], v[188:191]
    s_waitcnt lgkmcnt(0)
    s_barrier
    v_mfma_f32_16x16x32_bf16 v[96:99], v[72:75], v[56:59], v[96:99]
    ds_read_b128 v[16:19], v10 offset:49152
    v_mfma_f32_16x16x32_bf16 v[104:107], v[72:75], v[60:63], v[104:107]
    ds_read_b64_tr_b16 v[32:33], v14 offset:24576
    v_mfma_f32_16x16x32_bf16 v[112:115], v[72:75], v[64:67], v[112:115]
    ds_read_b64_tr_b16 v[34:35], v14 offset:25088
    v_mfma_f32_16x16x32_bf16 v[120:123], v[72:75], v[68:71], v[120:123]
    ds_read_b128 v[20:23], v10 offset:51200
    v_mfma_f32_16x16x32_bf16 v[100:103], v[76:79], v[56:59], v[100:103]
    ds_read_b128 v[24:27], v10 offset:53248
    v_mfma_f32_16x16x32_bf16 v[108:111], v[76:79], v[60:63], v[108:111]
    ds_read_b128 v[28:31], v10 offset:55296
    v_mfma_f32_16x16x32_bf16 v[116:119], v[76:79], v[64:67], v[116:119]
    ds_read_b64_tr_b16 v[36:37], v15 offset:24576
    v_mfma_f32_16x16x32_bf16 v[124:127], v[76:79], v[68:71], v[124:127]
    ds_read_b64_tr_b16 v[38:39], v15 offset:25088
    v_mfma_f32_16x16x32_bf16 v[128:131], v[80:83], v[56:59], v[128:131]
    ds_read_b64_tr_b16 v[40:41], v14 offset:32768
    v_mfma_f32_16x16x32_bf16 v[136:139], v[80:83], v[60:63], v[136:139]
    ds_read_b64_tr_b16 v[42:43], v14 offset:33280
    v_mfma_f32_16x16x32_bf16 v[144:147], v[80:83], v[64:67], v[144:147]
    ds_read_b64_tr_b16 v[44:45], v15 offset:32768
    v_mfma_f32_16x16x32_bf16 v[152:155], v[80:83], v[68:71], v[152:155]
    ds_read_b64_tr_b16 v[46:47], v15 offset:33280
    v_mfma_f32_16x16x32_bf16 v[132:135], v[84:87], v[56:59], v[132:135]
    ds_read_b64_tr_b16 v[48:49], v14 offset:40960
    v_mfma_f32_16x16x32_bf16 v[140:143], v[84:87], v[60:63], v[140:143]
    ds_read_b64_tr_b16 v[50:51], v14 offset:41472
    v_mfma_f32_16x16x32_bf16 v[148:151], v[84:87], v[64:67], v[148:151]
    ds_read_b64_tr_b16 v[52:53], v15 offset:40960
    v_mfma_f32_16x16x32_bf16 v[156:159], v[84:87], v[68:71], v[156:159]
    ds_read_b64_tr_b16 v[54:55], v15 offset:41472
    v_mfma_f32_16x16x32_bf16 v[160:163], v[56:59], v[88:91], v[160:163]
    v_mfma_f32_16x16x32_bf16 v[168:171], v[60:63], v[88:91], v[168:171]
    v_mfma_f32_16x16x32_bf16 v[176:179], v[64:67], v[88:91], v[176:179]
    v_mfma_f32_16x16x32_bf16 v[184:187], v[68:71], v[88:91], v[184:187]
    v_mfma_f32_16x16x32_bf16 v[164:167], v[56:59], v[92:95], v[164:167]
    v_mfma_f32_16x16x32_bf16 v[172:175], v[60:63], v[92:95], v[172:175]
    v_mfma_f32_16x16x32_bf16 v[180:183], v[64:67], v[92:95], v[180:183]
    v_mfma_f32_16x16x32_bf16 v[188:191], v[68:71], v[92:95], v[188:191]
    s_waitcnt lgkmcnt(13)
    v_mfma_f32_16x16x32_bf16 v[96:99], v[32:35], v[16:19], v[96:99]
    ds_read_b128 v[56:59], v11 offset:49152
    ds_read_b64_tr_b16 v[72:73], v14 offset:28672
    s_waitcnt lgkmcnt(14)
    v_mfma_f32_16x16x32_bf16 v[104:107], v[32:35], v[20:23], v[104:107]
    ds_read_b64_tr_b16 v[74:75], v14 offset:29184
    s_waitcnt lgkmcnt(14)
    v_mfma_f32_16x16x32_bf16 v[112:115], v[32:35], v[24:27], v[112:115]
    ds_read_b128 v[60:63], v11 offset:51200
    s_waitcnt lgkmcnt(14)
    v_mfma_f32_16x16x32_bf16 v[120:123], v[32:35], v[28:31], v[120:123]
    ds_read_b128 v[64:67], v11 offset:53248
    s_waitcnt lgkmcnt(13)
    v_mfma_f32_16x16x32_bf16 v[100:103], v[36:39], v[16:19], v[100:103]
    ds_read_b128 v[68:71], v11 offset:55296
    v_mfma_f32_16x16x32_bf16 v[108:111], v[36:39], v[20:23], v[108:111]
    ds_read_b64_tr_b16 v[76:77], v15 offset:28672
    v_mfma_f32_16x16x32_bf16 v[116:119], v[36:39], v[24:27], v[116:119]
    ds_read_b64_tr_b16 v[78:79], v15 offset:29184
    v_mfma_f32_16x16x32_bf16 v[124:127], v[36:39], v[28:31], v[124:127]
    ds_read_b64_tr_b16 v[80:81], v14 offset:36864
    s_waitcnt lgkmcnt(15)
    v_mfma_f32_16x16x32_bf16 v[128:131], v[40:43], v[16:19], v[128:131]
    ds_read_b64_tr_b16 v[82:83], v14 offset:37376
    v_mfma_f32_16x16x32_bf16 v[136:139], v[40:43], v[20:23], v[136:139]
    ds_read_b64_tr_b16 v[84:85], v15 offset:36864
    v_mfma_f32_16x16x32_bf16 v[144:147], v[40:43], v[24:27], v[144:147]
    ds_read_b64_tr_b16 v[86:87], v15 offset:37376
    v_mfma_f32_16x16x32_bf16 v[152:155], v[40:43], v[28:31], v[152:155]
    ds_read_b64_tr_b16 v[88:89], v14 offset:45056
    s_waitcnt lgkmcnt(15)
    v_mfma_f32_16x16x32_bf16 v[132:135], v[44:47], v[16:19], v[132:135]
    ds_read_b64_tr_b16 v[90:91], v14 offset:45568
    v_mfma_f32_16x16x32_bf16 v[140:143], v[44:47], v[20:23], v[140:143]
    ds_read_b64_tr_b16 v[92:93], v15 offset:45056
    v_mfma_f32_16x16x32_bf16 v[148:151], v[44:47], v[24:27], v[148:151]
    ds_read_b64_tr_b16 v[94:95], v15 offset:45568
    v_mfma_f32_16x16x32_bf16 v[156:159], v[44:47], v[28:31], v[156:159]
    s_sub_u32 s48, s48, 1
    v_mfma_f32_16x16x32_bf16 v[160:163], v[16:19], v[48:51], v[160:163]
    s_cmp_lg_u32 s48, 0
    v_mfma_f32_16x16x32_bf16 v[168:171], v[20:23], v[48:51], v[168:171]
    v_mfma_f32_16x16x32_bf16 v[176:179], v[24:27], v[48:51], v[176:179]
    v_mfma_f32_16x16x32_bf16 v[184:187], v[28:31], v[48:51], v[184:187]
    s_waitcnt lgkmcnt(15)
    v_mfma_f32_16x16x32_bf16 v[164:167], v[16:19], v[52:55], v[164:167]
    v_mfma_f32_16x16x32_bf16 v[172:175], v[20:23], v[52:55], v[172:175]
    v_mfma_f32_16x16x32_bf16 v[180:183], v[24:27], v[52:55], v[180:183]
    v_mfma_f32_16x16x32_bf16 v[188:191], v[28:31], v[52:55], v[188:191]
    s_waitcnt lgkmcnt(0)
    s_barrier
    s_cbranch_scc1 k1_cloop
k1_epi:
    s_waitcnt vmcnt(0)
    v_lshl_add_u32 v192, v4, 2, v5
    v_lshlrev_b32 v192, 6, v192
    v_lshl_add_u32 v192, v6, 3, v192
    s_lshl_b32 s19, s18, 11
    s_add_u32 s19, s19, 65536
    v_add_u32 v192, s19, v192
    ds_read_b64_tr_b16 v[16:17], v192 offset:0
    ds_read_b64_tr_b16 v[18:19], v192 offset:1024
    ds_read_b64_tr_b16 v[20:21], v192 offset:32
    ds_read_b64_tr_b16 v[22:23], v192 offset:1056
    v_mfma_f32_16x16x32_bf16 v[96:99], v[72:75], v[56:59], v[96:99]
    v_mfma_f32_16x16x32_bf16 v[104:107], v[72:75], v[60:63], v[104:107]
    v_mfma_f32_16x16x32_bf16 v[112:115], v[72:75], v[64:67], v[112:115]
    v_mfma_f32_16x16x32_bf16 v[120:123], v[72:75], v[68:71], v[120:123]
    v_mfma_f32_16x16x32_bf16 v[100:103], v[76:79], v[56:59], v[100:103]
    v_mfma_f32_16x16x32_bf16 v[108:111], v[76:79], v[60:63], v[108:111]
    v_mfma_f32_16x16x32_bf16 v[116:119], v[76:79], v[64:67], v[116:119]
    v_mfma_f32_16x16x32_bf16 v[124:127], v[76:79], v[68:71], v[124:127]
    v_mfma_f32_16x16x32_bf16 v[128:131], v[80:83], v[56:59], v[128:131]
    v_mfma_f32_16x16x32_bf16 v[136:139], v[80:83], v[60:63], v[136:139]
    v_mfma_f32_16x16x32_bf16 v[144:147], v[80:83], v[64:67], v[144:147]
    v_mfma_f32_16x16x32_bf16 v[152:155], v[80:83], v[68:71], v[152:155]
    v_mfma_f32_16x16x32_bf16 v[132:135], v[84:87], v[56:59], v[132:135]
    v_mfma_f32_16x16x32_bf16 v[140:143], v[84:87], v[60:63], v[140:143]
    v_mfma_f32_16x16x32_bf16 v[148:151], v[84:87], v[64:67], v[148:151]
    v_mfma_f32_16x16x32_bf16 v[156:159], v[84:87], v[68:71], v[156:159]
    v_mfma_f32_16x16x32_bf16 v[160:163], v[56:59], v[88:91], v[160:163]
    v_mfma_f32_16x16x32_bf16 v[168:171], v[60:63], v[88:91], v[168:171]
    v_mfma_f32_16x16x32_bf16 v[176:179], v[64:67], v[88:91], v[176:179]
    v_mfma_f32_16x16x32_bf16 v[184:187], v[68:71], v[88:91], v[184:187]
    v_mfma_f32_16x16x32_bf16 v[164:167], v[56:59], v[92:95], v[164:167]
    v_mfma_f32_16x16x32_bf16 v[172:175], v[60:63], v[92:95], v[172:175]
    v_mfma_f32_16x16x32_bf16 v[180:183], v[64:67], v[92:95], v[180:183]
    v_mfma_f32_16x16x32_bf16 v[188:191], v[68:71], v[92:95], v[188:191]
    s_lshl_b32 s19, s15, 1
    s_add_u32 s19, s19, s18
    s_lshl_b32 s20, s14, 3
    s_lshl_b32 s21, s17, 2
    s_add_u32 s20, s20, s21
    s_lshl_b32 s20, s20, 5
    s_add_u32 s20, s20, s19
    s_lshl_b32 s20, s20, 10
    s_lshl_b32 s22, s19, 4
    s_add_u32 s22, s22, s14
    s_lshl_b32 s23, s22, 12
    s_lshl_b32 s24, s17, 11
    s_add_u32 s23, s23, s24
    s_lshl_b32 s22, s22, 8
    s_lshl_b32 s24, s17, 7
    s_add_u32 s22, s22, s24
    s_mov_b32 s52, 0x3fb8aa3b
    s_mov_b32 s53, 0x3fb8aa3b
    v_lshlrev_b32 v193, 4, v2
    v_cvt_pk_bf16_f32 v24, v128, v129
    v_cvt_pk_bf16_f32 v25, v130, v131
    v_cvt_pk_bf16_f32 v26, v132, v133
    v_cvt_pk_bf16_f32 v27, v134, v135
    v_cvt_pk_bf16_f32 v28, v136, v137
    v_cvt_pk_bf16_f32 v29, v138, v139
    v_cvt_pk_bf16_f32 v30, v140, v141
    v_cvt_pk_bf16_f32 v31, v142, v143
    v_cvt_pk_bf16_f32 v32, v144, v145
    v_cvt_pk_bf16_f32 v33, v146, v147
    v_cvt_pk_bf16_f32 v34, v148, v149
    v_cvt_pk_bf16_f32 v35, v150, v151
    v_cvt_pk_bf16_f32 v36, v152, v153
    v_cvt_pk_bf16_f32 v37, v154, v155
    v_cvt_pk_bf16_f32 v38, v156, v157
    v_cvt_pk_bf16_f32 v39, v158, v159
    s_waitcnt lgkmcnt(0)
    v_mfma_f32_16x16x32_bf16 v[128:131], v[16:19], v[24:27], 0
    v_mfma_f32_16x16x32_bf16 v[132:135], v[20:23], v[24:27], 0
    v_mfma_f32_16x16x32_bf16 v[136:139], v[16:19], v[28:31], 0
    v_mfma_f32_16x16x32_bf16 v[140:143], v[20:23], v[28:31], 0
    v_mfma_f32_16x16x32_bf16 v[144:147], v[16:19], v[32:35], 0
    v_mfma_f32_16x16x32_bf16 v[148:151], v[20:23], v[32:35], 0
    v_mfma_f32_16x16x32_bf16 v[152:155], v[16:19], v[36:39], 0
    v_mfma_f32_16x16x32_bf16 v[156:159], v[20:23], v[36:39], 0
    v_cvt_pk_bf16_f32 v40, v96, v97
    v_cvt_pk_bf16_f32 v41, v98, v99
    v_cvt_pk_bf16_f32 v42, v100, v101
    v_cvt_pk_bf16_f32 v43, v102, v103
    v_cvt_pk_bf16_f32 v44, v104, v105
    v_cvt_pk_bf16_f32 v45, v106, v107
    v_cvt_pk_bf16_f32 v46, v108, v109
    v_cvt_pk_bf16_f32 v47, v110, v111
    v_cvt_pk_bf16_f32 v48, v112, v113
    v_cvt_pk_bf16_f32 v49, v114, v115
    v_cvt_pk_bf16_f32 v50, v116, v117
    v_cvt_pk_bf16_f32 v51, v118, v119
    v_cvt_pk_bf16_f32 v52, v120, v121
    v_cvt_pk_bf16_f32 v53, v122, v123
    v_cvt_pk_bf16_f32 v54, v124, v125
    v_cvt_pk_bf16_f32 v55, v126, v127
    v_mfma_f32_16x16x32_bf16 v[96:99], v[16:19], v[40:43], 0
    v_mfma_f32_16x16x32_bf16 v[100:103], v[20:23], v[40:43], 0
    v_mfma_f32_16x16x32_bf16 v[104:107], v[16:19], v[44:47], 0
    v_mfma_f32_16x16x32_bf16 v[108:111], v[20:23], v[44:47], 0
    v_mfma_f32_16x16x32_bf16 v[112:115], v[16:19], v[48:51], 0
    v_mfma_f32_16x16x32_bf16 v[116:119], v[20:23], v[48:51], 0
    v_mfma_f32_16x16x32_bf16 v[120:123], v[16:19], v[52:55], 0
    v_mfma_f32_16x16x32_bf16 v[124:127], v[20:23], v[52:55], 0
    v_cvt_pk_bf16_f32 v196, v160, v161
    v_cvt_pk_bf16_f32 v197, v162, v163
    v_cvt_pk_bf16_f32 v200, v164, v165
    v_cvt_pk_bf16_f32 v201, v166, v167
    v_cvt_pk_bf16_f32 v198, v168, v169
    v_cvt_pk_bf16_f32 v199, v170, v171
    v_cvt_pk_bf16_f32 v202, v172, v173
    v_cvt_pk_bf16_f32 v203, v174, v175
    v_cvt_pk_bf16_f32 v204, v176, v177
    v_cvt_pk_bf16_f32 v205, v178, v179
    v_cvt_pk_bf16_f32 v208, v180, v181
    v_cvt_pk_bf16_f32 v209, v182, v183
    v_cvt_pk_bf16_f32 v206, v184, v185
    v_cvt_pk_bf16_f32 v207, v186, v187
    v_cvt_pk_bf16_f32 v210, v188, v189
    v_cvt_pk_bf16_f32 v211, v190, v191
    s_lshl_b32 s24, s18, 1
    s_add_u32 s25, s24, s17
    s_lshl_b32 s25, s25, 12
    s_add_u32 s25, s25, 32768
    v_add_u32 v212, s25, v193
    s_xor_b32 s25, s25, 4096
    v_add_u32 v213, s25, v193
    ds_write_b128 v212, v[196:199] offset:0
    ds_write_b128 v212, v[200:203] offset:1024
    ds_write_b128 v212, v[204:207] offset:2048
    ds_write_b128 v212, v[208:211] offset:3072
    v_bfe_u32 v7, v3, 1, 1
    v_lshlrev_b32 v7, 2, v7
    v_and_b32 v8, 1, v3
    v_or_b32 v7, v7, v8
    v_bfe_u32 v8, v3, 2, 1
    v_lshl_or_b32 v7, v8, 1, v7
    v_xor_b32 v7, v7, v4
    v_lshlrev_b32 v7, 4, v7
    v_lshl_add_u32 v7, v3, 7, v7
    s_lshl_b32 s24, s18, 14
    s_lshl_b32 s25, s17, 13
    s_add_u32 s25, s25, s24
    v_add_u32 v214, s25, v7
    v_xor_b32 v215, 64, v214
    v_max3_f32 v216, v128, v129, v130
    v_min3_f32 v218, v128, v129, v130
    v_max3_f32 v216, v216, v131, v132
    v_min3_f32 v218, v218, v131, v132
    v_max3_f32 v216, v216, v133, v134
    v_min3_f32 v218, v218, v133, v134
    v_max_f32 v216, v216, v135
    v_min_f32 v218, v218, v135
    v_mul_f32 v216, 0x3fb8aa3b, v216
    v_mul_f32 v218, 0xbfb8aa3b, v218
    v_max3_f32 v220, v136, v137, v138
    v_min3_f32 v222, v136, v137, v138
    v_max3_f32 v220, v220, v139, v140
    v_min3_f32 v222, v222, v139, v140
    v_max3_f32 v220, v220, v141, v142
    v_min3_f32 v222, v222, v141, v142
    v_max_f32 v220, v220, v143
    v_min_f32 v222, v222, v143
    v_mul_f32 v220, 0x3fb8aa3b, v220
    v_mul_f32 v222, 0xbfb8aa3b, v222
    v_permlane32_swap_b32 v216, v218
    s_nop 0
    v_permlane32_swap_b32 v220, v222
    v_max_f32 v216, v216, v218
    v_max_f32 v220, v220, v222
    s_nop 1
    v_permlane16_swap_b32 v216, v220
    v_max_f32 v216, v216, v220
    v_mov_b32 v220, v216
    s_nop 1
    v_permlane16_swap_b32 v216, v220
    v_mov_b32 v218, v216
    v_mov_b32 v222, v220
    s_nop 0
    v_permlane32_swap_b32 v216, v218
    v_permlane32_swap_b32 v220, v222
    v_pk_fma_f32 v[160:161], v[128:129], s[52:53], v[216:217] op_sel_hi:[1,0,0] neg_lo:[0,0,1] neg_hi:[0,0,1]
    v_pk_fma_f32 v[176:177], v[128:129], s[52:53], v[218:219] op_sel_hi:[1,0,0] neg_lo:[1,0,1] neg_hi:[1,0,1]
    v_pk_fma_f32 v[162:163], v[130:131], s[52:53], v[216:217] op_sel_hi:[1,0,0] neg_lo:[0,0,1] neg_hi:[0,0,1]
    v_pk_fma_f32 v[178:179], v[130:131], s[52:53], v[218:219] op_sel_hi:[1,0,0] neg_lo:[1,0,1] neg_hi:[1,0,1]
    v_pk_fma_f32 v[164:165], v[132:133], s[52:53], v[216:217] op_sel_hi:[1,0,0] neg_lo:[0,0,1] neg_hi:[0,0,1]
    v_pk_fma_f32 v[180:181], v[132:133], s[52:53], v[218:219] op_sel_hi:[1,0,0] neg_lo:[1,0,1] neg_hi:[1,0,1]
    v_pk_fma_f32 v[166:167], v[134:135], s[52:53], v[216:217] op_sel_hi:[1,0,0] neg_lo:[0,0,1] neg_hi:[0,0,1]
    v_pk_fma_f32 v[182:183], v[134:135], s[52:53], v[218:219] op_sel_hi:[1,0,0] neg_lo:[1,0,1] neg_hi:[1,0,1]
    v_pk_fma_f32 v[168:169], v[136:137], s[52:53], v[220:221] op_sel_hi:[1,0,0] neg_lo:[0,0,1] neg_hi:[0,0,1]
    v_pk_fma_f32 v[184:185], v[136:137], s[52:53], v[222:223] op_sel_hi:[1,0,0] neg_lo:[1,0,1] neg_hi:[1,0,1]
    v_pk_fma_f32 v[170:171], v[138:139], s[52:53], v[220:221] op_sel_hi:[1,0,0] neg_lo:[0,0,1] neg_hi:[0,0,1]
    v_pk_fma_f32 v[186:187], v[138:139], s[52:53], v[222:223] op_sel_hi:[1,0,0] neg_lo:[1,0,1] neg_hi:[1,0,1]
    v_pk_fma_f32 v[172:173], v[140:141], s[52:53], v[220:221] op_sel_hi:[1,0,0] neg_lo:[0,0,1] neg_hi:[0,0,1]
    v_pk_fma_f32 v[188:189], v[140:141], s[52:53], v[222:223] op_sel_hi:[1,0,0] neg_lo:[1,0,1] neg_hi:[1,0,1]
    v_pk_fma_f32 v[174:175], v[142:143], s[52:53], v[220:221] op_sel_hi:[1,0,0] neg_lo:[0,0,1] neg_hi:[0,0,1]
    v_pk_fma_f32 v[190:191], v[142:143], s[52:53], v[222:223] op_sel_hi:[1,0,0] neg_lo:[1,0,1] neg_hi:[1,0,1]
    v_exp_f32 v160, v160
    v_exp_f32 v176, v176
    v_exp_f32 v161, v161
    v_exp_f32 v177, v177
    v_exp_f32 v162, v162
    v_exp_f32 v178, v178
    v_exp_f32 v163, v163
    v_exp_f32 v179, v179
    v_exp_f32 v164, v164
    v_exp_f32 v180, v180
    v_exp_f32 v165, v165
    v_exp_f32 v181, v181
    v_exp_f32 v166, v166
    v_exp_f32 v182, v182
    v_exp_f32 v167, v167
    v_exp_f32 v183, v183
    v_exp_f32 v168, v168
    v_exp_f32 v184, v184
    v_exp_f32 v169, v169
    v_exp_f32 v185, v185
    v_exp_f32 v170, v170
    v_exp_f32 v186, v186
    v_exp_f32 v171, v171
    v_exp_f32 v187, v187
    v_exp_f32 v172, v172
    v_exp_f32 v188, v188
    v_exp_f32 v173, v173
    v_exp_f32 v189, v189
    v_exp_f32 v174, v174
    v_exp_f32 v190, v190
    v_exp_f32 v175, v175
    v_exp_f32 v191, v191
    v_pk_add_f32 v[128:129], v[160:161], v[162:163]
    v_pk_add_f32 v[130:131], v[164:165], v[166:167]
    v_pk_add_f32 v[132:133], v[176:177], v[178:179]
    v_pk_add_f32 v[134:135], v[180:181], v[182:183]
    v_pk_add_f32 v[136:137], v[168:169], v[170:171]
    v_pk_add_f32 v[138:139], v[172:173], v[174:175]
    v_pk_add_f32 v[140:141], v[184:185], v[186:187]
    v_pk_add_f32 v[142:143], v[188:189], v[190:191]
    v_pk_add_f32 v[128:129], v[128:129], v[130:131]
    v_pk_add_f32 v[132:133], v[132:133], v[134:135]
    v_pk_add_f32 v[136:137], v[136:137], v[138:139]
    v_pk_add_f32 v[140:141], v[140:141], v[142:143]
    v_add_f32 v216, v128, v129
    v_add_f32 v218, v132, v133
    v_add_f32 v220, v136, v137
    v_add_f32 v222, v140, v141
    v_permlane32_swap_b32 v216, v218
    s_nop 0
    v_permlane32_swap_b32 v220, v222
    v_add_f32 v216, v216, v218
    v_add_f32 v220, v220, v222
    s_nop 1
    v_permlane16_swap_b32 v216, v220
    v_add_f32 v216, v216, v220
    v_mov_b32 v220, v216
    s_nop 1
    v_permlane16_swap_b32 v216, v220
    v_mov_b32 v218, v216
    v_mov_b32 v222, v220
    s_nop 0
    v_permlane32_swap_b32 v216, v218
    v_permlane32_swap_b32 v220, v222
    v_rcp_f32 v216, v216
    v_rcp_f32 v218, v218
    v_rcp_f32 v220, v220
    v_rcp_f32 v222, v222
    v_pk_mul_f32 v[160:161], v[160:161], v[216:217] op_sel_hi:[1,0]
    v_pk_mul_f32 v[176:177], v[176:177], v[218:219] op_sel_hi:[1,0]
    v_pk_mul_f32 v[162:163], v[162:163], v[216:217] op_sel_hi:[1,0]
    v_pk_mul_f32 v[178:179], v[178:179], v[218:219] op_sel_hi:[1,0]
    v_pk_mul_f32 v[164:165], v[164:165], v[216:217] op_sel_hi:[1,0]
    v_pk_mul_f32 v[180:181], v[180:181], v[218:219] op_sel_hi:[1,0]
    v_pk_mul_f32 v[166:167], v[166:167], v[216:217] op_sel_hi:[1,0]
    v_pk_mul_f32 v[182:183], v[182:183], v[218:219] op_sel_hi:[1,0]
    v_pk_mul_f32 v[168:169], v[168:169], v[220:221] op_sel_hi:[1,0]
    v_pk_mul_f32 v[184:185], v[184:185], v[222:223] op_sel_hi:[1,0]
    v_pk_mul_f32 v[170:171], v[170:171], v[220:221] op_sel_hi:[1,0]
    v_pk_mul_f32 v[186:187], v[186:187], v[222:223] op_sel_hi:[1,0]
    v_pk_mul_f32 v[172:173], v[172:173], v[220:221] op_sel_hi:[1,0]
    v_pk_mul_f32 v[188:189], v[188:189], v[222:223] op_sel_hi:[1,0]
    v_pk_mul_f32 v[174:175], v[174:175], v[220:221] op_sel_hi:[1,0]
    v_pk_mul_f32 v[190:191], v[190:191], v[222:223] op_sel_hi:[1,0]
    v_cvt_pk_bf16_f32 v24, v160, v161
    v_cvt_pk_bf16_f32 v28, v176, v177
    v_cvt_pk_bf16_f32 v25, v162, v163
    v_cvt_pk_bf16_f32 v29, v178, v179
    v_cvt_pk_bf16_f32 v26, v164, v165
    v_cvt_pk_bf16_f32 v30, v180, v181
    v_cvt_pk_bf16_f32 v27, v166, v167
    v_cvt_pk_bf16_f32 v31, v182, v183
    v_cvt_pk_bf16_f32 v32, v168, v169
    v_cvt_pk_bf16_f32 v36, v184, v185
    v_cvt_pk_bf16_f32 v33, v170, v171
    v_cvt_pk_bf16_f32 v37, v186, v187
    v_cvt_pk_bf16_f32 v34, v172, v173
    v_cvt_pk_bf16_f32 v38, v188, v189
    v_cvt_pk_bf16_f32 v35, v174, v175
    v_cvt_pk_bf16_f32 v39, v190, v191
    ds_write_b128 v214, v[24:27] offset:0
    ds_write_b128 v215, v[28:31] offset:0
    ds_write_b128 v214, v[32:35] offset:2048
    ds_write_b128 v215, v[36:39] offset:2048
    v_cvt_pk_bf16_f32 v40, v96, v97
    v_cvt_pk_bf16_f32 v41, v98, v99
    v_cvt_pk_bf16_f32 v42, v100, v101
    v_cvt_pk_bf16_f32 v43, v102, v103
    buffer_store_dwordx4 v[40:43], v193, s[36:39], s20 offen sc0 sc1
    s_add_u32 s20, s20, 32768
    v_cvt_pk_bf16_f32 v44, v104, v105
    v_cvt_pk_bf16_f32 v45, v106, v107
    v_cvt_pk_bf16_f32 v46, v108, v109
    v_cvt_pk_bf16_f32 v47, v110, v111
    buffer_store_dwordx4 v[44:47], v193, s[36:39], s20 offen sc0 sc1
    s_add_u32 s20, s20, 32768
    v_cvt_pk_bf16_f32 v48, v112, v113
    v_cvt_pk_bf16_f32 v49, v114, v115
    v_cvt_pk_bf16_f32 v50, v116, v117
    v_cvt_pk_bf16_f32 v51, v118, v119
    buffer_store_dwordx4 v[48:51], v193, s[36:39], s20 offen sc0 sc1
    s_add_u32 s20, s20, 32768
    v_cvt_pk_bf16_f32 v52, v120, v121
    v_cvt_pk_bf16_f32 v53, v122, v123
    v_cvt_pk_bf16_f32 v54, v124, v125
    v_cvt_pk_bf16_f32 v55, v126, v127
    buffer_store_dwordx4 v[52:55], v193, s[36:39], s20 offen sc0 sc1
    v_max3_f32 v216, v144, v145, v146
    v_min3_f32 v218, v144, v145, v146
    v_max3_f32 v216, v216, v147, v148
    v_min3_f32 v218, v218, v147, v148
    v_max3_f32 v216, v216, v149, v150
    v_min3_f32 v218, v218, v149, v150
    v_max_f32 v216, v216, v151
    v_min_f32 v218, v218, v151
    v_mul_f32 v216, 0x3fb8aa3b, v216
    v_mul_f32 v218, 0xbfb8aa3b, v218
    v_max3_f32 v220, v152, v153, v154
    v_min3_f32 v222, v152, v153, v154
    v_max3_f32 v220, v220, v155, v156
    v_min3_f32 v222, v222, v155, v156
    v_max3_f32 v220, v220, v157, v158
    v_min3_f32 v222, v222, v157, v158
    v_max_f32 v220, v220, v159
    v_min_f32 v222, v222, v159
    v_mul_f32 v220, 0x3fb8aa3b, v220
    v_mul_f32 v222, 0xbfb8aa3b, v222
    v_permlane32_swap_b32 v216, v218
    s_nop 0
    v_permlane32_swap_b32 v220, v222
    v_max_f32 v216, v216, v218
    v_max_f32 v220, v220, v222
    s_nop 1
    v_permlane16_swap_b32 v216, v220
    v_max_f32 v216, v216, v220
    v_mov_b32 v220, v216
    s_nop 1
    v_permlane16_swap_b32 v216, v220
    v_mov_b32 v218, v216
    v_mov_b32 v222, v220
    s_nop 0
    v_permlane32_swap_b32 v216, v218
    v_permlane32_swap_b32 v220, v222
    v_pk_fma_f32 v[160:161], v[144:145], s[52:53], v[216:217] op_sel_hi:[1,0,0] neg_lo:[0,0,1] neg_hi:[0,0,1]
    v_pk_fma_f32 v[176:177], v[144:145], s[52:53], v[218:219] op_sel_hi:[1,0,0] neg_lo:[1,0,1] neg_hi:[1,0,1]
    v_pk_fma_f32 v[162:163], v[146:147], s[52:53], v[216:217] op_sel_hi:[1,0,0] neg_lo:[0,0,1] neg_hi:[0,0,1]
    v_pk_fma_f32 v[178:179], v[146:147], s[52:53], v[218:219] op_sel_hi:[1,0,0] neg_lo:[1,0,1] neg_hi:[1,0,1]
    v_pk_fma_f32 v[164:165], v[148:149], s[52:53], v[216:217] op_sel_hi:[1,0,0] neg_lo:[0,0,1] neg_hi:[0,0,1]
    v_pk_fma_f32 v[180:181], v[148:149], s[52:53], v[218:219] op_sel_hi:[1,0,0] neg_lo:[1,0,1] neg_hi:[1,0,1]
    v_pk_fma_f32 v[166:167], v[150:151], s[52:53], v[216:217] op_sel_hi:[1,0,0] neg_lo:[0,0,1] neg_hi:[0,0,1]
    v_pk_fma_f32 v[182:183], v[150:151], s[52:53], v[218:219] op_sel_hi:[1,0,0] neg_lo:[1,0,1] neg_hi:[1,0,1]
    v_pk_fma_f32 v[168:169], v[152:153], s[52:53], v[220:221] op_sel_hi:[1,0,0] neg_lo:[0,0,1] neg_hi:[0,0,1]
    v_pk_fma_f32 v[184:185], v[152:153], s[52:53], v[222:223] op_sel_hi:[1,0,0] neg_lo:[1,0,1] neg_hi:[1,0,1]
    v_pk_fma_f32 v[170:171], v[154:155], s[52:53], v[220:221] op_sel_hi:[1,0,0] neg_lo:[0,0,1] neg_hi:[0,0,1]
    v_pk_fma_f32 v[186:187], v[154:155], s[52:53], v[222:223] op_sel_hi:[1,0,0] neg_lo:[1,0,1] neg_hi:[1,0,1]
    v_pk_fma_f32 v[172:173], v[156:157], s[52:53], v[220:221] op_sel_hi:[1,0,0] neg_lo:[0,0,1] neg_hi:[0,0,1]
    v_pk_fma_f32 v[188:189], v[156:157], s[52:53], v[222:223] op_sel_hi:[1,0,0] neg_lo:[1,0,1] neg_hi:[1,0,1]
    v_pk_fma_f32 v[174:175], v[158:159], s[52:53], v[220:221] op_sel_hi:[1,0,0] neg_lo:[0,0,1] neg_hi:[0,0,1]
    v_pk_fma_f32 v[190:191], v[158:159], s[52:53], v[222:223] op_sel_hi:[1,0,0] neg_lo:[1,0,1] neg_hi:[1,0,1]
    v_exp_f32 v160, v160
    v_exp_f32 v176, v176
    v_exp_f32 v161, v161
    v_exp_f32 v177, v177
    v_exp_f32 v162, v162
    v_exp_f32 v178, v178
    v_exp_f32 v163, v163
    v_exp_f32 v179, v179
    v_exp_f32 v164, v164
    v_exp_f32 v180, v180
    v_exp_f32 v165, v165
    v_exp_f32 v181, v181
    v_exp_f32 v166, v166
    v_exp_f32 v182, v182
    v_exp_f32 v167, v167
    v_exp_f32 v183, v183
    v_exp_f32 v168, v168
    v_exp_f32 v184, v184
    v_exp_f32 v169, v169
    v_exp_f32 v185, v185
    v_exp_f32 v170, v170
    v_exp_f32 v186, v186
    v_exp_f32 v171, v171
    v_exp_f32 v187, v187
    v_exp_f32 v172, v172
    v_exp_f32 v188, v188
    v_exp_f32 v173, v173
    v_exp_f32 v189, v189
    v_exp_f32 v174, v174
    v_exp_f32 v190, v190
    v_exp_f32 v175, v175
    v_exp_f32 v191, v191
    v_pk_add_f32 v[144:145], v[160:161], v[162:163]
    v_pk_add_f32 v[146:147], v[164:165], v[166:167]
    v_pk_add_f32 v[148:149], v[176:177], v[178:179]
    v_pk_add_f32 v[150:151], v[180:181], v[182:183]
    v_pk_add_f32 v[152:153], v[168:169], v[170:171]
    v_pk_add_f32 v[154:155], v[172:173], v[174:175]
    v_pk_add_f32 v[156:157], v[184:185], v[186:187]
    v_pk_add_f32 v[158:159], v[188:189], v[190:191]
    v_pk_add_f32 v[144:145], v[144:145], v[146:147]
    v_pk_add_f32 v[148:149], v[148:149], v[150:151]
    v_pk_add_f32 v[152:153], v[152:153], v[154:155]
    v_pk_add_f32 v[156:157], v[156:157], v[158:159]
    v_add_f32 v216, v144, v145
    v_add_f32 v218, v148, v149
    v_add_f32 v220, v152, v153
    v_add_f32 v222, v156, v157
    v_permlane32_swap_b32 v216, v218
    s_nop 0
    v_permlane32_swap_b32 v220, v222
    v_add_f32 v216, v216, v218
    v_add_f32 v220, v220, v222
    s_nop 1
    v_permlane16_swap_b32 v216, v220
    v_add_f32 v216, v216, v220
    v_mov_b32 v220, v216
    s_nop 1
    v_permlane16_swap_b32 v216, v220
    v_mov_b32 v218, v216
    v_mov_b32 v222, v220
    s_nop 0
    v_permlane32_swap_b32 v216, v218
    v_permlane32_swap_b32 v220, v222
    v_rcp_f32 v216, v216
    v_rcp_f32 v218, v218
    v_rcp_f32 v220, v220
    v_rcp_f32 v222, v222
    v_pk_mul_f32 v[160:161], v[160:161], v[216:217] op_sel_hi:[1,0]
    v_pk_mul_f32 v[176:177], v[176:177], v[218:219] op_sel_hi:[1,0]
    v_pk_mul_f32 v[162:163], v[162:163], v[216:217] op_sel_hi:[1,0]
    v_pk_mul_f32 v[178:179], v[178:179], v[218:219] op_sel_hi:[1,0]
    v_pk_mul_f32 v[164:165], v[164:165], v[216:217] op_sel_hi:[1,0]
    v_pk_mul_f32 v[180:181], v[180:181], v[218:219] op_sel_hi:[1,0]
    v_pk_mul_f32 v[166:167], v[166:167], v[216:217] op_sel_hi:[1,0]
    v_pk_mul_f32 v[182:183], v[182:183], v[218:219] op_sel_hi:[1,0]
    v_pk_mul_f32 v[168:169], v[168:169], v[220:221] op_sel_hi:[1,0]
    v_pk_mul_f32 v[184:185], v[184:185], v[222:223] op_sel_hi:[1,0]
    v_pk_mul_f32 v[170:171], v[170:171], v[220:221] op_sel_hi:[1,0]
    v_pk_mul_f32 v[186:187], v[186:187], v[222:223] op_sel_hi:[1,0]
    v_pk_mul_f32 v[172:173], v[172:173], v[220:221] op_sel_hi:[1,0]
    v_pk_mul_f32 v[188:189], v[188:189], v[222:223] op_sel_hi:[1,0]
    v_pk_mul_f32 v[174:175], v[174:175], v[220:221] op_sel_hi:[1,0]
    v_pk_mul_f32 v[190:191], v[190:191], v[222:223] op_sel_hi:[1,0]
    v_cvt_pk_bf16_f32 v24, v160, v161
    v_cvt_pk_bf16_f32 v28, v176, v177
    v_cvt_pk_bf16_f32 v25, v162, v163
    v_cvt_pk_bf16_f32 v29, v178, v179
    v_cvt_pk_bf16_f32 v26, v164, v165
    v_cvt_pk_bf16_f32 v30, v180, v181
    v_cvt_pk_bf16_f32 v27, v166, v167
    v_cvt_pk_bf16_f32 v31, v182, v183
    v_cvt_pk_bf16_f32 v32, v168, v169
    v_cvt_pk_bf16_f32 v36, v184, v185
    v_cvt_pk_bf16_f32 v33, v170, v171
    v_cvt_pk_bf16_f32 v37, v186, v187
    v_cvt_pk_bf16_f32 v34, v172, v173
    v_cvt_pk_bf16_f32 v38, v188, v189
    v_cvt_pk_bf16_f32 v35, v174, v175
    v_cvt_pk_bf16_f32 v39, v190, v191
    ds_write_b128 v214, v[24:27] offset:4096
    ds_write_b128 v215, v[28:31] offset:4096
    ds_write_b128 v214, v[32:35] offset:6144
    ds_write_b128 v215, v[36:39] offset:6144
    v_lshrrev_b32 v7, 1, v5
    v_lshlrev_b32 v7, 2, v7
    v_and_b32 v8, 1, v5
    v_or_b32 v7, v7, v8
    v_and_b32 v8, 1, v4
    v_lshl_or_b32 v7, v8, 1, v7
    v_xor_b32 v7, v7, v6
    s_lshl_b32 s25, s17, 2
    v_xor_b32 v7, s25, v7
    v_lshlrev_b32 v7, 4, v7
    v_lshl_add_u32 v8, v4, 2, v5
    v_lshl_add_u32 v224, v8, 7, v7
    s_lshl_b32 s25, s17, 13
    s_add_u32 s25, s25, s24
    v_add_u32 v225, s25, v224
    s_xor_b32 s25, s25, 8192
    v_add_u32 v224, s25, v224
    v_mov_b32 v56, 0x3f803f80
    v_mov_b32 v57, 0x3f803f80
    v_mov_b32 v58, 0x3f803f80
    v_mov_b32 v59, 0x3f803f80
    v_lshrrev_b32 v7, 2, v3
    v_lshl_add_u32 v7, v7, 3, v6
    v_lshlrev_b32 v7, 2, v7
    s_waitcnt lgkmcnt(0)
    s_barrier
    ds_read_b64_tr_b16 v[96:97], v225 offset:0
    ds_read_b64_tr_b16 v[98:99], v225 offset:2048
    ds_read_b64_tr_b16 v[100:101], v225 offset:8
    ds_read_b64_tr_b16 v[102:103], v225 offset:2056
    ds_read_b64_tr_b16 v[104:105], v225 offset:4096
    ds_read_b64_tr_b16 v[106:107], v225 offset:6144
    ds_read_b64_tr_b16 v[108:109], v225 offset:4104
    ds_read_b64_tr_b16 v[110:111], v225 offset:6152
    ds_read_b128 v[128:131], v213 offset:0
    ds_read_b128 v[132:135], v213 offset:1024
    ds_read_b64_tr_b16 v[112:113], v224 offset:0
    ds_read_b64_tr_b16 v[114:115], v224 offset:2048
    ds_read_b64_tr_b16 v[116:117], v224 offset:8
    ds_read_b64_tr_b16 v[118:119], v224 offset:2056
    ds_read_b128 v[136:139], v213 offset:2048
    ds_read_b128 v[140:143], v213 offset:3072
    ds_read_b64_tr_b16 v[120:121], v224 offset:4096
    ds_read_b64_tr_b16 v[122:123], v224 offset:6144
    ds_read_b64_tr_b16 v[124:125], v224 offset:4104
    ds_read_b64_tr_b16 v[126:127], v224 offset:6152
    s_waitcnt lgkmcnt(15)
    v_mfma_f32_16x16x32_bf16 v[160:163], v[96:99], v[196:199], 0
    v_mfma_f32_16x16x32_bf16 v[168:171], v[96:99], v[200:203], 0
    v_mfma_f32_16x16x32_bf16 v[176:179], v[56:59], v[96:99], 0
    v_mfma_f32_16x16x32_bf16 v[164:167], v[100:103], v[196:199], 0
    v_mfma_f32_16x16x32_bf16 v[172:175], v[100:103], v[200:203], 0
    v_mfma_f32_16x16x32_bf16 v[180:183], v[56:59], v[100:103], 0
    s_waitcnt lgkmcnt(14)
    v_mfma_f32_16x16x32_bf16 v[160:163], v[104:107], v[204:207], v[160:163]
    v_mfma_f32_16x16x32_bf16 v[168:171], v[104:107], v[208:211], v[168:171]
    v_mfma_f32_16x16x32_bf16 v[176:179], v[56:59], v[104:107], v[176:179]
    s_waitcnt lgkmcnt(12)
    v_mfma_f32_16x16x32_bf16 v[164:167], v[108:111], v[204:207], v[164:167]
    v_mfma_f32_16x16x32_bf16 v[172:175], v[108:111], v[208:211], v[172:175]
    v_mfma_f32_16x16x32_bf16 v[180:183], v[56:59], v[108:111], v[180:183]
    s_waitcnt lgkmcnt(8)
    v_mfma_f32_16x16x32_bf16 v[160:163], v[112:115], v[128:131], v[160:163]
    v_mfma_f32_16x16x32_bf16 v[168:171], v[112:115], v[132:135], v[168:171]
    v_mfma_f32_16x16x32_bf16 v[176:179], v[56:59], v[112:115], v[176:179]
    s_waitcnt lgkmcnt(6)
    v_mfma_f32_16x16x32_bf16 v[164:167], v[116:119], v[128:131], v[164:167]
    v_mfma_f32_16x16x32_bf16 v[172:175], v[116:119], v[132:135], v[172:175]
    v_mfma_f32_16x16x32_bf16 v[180:183], v[56:59], v[116:119], v[180:183]
    s_waitcnt lgkmcnt(2)
    v_mfma_f32_16x16x32_bf16 v[160:163], v[120:123], v[136:139], v[160:163]
    v_mfma_f32_16x16x32_bf16 v[168:171], v[120:123], v[140:143], v[168:171]
    v_mfma_f32_16x16x32_bf16 v[176:179], v[56:59], v[120:123], v[176:179]
    s_waitcnt lgkmcnt(0)
    v_mfma_f32_16x16x32_bf16 v[164:167], v[124:127], v[136:139], v[164:167]
    v_mfma_f32_16x16x32_bf16 v[172:175], v[124:127], v[140:143], v[172:175]
    v_mfma_f32_16x16x32_bf16 v[180:183], v[56:59], v[124:127], v[180:183]
    s_nop 1
    v_cvt_pk_bf16_f32 v160, v160, v161
    v_cvt_pk_bf16_f32 v161, v162, v163
    s_nop 1
    v_cvt_pk_bf16_f32 v162, v164, v165
    v_cvt_pk_bf16_f32 v163, v166, v167
    buffer_store_dwordx4 v[160:163], v193, s[40:43], s23 offen offset:0 sc0 sc1
    v_cvt_pk_bf16_f32 v168, v168, v169
    v_cvt_pk_bf16_f32 v169, v170, v171
    v_cvt_pk_bf16_f32 v170, v172, v173
    v_cvt_pk_bf16_f32 v171, v174, v175
    buffer_store_dwordx4 v[168:171], v193, s[40:43], s23 offen offset:1024 sc0 sc1
    buffer_store_dword v176, v7, s[44:47], s22 offen offset:0
    buffer_store_dword v180, v7, s[44:47], s22 offen offset:16
    s_endpgm
k1_prod:
    v_and_b32 v2, 63, v0
    v_lshrrev_b32 v3, 3, v2
    v_and_b32 v4, 7, v2
    s_sub_u32 s17, s16, 4
    s_lshl_b32 s18, s14, 7
    s_lshl_b32 s60, s17, 5
    s_add_u32 s60, s60, s18
    v_add_u32 v5, s60, v3
    s_mov_b32 s61, 2048
    v_mul_lo_u32 v5, v5, s61
    v_lshrrev_b32 v6, 4, v2
    v_xor_b32 v6, v6, v4
    v_lshl_add_u32 v8, v6, 4, v5
    v_xor_b32 v6, 4, v6
    v_lshl_add_u32 v9, v6, 4, v5
    v_add_u32 v10, 30720, v8
    v_add_u32 v11, 46080, v9
    v_add_u32 v9, 15360, v9
    s_and_b32 s60, s15, 7
    s_lshl_b32 s19, s15, 7
    s_lshr_b32 s61, s15, 3
    s_mul_i32 s61, s61, 393216
    s_cmp_eq_u32 s60, 3
    s_mov_b32 s51, 6144
    s_cmov_b32 s51, 128
    s_cselect_b32 s19, s61, s19
    s_mov_b32 s52, 2048
    s_cmov_b32 s52, 131072
    s_lshl_b32 s53, s51, 6
    s_lshl_b32 s60, s17, 4
    v_add_u32 v5, s60, v3
    v_mul_lo_u32 v12, v5, s51
    s_lshl_b32 s61, s51, 3
    s_sub_u32 s61, s61, 1024
    v_add_u32 v12, s19, v12
    v_bfe_u32 v6, v5, 1, 1
    v_lshlrev_b32 v6, 2, v6
    v_bfe_u32 v5, v5, 3, 1
    v_lshl_or_b32 v6, v5, 1, v6
    v_xor_b32 v6, v6, v4
    v_xor_b32 v5, 2, v6
    v_lshl_add_u32 v13, v5, 4, v12
    v_add_u32 v13, s61, v13
    v_lshl_add_u32 v12, v6, 4, v12
    v_add_u32 v14, s52, v12
    v_add_u32 v15, s52, v13
    v_add_u32 v16, s52, v14
    v_add_u32 v17, s52, v15
    v_lshlrev_b32 v18, 4, v2
    s_lshl_b32 s40, s17, 11
    s_lshl_b32 s43, s17, 12
    s_load_dwordx4 s[56:59], s[0:1], 72
    s_lshl_b32 s54, s2, 2
    s_add_u32 s54, s54, s17
    s_lshr_b32 s55, s54, 6
    s_and_b32 s54, s54, 63
    s_lshl_b32 s55, s55, 6
    v_lshl_add_u32 v81, v3, 3, s55
    s_movk_i32 s55, 12288
    v_mul_lo_u32 v80, v81, s55
    v_lshl_add_u32 v80, v4, 4, v80
    v_lshlrev_b32 v81, 1, v81
    v_and_b32 v82, 7, v2
    v_lshlrev_b32 v82, 5, v82
    v_bfe_u32 v5, v2, 3, 1
    v_lshl_add_u32 v82, v5, 4, v82
    v_bfe_u32 v5, v2, 4, 1
    v_lshl_add_u32 v82, v5, 3, v82
    v_bfe_u32 v5, v2, 5, 1
    v_lshl_add_u32 v82, v5, 2, v82
    s_waitcnt lgkmcnt(0)
    s_add_u32 s20, s4, 39845888
    s_addc_u32 s21, s5, 0
    s_and_b32 s21, s21, 0xffff
    s_mov_b32 s22, 4194304
    s_mov_b32 s23, 0x00020000
    s_add_u32 s24, s4, 55574528
    s_addc_u32 s25, s5, 0
    s_cmpk_eq_u32 s51, 128
    s_cselect_b32 s24, s24, s8
    s_cselect_b32 s25, s25, s9
    s_and_b32 s25, s25, 0xffff
    s_mov_b32 s26, 6291456
    s_mov_b32 s27, 0x00020000
    s_mov_b32 s36, s34
    s_and_b32 s37, s35, 0xffff
    s_mov_b32 s38, 7340032
    s_mov_b32 s39, 0x00020000
    s_mov_b32 s32, s10
    s_and_b32 s33, s11, 0xffff
    s_mov_b32 s34, 65536
    s_mov_b32 s35, 0x00020000
    s_mov_b32 s28, s12
    s_and_b32 s29, s13, 0xffff
    s_mov_b32 s30, 2097152
    s_mov_b32 s31, 0x00020000
    v_lshlrev_b32 v83, 6, v2
    s_lshl_b32 s46, s2, 2
    s_add_u32 s46, s46, s17
    s_lshl_b32 s46, s46, 12
    s_mov_b64 s[12:13], s[8:9]
    s_mov_b32 s8, s58
    s_and_b32 s9, s59, 0xffff
    s_mov_b32 s10, 12582912
    s_mov_b32 s11, 0x00020000
    s_lshl_b32 s7, s54, 7
    s_add_u32 s7, s7, 4096
    s_add_u32 m0, s43, 0
    s_mov_b32 s41, 0
    buffer_load_dwordx4 v8, s[20:23], s41 offen offset:0 lds
    buffer_load_dwordx4 v9, s[20:23], s41 offen offset:1024 lds
    buffer_load_dwordx4 v10, s[20:23], s41 offen offset:2048 lds
    buffer_load_dwordx4 v11, s[20:23], s41 offen offset:3072 lds
    s_mul_i32 s42, s53, 0
    s_add_u32 m0, s40, 65536
    s_nop 0
    buffer_load_dwordx4 v12, s[24:27], s42 offen offset:0 lds
    buffer_load_dwordx4 v13, s[24:27], s42 offen offset:1024 lds
    s_add_u32 m0, s40, 73728
    s_nop 0
    buffer_load_dwordx4 v14, s[24:27], s42 offen offset:0 lds
    buffer_load_dwordx4 v15, s[24:27], s42 offen offset:1024 lds
    s_add_u32 m0, s40, 81920
    s_nop 0
    buffer_load_dwordx4 v16, s[24:27], s42 offen offset:0 lds
    buffer_load_dwordx4 v17, s[24:27], s42 offen offset:1024 lds
    s_add_u32 m0, s43, 16384
    s_mov_b32 s41, 128
    buffer_load_dwordx4 v8, s[20:23], s41 offen offset:0 lds
    buffer_load_dwordx4 v9, s[20:23], s41 offen offset:1024 lds
    buffer_load_dwordx4 v10, s[20:23], s41 offen offset:2048 lds
    buffer_load_dwordx4 v11, s[20:23], s41 offen offset:3072 lds
    s_mul_i32 s42, s53, 1
    s_add_u32 m0, s40, 90112
    s_nop 0
    buffer_load_dwordx4 v12, s[24:27], s42 offen offset:0 lds
    buffer_load_dwordx4 v13, s[24:27], s42 offen offset:1024 lds
    s_add_u32 m0, s40, 98304
    s_nop 0
    buffer_load_dwordx4 v14, s[24:27], s42 offen offset:0 lds
    buffer_load_dwordx4 v15, s[24:27], s42 offen offset:1024 lds
    s_add_u32 m0, s40, 106496
    s_nop 0
    buffer_load_dwordx4 v16, s[24:27], s42 offen offset:0 lds
    buffer_load_dwordx4 v17, s[24:27], s42 offen offset:1024 lds
    s_waitcnt vmcnt(10)
    s_barrier
    s_add_u32 m0, s43, 32768
    s_mov_b32 s41, 256
    buffer_load_dwordx4 v8, s[20:23], s41 offen offset:0 lds
    buffer_load_dwordx4 v9, s[20:23], s41 offen offset:1024 lds
    buffer_load_dwordx4 v10, s[20:23], s41 offen offset:2048 lds
    buffer_load_dwordx4 v11, s[20:23], s41 offen offset:3072 lds
    s_mul_i32 s42, s53, 2
    s_add_u32 m0, s40, 114688
    s_nop 0
    buffer_load_dwordx4 v12, s[24:27], s42 offen offset:0 lds
    buffer_load_dwordx4 v13, s[24:27], s42 offen offset:1024 lds
    s_add_u32 m0, s40, 122880
    s_nop 0
    buffer_load_dwordx4 v14, s[24:27], s42 offen offset:0 lds
    buffer_load_dwordx4 v15, s[24:27], s42 offen offset:1024 lds
    s_add_u32 m0, s40, 131072
    s_nop 0
    buffer_load_dwordx4 v16, s[24:27], s42 offen offset:0 lds
    buffer_load_dwordx4 v17, s[24:27], s42 offen offset:1024 lds
    s_add_u32 m0, s43, 49152
    s_mov_b32 s41, 384
    buffer_load_dwordx4 v8, s[20:23], s41 offen offset:0 lds
    buffer_load_dwordx4 v9, s[20:23], s41 offen offset:1024 lds
    buffer_load_dwordx4 v10, s[20:23], s41 offen offset:2048 lds
    buffer_load_dwordx4 v11, s[20:23], s41 offen offset:3072 lds
    s_mul_i32 s42, s53, 3
    s_add_u32 m0, s40, 139264
    s_nop 0
    buffer_load_dwordx4 v12, s[24:27], s42 offen offset:0 lds
    buffer_load_dwordx4 v13, s[24:27], s42 offen offset:1024 lds
    s_add_u32 m0, s40, 147456
    s_nop 0
    buffer_load_dwordx4 v14, s[24:27], s42 offen offset:0 lds
    buffer_load_dwordx4 v15, s[24:27], s42 offen offset:1024 lds
    s_add_u32 m0, s40, 155648
    s_nop 0
    buffer_load_dwordx4 v16, s[24:27], s42 offen offset:0 lds
    buffer_load_dwordx4 v17, s[24:27], s42 offen offset:1024 lds
    s_waitcnt vmcnt(20)
    s_add_u32 s47, s46, 4194304
    v_add_u32 v84, s47, v83
    v_min_u32 v84, 6291392, v84
    global_load_dword v84, v84, s[12:13]
    s_barrier
    s_add_u32 m0, s43, 0
    s_mov_b32 s41, 512
    buffer_load_dwordx4 v8, s[20:23], s41 offen offset:0 lds
    buffer_load_dwordx4 v9, s[20:23], s41 offen offset:1024 lds
    buffer_load_dwordx4 v10, s[20:23], s41 offen offset:2048 lds
    buffer_load_dwordx4 v11, s[20:23], s41 offen offset:3072 lds
    s_mul_i32 s42, s53, 4
    s_add_u32 m0, s40, 65536
    s_nop 0
    buffer_load_dwordx4 v12, s[24:27], s42 offen offset:0 lds
    buffer_load_dwordx4 v13, s[24:27], s42 offen offset:1024 lds
    s_add_u32 m0, s40, 73728
    s_nop 0
    buffer_load_dwordx4 v14, s[24:27], s42 offen offset:0 lds
    buffer_load_dwordx4 v15, s[24:27], s42 offen offset:1024 lds
    s_add_u32 m0, s40, 81920
    s_nop 0
    buffer_load_dwordx4 v16, s[24:27], s42 offen offset:0 lds
    buffer_load_dwordx4 v17, s[24:27], s42 offen offset:1024 lds
    s_waitcnt vmcnt(21)
    global_load_dwordx4 v[76:79], v81, s[56:57]
    s_barrier
    s_add_u32 m0, s43, 16384
    s_mov_b32 s41, 640
    buffer_load_dwordx4 v8, s[20:23], s41 offen offset:0 lds
    buffer_load_dwordx4 v9, s[20:23], s41 offen offset:1024 lds
    buffer_load_dwordx4 v10, s[20:23], s41 offen offset:2048 lds
    buffer_load_dwordx4 v11, s[20:23], s41 offen offset:3072 lds
    s_mul_i32 s42, s53, 5
    s_add_u32 m0, s40, 90112
    s_nop 0
    buffer_load_dwordx4 v12, s[24:27], s42 offen offset:0 lds
    buffer_load_dwordx4 v13, s[24:27], s42 offen offset:1024 lds
    s_add_u32 m0, s40, 98304
    s_nop 0
    buffer_load_dwordx4 v14, s[24:27], s42 offen offset:0 lds
    buffer_load_dwordx4 v15, s[24:27], s42 offen offset:1024 lds
    s_add_u32 m0, s40, 106496
    s_nop 0
    buffer_load_dwordx4 v16, s[24:27], s42 offen offset:0 lds
    buffer_load_dwordx4 v17, s[24:27], s42 offen offset:1024 lds
    s_waitcnt vmcnt(22)
    buffer_load_dwordx4 v[20:23], v80, s[8:11], s7 offen nt
    s_add_u32 s7, s7, s55
    buffer_load_dwordx4 v[24:27], v80, s[8:11], s7 offen nt
    s_add_u32 s7, s7, s55
    s_getpc_b64 s[48:49]
pfo_4:
    s_sub_u32 s48, s48, pfo_4-k1_cloop
    s_subb_u32 s49, s49, 0
    s_lshl_b32 s50, s17, 12
    v_lshlrev_b32 v5, 6, v2
    v_add_u32 v5, s50, v5
    v_min_u32 v5, k1_kernel_end-k1_cloop, v5
    global_load_dword v5, v5, s[48:49]
    s_barrier
    s_add_u32 m0, s43, 32768
    s_mov_b32 s41, 768
    buffer_load_dwordx4 v8, s[20:23], s41 offen offset:0 lds
    buffer_load_dwordx4 v9, s[20:23], s41 offen offset:1024 lds
    buffer_load_dwordx4 v10, s[20:23], s41 offen offset:2048 lds
    buffer_load_dwordx4 v11, s[20:23], s41 offen offset:3072 lds
    s_mul_i32 s42, s53, 6
    s_add_u32 m0, s40, 114688
    s_nop 0
    buffer_load_dwordx4 v12, s[24:27], s42 offen offset:0 lds
    buffer_load_dwordx4 v13, s[24:27], s42 offen offset:1024 lds
    s_add_u32 m0, s40, 122880
    s_nop 0
    buffer_load_dwordx4 v14, s[24:27], s42 offen offset:0 lds
    buffer_load_dwordx4 v15, s[24:27], s42 offen offset:1024 lds
    s_add_u32 m0, s40, 131072
    s_nop 0
    buffer_load_dwordx4 v16, s[24:27], s42 offen offset:0 lds
    buffer_load_dwordx4 v17, s[24:27], s42 offen offset:1024 lds
    s_waitcnt vmcnt(24)
    buffer_load_dwordx4 v[28:31], v80, s[8:11], s7 offen nt
    s_add_u32 s7, s7, s55
    buffer_load_dwordx4 v[32:35], v80, s[8:11], s7 offen nt
    s_add_u32 s7, s7, s55
    s_barrier
    s_add_u32 m0, s43, 49152
    s_mov_b32 s41, 896
    buffer_load_dwordx4 v8, s[20:23], s41 offen offset:0 lds
    buffer_load_dwordx4 v9, s[20:23], s41 offen offset:1024 lds
    buffer_load_dwordx4 v10, s[20:23], s41 offen offset:2048 lds
    buffer_load_dwordx4 v11, s[20:23], s41 offen offset:3072 lds
    s_mul_i32 s42, s53, 7
    s_add_u32 m0, s40, 139264
    s_nop 0
    buffer_load_dwordx4 v12, s[24:27], s42 offen offset:0 lds
    buffer_load_dwordx4 v13, s[24:27], s42 offen offset:1024 lds
    s_add_u32 m0, s40, 147456
    s_nop 0
    buffer_load_dwordx4 v14, s[24:27], s42 offen offset:0 lds
    buffer_load_dwordx4 v15, s[24:27], s42 offen offset:1024 lds
    s_add_u32 m0, s40, 155648
    s_nop 0
    buffer_load_dwordx4 v16, s[24:27], s42 offen offset:0 lds
    buffer_load_dwordx4 v17, s[24:27], s42 offen offset:1024 lds
    s_waitcnt vmcnt(25)
    buffer_load_dwordx4 v[36:39], v80, s[8:11], s7 offen nt
    s_add_u32 s7, s7, s55
    buffer_load_dwordx4 v[40:43], v80, s[8:11], s7 offen nt
    s_add_u32 s7, s7, s55
    s_barrier
    s_add_u32 m0, s43, 0
    s_mov_b32 s41, 1024
    buffer_load_dwordx4 v8, s[20:23], s41 offen offset:0 lds
    buffer_load_dwordx4 v9, s[20:23], s41 offen offset:1024 lds
    buffer_load_dwordx4 v10, s[20:23], s41 offen offset:2048 lds
    buffer_load_dwordx4 v11, s[20:23], s41 offen offset:3072 lds
    s_mul_i32 s42, s53, 8
    s_add_u32 m0, s40, 65536
    s_nop 0
    buffer_load_dwordx4 v12, s[24:27], s42 offen offset:0 lds
    buffer_load_dwordx4 v13, s[24:27], s42 offen offset:1024 lds
    s_add_u32 m0, s40, 73728
    s_nop 0
    buffer_load_dwordx4 v14, s[24:27], s42 offen offset:0 lds
    buffer_load_dwordx4 v15, s[24:27], s42 offen offset:1024 lds
    s_add_u32 m0, s40, 81920
    s_nop 0
    buffer_load_dwordx4 v16, s[24:27], s42 offen offset:0 lds
    buffer_load_dwordx4 v17, s[24:27], s42 offen offset:1024 lds
    s_mov_b32 s6, 0xffff0000
    v_lshlrev_b32 v52, 16, v76
    v_and_b32 v53, s6, v76
    v_lshlrev_b32 v54, 16, v77
    v_and_b32 v55, s6, v77
    v_lshlrev_b32 v56, 16, v78
    v_and_b32 v57, s6, v78
    v_lshlrev_b32 v58, 16, v79
    v_and_b32 v59, s6, v79
    v_mul_f32 v68, 0xbfb8aa3b, v52
    v_mul_f32 v69, 0xbfb8aa3b, v53
    v_mul_f32 v70, 0xbfb8aa3b, v54
    v_mul_f32 v71, 0xbfb8aa3b, v55
    v_mul_f32 v72, 0xbfb8aa3b, v56
    v_mul_f32 v73, 0xbfb8aa3b, v57
    v_mul_f32 v74, 0xbfb8aa3b, v58
    v_mul_f32 v75, 0xbfb8aa3b, v59
    v_exp_f32 v68, v68
    v_exp_f32 v69, v69
    v_exp_f32 v70, v70
    v_exp_f32 v71, v71
    v_exp_f32 v72, v72
    v_exp_f32 v73, v73
    v_exp_f32 v74, v74
    v_exp_f32 v75, v75
    v_add_f32 v68, 1.0, v68
    v_add_f32 v69, 1.0, v69
    v_add_f32 v70, 1.0, v70
    v_add_f32 v71, 1.0, v71
    v_add_f32 v72, 1.0, v72
    v_add_f32 v73, 1.0, v73
    v_add_f32 v74, 1.0, v74
    v_add_f32 v75, 1.0, v75
    v_rcp_f32 v68, v68
    v_rcp_f32 v69, v69
    v_rcp_f32 v70, v70
    v_rcp_f32 v71, v71
    v_rcp_f32 v72, v72
    v_rcp_f32 v73, v73
    v_rcp_f32 v74, v74
    v_rcp_f32 v75, v75
    v_mul_f32 v52, v52, v68
    v_mul_f32 v53, v53, v69
    v_mul_f32 v54, v54, v70
    v_mul_f32 v55, v55, v71
    v_mul_f32 v56, v56, v72
    v_mul_f32 v57, v57, v73
    v_mul_f32 v58, v58, v74
    v_mul_f32 v59, v59, v75
    v_cvt_pk_bf16_f32 v68, v52, v53
    v_cvt_pk_bf16_f32 v70, v54, v55
    v_cvt_pk_bf16_f32 v72, v56, v57
    v_cvt_pk_bf16_f32 v74, v58, v59
    v_lshlrev_b32 v52, 16, v68
    v_and_b32 v53, s6, v68
    v_lshlrev_b32 v54, 16, v70
    v_and_b32 v55, s6, v70
    v_lshlrev_b32 v56, 16, v72
    v_and_b32 v57, s6, v72
    v_lshlrev_b32 v58, 16, v74
    v_and_b32 v59, s6, v74
    s_waitcnt vmcnt(24)
    buffer_load_dwordx4 v[44:47], v80, s[8:11], s7 offen nt
    s_add_u32 s7, s7, s55
    buffer_load_dwordx4 v[48:51], v80, s[8:11], s7 offen nt
    s_barrier
    s_add_u32 m0, s43, 16384
    s_mov_b32 s41, 1152
    buffer_load_dwordx4 v8, s[20:23], s41 offen offset:0 lds
    buffer_load_dwordx4 v9, s[20:23], s41 offen offset:1024 lds
    buffer_load_dwordx4 v10, s[20:23], s41 offen offset:2048 lds
    buffer_load_dwordx4 v11, s[20:23], s41 offen offset:3072 lds
    s_mul_i32 s42, s53, 9
    s_add_u32 m0, s40, 90112
    s_nop 0
    buffer_load_dwordx4 v12, s[24:27], s42 offen offset:0 lds
    buffer_load_dwordx4 v13, s[24:27], s42 offen offset:1024 lds
    s_add_u32 m0, s40, 98304
    s_nop 0
    buffer_load_dwordx4 v14, s[24:27], s42 offen offset:0 lds
    buffer_load_dwordx4 v15, s[24:27], s42 offen offset:1024 lds
    s_add_u32 m0, s40, 106496
    s_nop 0
    buffer_load_dwordx4 v16, s[24:27], s42 offen offset:0 lds
    buffer_load_dwordx4 v17, s[24:27], s42 offen offset:1024 lds
    s_waitcnt vmcnt(24)
    s_barrier
    s_add_u32 m0, s43, 32768
    s_mov_b32 s41, 1280
    buffer_load_dwordx4 v8, s[20:23], s41 offen offset:0 lds
    buffer_load_dwordx4 v9, s[20:23], s41 offen offset:1024 lds
    buffer_load_dwordx4 v10, s[20:23], s41 offen offset:2048 lds
    buffer_load_dwordx4 v11, s[20:23], s41 offen offset:3072 lds
    s_mul_i32 s42, s53, 10
    s_add_u32 m0, s40, 114688
    s_nop 0
    buffer_load_dwordx4 v12, s[24:27], s42 offen offset:0 lds
    buffer_load_dwordx4 v13, s[24:27], s42 offen offset:1024 lds
    s_add_u32 m0, s40, 122880
    s_nop 0
    buffer_load_dwordx4 v14, s[24:27], s42 offen offset:0 lds
    buffer_load_dwordx4 v15, s[24:27], s42 offen offset:1024 lds
    s_add_u32 m0, s40, 131072
    s_nop 0
    buffer_load_dwordx4 v16, s[24:27], s42 offen offset:0 lds
    buffer_load_dwordx4 v17, s[24:27], s42 offen offset:1024 lds
    s_waitcnt vmcnt(22)
    s_barrier
    s_add_u32 m0, s43, 49152
    s_mov_b32 s41, 1408
    buffer_load_dwordx4 v8, s[20:23], s41 offen offset:0 lds
    buffer_load_dwordx4 v9, s[20:23], s41 offen offset:1024 lds
    buffer_load_dwordx4 v10, s[20:23], s41 offen offset:2048 lds
    buffer_load_dwordx4 v11, s[20:23], s41 offen offset:3072 lds
    s_mul_i32 s42, s53, 11
    s_add_u32 m0, s40, 139264
    s_nop 0
    buffer_load_dwordx4 v12, s[24:27], s42 offen offset:0 lds
    buffer_load_dwordx4 v13, s[24:27], s42 offen offset:1024 lds
    s_add_u32 m0, s40, 147456
    s_nop 0
    buffer_load_dwordx4 v14, s[24:27], s42 offen offset:0 lds
    buffer_load_dwordx4 v15, s[24:27], s42 offen offset:1024 lds
    s_add_u32 m0, s40, 155648
    s_nop 0
    buffer_load_dwordx4 v16, s[24:27], s42 offen offset:0 lds
    buffer_load_dwordx4 v17, s[24:27], s42 offen offset:1024 lds
    s_waitcnt vmcnt(20)
    s_barrier
    s_add_u32 m0, s43, 0
    s_mov_b32 s41, 1536
    buffer_load_dwordx4 v8, s[20:23], s41 offen offset:0 lds
    buffer_load_dwordx4 v9, s[20:23], s41 offen offset:1024 lds
    buffer_load_dwordx4 v10, s[20:23], s41 offen offset:2048 lds
    buffer_load_dwordx4 v11, s[20:23], s41 offen offset:3072 lds
    s_mul_i32 s42, s53, 12
    s_add_u32 m0, s40, 65536
    s_nop 0
    buffer_load_dwordx4 v12, s[24:27], s42 offen offset:0 lds
    buffer_load_dwordx4 v13, s[24:27], s42 offen offset:1024 lds
    s_add_u32 m0, s40, 73728
    s_nop 0
    buffer_load_dwordx4 v14, s[24:27], s42 offen offset:0 lds
    buffer_load_dwordx4 v15, s[24:27], s42 offen offset:1024 lds
    s_add_u32 m0, s40, 81920
    s_nop 0
    buffer_load_dwordx4 v16, s[24:27], s42 offen offset:0 lds
    buffer_load_dwordx4 v17, s[24:27], s42 offen offset:1024 lds
    s_waitcnt vmcnt(20)
    s_barrier
    s_add_u32 m0, s43, 16384
    s_mov_b32 s41, 1664
    buffer_load_dwordx4 v8, s[20:23], s41 offen offset:0 lds
    buffer_load_dwordx4 v9, s[20:23], s41 offen offset:1024 lds
    buffer_load_dwordx4 v10, s[20:23], s41 offen offset:2048 lds
    buffer_load_dwordx4 v11, s[20:23], s41 offen offset:3072 lds
    s_mul_i32 s42, s53, 13
    s_add_u32 m0, s40, 90112
    s_nop 0
    buffer_load_dwordx4 v12, s[24:27], s42 offen offset:0 lds
    buffer_load_dwordx4 v13, s[24:27], s42 offen offset:1024 lds
    s_add_u32 m0, s40, 98304
    s_nop 0
    buffer_load_dwordx4 v14, s[24:27], s42 offen offset:0 lds
    buffer_load_dwordx4 v15, s[24:27], s42 offen offset:1024 lds
    s_add_u32 m0, s40, 106496
    s_nop 0
    buffer_load_dwordx4 v16, s[24:27], s42 offen offset:0 lds
    buffer_load_dwordx4 v17, s[24:27], s42 offen offset:1024 lds
    s_waitcnt vmcnt(20)
    s_barrier
    s_add_u32 m0, s43, 32768
    s_mov_b32 s41, 1792
    buffer_load_dwordx4 v8, s[20:23], s41 offen offset:0 lds
    buffer_load_dwordx4 v9, s[20:23], s41 offen offset:1024 lds
    buffer_load_dwordx4 v10, s[20:23], s41 offen offset:2048 lds
    buffer_load_dwordx4 v11, s[20:23], s41 offen offset:3072 lds
    s_mul_i32 s42, s53, 14
    s_add_u32 m0, s40, 114688
    s_nop 0
    buffer_load_dwordx4 v12, s[24:27], s42 offen offset:0 lds
    buffer_load_dwordx4 v13, s[24:27], s42 offen offset:1024 lds
    s_add_u32 m0, s40, 122880
    s_nop 0
    buffer_load_dwordx4 v14, s[24:27], s42 offen offset:0 lds
    buffer_load_dwordx4 v15, s[24:27], s42 offen offset:1024 lds
    s_add_u32 m0, s40, 131072
    s_nop 0
    buffer_load_dwordx4 v16, s[24:27], s42 offen offset:0 lds
    buffer_load_dwordx4 v17, s[24:27], s42 offen offset:1024 lds
    s_waitcnt vmcnt(20)
    s_barrier
    s_add_u32 m0, s43, 49152
    s_mov_b32 s41, 1920
    buffer_load_dwordx4 v8, s[20:23], s41 offen offset:0 lds
    buffer_load_dwordx4 v9, s[20:23], s41 offen offset:1024 lds
    buffer_load_dwordx4 v10, s[20:23], s41 offen offset:2048 lds
    buffer_load_dwordx4 v11, s[20:23], s41 offen offset:3072 lds
    s_mul_i32 s42, s53, 15
    s_add_u32 m0, s40, 139264
    s_nop 0
    buffer_load_dwordx4 v12, s[24:27], s42 offen offset:0 lds
    buffer_load_dwordx4 v13, s[24:27], s42 offen offset:1024 lds
    s_add_u32 m0, s40, 147456
    s_nop 0
    buffer_load_dwordx4 v14, s[24:27], s42 offen offset:0 lds
    buffer_load_dwordx4 v15, s[24:27], s42 offen offset:1024 lds
    s_add_u32 m0, s40, 155648
    s_nop 0
    buffer_load_dwordx4 v16, s[24:27], s42 offen offset:0 lds
    buffer_load_dwordx4 v17, s[24:27], s42 offen offset:1024 lds
    s_waitcnt vmcnt(20)
    s_barrier
    s_lshl_b32 s44, s17, 10
    s_add_u32 m0, s44, 65536
    s_lshl_b32 s45, s15, 12
    s_add_u32 s45, s45, s44
    buffer_load_dwordx4 v18, s[32:35], s45 offen lds
    s_waitcnt vmcnt(11)
    s_getpc_b64 s[48:49]
pfc_3:
    s_add_u32 s48, s48, k1b_kernel-pfc_3
    s_addc_u32 s49, s49, 0
    s_lshr_b32 s50, s2, 3
    s_lshl_b32 s50, s50, 2
    s_add_u32 s50, s50, s17
    s_lshl_b32 s50, s50, 8
    v_and_b32 v84, 3, v2
    v_lshlrev_b32 v84, 6, v84
    v_add_u32 v84, s50, v84
    v_min_u32 v84, k2_kernel_end-k1b_kernel, v84
    global_load_dword v84, v84, s[48:49]
    s_add_u32 s47, s46, 0
    buffer_load_dword v84, v83, s[28:31], s47 offen
    s_add_u32 s47, s46, 0
    buffer_load_dword v84, v83, s[36:39], s47 offen
    s_add_u32 s47, s46, 4194304
    buffer_load_dword v84, v83, s[36:39], s47 offen
    s_barrier
    s_waitcnt vmcnt(5)
    s_barrier
    s_waitcnt vmcnt(4)
    s_barrier
    s_add_u32 s56, s4, 360448
    s_addc_u32 s57, s5, 0
    s_and_b32 s57, s57, 0xffff
    s_mov_b32 s58, 16384
    s_mov_b32 s59, 0x00020000
    s_waitcnt vmcnt(63)
    v_lshlrev_b32 v68, 16, v20
    v_and_b32 v69, s6, v20
    v_lshlrev_b32 v70, 16, v21
    v_and_b32 v71, s6, v21
    v_lshlrev_b32 v72, 16, v22
    v_and_b32 v73, s6, v22
    v_lshlrev_b32 v74, 16, v23
    v_and_b32 v75, s6, v23
    v_mul_f32 v60, v68, v52
    v_mul_f32 v61, v69, v52
    v_mul_f32 v62, v70, v52
    v_mul_f32 v63, v71, v52
    v_mul_f32 v64, v72, v52
    v_mul_f32 v65, v73, v52
    v_mul_f32 v66, v74, v52
    v_mul_f32 v67, v75, v52
    s_waitcnt vmcnt(63)
    v_lshlrev_b32 v68, 16, v24
    v_and_b32 v69, s6, v24
    v_lshlrev_b32 v70, 16, v25
    v_and_b32 v71, s6, v25
    v_lshlrev_b32 v72, 16, v26
    v_and_b32 v73, s6, v26
    v_lshlrev_b32 v74, 16, v27
    v_and_b32 v75, s6, v27
    v_fmac_f32 v60, v68, v53
    v_fmac_f32 v61, v69, v53
    v_fmac_f32 v62, v70, v53
    v_fmac_f32 v63, v71, v53
    v_fmac_f32 v64, v72, v53
    v_fmac_f32 v65, v73, v53
    v_fmac_f32 v66, v74, v53
    v_fmac_f32 v67, v75, v53
    s_waitcnt vmcnt(63)
    v_lshlrev_b32 v68, 16, v28
    v_and_b32 v69, s6, v28
    v_lshlrev_b32 v70, 16, v29
    v_and_b32 v71, s6, v29
    v_lshlrev_b32 v72, 16, v30
    v_and_b32 v73, s6, v30
    v_lshlrev_b32 v74, 16, v31
    v_and_b32 v75, s6, v31
    v_fmac_f32 v60, v68, v54
    v_fmac_f32 v61, v69, v54
    v_fmac_f32 v62, v70, v54
    v_fmac_f32 v63, v71, v54
    v_fmac_f32 v64, v72, v54
    v_fmac_f32 v65, v73, v54
    v_fmac_f32 v66, v74, v54
    v_fmac_f32 v67, v75, v54
    s_waitcnt vmcnt(63)
    v_lshlrev_b32 v68, 16, v32
    v_and_b32 v69, s6, v32
    v_lshlrev_b32 v70, 16, v33
    v_and_b32 v71, s6, v33
    v_lshlrev_b32 v72, 16, v34
    v_and_b32 v73, s6, v34
    v_lshlrev_b32 v74, 16, v35
    v_and_b32 v75, s6, v35
    v_fmac_f32 v60, v68, v55
    v_fmac_f32 v61, v69, v55
    v_fmac_f32 v62, v70, v55
    v_fmac_f32 v63, v71, v55
    v_fmac_f32 v64, v72, v55
    v_fmac_f32 v65, v73, v55
    v_fmac_f32 v66, v74, v55
    v_fmac_f32 v67, v75, v55
    s_waitcnt vmcnt(63)
    v_lshlrev_b32 v68, 16, v36
    v_and_b32 v69, s6, v36
    v_lshlrev_b32 v70, 16, v37
    v_and_b32 v71, s6, v37
    v_lshlrev_b32 v72, 16, v38
    v_and_b32 v73, s6, v38
    v_lshlrev_b32 v74, 16, v39
    v_and_b32 v75, s6, v39
    v_fmac_f32 v60, v68, v56
    v_fmac_f32 v61, v69, v56
    v_fmac_f32 v62, v70, v56
    v_fmac_f32 v63, v71, v56
    v_fmac_f32 v64, v72, v56
    v_fmac_f32 v65, v73, v56
    v_fmac_f32 v66, v74, v56
    v_fmac_f32 v67, v75, v56
    s_waitcnt vmcnt(63)
    v_lshlrev_b32 v68, 16, v40
    v_and_b32 v69, s6, v40
    v_lshlrev_b32 v70, 16, v41
    v_and_b32 v71, s6, v41
    v_lshlrev_b32 v72, 16, v42
    v_and_b32 v73, s6, v42
    v_lshlrev_b32 v74, 16, v43
    v_and_b32 v75, s6, v43
    v_fmac_f32 v60, v68, v57
    v_fmac_f32 v61, v69, v57
    v_fmac_f32 v62, v70, v57
    v_fmac_f32 v63, v71, v57
    v_fmac_f32 v64, v72, v57
    v_fmac_f32 v65, v73, v57
    v_fmac_f32 v66, v74, v57
    v_fmac_f32 v67, v75, v57
    s_waitcnt vmcnt(63)
    v_lshlrev_b32 v68, 16, v44
    v_and_b32 v69, s6, v44
    v_lshlrev_b32 v70, 16, v45
    v_and_b32 v71, s6, v45
    v_lshlrev_b32 v72, 16, v46
    v_and_b32 v73, s6, v46
    v_lshlrev_b32 v74, 16, v47
    v_and_b32 v75, s6, v47
    v_fmac_f32 v60, v68, v58
    v_fmac_f32 v61, v69, v58
    v_fmac_f32 v62, v70, v58
    v_fmac_f32 v63, v71, v58
    v_fmac_f32 v64, v72, v58
    v_fmac_f32 v65, v73, v58
    v_fmac_f32 v66, v74, v58
    v_fmac_f32 v67, v75, v58
    s_waitcnt vmcnt(63)
    v_lshlrev_b32 v68, 16, v48
    v_and_b32 v69, s6, v48
    v_lshlrev_b32 v70, 16, v49
    v_and_b32 v71, s6, v49
    v_lshlrev_b32 v72, 16, v50
    v_and_b32 v73, s6, v50
    v_lshlrev_b32 v74, 16, v51
    v_and_b32 v75, s6, v51
    v_fmac_f32 v60, v68, v59
    v_fmac_f32 v61, v69, v59
    v_fmac_f32 v62, v70, v59
    v_fmac_f32 v63, v71, v59
    v_fmac_f32 v64, v72, v59
    v_fmac_f32 v65, v73, v59
    v_fmac_f32 v66, v74, v59
    v_fmac_f32 v67, v75, v59
    v_permlane32_swap_b32 v60, v61
    v_permlane32_swap_b32 v62, v63
    v_permlane32_swap_b32 v64, v65
    v_permlane32_swap_b32 v66, v67
    v_add_f32 v60, v60, v61
    v_add_f32 v62, v62, v63
    v_add_f32 v64, v64, v65
    v_add_f32 v66, v66, v67
    v_permlane16_swap_b32 v60, v62
    s_nop 0
    v_permlane16_swap_b32 v64, v66
    v_add_f32 v60, v60, v62
    v_add_f32 v64, v64, v66
    s_nop 0
    v_add_f32_dpp v60, v60, v60 row_ror:8 row_mask:0xf bank_mask:0xf
    s_nop 1
    v_add_f32_dpp v60, v64, v64 row_ror:8 row_mask:0xf bank_mask:0xc
    s_lshl_b32 s60, s54, 8
    buffer_atomic_add_f32 v60, v82, s[56:59], s60 offen
    s_barrier
k1_kernel_end:
    s_endpgm
.text
.globl k1b_kernel
.p2align 8
.type k1b_kernel,@function
k1b_kernel:
    s_cmp_ge_u32 s2, 480
    s_cbranch_scc1 k1b_kernel_end
    v_lshrrev_b32 v1, 6, v0
    s_nop 0
    v_readfirstlane_b32 s16, v1
    s_load_dwordx2 s[4:5], s[0:1], 104
    s_load_dwordx2 s[8:9], s[0:1], 40
    s_cmp_lt_u32 s2, 256
    s_cbranch_scc1 k1b_main
    s_sub_u32 s40, s2, 256
    s_and_b32 s17, s40, 7
    s_mul_i32 s17, s17, 7
    s_lshr_b32 s18, s40, 3
    s_mul_i32 s19, s18, 37
    s_lshr_b32 s19, s19, 8
    s_mul_i32 s3, s19, 7
    s_sub_u32 s3, s18, s3
    s_add_u32 s3, s3, s17
    v_and_b32 v1, 63, v0
    v_lshrrev_b32 v3, 3, v0
    v_lshlrev_b32 v3, 2, v3
    s_lshl_b32 s19, s19, 8
    v_add_u32 v3, s19, v3
    v_lshlrev_b32 v4, 2, v3
    s_movk_i32 s18, 7168
    v_mul_lo_u32 v5, v3, s18
    v_and_b32 v6, 7, v0
    v_lshl_add_u32 v5, v6, 4, v5
    s_lshl_b32 s19, s3, 7
    s_mov_b32 s22, 7340032
    s_mov_b32 s23, 0x00020000
    s_waitcnt lgkmcnt(0)
    s_mov_b32 s20, s8
    s_and_b32 s21, s9, 0xffff
    s_add_u32 s24, s4, 364544
    s_addc_u32 s25, s5, 0
    s_and_b32 s25, s25, 0xffff
    s_mov_b32 s26, 8192
    s_mov_b32 s27, 0x00020000
    buffer_load_dwordx4 v[12:15], v4, s[24:27], 0 offen
    s_movk_i32 s17, 4096
    buffer_load_dwordx4 v[8:11], v4, s[24:27], s17 offen
    s_add_u32 s36, s4, 16384
    s_addc_u32 s37, s5, 0
    s_and_b32 s37, s37, 0xffff
    s_mov_b32 s38, 4096
    s_mov_b32 s39, 0x00020000
    v_lshlrev_b32 v24, 2, v1
    s_lshl_b32 s40, s40, 8
    s_add_u32 s41, s40, 4096
    buffer_load_dword v16, v24, s[24:27], s41 offen
    buffer_load_dwordx4 v[64:67], v5, s[20:23], s19 offen
    s_add_u32 s19, s19, s18
    buffer_load_dwordx4 v[68:71], v5, s[20:23], s19 offen
    s_add_u32 s19, s19, s18
    buffer_load_dwordx4 v[72:75], v5, s[20:23], s19 offen
    s_add_u32 s19, s19, s18
    buffer_load_dwordx4 v[76:79], v5, s[20:23], s19 offen
    s_add_u32 s28, s4, 98304
    s_addc_u32 s29, s5, 0
    s_and_b32 s29, s29, 0xffff
    s_mov_b32 s30, 28672
    s_mov_b32 s31, 0x00020000
    s_mov_b32 s18, 0xffff0000
    v_and_b32 v7, 7, v1
    v_lshlrev_b32 v7, 5, v7
    v_bfe_u32 v17, v1, 3, 1
    v_lshl_add_u32 v7, v17, 4, v7
    v_bfe_u32 v17, v1, 4, 1
    v_lshl_add_u32 v7, v17, 3, v7
    v_bfe_u32 v17, v1, 5, 1
    v_lshl_add_u32 v7, v17, 2, v7
    s_lshl_b32 s17, s16, 9
    v_add_u32 v7, s17, v7
    s_waitcnt vmcnt(4)
    v_cvt_pk_bf16_f32 v48, v8, v9
    v_cvt_pk_bf16_f32 v50, v10, v11
    v_cvt_pk_bf16_f32 v52, v12, v13
    v_cvt_pk_bf16_f32 v54, v14, v15
    v_cvt_pk_bf16_f32 v16, v16, v16
    v_lshlrev_b32 v8, 16, v48
    v_and_b32 v9, s18, v48
    v_lshlrev_b32 v10, 16, v50
    v_and_b32 v11, s18, v50
    v_lshlrev_b32 v12, 16, v52
    v_and_b32 v13, s18, v52
    v_lshlrev_b32 v14, 16, v54
    v_and_b32 v15, s18, v54
    v_and_b32 v16, s18, v16
    v_add_f32 v8, 1.0, v8
    v_add_f32 v9, 1.0, v9
    v_add_f32 v10, 1.0, v10
    v_add_f32 v11, 1.0, v11
    v_add_f32 v16, 1.0, v16
    v_cvt_pk_bf16_f32 v48, v8, v9
    v_cvt_pk_bf16_f32 v50, v10, v11
    v_cvt_pk_bf16_f32 v16, v16, v16
    v_lshlrev_b32 v8, 16, v48
    v_and_b32 v9, s18, v48
    v_lshlrev_b32 v10, 16, v50
    v_and_b32 v11, s18, v50
    v_and_b32 v16, s18, v16
    buffer_store_dword v16, v24, s[36:39], s40 offen
    s_waitcnt vmcnt(4)
    v_lshlrev_b32 v48, 16, v64
    v_and_b32 v49, s18, v64
    v_lshlrev_b32 v50, 16, v65
    v_and_b32 v51, s18, v65
    v_lshlrev_b32 v52, 16, v66
    v_and_b32 v53, s18, v66
    v_lshlrev_b32 v54, 16, v67
    v_and_b32 v55, s18, v67
    v_mul_f32 v32, v48, v8
    v_mul_f32 v33, v49, v8
    v_mul_f32 v34, v50, v8
    v_mul_f32 v35, v51, v8
    v_mul_f32 v36, v52, v8
    v_mul_f32 v37, v53, v8
    v_mul_f32 v38, v54, v8
    v_mul_f32 v39, v55, v8
    v_mul_f32 v40, v48, v12
    v_mul_f32 v41, v49, v12
    v_mul_f32 v42, v50, v12
    v_mul_f32 v43, v51, v12
    v_mul_f32 v44, v52, v12
    v_mul_f32 v45, v53, v12
    v_mul_f32 v46, v54, v12
    v_mul_f32 v47, v55, v12
    s_waitcnt vmcnt(3)
    v_lshlrev_b32 v48, 16, v68
    v_and_b32 v49, s18, v68
    v_lshlrev_b32 v50, 16, v69
    v_and_b32 v51, s18, v69
    v_lshlrev_b32 v52, 16, v70
    v_and_b32 v53, s18, v70
    v_lshlrev_b32 v54, 16, v71
    v_and_b32 v55, s18, v71
    v_fmac_f32 v32, v48, v9
    v_fmac_f32 v33, v49, v9
    v_fmac_f32 v34, v50, v9
    v_fmac_f32 v35, v51, v9
    v_fmac_f32 v36, v52, v9
    v_fmac_f32 v37, v53, v9
    v_fmac_f32 v38, v54, v9
    v_fmac_f32 v39, v55, v9
    v_fmac_f32 v40, v48, v13
    v_fmac_f32 v41, v49, v13
    v_fmac_f32 v42, v50, v13
    v_fmac_f32 v43, v51, v13
    v_fmac_f32 v44, v52, v13
    v_fmac_f32 v45, v53, v13
    v_fmac_f32 v46, v54, v13
    v_fmac_f32 v47, v55, v13
    s_waitcnt vmcnt(2)
    v_lshlrev_b32 v48, 16, v72
    v_and_b32 v49, s18, v72
    v_lshlrev_b32 v50, 16, v73
    v_and_b32 v51, s18, v73
    v_lshlrev_b32 v52, 16, v74
    v_and_b32 v53, s18, v74
    v_lshlrev_b32 v54, 16, v75
    v_and_b32 v55, s18, v75
    v_fmac_f32 v32, v48, v10
    v_fmac_f32 v33, v49, v10
    v_fmac_f32 v34, v50, v10
    v_fmac_f32 v35, v51, v10
    v_fmac_f32 v36, v52, v10
    v_fmac_f32 v37, v53, v10
    v_fmac_f32 v38, v54, v10
    v_fmac_f32 v39, v55, v10
    v_fmac_f32 v40, v48, v14
    v_fmac_f32 v41, v49, v14
    v_fmac_f32 v42, v50, v14
    v_fmac_f32 v43, v51, v14
    v_fmac_f32 v44, v52, v14
    v_fmac_f32 v45, v53, v14
    v_fmac_f32 v46, v54, v14
    v_fmac_f32 v47, v55, v14
    s_waitcnt vmcnt(1)
    v_lshlrev_b32 v48, 16, v76
    v_and_b32 v49, s18, v76
    v_lshlrev_b32 v50, 16, v77
    v_and_b32 v51, s18, v77
    v_lshlrev_b32 v52, 16, v78
    v_and_b32 v53, s18, v78
    v_lshlrev_b32 v54, 16, v79
    v_and_b32 v55, s18, v79
    v_fmac_f32 v32, v48, v11
    v_fmac_f32 v33, v49, v11
    v_fmac_f32 v34, v50, v11
    v_fmac_f32 v35, v51, v11
    v_fmac_f32 v36, v52, v11
    v_fmac_f32 v37, v53, v11
    v_fmac_f32 v38, v54, v11
    v_fmac_f32 v39, v55, v11
    v_fmac_f32 v40, v48, v15
    v_fmac_f32 v41, v49, v15
    v_fmac_f32 v42, v50, v15
    v_fmac_f32 v43, v51, v15
    v_fmac_f32 v44, v52, v15
    v_fmac_f32 v45, v53, v15
    v_fmac_f32 v46, v54, v15
    v_fmac_f32 v47, v55, v15
    v_permlane32_swap_b32 v32, v33
    v_permlane32_swap_b32 v34, v35
    v_permlane32_swap_b32 v36, v37
    v_permlane32_swap_b32 v38, v39
    v_permlane32_swap_b32 v40, v41
    v_permlane32_swap_b32 v42, v43
    v_permlane32_swap_b32 v44, v45
    v_permlane32_swap_b32 v46, v47
    v_add_f32 v32, v32, v33
    v_add_f32 v34, v34, v35
    v_add_f32 v36, v36, v37
    v_add_f32 v38, v38, v39
    v_add_f32 v40, v40, v41
    v_add_f32 v42, v42, v43
    v_add_f32 v44, v44, v45
    v_add_f32 v46, v46, v47
    v_permlane16_swap_b32 v32, v34
    v_permlane16_swap_b32 v36, v38
    v_permlane16_swap_b32 v40, v42
    v_permlane16_swap_b32 v44, v46
    v_add_f32 v32, v32, v34
    v_add_f32 v36, v36, v38
    v_add_f32 v40, v40, v42
    v_add_f32 v44, v44, v46
    v_add_f32_dpp v32, v32, v32 row_ror:8 row_mask:0xf bank_mask:0xf
    v_add_f32_dpp v40, v40, v40 row_ror:8 row_mask:0xf bank_mask:0xf
    s_nop 0
    v_add_f32_dpp v32, v36, v36 row_ror:8 row_mask:0xf bank_mask:0xc
    v_add_f32_dpp v40, v44, v44 row_ror:8 row_mask:0xf bank_mask:0xc
    ds_write2st64_b32 v7, v32, v40 offset0:0 offset1:1
    s_waitcnt lgkmcnt(0)
    s_barrier
    s_cmp_ge_u32 s16, 2
    s_cbranch_scc1 k1b_kernel_end
    v_lshlrev_b32 v7, 2, v0
    ds_read2st64_b32 v[8:9], v7 offset0:0 offset1:2
    ds_read2st64_b32 v[10:11], v7 offset0:4 offset1:6
    ds_read2st64_b32 v[12:13], v7 offset0:8 offset1:10
    ds_read2st64_b32 v[14:15], v7 offset0:12 offset1:14
    s_mul_i32 s17, s16, 14336
    s_lshl_b32 s19, s3, 8
    s_add_u32 s17, s17, s19
    s_waitcnt lgkmcnt(0)
    v_add_f32 v8, v8, v9
    v_add_f32 v10, v10, v11
    v_add_f32 v12, v12, v13
    v_add_f32 v14, v14, v15
    v_add_f32 v8, v8, v10
    v_add_f32 v12, v12, v14
    v_add_f32 v8, v8, v12
    buffer_atomic_add_f32 v8, v24, s[28:31], s17 offen
    s_endpgm
k1b_main:
    s_and_b32 s3, s2, 7
    s_lshr_b32 s6, s2, 3
    s_lshr_b32 s14, s3, 1
    s_lshl_b32 s14, s14, 3
    s_and_b32 s7, s6, 7
    s_add_u32 s14, s14, s7
    s_and_b32 s15, s3, 1
    s_lshl_b32 s15, s15, 2
    s_lshr_b32 s7, s6, 3
    s_add_u32 s15, s15, s7
    s_lshl_b32 s15, s15, 4
    s_lshl_b32 s7, s16, 1
    s_add_u32 s15, s15, s7
    s_lshl_b32 s17, s15, 5
    s_add_u32 s17, s17, s14
    s_lshl_b32 s17, s17, 10
    s_add_u32 s18, s17, 32768
    s_lshl_b32 s19, s14, 16
    s_lshr_b32 s7, s16, 2
    s_lshl_b32 s7, s7, 15
    s_add_u32 s19, s19, s7
    s_and_b32 s7, s16, 3
    s_lshl_b32 s7, s7, 10
    s_add_u32 s19, s19, s7
    s_lshl_b32 s20, s14, 12
    v_and_b32 v12, 63, v0
    v_lshlrev_b32 v5, 4, v12
    v_lshrrev_b32 v14, 2, v12
    v_lshlrev_b32 v14, 8, v14
    v_and_b32 v1, 3, v0
    v_lshl_add_u32 v14, v1, 3, v14
    s_lshl_b32 s7, s16, 5
    s_add_u32 s20, s20, s7
    s_waitcnt lgkmcnt(0)
    s_add_u32 s24, s4, 5242880
    s_addc_u32 s25, s5, 0
    s_and_b32 s25, s25, 0xffff
    s_mov_b32 s26, 4194304
    s_mov_b32 s27, 0x00020000
    s_add_u32 s28, s4, 1048576
    s_addc_u32 s29, s5, 0
    s_and_b32 s29, s29, 0xffff
    s_mov_b32 s30, 4194304
    s_mov_b32 s31, 0x00020000
    s_add_u32 s32, s4, 131072
    s_addc_u32 s33, s5, 0
    s_and_b32 s33, s33, 0xffff
    s_mov_b32 s34, 131072
    s_mov_b32 s35, 0x00020000
    s_add_u32 s36, s4, 9437184
    s_addc_u32 s37, s5, 0
    s_and_b32 s37, s37, 0xffff
    s_mov_b32 s38, 4194304
    s_mov_b32 s39, 0x00020000
    buffer_load_dwordx4 v[28:31], v5, s[24:27], s17 offen
    buffer_load_dwordx4 v[32:35], v5, s[24:27], s18 offen
    buffer_load_dwordx2 v[2:3], v14, s[32:35], s20 offen
    buffer_load_dwordx4 v[64:67], v5, s[28:31], s19 offen
    s_add_u32 s19, s19, 4096
    buffer_load_dwordx4 v[72:75], v5, s[28:31], s19 offen
    s_add_u32 s19, s19, 4096
    buffer_load_dwordx4 v[80:83], v5, s[28:31], s19 offen
    s_add_u32 s19, s19, 4096
    buffer_load_dwordx4 v[88:91], v5, s[28:31], s19 offen
    s_add_u32 s19, s19, 4096
    buffer_load_dwordx4 v[96:99], v5, s[28:31], s19 offen
    s_add_u32 s19, s19, 4096
    buffer_load_dwordx4 v[104:107], v5, s[28:31], s19 offen
    s_add_u32 s19, s19, 4096
    buffer_load_dwordx4 v[112:115], v5, s[28:31], s19 offen
    s_add_u32 s19, s19, 4096
    buffer_load_dwordx4 v[120:123], v5, s[28:31], s19 offen
    s_mov_b32 s52, 0x3fb8aa3b
    s_mov_b32 s53, 0x3fb8aa3b
    s_mov_b32 s21, 0xffff0000
    v_bfe_u32 v13, v0, 4, 2
    v_lshlrev_b32 v7, 15, v13
    v_and_b32 v12, 15, v0
    v_lshl_add_u32 v7, v12, 4, v7
    s_lshl_b32 s22, s14, 17
    s_lshl_b32 s7, s15, 8
    s_add_u32 s22, s22, s7
    s_and_b32 s7, s16, 3
    s_lshl_b32 s7, s7, 10
    s_lshr_b32 s23, s16, 2
    s_mul_i32 s23, s23, 4608
    s_add_u32 s7, s7, s23
    v_add_u32 v9, s7, v5
    s_lshl_b32 s7, s16, 4
    v_lshlrev_b32 v1, 2, v1
    v_add_u32 v1, s7, v1
    v_lshlrev_b32 v11, 4, v13
    s_waitcnt vmcnt(9)
    v_lshlrev_b32 v12, 16, v28
    v_and_b32 v13, s21, v28
    v_lshlrev_b32 v14, 16, v29
    v_and_b32 v15, s21, v29
    v_lshlrev_b32 v16, 16, v30
    v_and_b32 v17, s21, v30
    v_lshlrev_b32 v18, 16, v31
    v_and_b32 v19, s21, v31
    v_lshlrev_b32 v20, 16, v32
    v_and_b32 v21, s21, v32
    v_lshlrev_b32 v22, 16, v33
    v_and_b32 v23, s21, v33
    v_lshlrev_b32 v24, 16, v34
    v_and_b32 v25, s21, v34
    v_lshlrev_b32 v26, 16, v35
    v_and_b32 v27, s21, v35
    v_max3_f32 v4, v12, v13, v14
    v_min3_f32 v6, v12, v13, v14
    v_max3_f32 v4, v4, v15, v16
    v_min3_f32 v6, v6, v15, v16
    v_max3_f32 v4, v4, v17, v18
    v_min3_f32 v6, v6, v17, v18
    v_max_f32 v4, v4, v19
    v_min_f32 v6, v6, v19
    v_mul_f32 v4, 0x3fb8aa3b, v4
    v_mul_f32 v6, 0xbfb8aa3b, v6
    v_max3_f32 v8, v20, v21, v22
    v_min3_f32 v10, v20, v21, v22
    v_max3_f32 v8, v8, v23, v24
    v_min3_f32 v10, v10, v23, v24
    v_max3_f32 v8, v8, v25, v26
    v_min3_f32 v10, v10, v25, v26
    v_max_f32 v8, v8, v27
    v_min_f32 v10, v10, v27
    v_mul_f32 v8, 0x3fb8aa3b, v8
    v_mul_f32 v10, 0xbfb8aa3b, v10
    v_permlane32_swap_b32 v4, v6
    s_nop 0
    v_permlane32_swap_b32 v8, v10
    v_max_f32 v4, v4, v6
    v_max_f32 v8, v8, v10
    s_nop 1
    v_permlane16_swap_b32 v4, v8
    v_max_f32 v4, v4, v8
    v_mov_b32 v8, v4
    s_nop 1
    v_permlane16_swap_b32 v4, v8
    v_mov_b32 v6, v4
    v_mov_b32 v10, v8
    s_nop 0
    v_permlane32_swap_b32 v4, v6
    v_permlane32_swap_b32 v8, v10
    v_pk_fma_f32 v[28:29], v[12:13], s[52:53], v[4:5] op_sel_hi:[1,0,0] neg_lo:[0,0,1] neg_hi:[0,0,1]
    v_pk_fma_f32 v[44:45], v[12:13], s[52:53], v[6:7] op_sel_hi:[1,0,0] neg_lo:[1,0,1] neg_hi:[1,0,1]
    v_pk_fma_f32 v[30:31], v[14:15], s[52:53], v[4:5] op_sel_hi:[1,0,0] neg_lo:[0,0,1] neg_hi:[0,0,1]
    v_pk_fma_f32 v[46:47], v[14:15], s[52:53], v[6:7] op_sel_hi:[1,0,0] neg_lo:[1,0,1] neg_hi:[1,0,1]
    v_pk_fma_f32 v[32:33], v[16:17], s[52:53], v[4:5] op_sel_hi:[1,0,0] neg_lo:[0,0,1] neg_hi:[0,0,1]
    v_pk_fma_f32 v[48:49], v[16:17], s[52:53], v[6:7] op_sel_hi:[1,0,0] neg_lo:[1,0,1] neg_hi:[1,0,1]
    v_pk_fma_f32 v[34:35], v[18:19], s[52:53], v[4:5] op_sel_hi:[1,0,0] neg_lo:[0,0,1] neg_hi:[0,0,1]
    v_pk_fma_f32 v[50:51], v[18:19], s[52:53], v[6:7] op_sel_hi:[1,0,0] neg_lo:[1,0,1] neg_hi:[1,0,1]
    v_pk_fma_f32 v[36:37], v[20:21], s[52:53], v[8:9] op_sel_hi:[1,0,0] neg_lo:[0,0,1] neg_hi:[0,0,1]
    v_pk_fma_f32 v[52:53], v[20:21], s[52:53], v[10:11] op_sel_hi:[1,0,0] neg_lo:[1,0,1] neg_hi:[1,0,1]
    v_pk_fma_f32 v[38:39], v[22:23], s[52:53], v[8:9] op_sel_hi:[1,0,0] neg_lo:[0,0,1] neg_hi:[0,0,1]
    v_pk_fma_f32 v[54:55], v[22:23], s[52:53], v[10:11] op_sel_hi:[1,0,0] neg_lo:[1,0,1] neg_hi:[1,0,1]
    v_pk_fma_f32 v[40:41], v[24:25], s[52:53], v[8:9] op_sel_hi:[1,0,0] neg_lo:[0,0,1] neg_hi:[0,0,1]
    v_pk_fma_f32 v[56:57], v[24:25], s[52:53], v[10:11] op_sel_hi:[1,0,0] neg_lo:[1,0,1] neg_hi:[1,0,1]
    v_pk_fma_f32 v[42:43], v[26:27], s[52:53], v[8:9] op_sel_hi:[1,0,0] neg_lo:[0,0,1] neg_hi:[0,0,1]
    v_pk_fma_f32 v[58:59], v[26:27], s[52:53], v[10:11] op_sel_hi:[1,0,0] neg_lo:[1,0,1] neg_hi:[1,0,1]
    v_exp_f32 v28, v28
    v_exp_f32 v44, v44
    v_exp_f32 v29, v29
    v_exp_f32 v45, v45
    v_exp_f32 v30, v30
    v_exp_f32 v46, v46
    v_exp_f32 v31, v31
    v_exp_f32 v47, v47
    v_exp_f32 v32, v32
    v_exp_f32 v48, v48
    v_exp_f32 v33, v33
    v_exp_f32 v49, v49
    v_exp_f32 v34, v34
    v_exp_f32 v50, v50
    v_exp_f32 v35, v35
    v_exp_f32 v51, v51
    v_exp_f32 v36, v36
    v_exp_f32 v52, v52
    v_exp_f32 v37, v37
    v_exp_f32 v53, v53
    v_exp_f32 v38, v38
    v_exp_f32 v54, v54
    v_exp_f32 v39, v39
    v_exp_f32 v55, v55
    v_exp_f32 v40, v40
    v_exp_f32 v56, v56
    v_exp_f32 v41, v41
    v_exp_f32 v57, v57
    v_exp_f32 v42, v42
    v_exp_f32 v58, v58
    v_exp_f32 v43, v43
    v_exp_f32 v59, v59
    v_pk_add_f32 v[12:13], v[28:29], v[30:31]
    v_pk_add_f32 v[14:15], v[32:33], v[34:35]
    v_pk_add_f32 v[16:17], v[44:45], v[46:47]
    v_pk_add_f32 v[18:19], v[48:49], v[50:51]
    v_pk_add_f32 v[20:21], v[36:37], v[38:39]
    v_pk_add_f32 v[22:23], v[40:41], v[42:43]
    v_pk_add_f32 v[24:25], v[52:53], v[54:55]
    v_pk_add_f32 v[26:27], v[56:57], v[58:59]
    v_pk_add_f32 v[12:13], v[12:13], v[14:15]
    v_pk_add_f32 v[16:17], v[16:17], v[18:19]
    v_pk_add_f32 v[20:21], v[20:21], v[22:23]
    v_pk_add_f32 v[24:25], v[24:25], v[26:27]
    v_add_f32 v4, v12, v13
    v_add_f32 v6, v16, v17
    v_add_f32 v8, v20, v21
    v_add_f32 v10, v24, v25
    v_permlane32_swap_b32 v4, v6
    s_nop 0
    v_permlane32_swap_b32 v8, v10
    v_add_f32 v4, v4, v6
    v_add_f32 v8, v8, v10
    s_nop 1
    v_permlane16_swap_b32 v4, v8
    v_add_f32 v4, v4, v8
    v_mov_b32 v8, v4
    s_nop 1
    v_permlane16_swap_b32 v4, v8
    v_mov_b32 v6, v4
    v_mov_b32 v10, v8
    s_nop 0
    v_permlane32_swap_b32 v4, v6
    v_permlane32_swap_b32 v8, v10
    v_rcp_f32 v4, v4
    v_rcp_f32 v6, v6
    v_rcp_f32 v8, v8
    v_rcp_f32 v10, v10
    v_pk_mul_f32 v[28:29], v[28:29], v[4:5] op_sel_hi:[1,0]
    v_pk_mul_f32 v[44:45], v[44:45], v[6:7] op_sel_hi:[1,0]
    v_pk_mul_f32 v[30:31], v[30:31], v[4:5] op_sel_hi:[1,0]
    v_pk_mul_f32 v[46:47], v[46:47], v[6:7] op_sel_hi:[1,0]
    v_pk_mul_f32 v[32:33], v[32:33], v[4:5] op_sel_hi:[1,0]
    v_pk_mul_f32 v[48:49], v[48:49], v[6:7] op_sel_hi:[1,0]
    v_pk_mul_f32 v[34:35], v[34:35], v[4:5] op_sel_hi:[1,0]
    v_pk_mul_f32 v[50:51], v[50:51], v[6:7] op_sel_hi:[1,0]
    v_pk_mul_f32 v[36:37], v[36:37], v[8:9] op_sel_hi:[1,0]
    v_pk_mul_f32 v[52:53], v[52:53], v[10:11] op_sel_hi:[1,0]
    v_pk_mul_f32 v[38:39], v[38:39], v[8:9] op_sel_hi:[1,0]
    v_pk_mul_f32 v[54:55], v[54:55], v[10:11] op_sel_hi:[1,0]
    v_pk_mul_f32 v[40:41], v[40:41], v[8:9] op_sel_hi:[1,0]
    v_pk_mul_f32 v[56:57], v[56:57], v[10:11] op_sel_hi:[1,0]
    v_pk_mul_f32 v[42:43], v[42:43], v[8:9] op_sel_hi:[1,0]
    v_pk_mul_f32 v[58:59], v[58:59], v[10:11] op_sel_hi:[1,0]
    v_cvt_pk_bf16_f32 v12, v28, v29
    v_cvt_pk_bf16_f32 v16, v44, v45
    v_cvt_pk_bf16_f32 v13, v30, v31
    v_cvt_pk_bf16_f32 v17, v46, v47
    v_cvt_pk_bf16_f32 v14, v32, v33
    v_cvt_pk_bf16_f32 v18, v48, v49
    v_cvt_pk_bf16_f32 v15, v34, v35
    v_cvt_pk_bf16_f32 v19, v50, v51
    v_cvt_pk_bf16_f32 v20, v36, v37
    v_cvt_pk_bf16_f32 v24, v52, v53
    v_cvt_pk_bf16_f32 v21, v38, v39
    v_cvt_pk_bf16_f32 v25, v54, v55
    v_cvt_pk_bf16_f32 v22, v40, v41
    v_cvt_pk_bf16_f32 v26, v56, v57
    v_cvt_pk_bf16_f32 v23, v42, v43
    v_cvt_pk_bf16_f32 v27, v58, v59
    s_waitcnt vmcnt(8)
    v_add_f32_dpp v2, v2, v2 row_ror:4 row_mask:0xf bank_mask:0xf
    v_add_f32_dpp v3, v3, v3 row_ror:4 row_mask:0xf bank_mask:0xf
    s_nop 0
    v_add_f32_dpp v2, v2, v2 row_ror:8 row_mask:0xf bank_mask:0xf
    v_add_f32_dpp v3, v3, v3 row_ror:8 row_mask:0xf bank_mask:0xf
    s_nop 1
    v_permlane32_swap_b32 v2, v3
    v_add_f32 v2, v2, v3
    v_mov_b32 v3, v2
    s_nop 1
    v_permlane16_swap_b32 v2, v3
    v_add_f32 v2, v2, v3
    v_mov_b32 v3, v2
    s_nop 1
    v_permlane32_swap_b32 v2, v3
    v_cvt_pk_bf16_f32 v2, v2, v3
    ds_write_b32 v1, v2 offset:4096
    s_waitcnt vmcnt(7)
    v_lshlrev_b32 v60, 16, v64
    v_and_b32 v61, s21, v64
    v_lshlrev_b32 v62, 16, v65
    v_and_b32 v63, s21, v65
    v_lshlrev_b32 v64, 16, v66
    v_and_b32 v65, s21, v66
    v_lshlrev_b32 v66, 16, v67
    v_and_b32 v67, s21, v67
    s_waitcnt vmcnt(6)
    v_lshlrev_b32 v68, 16, v72
    v_and_b32 v69, s21, v72
    v_lshlrev_b32 v70, 16, v73
    v_and_b32 v71, s21, v73
    v_lshlrev_b32 v72, 16, v74
    v_and_b32 v73, s21, v74
    v_lshlrev_b32 v74, 16, v75
    v_and_b32 v75, s21, v75
    v_pk_add_f32 v[60:61], v[60:61], v[68:69]
    v_pk_add_f32 v[62:63], v[62:63], v[70:71]
    v_pk_add_f32 v[64:65], v[64:65], v[72:73]
    v_pk_add_f32 v[66:67], v[66:67], v[74:75]
    s_waitcnt vmcnt(5)
    v_lshlrev_b32 v76, 16, v80
    v_and_b32 v77, s21, v80
    v_lshlrev_b32 v78, 16, v81
    v_and_b32 v79, s21, v81
    v_lshlrev_b32 v80, 16, v82
    v_and_b32 v81, s21, v82
    v_lshlrev_b32 v82, 16, v83
    v_and_b32 v83, s21, v83
    v_pk_add_f32 v[60:61], v[60:61], v[76:77]
    v_pk_add_f32 v[62:63], v[62:63], v[78:79]
    v_pk_add_f32 v[64:65], v[64:65], v[80:81]
    v_pk_add_f32 v[66:67], v[66:67], v[82:83]
    s_waitcnt vmcnt(4)
    v_lshlrev_b32 v84, 16, v88
    v_and_b32 v85, s21, v88
    v_lshlrev_b32 v86, 16, v89
    v_and_b32 v87, s21, v89
    v_lshlrev_b32 v88, 16, v90
    v_and_b32 v89, s21, v90
    v_lshlrev_b32 v90, 16, v91
    v_and_b32 v91, s21, v91
    v_pk_add_f32 v[60:61], v[60:61], v[84:85]
    v_pk_add_f32 v[62:63], v[62:63], v[86:87]
    v_pk_add_f32 v[64:65], v[64:65], v[88:89]
    v_pk_add_f32 v[66:67], v[66:67], v[90:91]
    s_waitcnt vmcnt(3)
    v_lshlrev_b32 v92, 16, v96
    v_and_b32 v93, s21, v96
    v_lshlrev_b32 v94, 16, v97
    v_and_b32 v95, s21, v97
    v_lshlrev_b32 v96, 16, v98
    v_and_b32 v97, s21, v98
    v_lshlrev_b32 v98, 16, v99
    v_and_b32 v99, s21, v99
    v_pk_add_f32 v[60:61], v[60:61], v[92:93]
    v_pk_add_f32 v[62:63], v[62:63], v[94:95]
    v_pk_add_f32 v[64:65], v[64:65], v[96:97]
    v_pk_add_f32 v[66:67], v[66:67], v[98:99]
    s_waitcnt vmcnt(2)
    v_lshlrev_b32 v100, 16, v104
    v_and_b32 v101, s21, v104
    v_lshlrev_b32 v102, 16, v105
    v_and_b32 v103, s21, v105
    v_lshlrev_b32 v104, 16, v106
    v_and_b32 v105, s21, v106
    v_lshlrev_b32 v106, 16, v107
    v_and_b32 v107, s21, v107
    v_pk_add_f32 v[60:61], v[60:61], v[100:101]
    v_pk_add_f32 v[62:63], v[62:63], v[102:103]
    v_pk_add_f32 v[64:65], v[64:65], v[104:105]
    v_pk_add_f32 v[66:67], v[66:67], v[106:107]
    s_waitcnt vmcnt(1)
    v_lshlrev_b32 v108, 16, v112
    v_and_b32 v109, s21, v112
    v_lshlrev_b32 v110, 16, v113
    v_and_b32 v111, s21, v113
    v_lshlrev_b32 v112, 16, v114
    v_and_b32 v113, s21, v114
    v_lshlrev_b32 v114, 16, v115
    v_and_b32 v115, s21, v115
    v_pk_add_f32 v[60:61], v[60:61], v[108:109]
    v_pk_add_f32 v[62:63], v[62:63], v[110:111]
    v_pk_add_f32 v[64:65], v[64:65], v[112:113]
    v_pk_add_f32 v[66:67], v[66:67], v[114:115]
    s_waitcnt vmcnt(0)
    v_lshlrev_b32 v116, 16, v120
    v_and_b32 v117, s21, v120
    v_lshlrev_b32 v118, 16, v121
    v_and_b32 v119, s21, v121
    v_lshlrev_b32 v120, 16, v122
    v_and_b32 v121, s21, v122
    v_lshlrev_b32 v122, 16, v123
    v_and_b32 v123, s21, v123
    v_pk_add_f32 v[60:61], v[60:61], v[116:117]
    v_pk_add_f32 v[62:63], v[62:63], v[118:119]
    v_pk_add_f32 v[64:65], v[64:65], v[120:121]
    v_pk_add_f32 v[66:67], v[66:67], v[122:123]
    v_cvt_pk_bf16_f32 v68, v60, v61
    v_cvt_pk_bf16_f32 v69, v62, v63
    v_cvt_pk_bf16_f32 v70, v64, v65
    v_cvt_pk_bf16_f32 v71, v66, v67
    ds_write_b128 v9, v[68:71]
    s_waitcnt lgkmcnt(0)
    s_barrier
    ds_read_b128 v[84:87], v11 offset:4096
    ds_read_b128 v[88:91], v11 offset:4160
    ds_read_b128 v[68:71], v5 offset:0
    ds_read_b128 v[72:75], v5 offset:1024
    ds_read_b128 v[76:79], v5 offset:2048
    ds_read_b128 v[80:83], v5 offset:3072
    ds_read_b128 v[92:95], v5 offset:4608
    ds_read_b128 v[96:99], v5 offset:5632
    ds_read_b128 v[100:103], v5 offset:6656
    ds_read_b128 v[104:107], v5 offset:7680
    s_waitcnt lgkmcnt(8)
    v_mfma_f32_16x16x32_bf16 v[44:47], v[84:87], v[12:15], 0
    v_mfma_f32_16x16x32_bf16 v[44:47], v[88:91], v[16:19], v[44:47]
    v_mfma_f32_16x16x32_bf16 v[48:51], v[84:87], v[20:23], 0
    v_mfma_f32_16x16x32_bf16 v[48:51], v[88:91], v[24:27], v[48:51]
    s_waitcnt lgkmcnt(4)
    v_mfma_f32_16x16x32_bf16 v[28:31], v[68:71], v[12:15], 0
    v_mfma_f32_16x16x32_bf16 v[32:35], v[72:75], v[12:15], 0
    v_mfma_f32_16x16x32_bf16 v[36:39], v[68:71], v[20:23], 0
    v_mfma_f32_16x16x32_bf16 v[40:43], v[72:75], v[20:23], 0
    v_mfma_f32_16x16x32_bf16 v[28:31], v[76:79], v[16:19], v[28:31]
    v_mfma_f32_16x16x32_bf16 v[32:35], v[80:83], v[16:19], v[32:35]
    v_mfma_f32_16x16x32_bf16 v[36:39], v[76:79], v[24:27], v[36:39]
    v_mfma_f32_16x16x32_bf16 v[40:43], v[80:83], v[24:27], v[40:43]
    s_waitcnt lgkmcnt(0)
    v_mfma_f32_16x16x32_bf16 v[28:31], v[92:95], v[12:15], v[28:31]
    v_mfma_f32_16x16x32_bf16 v[32:35], v[96:99], v[12:15], v[32:35]
    v_mfma_f32_16x16x32_bf16 v[36:39], v[92:95], v[20:23], v[36:39]
    v_mfma_f32_16x16x32_bf16 v[40:43], v[96:99], v[20:23], v[40:43]
    v_mfma_f32_16x16x32_bf16 v[28:31], v[100:103], v[16:19], v[28:31]
    v_mfma_f32_16x16x32_bf16 v[32:35], v[104:107], v[16:19], v[32:35]
    v_mfma_f32_16x16x32_bf16 v[36:39], v[100:103], v[24:27], v[36:39]
    v_mfma_f32_16x16x32_bf16 v[40:43], v[104:107], v[24:27], v[40:43]
    v_add_f32 v44, 0x358637bd, v44
    v_rcp_f32 v44, v44
    v_add_f32 v48, 0x358637bd, v48
    v_rcp_f32 v48, v48
    s_nop 0
    v_pk_mul_f32 v[28:29], v[28:29], v[44:45] op_sel_hi:[1,0]
    v_pk_mul_f32 v[30:31], v[30:31], v[44:45] op_sel_hi:[1,0]
    v_pk_mul_f32 v[32:33], v[32:33], v[44:45] op_sel_hi:[1,0]
    v_pk_mul_f32 v[34:35], v[34:35], v[44:45] op_sel_hi:[1,0]
    v_cvt_pk_bf16_f32 v60, v28, v29
    v_cvt_pk_bf16_f32 v61, v30, v31
    v_cvt_pk_bf16_f32 v62, v32, v33
    v_cvt_pk_bf16_f32 v63, v34, v35
    buffer_store_dwordx4 v[60:63], v7, s[36:39], s22 offen offset:0 sc0 sc1
    v_pk_mul_f32 v[36:37], v[36:37], v[48:49] op_sel_hi:[1,0]
    v_pk_mul_f32 v[38:39], v[38:39], v[48:49] op_sel_hi:[1,0]
    v_pk_mul_f32 v[40:41], v[40:41], v[48:49] op_sel_hi:[1,0]
    v_pk_mul_f32 v[42:43], v[42:43], v[48:49] op_sel_hi:[1,0]
    v_cvt_pk_bf16_f32 v64, v36, v37
    v_cvt_pk_bf16_f32 v65, v38, v39
    v_cvt_pk_bf16_f32 v66, v40, v41
    v_cvt_pk_bf16_f32 v67, v42, v43
    buffer_store_dwordx4 v[64:67], v7, s[36:39], s22 offen offset:256 sc0 sc1
k1b_kernel_end:
    s_endpgm
.text
.globl k2_kernel
.p2align 8
.type k2_kernel,@function
k2_kernel:
    s_cmp_ge_u32 s2, 256
    s_cbranch_scc1 k2_kernel_end
    v_lshrrev_b32 v1, 6, v0
    s_nop 0
    v_readfirstlane_b32 s16, v1
    s_load_dwordx2 s[4:5], s[0:1], 104
    s_load_dwordx2 s[8:9], s[0:1], 24
    s_load_dwordx2 s[10:11], s[0:1], 0
    s_load_dwordx2 s[12:13], s[0:1], 48
    s_and_b32 s3, s2, 7
    s_lshr_b32 s6, s2, 3
    s_and_b32 s14, s3, 1
    s_lshl_b32 s14, s14, 3
    s_and_b32 s7, s6, 7
    s_add_u32 s14, s14, s7
    s_lshr_b32 s15, s3, 1
    s_lshl_b32 s15, s15, 2
    s_lshr_b32 s7, s6, 3
    s_add_u32 s15, s15, s7
    s_cmp_ge_u32 s16, 4
    s_cbranch_scc1 k2_kernel_prod
    v_and_b32 v2, 63, v0
    v_and_b32 v3, 15, v0
    v_bfe_u32 v4, v0, 4, 2
    v_bfe_u32 v5, v0, 2, 2
    v_and_b32 v6, 3, v0
    s_lshr_b32 s17, s16, 1
    s_and_b32 s18, s16, 1
    v_lshlrev_b32 v10, 11, v4
    v_lshl_add_u32 v10, v3, 4, v10
    s_lshl_b32 s60, s17, 10
    v_add_u32 v10, s60, v10
    v_add_u32 v11, 65536, v10
    v_lshl_add_u32 v12, v4, 2, v5
    v_lshlrev_b32 v12, 7, v12
    v_lshl_add_u32 v12, v6, 3, v12
    v_lshrrev_b32 v7, 1, v5
    v_xor_b32 v7, s18, v7
    v_lshl_add_u32 v12, v7, 6, v12
    v_and_b32 v7, 1, v4
    v_lshl_add_u32 v12, v7, 5, v12
    v_add_u32 v12, 98304, v12
    v_xor_b32 v13, 32, v12
    v_lshlrev_b32 v128, 15, v4
    v_lshl_add_u32 v128, v3, 4, v128
    s_lshl_b32 s19, s15, 1
    s_add_u32 s19, s19, s18
    s_lshl_b32 s20, s14, 1
    s_add_u32 s20, s20, s17
    s_lshl_b32 s21, s19, 17
    s_lshl_b32 s22, s20, 10
    s_add_u32 s21, s21, s22
    v_and_b32 v7, 1, v4
    v_lshlrev_b32 v129, 5, v7
    v_lshrrev_b32 v7, 1, v4
    v_lshl_add_u32 v129, v7, 4, v129
    v_lshl_add_u32 v129, v3, 11, v129
    s_lshl_b32 s22, s20, 17
    s_lshl_b32 s23, s19, 6
    s_add_u32 s22, s22, s23
    v_lshlrev_b32 v130, 4, v4
    s_lshl_b32 s23, s19, 7
    v_mov_b32 v64, 0
    v_mov_b32 v65, 0
    v_mov_b32 v66, 0
    v_mov_b32 v67, 0
    v_mov_b32 v68, 0
    v_mov_b32 v69, 0
    v_mov_b32 v70, 0
    v_mov_b32 v71, 0
    v_mov_b32 v72, 0
    v_mov_b32 v73, 0
    v_mov_b32 v74, 0
    v_mov_b32 v75, 0
    v_mov_b32 v76, 0
    v_mov_b32 v77, 0
    v_mov_b32 v78, 0
    v_mov_b32 v79, 0
    v_mov_b32 v80, 0
    v_mov_b32 v81, 0
    v_mov_b32 v82, 0
    v_mov_b32 v83, 0
    v_mov_b32 v84, 0
    v_mov_b32 v85, 0
    v_mov_b32 v86, 0
    v_mov_b32 v87, 0
    v_mov_b32 v88, 0
    v_mov_b32 v89, 0
    v_mov_b32 v90, 0
    v_mov_b32 v91, 0
    v_mov_b32 v92, 0
    v_mov_b32 v93, 0
    v_mov_b32 v94, 0
    v_mov_b32 v95, 0
    v_mov_b32 v40, 0
    v_mov_b32 v41, 0
    v_mov_b32 v42, 0
    v_mov_b32 v43, 0
    v_mov_b32 v44, 0
    v_mov_b32 v45, 0
    v_mov_b32 v46, 0
    v_mov_b32 v47, 0
    v_mov_b32 v48, 0
    v_mov_b32 v49, 0
    v_mov_b32 v50, 0
    v_mov_b32 v51, 0
    v_mov_b32 v52, 0
    v_mov_b32 v53, 0
    v_mov_b32 v54, 0
    v_mov_b32 v55, 0
    v_mov_b32 v56, 0
    v_mov_b32 v57, 0
    v_mov_b32 v58, 0
    v_mov_b32 v59, 0
    v_mov_b32 v60, 0
    v_mov_b32 v61, 0
    v_mov_b32 v62, 0
    v_mov_b32 v63, 0
    s_waitcnt lgkmcnt(0)
    s_mov_b32 s24, s10
    s_and_b32 s25, s11, 0xffff
    s_mov_b32 s26, 4194304
    s_mov_b32 s27, 0x00020000
    s_mov_b32 s28, s4
    s_and_b32 s29, s5, 0xffff
    s_mov_b32 s30, 376832
    s_mov_b32 s31, 0x00020000
    s_add_u32 s36, s4, 13631488
    s_addc_u32 s37, s5, 0
    s_and_b32 s37, s37, 0xffff
    s_mov_b32 s38, 4194304
    s_mov_b32 s39, 0x00020000
    s_add_u32 s40, s4, 44040192
    s_addc_u32 s41, s5, 0
    s_and_b32 s41, s41, 0xffff
    s_mov_b32 s42, 4194304
    s_mov_b32 s43, 0x00020000
    s_add_u32 s44, s4, 65536
    s_addc_u32 s45, s5, 0
    s_and_b32 s45, s45, 0xffff
    s_mov_b32 s46, 16384
    s_mov_b32 s47, 0x00020000
    s_mov_b32 s50, 0xffff0000
    s_mov_b32 s48, 1
    s_barrier
k2_kernel_cloop:
    v_mfma_f32_16x16x32_bf16 v[64:67], v[56:59], v[40:43], v[64:67]
    ds_read_b128 v[16:19], v10 offset:0
    v_mfma_f32_16x16x32_bf16 v[72:75], v[56:59], v[44:47], v[72:75]
    ds_read_b64_tr_b16 v[32:33], v12 offset:0
    v_mfma_f32_16x16x32_bf16 v[80:83], v[56:59], v[48:51], v[80:83]
    ds_read_b64_tr_b16 v[34:35], v12 offset:2048
    v_mfma_f32_16x16x32_bf16 v[88:91], v[56:59], v[52:55], v[88:91]
    ds_read_b128 v[20:23], v10 offset:256
    v_mfma_f32_16x16x32_bf16 v[68:71], v[60:63], v[40:43], v[68:71]
    ds_read_b128 v[24:27], v10 offset:512
    v_mfma_f32_16x16x32_bf16 v[76:79], v[60:63], v[44:47], v[76:79]
    ds_read_b128 v[28:31], v10 offset:768
    v_mfma_f32_16x16x32_bf16 v[84:87], v[60:63], v[48:51], v[84:87]
    ds_read_b64_tr_b16 v[36:37], v13 offset:0
    v_mfma_f32_16x16x32_bf16 v[92:95], v[60:63], v[52:55], v[92:95]
    ds_read_b64_tr_b16 v[38:39], v13 offset:2048
    s_waitcnt lgkmcnt(5)
    v_mfma_f32_16x16x32_bf16 v[64:67], v[32:35], v[16:19], v[64:67]
    ds_read_b128 v[40:43], v10 offset:8192
    ds_read_b64_tr_b16 v[56:57], v12 offset:4096
    s_waitcnt lgkmcnt(6)
    v_mfma_f32_16x16x32_bf16 v[72:75], v[32:35], v[20:23], v[72:75]
    ds_read_b64_tr_b16 v[58:59], v12 offset:6144
    s_waitcnt lgkmcnt(6)
    v_mfma_f32_16x16x32_bf16 v[80:83], v[32:35], v[24:27], v[80:83]
    ds_read_b128 v[44:47], v10 offset:8448
    s_waitcnt lgkmcnt(6)
    v_mfma_f32_16x16x32_bf16 v[88:91], v[32:35], v[28:31], v[88:91]
    ds_read_b128 v[48:51], v10 offset:8704
    s_waitcnt lgkmcnt(5)
    v_mfma_f32_16x16x32_bf16 v[68:71], v[36:39], v[16:19], v[68:71]
    ds_read_b128 v[52:55], v10 offset:8960
    v_mfma_f32_16x16x32_bf16 v[76:79], v[36:39], v[20:23], v[76:79]
    ds_read_b64_tr_b16 v[60:61], v13 offset:4096
    v_mfma_f32_16x16x32_bf16 v[84:87], v[36:39], v[24:27], v[84:87]
    ds_read_b64_tr_b16 v[62:63], v13 offset:6144
    v_mfma_f32_16x16x32_bf16 v[92:95], v[36:39], v[28:31], v[92:95]
    s_waitcnt lgkmcnt(0)
    s_barrier
    v_mfma_f32_16x16x32_bf16 v[64:67], v[56:59], v[40:43], v[64:67]
    ds_read_b128 v[16:19], v10 offset:16384
    v_mfma_f32_16x16x32_bf16 v[72:75], v[56:59], v[44:47], v[72:75]
    ds_read_b64_tr_b16 v[32:33], v12 offset:8192
    v_mfma_f32_16x16x32_bf16 v[80:83], v[56:59], v[48:51], v[80:83]
    ds_read_b64_tr_b16 v[34:35], v12 offset:10240
    v_mfma_f32_16x16x32_bf16 v[88:91], v[56:59], v[52:55], v[88:91]
    ds_read_b128 v[20:23], v10 offset:16640
    v_mfma_f32_16x16x32_bf16 v[68:71], v[60:63], v[40:43], v[68:71]
    ds_read_b128 v[24:27], v10 offset:16896
    v_mfma_f32_16x16x32_bf16 v[76:79], v[60:63], v[44:47], v[76:79]
    ds_read_b128 v[28:31], v10 offset:17152
    v_mfma_f32_16x16x32_bf16 v[84:87], v[60:63], v[48:51], v[84:87]
    ds_read_b64_tr_b16 v[36:37], v13 offset:8192
    v_mfma_f32_16x16x32_bf16 v[92:95], v[60:63], v[52:55], v[92:95]
    ds_read_b64_tr_b16 v[38:39], v13 offset:10240
    s_waitcnt lgkmcnt(5)
    v_mfma_f32_16x16x32_bf16 v[64:67], v[32:35], v[16:19], v[64:67]
    ds_read_b128 v[40:43], v10 offset:24576
    ds_read_b64_tr_b16 v[56:57], v12 offset:12288
    s_waitcnt lgkmcnt(6)
    v_mfma_f32_16x16x32_bf16 v[72:75], v[32:35], v[20:23], v[72:75]
    ds_read_b64_tr_b16 v[58:59], v12 offset:14336
    s_waitcnt lgkmcnt(6)
    v_mfma_f32_16x16x32_bf16 v[80:83], v[32:35], v[24:27], v[80:83]
    ds_read_b128 v[44:47], v10 offset:24832
    s_waitcnt lgkmcnt(6)
    v_mfma_f32_16x16x32_bf16 v[88:91], v[32:35], v[28:31], v[88:91]
    ds_read_b128 v[48:51], v10 offset:25088
    s_waitcnt lgkmcnt(5)
    v_mfma_f32_16x16x32_bf16 v[68:71], v[36:39], v[16:19], v[68:71]
    ds_read_b128 v[52:55], v10 offset:25344
    v_mfma_f32_16x16x32_bf16 v[76:79], v[36:39], v[20:23], v[76:79]
    ds_read_b64_tr_b16 v[60:61], v13 offset:12288
    v_mfma_f32_16x16x32_bf16 v[84:87], v[36:39], v[24:27], v[84:87]
    ds_read_b64_tr_b16 v[62:63], v13 offset:14336
    v_mfma_f32_16x16x32_bf16 v[92:95], v[36:39], v[28:31], v[92:95]
    s_waitcnt lgkmcnt(0)
    s_barrier
    v_mfma_f32_16x16x32_bf16 v[64:67], v[56:59], v[40:43], v[64:67]
    ds_read_b128 v[16:19], v10 offset:32768
    v_mfma_f32_16x16x32_bf16 v[72:75], v[56:59], v[44:47], v[72:75]
    ds_read_b64_tr_b16 v[32:33], v12 offset:16384
    v_mfma_f32_16x16x32_bf16 v[80:83], v[56:59], v[48:51], v[80:83]
    ds_read_b64_tr_b16 v[34:35], v12 offset:18432
    v_mfma_f32_16x16x32_bf16 v[88:91], v[56:59], v[52:55], v[88:91]
    ds_read_b128 v[20:23], v10 offset:33024
    v_mfma_f32_16x16x32_bf16 v[68:71], v[60:63], v[40:43], v[68:71]
    ds_read_b128 v[24:27], v10 offset:33280
    v_mfma_f32_16x16x32_bf16 v[76:79], v[60:63], v[44:47], v[76:79]
    ds_read_b128 v[28:31], v10 offset:33536
    v_mfma_f32_16x16x32_bf16 v[84:87], v[60:63], v[48:51], v[84:87]
    ds_read_b64_tr_b16 v[36:37], v13 offset:16384
    v_mfma_f32_16x16x32_bf16 v[92:95], v[60:63], v[52:55], v[92:95]
    ds_read_b64_tr_b16 v[38:39], v13 offset:18432
    s_waitcnt lgkmcnt(5)
    v_mfma_f32_16x16x32_bf16 v[64:67], v[32:35], v[16:19], v[64:67]
    ds_read_b128 v[40:43], v10 offset:40960
    ds_read_b64_tr_b16 v[56:57], v12 offset:20480
    s_waitcnt lgkmcnt(6)
    v_mfma_f32_16x16x32_bf16 v[72:75], v[32:35], v[20:23], v[72:75]
    ds_read_b64_tr_b16 v[58:59], v12 offset:22528
    s_waitcnt lgkmcnt(6)
    v_mfma_f32_16x16x32_bf16 v[80:83], v[32:35], v[24:27], v[80:83]
    ds_read_b128 v[44:47], v10 offset:41216
    s_waitcnt lgkmcnt(6)
    v_mfma_f32_16x16x32_bf16 v[88:91], v[32:35], v[28:31], v[88:91]
    ds_read_b128 v[48:51], v10 offset:41472
    s_waitcnt lgkmcnt(5)
    v_mfma_f32_16x16x32_bf16 v[68:71], v[36:39], v[16:19], v[68:71]
    ds_read_b128 v[52:55], v10 offset:41728
    v_mfma_f32_16x16x32_bf16 v[76:79], v[36:39], v[20:23], v[76:79]
    ds_read_b64_tr_b16 v[60:61], v13 offset:20480
    v_mfma_f32_16x16x32_bf16 v[84:87], v[36:39], v[24:27], v[84:87]
    ds_read_b64_tr_b16 v[62:63], v13 offset:22528
    v_mfma_f32_16x16x32_bf16 v[92:95], v[36:39], v[28:31], v[92:95]
    s_waitcnt lgkmcnt(0)
    s_barrier
    v_mfma_f32_16x16x32_bf16 v[64:67], v[56:59], v[40:43], v[64:67]
    ds_read_b128 v[16:19], v10 offset:49152
    v_mfma_f32_16x16x32_bf16 v[72:75], v[56:59], v[44:47], v[72:75]
    ds_read_b64_tr_b16 v[32:33], v12 offset:24576
    v_mfma_f32_16x16x32_bf16 v[80:83], v[56:59], v[48:51], v[80:83]
    ds_read_b64_tr_b16 v[34:35], v12 offset:26624
    v_mfma_f32_16x16x32_bf16 v[88:91], v[56:59], v[52:55], v[88:91]
    ds_read_b128 v[20:23], v10 offset:49408
    v_mfma_f32_16x16x32_bf16 v[68:71], v[60:63], v[40:43], v[68:71]
    ds_read_b128 v[24:27], v10 offset:49664
    v_mfma_f32_16x16x32_bf16 v[76:79], v[60:63], v[44:47], v[76:79]
    ds_read_b128 v[28:31], v10 offset:49920
    v_mfma_f32_16x16x32_bf16 v[84:87], v[60:63], v[48:51], v[84:87]
    ds_read_b64_tr_b16 v[36:37], v13 offset:24576
    v_mfma_f32_16x16x32_bf16 v[92:95], v[60:63], v[52:55], v[92:95]
    ds_read_b64_tr_b16 v[38:39], v13 offset:26624
    s_waitcnt lgkmcnt(5)
    v_mfma_f32_16x16x32_bf16 v[64:67], v[32:35], v[16:19], v[64:67]
    ds_read_b128 v[40:43], v10 offset:57344
    ds_read_b64_tr_b16 v[56:57], v12 offset:28672
    s_waitcnt lgkmcnt(6)
    v_mfma_f32_16x16x32_bf16 v[72:75], v[32:35], v[20:23], v[72:75]
    ds_read_b64_tr_b16 v[58:59], v12 offset:30720
    s_waitcnt lgkmcnt(6)
    v_mfma_f32_16x16x32_bf16 v[80:83], v[32:35], v[24:27], v[80:83]
    ds_read_b128 v[44:47], v10 offset:57600
    s_waitcnt lgkmcnt(6)
    v_mfma_f32_16x16x32_bf16 v[88:91], v[32:35], v[28:31], v[88:91]
    ds_read_b128 v[48:51], v10 offset:57856
    s_waitcnt lgkmcnt(5)
    v_mfma_f32_16x16x32_bf16 v[68:71], v[36:39], v[16:19], v[68:71]
    ds_read_b128 v[52:55], v10 offset:58112
    v_mfma_f32_16x16x32_bf16 v[76:79], v[36:39], v[20:23], v[76:79]
    ds_read_b64_tr_b16 v[60:61], v13 offset:28672
    v_mfma_f32_16x16x32_bf16 v[84:87], v[36:39], v[24:27], v[84:87]
    ds_read_b64_tr_b16 v[62:63], v13 offset:30720
    v_mfma_f32_16x16x32_bf16 v[92:95], v[36:39], v[28:31], v[92:95]
    s_waitcnt lgkmcnt(0)
    s_barrier
    v_mfma_f32_16x16x32_bf16 v[64:67], v[56:59], v[40:43], v[64:67]
    ds_read_b128 v[16:19], v11 offset:0
    v_mfma_f32_16x16x32_bf16 v[72:75], v[56:59], v[44:47], v[72:75]
    ds_read_b64_tr_b16 v[32:33], v12 offset:32768
    v_mfma_f32_16x16x32_bf16 v[80:83], v[56:59], v[48:51], v[80:83]
    ds_read_b64_tr_b16 v[34:35], v12 offset:34816
    v_mfma_f32_16x16x32_bf16 v[88:91], v[56:59], v[52:55], v[88:91]
    ds_read_b128 v[20:23], v11 offset:256
    v_mfma_f32_16x16x32_bf16 v[68:71], v[60:63], v[40:43], v[68:71]
    ds_read_b128 v[24:27], v11 offset:512
    v_mfma_f32_16x16x32_bf16 v[76:79], v[60:63], v[44:47], v[76:79]
    ds_read_b128 v[28:31], v11 offset:768
    v_mfma_f32_16x16x32_bf16 v[84:87], v[60:63], v[48:51], v[84:87]
    ds_read_b64_tr_b16 v[36:37], v13 offset:32768
    v_mfma_f32_16x16x32_bf16 v[92:95], v[60:63], v[52:55], v[92:95]
    ds_read_b64_tr_b16 v[38:39], v13 offset:34816
    s_waitcnt lgkmcnt(5)
    v_mfma_f32_16x16x32_bf16 v[64:67], v[32:35], v[16:19], v[64:67]
    ds_read_b128 v[40:43], v11 offset:8192
    ds_read_b64_tr_b16 v[56:57], v12 offset:36864
    s_waitcnt lgkmcnt(6)
    v_mfma_f32_16x16x32_bf16 v[72:75], v[32:35], v[20:23], v[72:75]
    ds_read_b64_tr_b16 v[58:59], v12 offset:38912
    s_waitcnt lgkmcnt(6)
    v_mfma_f32_16x16x32_bf16 v[80:83], v[32:35], v[24:27], v[80:83]
    ds_read_b128 v[44:47], v11 offset:8448
    s_waitcnt lgkmcnt(6)
    v_mfma_f32_16x16x32_bf16 v[88:91], v[32:35], v[28:31], v[88:91]
    ds_read_b128 v[48:51], v11 offset:8704
    s_waitcnt lgkmcnt(5)
    v_mfma_f32_16x16x32_bf16 v[68:71], v[36:39], v[16:19], v[68:71]
    ds_read_b128 v[52:55], v11 offset:8960
    v_mfma_f32_16x16x32_bf16 v[76:79], v[36:39], v[20:23], v[76:79]
    ds_read_b64_tr_b16 v[60:61], v13 offset:36864
    v_mfma_f32_16x16x32_bf16 v[84:87], v[36:39], v[24:27], v[84:87]
    ds_read_b64_tr_b16 v[62:63], v13 offset:38912
    v_mfma_f32_16x16x32_bf16 v[92:95], v[36:39], v[28:31], v[92:95]
    s_waitcnt lgkmcnt(0)
    s_barrier
    v_mfma_f32_16x16x32_bf16 v[64:67], v[56:59], v[40:43], v[64:67]
    ds_read_b128 v[16:19], v11 offset:16384
    v_mfma_f32_16x16x32_bf16 v[72:75], v[56:59], v[44:47], v[72:75]
    ds_read_b64_tr_b16 v[32:33], v12 offset:40960
    v_mfma_f32_16x16x32_bf16 v[80:83], v[56:59], v[48:51], v[80:83]
    ds_read_b64_tr_b16 v[34:35], v12 offset:43008
    v_mfma_f32_16x16x32_bf16 v[88:91], v[56:59], v[52:55], v[88:91]
    ds_read_b128 v[20:23], v11 offset:16640
    v_mfma_f32_16x16x32_bf16 v[68:71], v[60:63], v[40:43], v[68:71]
    ds_read_b128 v[24:27], v11 offset:16896
    v_mfma_f32_16x16x32_bf16 v[76:79], v[60:63], v[44:47], v[76:79]
    ds_read_b128 v[28:31], v11 offset:17152
    v_mfma_f32_16x16x32_bf16 v[84:87], v[60:63], v[48:51], v[84:87]
    ds_read_b64_tr_b16 v[36:37], v13 offset:40960
    v_mfma_f32_16x16x32_bf16 v[92:95], v[60:63], v[52:55], v[92:95]
    ds_read_b64_tr_b16 v[38:39], v13 offset:43008
    s_waitcnt lgkmcnt(5)
    v_mfma_f32_16x16x32_bf16 v[64:67], v[32:35], v[16:19], v[64:67]
    ds_read_b128 v[40:43], v11 offset:24576
    ds_read_b64_tr_b16 v[56:57], v12 offset:45056
    s_waitcnt lgkmcnt(6)
    v_mfma_f32_16x16x32_bf16 v[72:75], v[32:35], v[20:23], v[72:75]
    ds_read_b64_tr_b16 v[58:59], v12 offset:47104
    s_waitcnt lgkmcnt(6)
    v_mfma_f32_16x16x32_bf16 v[80:83], v[32:35], v[24:27], v[80:83]
    ds_read_b128 v[44:47], v11 offset:24832
    s_waitcnt lgkmcnt(6)
    v_mfma_f32_16x16x32_bf16 v[88:91], v[32:35], v[28:31], v[88:91]
    ds_read_b128 v[48:51], v11 offset:25088
    s_waitcnt lgkmcnt(5)
    v_mfma_f32_16x16x32_bf16 v[68:71], v[36:39], v[16:19], v[68:71]
    ds_read_b128 v[52:55], v11 offset:25344
    v_mfma_f32_16x16x32_bf16 v[76:79], v[36:39], v[20:23], v[76:79]
    ds_read_b64_tr_b16 v[60:61], v13 offset:45056
    v_mfma_f32_16x16x32_bf16 v[84:87], v[36:39], v[24:27], v[84:87]
    ds_read_b64_tr_b16 v[62:63], v13 offset:47104
    v_mfma_f32_16x16x32_bf16 v[92:95], v[36:39], v[28:31], v[92:95]
    s_waitcnt lgkmcnt(0)
    s_barrier
    v_mfma_f32_16x16x32_bf16 v[64:67], v[56:59], v[40:43], v[64:67]
    ds_read_b128 v[16:19], v10 offset:0
    v_mfma_f32_16x16x32_bf16 v[72:75], v[56:59], v[44:47], v[72:75]
    ds_read_b64_tr_b16 v[32:33], v12 offset:0
    v_mfma_f32_16x16x32_bf16 v[80:83], v[56:59], v[48:51], v[80:83]
    ds_read_b64_tr_b16 v[34:35], v12 offset:2048
    v_mfma_f32_16x16x32_bf16 v[88:91], v[56:59], v[52:55], v[88:91]
    ds_read_b128 v[20:23], v10 offset:256
    v_mfma_f32_16x16x32_bf16 v[68:71], v[60:63], v[40:43], v[68:71]
    ds_read_b128 v[24:27], v10 offset:512
    v_mfma_f32_16x16x32_bf16 v[76:79], v[60:63], v[44:47], v[76:79]
    ds_read_b128 v[28:31], v10 offset:768
    v_mfma_f32_16x16x32_bf16 v[84:87], v[60:63], v[48:51], v[84:87]
    ds_read_b64_tr_b16 v[36:37], v13 offset:0
    v_mfma_f32_16x16x32_bf16 v[92:95], v[60:63], v[52:55], v[92:95]
    ds_read_b64_tr_b16 v[38:39], v13 offset:2048
    s_waitcnt lgkmcnt(5)
    v_mfma_f32_16x16x32_bf16 v[64:67], v[32:35], v[16:19], v[64:67]
    ds_read_b128 v[40:43], v10 offset:8192
    ds_read_b64_tr_b16 v[56:57], v12 offset:4096
    s_waitcnt lgkmcnt(6)
    v_mfma_f32_16x16x32_bf16 v[72:75], v[32:35], v[20:23], v[72:75]
    ds_read_b64_tr_b16 v[58:59], v12 offset:6144
    s_waitcnt lgkmcnt(6)
    v_mfma_f32_16x16x32_bf16 v[80:83], v[32:35], v[24:27], v[80:83]
    ds_read_b128 v[44:47], v10 offset:8448
    s_waitcnt lgkmcnt(6)
    v_mfma_f32_16x16x32_bf16 v[88:91], v[32:35], v[28:31], v[88:91]
    ds_read_b128 v[48:51], v10 offset:8704
    s_waitcnt lgkmcnt(5)
    v_mfma_f32_16x16x32_bf16 v[68:71], v[36:39], v[16:19], v[68:71]
    ds_read_b128 v[52:55], v10 offset:8960
    v_mfma_f32_16x16x32_bf16 v[76:79], v[36:39], v[20:23], v[76:79]
    ds_read_b64_tr_b16 v[60:61], v13 offset:4096
    v_mfma_f32_16x16x32_bf16 v[84:87], v[36:39], v[24:27], v[84:87]
    ds_read_b64_tr_b16 v[62:63], v13 offset:6144
    v_mfma_f32_16x16x32_bf16 v[92:95], v[36:39], v[28:31], v[92:95]
    s_waitcnt lgkmcnt(0)
    s_barrier
    v_mfma_f32_16x16x32_bf16 v[64:67], v[56:59], v[40:43], v[64:67]
    ds_read_b128 v[16:19], v10 offset:16384
    v_mfma_f32_16x16x32_bf16 v[72:75], v[56:59], v[44:47], v[72:75]
    ds_read_b64_tr_b16 v[32:33], v12 offset:8192
    v_mfma_f32_16x16x32_bf16 v[80:83], v[56:59], v[48:51], v[80:83]
    ds_read_b64_tr_b16 v[34:35], v12 offset:10240
    v_mfma_f32_16x16x32_bf16 v[88:91], v[56:59], v[52:55], v[88:91]
    ds_read_b128 v[20:23], v10 offset:16640
    v_mfma_f32_16x16x32_bf16 v[68:71], v[60:63], v[40:43], v[68:71]
    ds_read_b128 v[24:27], v10 offset:16896
    v_mfma_f32_16x16x32_bf16 v[76:79], v[60:63], v[44:47], v[76:79]
    ds_read_b128 v[28:31], v10 offset:17152
    v_mfma_f32_16x16x32_bf16 v[84:87], v[60:63], v[48:51], v[84:87]
    ds_read_b64_tr_b16 v[36:37], v13 offset:8192
    v_mfma_f32_16x16x32_bf16 v[92:95], v[60:63], v[52:55], v[92:95]
    ds_read_b64_tr_b16 v[38:39], v13 offset:10240
    s_waitcnt lgkmcnt(5)
    v_mfma_f32_16x16x32_bf16 v[64:67], v[32:35], v[16:19], v[64:67]
    ds_read_b128 v[40:43], v10 offset:24576
    ds_read_b64_tr_b16 v[56:57], v12 offset:12288
    s_waitcnt lgkmcnt(6)
    v_mfma_f32_16x16x32_bf16 v[72:75], v[32:35], v[20:23], v[72:75]
    ds_read_b64_tr_b16 v[58:59], v12 offset:14336
    s_waitcnt lgkmcnt(6)
    v_mfma_f32_16x16x32_bf16 v[80:83], v[32:35], v[24:27], v[80:83]
    ds_read_b128 v[44:47], v10 offset:24832
    s_waitcnt lgkmcnt(6)
    v_mfma_f32_16x16x32_bf16 v[88:91], v[32:35], v[28:31], v[88:91]
    ds_read_b128 v[48:51], v10 offset:25088
    s_waitcnt lgkmcnt(5)
    v_mfma_f32_16x16x32_bf16 v[68:71], v[36:39], v[16:19], v[68:71]
    ds_read_b128 v[52:55], v10 offset:25344
    v_mfma_f32_16x16x32_bf16 v[76:79], v[36:39], v[20:23], v[76:79]
    ds_read_b64_tr_b16 v[60:61], v13 offset:12288
    v_mfma_f32_16x16x32_bf16 v[84:87], v[36:39], v[24:27], v[84:87]
    ds_read_b64_tr_b16 v[62:63], v13 offset:14336
    v_mfma_f32_16x16x32_bf16 v[92:95], v[36:39], v[28:31], v[92:95]
    s_waitcnt lgkmcnt(0)
    s_barrier
    v_mfma_f32_16x16x32_bf16 v[64:67], v[56:59], v[40:43], v[64:67]
    ds_read_b128 v[16:19], v10 offset:32768
    v_mfma_f32_16x16x32_bf16 v[72:75], v[56:59], v[44:47], v[72:75]
    ds_read_b64_tr_b16 v[32:33], v12 offset:16384
    v_mfma_f32_16x16x32_bf16 v[80:83], v[56:59], v[48:51], v[80:83]
    ds_read_b64_tr_b16 v[34:35], v12 offset:18432
    v_mfma_f32_16x16x32_bf16 v[88:91], v[56:59], v[52:55], v[88:91]
    ds_read_b128 v[20:23], v10 offset:33024
    v_mfma_f32_16x16x32_bf16 v[68:71], v[60:63], v[40:43], v[68:71]
    ds_read_b128 v[24:27], v10 offset:33280
    v_mfma_f32_16x16x32_bf16 v[76:79], v[60:63], v[44:47], v[76:79]
    ds_read_b128 v[28:31], v10 offset:33536
    v_mfma_f32_16x16x32_bf16 v[84:87], v[60:63], v[48:51], v[84:87]
    ds_read_b64_tr_b16 v[36:37], v13 offset:16384
    v_mfma_f32_16x16x32_bf16 v[92:95], v[60:63], v[52:55], v[92:95]
    ds_read_b64_tr_b16 v[38:39], v13 offset:18432
    s_waitcnt lgkmcnt(5)
    v_mfma_f32_16x16x32_bf16 v[64:67], v[32:35], v[16:19], v[64:67]
    ds_read_b128 v[40:43], v10 offset:40960
    ds_read_b64_tr_b16 v[56:57], v12 offset:20480
    s_waitcnt lgkmcnt(6)
    v_mfma_f32_16x16x32_bf16 v[72:75], v[32:35], v[20:23], v[72:75]
    ds_read_b64_tr_b16 v[58:59], v12 offset:22528
    s_waitcnt lgkmcnt(6)
    v_mfma_f32_16x16x32_bf16 v[80:83], v[32:35], v[24:27], v[80:83]
    ds_read_b128 v[44:47], v10 offset:41216
    s_waitcnt lgkmcnt(6)
    v_mfma_f32_16x16x32_bf16 v[88:91], v[32:35], v[28:31], v[88:91]
    ds_read_b128 v[48:51], v10 offset:41472
    s_waitcnt lgkmcnt(5)
    v_mfma_f32_16x16x32_bf16 v[68:71], v[36:39], v[16:19], v[68:71]
    ds_read_b128 v[52:55], v10 offset:41728
    v_mfma_f32_16x16x32_bf16 v[76:79], v[36:39], v[20:23], v[76:79]
    ds_read_b64_tr_b16 v[60:61], v13 offset:20480
    v_mfma_f32_16x16x32_bf16 v[84:87], v[36:39], v[24:27], v[84:87]
    ds_read_b64_tr_b16 v[62:63], v13 offset:22528
    v_mfma_f32_16x16x32_bf16 v[92:95], v[36:39], v[28:31], v[92:95]
    s_waitcnt lgkmcnt(0)
    s_barrier
    v_mfma_f32_16x16x32_bf16 v[64:67], v[56:59], v[40:43], v[64:67]
    ds_read_b128 v[16:19], v10 offset:49152
    v_mfma_f32_16x16x32_bf16 v[72:75], v[56:59], v[44:47], v[72:75]
    ds_read_b64_tr_b16 v[32:33], v12 offset:24576
    v_mfma_f32_16x16x32_bf16 v[80:83], v[56:59], v[48:51], v[80:83]
    ds_read_b64_tr_b16 v[34:35], v12 offset:26624
    v_mfma_f32_16x16x32_bf16 v[88:91], v[56:59], v[52:55], v[88:91]
    ds_read_b128 v[20:23], v10 offset:49408
    v_mfma_f32_16x16x32_bf16 v[68:71], v[60:63], v[40:43], v[68:71]
    ds_read_b128 v[24:27], v10 offset:49664
    v_mfma_f32_16x16x32_bf16 v[76:79], v[60:63], v[44:47], v[76:79]
    ds_read_b128 v[28:31], v10 offset:49920
    v_mfma_f32_16x16x32_bf16 v[84:87], v[60:63], v[48:51], v[84:87]
    ds_read_b64_tr_b16 v[36:37], v13 offset:24576
    v_mfma_f32_16x16x32_bf16 v[92:95], v[60:63], v[52:55], v[92:95]
    ds_read_b64_tr_b16 v[38:39], v13 offset:26624
    s_waitcnt lgkmcnt(5)
    v_mfma_f32_16x16x32_bf16 v[64:67], v[32:35], v[16:19], v[64:67]
    ds_read_b128 v[40:43], v10 offset:57344
    ds_read_b64_tr_b16 v[56:57], v12 offset:28672
    s_waitcnt lgkmcnt(6)
    v_mfma_f32_16x16x32_bf16 v[72:75], v[32:35], v[20:23], v[72:75]
    ds_read_b64_tr_b16 v[58:59], v12 offset:30720
    s_waitcnt lgkmcnt(6)
    v_mfma_f32_16x16x32_bf16 v[80:83], v[32:35], v[24:27], v[80:83]
    ds_read_b128 v[44:47], v10 offset:57600
    s_waitcnt lgkmcnt(6)
    v_mfma_f32_16x16x32_bf16 v[88:91], v[32:35], v[28:31], v[88:91]
    ds_read_b128 v[48:51], v10 offset:57856
    s_waitcnt lgkmcnt(5)
    v_mfma_f32_16x16x32_bf16 v[68:71], v[36:39], v[16:19], v[68:71]
    ds_read_b128 v[52:55], v10 offset:58112
    v_mfma_f32_16x16x32_bf16 v[76:79], v[36:39], v[20:23], v[76:79]
    ds_read_b64_tr_b16 v[60:61], v13 offset:28672
    v_mfma_f32_16x16x32_bf16 v[84:87], v[36:39], v[24:27], v[84:87]
    ds_read_b64_tr_b16 v[62:63], v13 offset:30720
    v_mfma_f32_16x16x32_bf16 v[92:95], v[36:39], v[28:31], v[92:95]
    s_waitcnt lgkmcnt(0)
    s_barrier
    v_mfma_f32_16x16x32_bf16 v[64:67], v[56:59], v[40:43], v[64:67]
    ds_read_b128 v[16:19], v11 offset:0
    v_mfma_f32_16x16x32_bf16 v[72:75], v[56:59], v[44:47], v[72:75]
    ds_read_b64_tr_b16 v[32:33], v12 offset:32768
    v_mfma_f32_16x16x32_bf16 v[80:83], v[56:59], v[48:51], v[80:83]
    ds_read_b64_tr_b16 v[34:35], v12 offset:34816
    v_mfma_f32_16x16x32_bf16 v[88:91], v[56:59], v[52:55], v[88:91]
    ds_read_b128 v[20:23], v11 offset:256
    v_mfma_f32_16x16x32_bf16 v[68:71], v[60:63], v[40:43], v[68:71]
    ds_read_b128 v[24:27], v11 offset:512
    v_mfma_f32_16x16x32_bf16 v[76:79], v[60:63], v[44:47], v[76:79]
    ds_read_b128 v[28:31], v11 offset:768
    v_mfma_f32_16x16x32_bf16 v[84:87], v[60:63], v[48:51], v[84:87]
    ds_read_b64_tr_b16 v[36:37], v13 offset:32768
    v_mfma_f32_16x16x32_bf16 v[92:95], v[60:63], v[52:55], v[92:95]
    ds_read_b64_tr_b16 v[38:39], v13 offset:34816
    s_waitcnt lgkmcnt(5)
    v_mfma_f32_16x16x32_bf16 v[64:67], v[32:35], v[16:19], v[64:67]
    ds_read_b128 v[40:43], v11 offset:8192
    ds_read_b64_tr_b16 v[56:57], v12 offset:36864
    s_waitcnt lgkmcnt(6)
    v_mfma_f32_16x16x32_bf16 v[72:75], v[32:35], v[20:23], v[72:75]
    ds_read_b64_tr_b16 v[58:59], v12 offset:38912
    s_waitcnt lgkmcnt(6)
    v_mfma_f32_16x16x32_bf16 v[80:83], v[32:35], v[24:27], v[80:83]
    ds_read_b128 v[44:47], v11 offset:8448
    s_waitcnt lgkmcnt(6)
    v_mfma_f32_16x16x32_bf16 v[88:91], v[32:35], v[28:31], v[88:91]
    ds_read_b128 v[48:51], v11 offset:8704
    s_waitcnt lgkmcnt(5)
    v_mfma_f32_16x16x32_bf16 v[68:71], v[36:39], v[16:19], v[68:71]
    ds_read_b128 v[52:55], v11 offset:8960
    v_mfma_f32_16x16x32_bf16 v[76:79], v[36:39], v[20:23], v[76:79]
    ds_read_b64_tr_b16 v[60:61], v13 offset:36864
    v_mfma_f32_16x16x32_bf16 v[84:87], v[36:39], v[24:27], v[84:87]
    ds_read_b64_tr_b16 v[62:63], v13 offset:38912
    v_mfma_f32_16x16x32_bf16 v[92:95], v[36:39], v[28:31], v[92:95]
    s_waitcnt lgkmcnt(0)
    s_barrier
    v_mfma_f32_16x16x32_bf16 v[64:67], v[56:59], v[40:43], v[64:67]
    ds_read_b128 v[16:19], v11 offset:16384
    v_mfma_f32_16x16x32_bf16 v[72:75], v[56:59], v[44:47], v[72:75]
    ds_read_b64_tr_b16 v[32:33], v12 offset:40960
    v_mfma_f32_16x16x32_bf16 v[80:83], v[56:59], v[48:51], v[80:83]
    ds_read_b64_tr_b16 v[34:35], v12 offset:43008
    v_mfma_f32_16x16x32_bf16 v[88:91], v[56:59], v[52:55], v[88:91]
    ds_read_b128 v[20:23], v11 offset:16640
    v_mfma_f32_16x16x32_bf16 v[68:71], v[60:63], v[40:43], v[68:71]
    ds_read_b128 v[24:27], v11 offset:16896
    v_mfma_f32_16x16x32_bf16 v[76:79], v[60:63], v[44:47], v[76:79]
    ds_read_b128 v[28:31], v11 offset:17152
    v_mfma_f32_16x16x32_bf16 v[84:87], v[60:63], v[48:51], v[84:87]
    ds_read_b64_tr_b16 v[36:37], v13 offset:40960
    v_mfma_f32_16x16x32_bf16 v[92:95], v[60:63], v[52:55], v[92:95]
    ds_read_b64_tr_b16 v[38:39], v13 offset:43008
    s_add_u32 s49, s22, 0
    buffer_load_dwordx4 v[96:99], v129, s[24:27], s49 offen
    s_add_u32 s49, s22, 32768
    buffer_load_dwordx4 v[100:103], v129, s[24:27], s49 offen
    s_add_u32 s49, s22, 65536
    buffer_load_dwordx4 v[104:107], v129, s[24:27], s49 offen
    s_waitcnt lgkmcnt(5)
    v_mfma_f32_16x16x32_bf16 v[64:67], v[32:35], v[16:19], v[64:67]
    ds_read_b128 v[40:43], v11 offset:24576
    ds_read_b64_tr_b16 v[56:57], v12 offset:45056
    s_waitcnt lgkmcnt(6)
    v_mfma_f32_16x16x32_bf16 v[72:75], v[32:35], v[20:23], v[72:75]
    ds_read_b64_tr_b16 v[58:59], v12 offset:47104
    s_waitcnt lgkmcnt(6)
    v_mfma_f32_16x16x32_bf16 v[80:83], v[32:35], v[24:27], v[80:83]
    ds_read_b128 v[44:47], v11 offset:24832
    s_waitcnt lgkmcnt(6)
    v_mfma_f32_16x16x32_bf16 v[88:91], v[32:35], v[28:31], v[88:91]
    ds_read_b128 v[48:51], v11 offset:25088
    s_waitcnt lgkmcnt(5)
    v_mfma_f32_16x16x32_bf16 v[68:71], v[36:39], v[16:19], v[68:71]
    ds_read_b128 v[52:55], v11 offset:25344
    v_mfma_f32_16x16x32_bf16 v[76:79], v[36:39], v[20:23], v[76:79]
    ds_read_b64_tr_b16 v[60:61], v13 offset:45056
    v_mfma_f32_16x16x32_bf16 v[84:87], v[36:39], v[24:27], v[84:87]
    ds_read_b64_tr_b16 v[62:63], v13 offset:47104
    v_mfma_f32_16x16x32_bf16 v[92:95], v[36:39], v[28:31], v[92:95]
    s_add_u32 s49, s22, 98304
    buffer_load_dwordx4 v[108:111], v129, s[24:27], s49 offen
    s_add_u32 s49, s23, 360448
    buffer_load_dwordx4 v[112:115], v130, s[28:31], s49 offen offset:0
    buffer_load_dwordx4 v[116:119], v130, s[28:31], s49 offen offset:64
    s_add_u32 s49, s23, 16384
    buffer_load_dwordx4 v[120:123], v130, s[28:31], s49 offen offset:0
    buffer_load_dwordx4 v[124:127], v130, s[28:31], s49 offen offset:64
    s_waitcnt lgkmcnt(0)
    s_barrier
    v_mfma_f32_16x16x32_bf16 v[64:67], v[56:59], v[40:43], v[64:67]
    ds_read_b128 v[16:19], v10 offset:0
    v_mfma_f32_16x16x32_bf16 v[72:75], v[56:59], v[44:47], v[72:75]
    ds_read_b64_tr_b16 v[32:33], v12 offset:0
    v_mfma_f32_16x16x32_bf16 v[80:83], v[56:59], v[48:51], v[80:83]
    ds_read_b64_tr_b16 v[34:35], v12 offset:2048
    v_mfma_f32_16x16x32_bf16 v[88:91], v[56:59], v[52:55], v[88:91]
    ds_read_b128 v[20:23], v10 offset:256
    v_mfma_f32_16x16x32_bf16 v[68:71], v[60:63], v[40:43], v[68:71]
    ds_read_b128 v[24:27], v10 offset:512
    v_mfma_f32_16x16x32_bf16 v[76:79], v[60:63], v[44:47], v[76:79]
    ds_read_b128 v[28:31], v10 offset:768
    v_mfma_f32_16x16x32_bf16 v[84:87], v[60:63], v[48:51], v[84:87]
    ds_read_b64_tr_b16 v[36:37], v13 offset:0
    v_mfma_f32_16x16x32_bf16 v[92:95], v[60:63], v[52:55], v[92:95]
    ds_read_b64_tr_b16 v[38:39], v13 offset:2048
    s_waitcnt lgkmcnt(5)
    v_mfma_f32_16x16x32_bf16 v[64:67], v[32:35], v[16:19], v[64:67]
    ds_read_b128 v[40:43], v10 offset:8192
    ds_read_b64_tr_b16 v[56:57], v12 offset:4096
    s_waitcnt lgkmcnt(6)
    v_mfma_f32_16x16x32_bf16 v[72:75], v[32:35], v[20:23], v[72:75]
    ds_read_b64_tr_b16 v[58:59], v12 offset:6144
    s_waitcnt lgkmcnt(6)
    v_mfma_f32_16x16x32_bf16 v[80:83], v[32:35], v[24:27], v[80:83]
    ds_read_b128 v[44:47], v10 offset:8448
    s_waitcnt lgkmcnt(6)
    v_mfma_f32_16x16x32_bf16 v[88:91], v[32:35], v[28:31], v[88:91]
    ds_read_b128 v[48:51], v10 offset:8704
    s_waitcnt lgkmcnt(5)
    v_mfma_f32_16x16x32_bf16 v[68:71], v[36:39], v[16:19], v[68:71]
    ds_read_b128 v[52:55], v10 offset:8960
    v_mfma_f32_16x16x32_bf16 v[76:79], v[36:39], v[20:23], v[76:79]
    ds_read_b64_tr_b16 v[60:61], v13 offset:4096
    v_mfma_f32_16x16x32_bf16 v[84:87], v[36:39], v[24:27], v[84:87]
    ds_read_b64_tr_b16 v[62:63], v13 offset:6144
    v_mfma_f32_16x16x32_bf16 v[92:95], v[36:39], v[28:31], v[92:95]
    s_waitcnt lgkmcnt(0)
    s_barrier
    v_mfma_f32_16x16x32_bf16 v[64:67], v[56:59], v[40:43], v[64:67]
    ds_read_b128 v[16:19], v10 offset:16384
    v_mfma_f32_16x16x32_bf16 v[72:75], v[56:59], v[44:47], v[72:75]
    ds_read_b64_tr_b16 v[32:33], v12 offset:8192
    v_mfma_f32_16x16x32_bf16 v[80:83], v[56:59], v[48:51], v[80:83]
    ds_read_b64_tr_b16 v[34:35], v12 offset:10240
    v_mfma_f32_16x16x32_bf16 v[88:91], v[56:59], v[52:55], v[88:91]
    ds_read_b128 v[20:23], v10 offset:16640
    v_mfma_f32_16x16x32_bf16 v[68:71], v[60:63], v[40:43], v[68:71]
    ds_read_b128 v[24:27], v10 offset:16896
    v_mfma_f32_16x16x32_bf16 v[76:79], v[60:63], v[44:47], v[76:79]
    ds_read_b128 v[28:31], v10 offset:17152
    v_mfma_f32_16x16x32_bf16 v[84:87], v[60:63], v[48:51], v[84:87]
    ds_read_b64_tr_b16 v[36:37], v13 offset:8192
    v_mfma_f32_16x16x32_bf16 v[92:95], v[60:63], v[52:55], v[92:95]
    ds_read_b64_tr_b16 v[38:39], v13 offset:10240
    s_waitcnt lgkmcnt(5)
    v_mfma_f32_16x16x32_bf16 v[64:67], v[32:35], v[16:19], v[64:67]
    ds_read_b128 v[40:43], v10 offset:24576
    ds_read_b64_tr_b16 v[56:57], v12 offset:12288
    s_waitcnt lgkmcnt(6)
    v_mfma_f32_16x16x32_bf16 v[72:75], v[32:35], v[20:23], v[72:75]
    ds_read_b64_tr_b16 v[58:59], v12 offset:14336
    s_waitcnt lgkmcnt(6)
    v_mfma_f32_16x16x32_bf16 v[80:83], v[32:35], v[24:27], v[80:83]
    ds_read_b128 v[44:47], v10 offset:24832
    s_waitcnt lgkmcnt(6)
    v_mfma_f32_16x16x32_bf16 v[88:91], v[32:35], v[28:31], v[88:91]
    ds_read_b128 v[48:51], v10 offset:25088
    s_waitcnt lgkmcnt(5)
    v_mfma_f32_16x16x32_bf16 v[68:71], v[36:39], v[16:19], v[68:71]
    ds_read_b128 v[52:55], v10 offset:25344
    v_mfma_f32_16x16x32_bf16 v[76:79], v[36:39], v[20:23], v[76:79]
    ds_read_b64_tr_b16 v[60:61], v13 offset:12288
    v_mfma_f32_16x16x32_bf16 v[84:87], v[36:39], v[24:27], v[84:87]
    ds_read_b64_tr_b16 v[62:63], v13 offset:14336
    v_mfma_f32_16x16x32_bf16 v[92:95], v[36:39], v[28:31], v[92:95]
    s_waitcnt lgkmcnt(0)
    s_barrier
    v_mfma_f32_16x16x32_bf16 v[64:67], v[56:59], v[40:43], v[64:67]
    ds_read_b128 v[16:19], v10 offset:32768
    v_mfma_f32_16x16x32_bf16 v[72:75], v[56:59], v[44:47], v[72:75]
    ds_read_b64_tr_b16 v[32:33], v12 offset:16384
    v_mfma_f32_16x16x32_bf16 v[80:83], v[56:59], v[48:51], v[80:83]
    ds_read_b64_tr_b16 v[34:35], v12 offset:18432
    v_mfma_f32_16x16x32_bf16 v[88:91], v[56:59], v[52:55], v[88:91]
    ds_read_b128 v[20:23], v10 offset:33024
    v_mfma_f32_16x16x32_bf16 v[68:71], v[60:63], v[40:43], v[68:71]
    ds_read_b128 v[24:27], v10 offset:33280
    v_mfma_f32_16x16x32_bf16 v[76:79], v[60:63], v[44:47], v[76:79]
    ds_read_b128 v[28:31], v10 offset:33536
    v_mfma_f32_16x16x32_bf16 v[84:87], v[60:63], v[48:51], v[84:87]
    ds_read_b64_tr_b16 v[36:37], v13 offset:16384
    v_mfma_f32_16x16x32_bf16 v[92:95], v[60:63], v[52:55], v[92:95]
    ds_read_b64_tr_b16 v[38:39], v13 offset:18432
    s_waitcnt lgkmcnt(5)
    v_mfma_f32_16x16x32_bf16 v[64:67], v[32:35], v[16:19], v[64:67]
    ds_read_b128 v[40:43], v10 offset:40960
    ds_read_b64_tr_b16 v[56:57], v12 offset:20480
    s_waitcnt lgkmcnt(6)
    v_mfma_f32_16x16x32_bf16 v[72:75], v[32:35], v[20:23], v[72:75]
    ds_read_b64_tr_b16 v[58:59], v12 offset:22528
    s_waitcnt lgkmcnt(6)
    v_mfma_f32_16x16x32_bf16 v[80:83], v[32:35], v[24:27], v[80:83]
    ds_read_b128 v[44:47], v10 offset:41216
    s_waitcnt lgkmcnt(6)
    v_mfma_f32_16x16x32_bf16 v[88:91], v[32:35], v[28:31], v[88:91]
    ds_read_b128 v[48:51], v10 offset:41472
    s_waitcnt lgkmcnt(5)
    v_mfma_f32_16x16x32_bf16 v[68:71], v[36:39], v[16:19], v[68:71]
    ds_read_b128 v[52:55], v10 offset:41728
    v_mfma_f32_16x16x32_bf16 v[76:79], v[36:39], v[20:23], v[76:79]
    ds_read_b64_tr_b16 v[60:61], v13 offset:20480
    v_mfma_f32_16x16x32_bf16 v[84:87], v[36:39], v[24:27], v[84:87]
    ds_read_b64_tr_b16 v[62:63], v13 offset:22528
    v_mfma_f32_16x16x32_bf16 v[92:95], v[36:39], v[28:31], v[92:95]
    s_waitcnt lgkmcnt(0)
    s_barrier
    v_mfma_f32_16x16x32_bf16 v[64:67], v[56:59], v[40:43], v[64:67]
    ds_read_b128 v[16:19], v10 offset:49152
    v_mfma_f32_16x16x32_bf16 v[72:75], v[56:59], v[44:47], v[72:75]
    ds_read_b64_tr_b16 v[32:33], v12 offset:24576
    v_mfma_f32_16x16x32_bf16 v[80:83], v[56:59], v[48:51], v[80:83]
    ds_read_b64_tr_b16 v[34:35], v12 offset:26624
    v_mfma_f32_16x16x32_bf16 v[88:91], v[56:59], v[52:55], v[88:91]
    ds_read_b128 v[20:23], v10 offset:49408
    v_mfma_f32_16x16x32_bf16 v[68:71], v[60:63], v[40:43], v[68:71]
    ds_read_b128 v[24:27], v10 offset:49664
    v_mfma_f32_16x16x32_bf16 v[76:79], v[60:63], v[44:47], v[76:79]
    ds_read_b128 v[28:31], v10 offset:49920
    v_mfma_f32_16x16x32_bf16 v[84:87], v[60:63], v[48:51], v[84:87]
    ds_read_b64_tr_b16 v[36:37], v13 offset:24576
    v_mfma_f32_16x16x32_bf16 v[92:95], v[60:63], v[52:55], v[92:95]
    ds_read_b64_tr_b16 v[38:39], v13 offset:26624
    s_waitcnt lgkmcnt(5)
    v_mfma_f32_16x16x32_bf16 v[64:67], v[32:35], v[16:19], v[64:67]
    ds_read_b128 v[40:43], v10 offset:57344
    ds_read_b64_tr_b16 v[56:57], v12 offset:28672
    s_waitcnt lgkmcnt(6)
    v_mfma_f32_16x16x32_bf16 v[72:75], v[32:35], v[20:23], v[72:75]
    ds_read_b64_tr_b16 v[58:59], v12 offset:30720
    s_waitcnt lgkmcnt(6)
    v_mfma_f32_16x16x32_bf16 v[80:83], v[32:35], v[24:27], v[80:83]
    ds_read_b128 v[44:47], v10 offset:57600
    s_waitcnt lgkmcnt(6)
    v_mfma_f32_16x16x32_bf16 v[88:91], v[32:35], v[28:31], v[88:91]
    ds_read_b128 v[48:51], v10 offset:57856
    s_waitcnt lgkmcnt(5)
    v_mfma_f32_16x16x32_bf16 v[68:71], v[36:39], v[16:19], v[68:71]
    ds_read_b128 v[52:55], v10 offset:58112
    v_mfma_f32_16x16x32_bf16 v[76:79], v[36:39], v[20:23], v[76:79]
    ds_read_b64_tr_b16 v[60:61], v13 offset:28672
    v_mfma_f32_16x16x32_bf16 v[84:87], v[36:39], v[24:27], v[84:87]
    ds_read_b64_tr_b16 v[62:63], v13 offset:30720
    v_mfma_f32_16x16x32_bf16 v[92:95], v[36:39], v[28:31], v[92:95]
    s_sub_u32 s48, s48, 1
    s_cmp_lg_u32 s48, 0
    s_waitcnt lgkmcnt(0)
    s_barrier
    s_cbranch_scc1 k2_kernel_cloop
    s_waitcnt vmcnt(0)
    v_mfma_f32_16x16x32_bf16 v[64:67], v[56:59], v[40:43], v[64:67]
    v_min3_f32 v7, |v120|, |v121|, |v122|
    v_min3_f32 v8, |v123|, |v124|, |v125|
    v_min3_f32 v7, v7, |v126|, |v127|
    v_min_f32 v7, v7, v8
    v_mfma_f32_16x16x32_bf16 v[72:75], v[56:59], v[44:47], v[72:75]
    v_cmp_eq_f32 vcc, 0, v7
    v_permlane16_swap_b32 v96, v98
    v_permlane16_swap_b32 v97, v99
    v_permlane16_swap_b32 v100, v102
    v_mfma_f32_16x16x32_bf16 v[80:83], v[56:59], v[48:51], v[80:83]
    v_permlane16_swap_b32 v101, v103
    v_permlane16_swap_b32 v104, v106
    v_permlane16_swap_b32 v105, v107
    v_permlane16_swap_b32 v108, v110
    v_mfma_f32_16x16x32_bf16 v[88:91], v[56:59], v[52:55], v[88:91]
    v_permlane16_swap_b32 v109, v111
    v_cvt_pk_bf16_f32 v113, v112, v113
    v_cvt_pk_bf16_f32 v115, v114, v115
    v_cvt_pk_bf16_f32 v117, v116, v117
    v_mfma_f32_16x16x32_bf16 v[68:71], v[60:63], v[40:43], v[68:71]
    v_cvt_pk_bf16_f32 v119, v118, v119
    v_lshlrev_b32 v112, 16, v113
    v_and_b32 v113, s50, v113
    v_lshlrev_b32 v114, 16, v115
    v_mfma_f32_16x16x32_bf16 v[76:79], v[60:63], v[44:47], v[76:79]
    v_and_b32 v115, s50, v115
    v_lshlrev_b32 v116, 16, v117
    v_and_b32 v117, s50, v117
    v_lshlrev_b32 v118, 16, v119
    v_mfma_f32_16x16x32_bf16 v[84:87], v[60:63], v[48:51], v[84:87]
    v_and_b32 v119, s50, v119
    v_lshlrev_b32 v16, 16, v96
    v_and_b32 v17, s50, v96
    v_lshlrev_b32 v18, 16, v97
    v_mfma_f32_16x16x32_bf16 v[92:95], v[60:63], v[52:55], v[92:95]
    v_and_b32 v19, s50, v97
    v_lshlrev_b32 v20, 16, v98
    v_and_b32 v21, s50, v98
    v_lshlrev_b32 v22, 16, v99
    v_and_b32 v23, s50, v99
    v_lshlrev_b32 v24, 16, v100
    v_and_b32 v25, s50, v100
    v_lshlrev_b32 v26, 16, v101
    v_and_b32 v27, s50, v101
    v_lshlrev_b32 v28, 16, v102
    v_and_b32 v29, s50, v102
    v_lshlrev_b32 v30, 16, v103
    v_and_b32 v31, s50, v103
    v_pk_fma_f32 v[64:65], v[64:65], v[112:113], v[16:17]
    v_pk_fma_f32 v[66:67], v[66:67], v[114:115], v[18:19]
    v_pk_fma_f32 v[68:69], v[68:69], v[116:117], v[20:21]
    v_pk_fma_f32 v[70:71], v[70:71], v[118:119], v[22:23]
    v_pk_mul_f32 v[16:17], v[64:65], v[120:121]
    v_pk_mul_f32 v[18:19], v[66:67], v[122:123]
    v_pk_mul_f32 v[20:21], v[68:69], v[124:125]
    v_pk_mul_f32 v[22:23], v[70:71], v[126:127]
    v_cvt_pk_bf16_f32 v40, v16, v17
    v_cvt_pk_bf16_f32 v41, v18, v19
    v_cvt_pk_bf16_f32 v42, v20, v21
    v_cvt_pk_bf16_f32 v43, v22, v23
    buffer_store_dwordx4 v[40:43], v128, s[40:43], s21 offen offset:0 sc0 sc1
    v_pk_mul_f32 v[16:17], v[64:65], v[64:65]
    v_pk_add_f32 v[18:19], v[64:65], v[66:67]
    v_pk_fma_f32 v[16:17], v[66:67], v[66:67], v[16:17]
    v_pk_fma_f32 v[16:17], v[68:69], v[68:69], v[16:17]
    v_pk_add_f32 v[18:19], v[18:19], v[68:69]
    v_pk_fma_f32 v[16:17], v[70:71], v[70:71], v[16:17]
    v_pk_add_f32 v[18:19], v[18:19], v[70:71]
    v_add_f32 v136, v16, v17
    v_add_f32 v132, v18, v19
    v_pk_fma_f32 v[72:73], v[72:73], v[112:113], v[24:25]
    v_pk_fma_f32 v[74:75], v[74:75], v[114:115], v[26:27]
    v_pk_fma_f32 v[76:77], v[76:77], v[116:117], v[28:29]
    v_pk_fma_f32 v[78:79], v[78:79], v[118:119], v[30:31]
    v_pk_mul_f32 v[24:25], v[72:73], v[120:121]
    v_pk_mul_f32 v[26:27], v[74:75], v[122:123]
    v_pk_mul_f32 v[28:29], v[76:77], v[124:125]
    v_pk_mul_f32 v[30:31], v[78:79], v[126:127]
    v_cvt_pk_bf16_f32 v44, v24, v25
    v_cvt_pk_bf16_f32 v45, v26, v27
    v_cvt_pk_bf16_f32 v46, v28, v29
    v_cvt_pk_bf16_f32 v47, v30, v31
    buffer_store_dwordx4 v[44:47], v128, s[40:43], s21 offen offset:256 sc0 sc1
    v_pk_mul_f32 v[24:25], v[72:73], v[72:73]
    v_pk_add_f32 v[26:27], v[72:73], v[74:75]
    v_pk_fma_f32 v[24:25], v[74:75], v[74:75], v[24:25]
    v_pk_fma_f32 v[24:25], v[76:77], v[76:77], v[24:25]
    v_pk_add_f32 v[26:27], v[26:27], v[76:77]
    v_pk_fma_f32 v[24:25], v[78:79], v[78:79], v[24:25]
    v_pk_add_f32 v[26:27], v[26:27], v[78:79]
    v_add_f32 v137, v24, v25
    v_add_f32 v133, v26, v27
    v_lshlrev_b32 v16, 16, v104
    v_and_b32 v17, s50, v104
    v_lshlrev_b32 v18, 16, v105
    v_and_b32 v19, s50, v105
    v_lshlrev_b32 v20, 16, v106
    v_and_b32 v21, s50, v106
    v_lshlrev_b32 v22, 16, v107
    v_and_b32 v23, s50, v107
    v_pk_fma_f32 v[80:81], v[80:81], v[112:113], v[16:17]
    v_pk_fma_f32 v[82:83], v[82:83], v[114:115], v[18:19]
    v_pk_fma_f32 v[84:85], v[84:85], v[116:117], v[20:21]
    v_pk_fma_f32 v[86:87], v[86:87], v[118:119], v[22:23]
    v_pk_mul_f32 v[16:17], v[80:81], v[120:121]
    v_pk_mul_f32 v[18:19], v[82:83], v[122:123]
    v_pk_mul_f32 v[20:21], v[84:85], v[124:125]
    v_pk_mul_f32 v[22:23], v[86:87], v[126:127]
    v_cvt_pk_bf16_f32 v48, v16, v17
    v_cvt_pk_bf16_f32 v49, v18, v19
    v_cvt_pk_bf16_f32 v50, v20, v21
    v_cvt_pk_bf16_f32 v51, v22, v23
    buffer_store_dwordx4 v[48:51], v128, s[40:43], s21 offen offset:512 sc0 sc1
    v_pk_mul_f32 v[16:17], v[80:81], v[80:81]
    v_pk_add_f32 v[18:19], v[80:81], v[82:83]
    v_pk_fma_f32 v[16:17], v[82:83], v[82:83], v[16:17]
    v_pk_fma_f32 v[16:17], v[84:85], v[84:85], v[16:17]
    v_pk_add_f32 v[18:19], v[18:19], v[84:85]
    v_pk_fma_f32 v[16:17], v[86:87], v[86:87], v[16:17]
    v_pk_add_f32 v[18:19], v[18:19], v[86:87]
    v_add_f32 v138, v16, v17
    v_add_f32 v134, v18, v19
    v_lshlrev_b32 v24, 16, v108
    v_and_b32 v25, s50, v108
    v_lshlrev_b32 v26, 16, v109
    v_and_b32 v27, s50, v109
    v_lshlrev_b32 v28, 16, v110
    v_and_b32 v29, s50, v110
    v_lshlrev_b32 v30, 16, v111
    v_and_b32 v31, s50, v111
    v_pk_fma_f32 v[88:89], v[88:89], v[112:113], v[24:25]
    v_pk_fma_f32 v[90:91], v[90:91], v[114:115], v[26:27]
    v_pk_fma_f32 v[92:93], v[92:93], v[116:117], v[28:29]
    v_pk_fma_f32 v[94:95], v[94:95], v[118:119], v[30:31]
    v_pk_mul_f32 v[24:25], v[88:89], v[120:121]
    v_pk_mul_f32 v[26:27], v[90:91], v[122:123]
    v_pk_mul_f32 v[28:29], v[92:93], v[124:125]
    v_pk_mul_f32 v[30:31], v[94:95], v[126:127]
    v_cvt_pk_bf16_f32 v52, v24, v25
    v_cvt_pk_bf16_f32 v53, v26, v27
    v_cvt_pk_bf16_f32 v54, v28, v29
    v_cvt_pk_bf16_f32 v55, v30, v31
    buffer_store_dwordx4 v[52:55], v128, s[40:43], s21 offen offset:768 sc0 sc1
    v_pk_mul_f32 v[24:25], v[88:89], v[88:89]
    v_pk_add_f32 v[26:27], v[88:89], v[90:91]
    v_pk_fma_f32 v[24:25], v[90:91], v[90:91], v[24:25]
    v_pk_fma_f32 v[24:25], v[92:93], v[92:93], v[24:25]
    v_pk_add_f32 v[26:27], v[26:27], v[92:93]
    v_pk_fma_f32 v[24:25], v[94:95], v[94:95], v[24:25]
    v_pk_add_f32 v[26:27], v[26:27], v[94:95]
    v_add_f32 v139, v24, v25
    v_add_f32 v135, v26, v27
    v_permlane32_swap_b32 v132, v134
    s_nop 0
    v_permlane32_swap_b32 v133, v135
    v_permlane32_swap_b32 v136, v138
    v_permlane32_swap_b32 v137, v139
    v_add_f32 v132, v132, v134
    v_add_f32 v133, v133, v135
    v_add_f32 v136, v136, v138
    v_add_f32 v137, v137, v139
    v_permlane16_swap_b32 v132, v133
    s_nop 0
    v_permlane16_swap_b32 v136, v137
    v_add_f32 v132, v132, v133
    v_add_f32 v136, v136, v137
    v_lshlrev_b32 v7, 2, v2
    s_lshl_b32 s49, s20, 8
    buffer_atomic_add_f32 v132, v7, s[44:47], s49 offen
    s_add_u32 s49, s49, 8192
    buffer_atomic_add_f32 v136, v7, s[44:47], s49 offen
    s_cbranch_vccz k2_nz
    s_mov_b64 exec, vcc
    v_cvt_pk_bf16_f32 v96, v64, v65
    v_cvt_pk_bf16_f32 v97, v66, v67
    v_cvt_pk_bf16_f32 v98, v68, v69
    v_cvt_pk_bf16_f32 v99, v70, v71
    buffer_store_dwordx4 v[96:99], v128, s[36:39], s21 offen offset:0 sc0 sc1
    v_cvt_pk_bf16_f32 v100, v72, v73
    v_cvt_pk_bf16_f32 v101, v74, v75
    v_cvt_pk_bf16_f32 v102, v76, v77
    v_cvt_pk_bf16_f32 v103, v78, v79
    buffer_store_dwordx4 v[100:103], v128, s[36:39], s21 offen offset:256 sc0 sc1
    v_cvt_pk_bf16_f32 v104, v80, v81
    v_cvt_pk_bf16_f32 v105, v82, v83
    v_cvt_pk_bf16_f32 v106, v84, v85
    v_cvt_pk_bf16_f32 v107, v86, v87
    buffer_store_dwordx4 v[104:107], v128, s[36:39], s21 offen offset:512 sc0 sc1
    v_cvt_pk_bf16_f32 v108, v88, v89
    v_cvt_pk_bf16_f32 v109, v90, v91
    v_cvt_pk_bf16_f32 v110, v92, v93
    v_cvt_pk_bf16_f32 v111, v94, v95
    buffer_store_dwordx4 v[108:111], v128, s[36:39], s21 offen offset:768 sc0 sc1
    s_mov_b64 exec, -1
k2_nz:
    s_endpgm
k2_kernel_prod:
    v_and_b32 v2, 63, v0
    v_lshrrev_b32 v3, 3, v2
    v_and_b32 v4, 7, v2
    s_sub_u32 s17, s16, 4
    s_lshl_b32 s18, s14, 7
    s_lshl_b32 s60, s17, 16
    s_lshl_b32 s61, s18, 4
    s_add_u32 s60, s60, s61
    v_lshlrev_b32 v8, 4, v2
    v_add_u32 v8, s60, v8
    v_add_u32 v9, 30720, v8
    s_and_b32 s60, s15, 7
    s_lshl_b32 s19, s15, 7
    s_lshr_b32 s61, s15, 3
    s_mul_i32 s61, s61, 131072
    s_cmp_eq_u32 s60, 3
    s_mov_b32 s51, 2048
    s_cmov_b32 s51, 128
    s_cselect_b32 s19, s61, s19
    s_lshl_b32 s53, s51, 6
    s_lshl_b32 s60, s17, 4
    v_add_u32 v5, s60, v3
    v_mul_lo_u32 v10, v5, s51
    s_lshl_b32 s61, s51, 3
    s_sub_u32 s61, s61, 1024
    v_add_u32 v10, s19, v10
    v_bfe_u32 v6, v5, 1, 1
    v_lshlrev_b32 v6, 2, v6
    v_bfe_u32 v5, v5, 2, 1
    v_lshl_or_b32 v6, v5, 1, v6
    v_xor_b32 v6, v6, v4
    v_lshl_add_u32 v10, v6, 4, v10
    v_add_u32 v11, s61, v10
    s_lshl_b32 s40, s17, 11
    s_lshl_b32 s43, s17, 12
    s_waitcnt lgkmcnt(0)
    s_add_u32 s20, s4, 9437184
    s_addc_u32 s21, s5, 0
    s_and_b32 s21, s21, 0xffff
    s_mov_b32 s22, 4194304
    s_mov_b32 s23, 0x00020000
    s_add_u32 s24, s4, 56360960
    s_addc_u32 s25, s5, 0
    s_cmpk_eq_u32 s51, 128
    s_cselect_b32 s24, s24, s8
    s_cselect_b32 s25, s25, s9
    s_and_b32 s25, s25, 0xffff
    s_mov_b32 s26, 2097152
    s_mov_b32 s27, 0x00020000
    v_lshlrev_b32 v12, 6, v2
    s_lshl_b32 s46, s2, 2
    s_add_u32 s46, s46, s17
    s_lshl_b32 s46, s46, 12
    s_mov_b32 s28, s12
    s_and_b32 s29, s13, 0xffff
    s_mov_b32 s30, 8388608
    s_mov_b32 s31, 0x00020000
    s_lshl_b32 s12, s2, 2
    s_add_u32 s12, s12, s17
    s_mul_i32 s12, s12, 2048
    s_add_u32 m0, s43, 0
    s_mov_b32 s41, 0
    buffer_load_dwordx4 v8, s[20:23], s41 offen offset:0 lds
    buffer_load_dwordx4 v8, s[20:23], s41 offen offset:1024 lds
    buffer_load_dwordx4 v9, s[20:23], s41 offen offset:2048 lds
    buffer_load_dwordx4 v9, s[20:23], s41 offen offset:3072 lds
    s_mul_i32 s42, s53, 0
    s_add_u32 m0, s40, 98304
    s_nop 0
    buffer_load_dwordx4 v10, s[24:27], s42 offen offset:0 lds
    buffer_load_dwordx4 v11, s[24:27], s42 offen offset:1024 lds
    s_add_u32 m0, s43, 16384
    s_mov_b32 s41, 262144
    buffer_load_dwordx4 v8, s[20:23], s41 offen offset:0 lds
    buffer_load_dwordx4 v8, s[20:23], s41 offen offset:1024 lds
    buffer_load_dwordx4 v9, s[20:23], s41 offen offset:2048 lds
    buffer_load_dwordx4 v9, s[20:23], s41 offen offset:3072 lds
    s_mul_i32 s42, s53, 1
    s_add_u32 m0, s40, 106496
    s_nop 0
    buffer_load_dwordx4 v10, s[24:27], s42 offen offset:0 lds
    buffer_load_dwordx4 v11, s[24:27], s42 offen offset:1024 lds
    s_add_u32 m0, s43, 32768
    s_mov_b32 s41, 524288
    buffer_load_dwordx4 v8, s[20:23], s41 offen offset:0 lds
    buffer_load_dwordx4 v8, s[20:23], s41 offen offset:1024 lds
    buffer_load_dwordx4 v9, s[20:23], s41 offen offset:2048 lds
    buffer_load_dwordx4 v9, s[20:23], s41 offen offset:3072 lds
    s_mul_i32 s42, s53, 2
    s_add_u32 m0, s40, 114688
    s_nop 0
    buffer_load_dwordx4 v10, s[24:27], s42 offen offset:0 lds
    buffer_load_dwordx4 v11, s[24:27], s42 offen offset:1024 lds
    s_add_u32 m0, s43, 49152
    s_mov_b32 s41, 786432
    buffer_load_dwordx4 v8, s[20:23], s41 offen offset:0 lds
    buffer_load_dwordx4 v8, s[20:23], s41 offen offset:1024 lds
    buffer_load_dwordx4 v9, s[20:23], s41 offen offset:2048 lds
    buffer_load_dwordx4 v9, s[20:23], s41 offen offset:3072 lds
    s_mul_i32 s42, s53, 3
    s_add_u32 m0, s40, 122880
    s_nop 0
    buffer_load_dwordx4 v10, s[24:27], s42 offen offset:0 lds
    buffer_load_dwordx4 v11, s[24:27], s42 offen offset:1024 lds
    s_waitcnt vmcnt(18)
    s_barrier
    s_add_u32 m0, s43, 65536
    s_mov_b32 s41, 1048576
    buffer_load_dwordx4 v8, s[20:23], s41 offen offset:0 lds
    buffer_load_dwordx4 v8, s[20:23], s41 offen offset:1024 lds
    buffer_load_dwordx4 v9, s[20:23], s41 offen offset:2048 lds
    buffer_load_dwordx4 v9, s[20:23], s41 offen offset:3072 lds
    s_mul_i32 s42, s53, 4
    s_add_u32 m0, s40, 131072
    s_nop 0
    buffer_load_dwordx4 v10, s[24:27], s42 offen offset:0 lds
    buffer_load_dwordx4 v11, s[24:27], s42 offen offset:1024 lds
    s_add_u32 m0, s43, 81920
    s_mov_b32 s41, 1310720
    buffer_load_dwordx4 v8, s[20:23], s41 offen offset:0 lds
    buffer_load_dwordx4 v8, s[20:23], s41 offen offset:1024 lds
    buffer_load_dwordx4 v9, s[20:23], s41 offen offset:2048 lds
    buffer_load_dwordx4 v9, s[20:23], s41 offen offset:3072 lds
    s_mul_i32 s42, s53, 5
    s_add_u32 m0, s40, 139264
    s_nop 0
    buffer_load_dwordx4 v10, s[24:27], s42 offen offset:0 lds
    buffer_load_dwordx4 v11, s[24:27], s42 offen offset:1024 lds
    s_buffer_load_dword s13, s[28:31], s12 offset:0
    s_buffer_load_dword s13, s[28:31], s12 offset:64
    s_waitcnt vmcnt(24)
    s_barrier
    s_add_u32 m0, s43, 0
    s_mov_b32 s41, 1572864
    buffer_load_dwordx4 v8, s[20:23], s41 offen offset:0 lds
    buffer_load_dwordx4 v8, s[20:23], s41 offen offset:1024 lds
    buffer_load_dwordx4 v9, s[20:23], s41 offen offset:2048 lds
    buffer_load_dwordx4 v9, s[20:23], s41 offen offset:3072 lds
    s_mul_i32 s42, s53, 6
    s_add_u32 m0, s40, 98304
    s_nop 0
    buffer_load_dwordx4 v10, s[24:27], s42 offen offset:0 lds
    buffer_load_dwordx4 v11, s[24:27], s42 offen offset:1024 lds
    s_buffer_load_dword s13, s[28:31], s12 offset:128
    s_buffer_load_dword s13, s[28:31], s12 offset:192
    s_waitcnt vmcnt(24)
    s_barrier
    s_add_u32 m0, s43, 16384
    s_mov_b32 s41, 1835008
    buffer_load_dwordx4 v8, s[20:23], s41 offen offset:0 lds
    buffer_load_dwordx4 v8, s[20:23], s41 offen offset:1024 lds
    buffer_load_dwordx4 v9, s[20:23], s41 offen offset:2048 lds
    buffer_load_dwordx4 v9, s[20:23], s41 offen offset:3072 lds
    s_mul_i32 s42, s53, 7
    s_add_u32 m0, s40, 106496
    s_nop 0
    buffer_load_dwordx4 v10, s[24:27], s42 offen offset:0 lds
    buffer_load_dwordx4 v11, s[24:27], s42 offen offset:1024 lds
    s_buffer_load_dword s13, s[28:31], s12 offset:256
    s_buffer_load_dword s13, s[28:31], s12 offset:320
    s_waitcnt vmcnt(24)
    s_barrier
    s_add_u32 m0, s43, 32768
    s_mov_b32 s41, 2097152
    buffer_load_dwordx4 v8, s[20:23], s41 offen offset:0 lds
    buffer_load_dwordx4 v8, s[20:23], s41 offen offset:1024 lds
    buffer_load_dwordx4 v9, s[20:23], s41 offen offset:2048 lds
    buffer_load_dwordx4 v9, s[20:23], s41 offen offset:3072 lds
    s_mul_i32 s42, s53, 8
    s_add_u32 m0, s40, 114688
    s_nop 0
    buffer_load_dwordx4 v10, s[24:27], s42 offen offset:0 lds
    buffer_load_dwordx4 v11, s[24:27], s42 offen offset:1024 lds
    s_buffer_load_dword s13, s[28:31], s12 offset:384
    s_buffer_load_dword s13, s[28:31], s12 offset:448
    s_waitcnt vmcnt(24)
    s_barrier
    s_add_u32 m0, s43, 49152
    s_mov_b32 s41, 2359296
    buffer_load_dwordx4 v8, s[20:23], s41 offen offset:0 lds
    buffer_load_dwordx4 v8, s[20:23], s41 offen offset:1024 lds
    buffer_load_dwordx4 v9, s[20:23], s41 offen offset:2048 lds
    buffer_load_dwordx4 v9, s[20:23], s41 offen offset:3072 lds
    s_mul_i32 s42, s53, 9
    s_add_u32 m0, s40, 122880
    s_nop 0
    buffer_load_dwordx4 v10, s[24:27], s42 offen offset:0 lds
    buffer_load_dwordx4 v11, s[24:27], s42 offen offset:1024 lds
    s_buffer_load_dword s13, s[28:31], s12 offset:512
    s_buffer_load_dword s13, s[28:31], s12 offset:576
    s_waitcnt vmcnt(24)
    s_barrier
    s_add_u32 m0, s43, 65536
    s_mov_b32 s41, 2621440
    buffer_load_dwordx4 v8, s[20:23], s41 offen offset:0 lds
    buffer_load_dwordx4 v8, s[20:23], s41 offen offset:1024 lds
    buffer_load_dwordx4 v9, s[20:23], s41 offen offset:2048 lds
    buffer_load_dwordx4 v9, s[20:23], s41 offen offset:3072 lds
    s_mul_i32 s42, s53, 10
    s_add_u32 m0, s40, 131072
    s_nop 0
    buffer_load_dwordx4 v10, s[24:27], s42 offen offset:0 lds
    buffer_load_dwordx4 v11, s[24:27], s42 offen offset:1024 lds
    s_buffer_load_dword s13, s[28:31], s12 offset:640
    s_buffer_load_dword s13, s[28:31], s12 offset:704
    s_waitcnt vmcnt(24)
    s_barrier
    s_add_u32 m0, s43, 81920
    s_mov_b32 s41, 2883584
    buffer_load_dwordx4 v8, s[20:23], s41 offen offset:0 lds
    buffer_load_dwordx4 v8, s[20:23], s41 offen offset:1024 lds
    buffer_load_dwordx4 v9, s[20:23], s41 offen offset:2048 lds
    buffer_load_dwordx4 v9, s[20:23], s41 offen offset:3072 lds
    s_mul_i32 s42, s53, 11
    s_add_u32 m0, s40, 139264
    s_nop 0
    buffer_load_dwordx4 v10, s[24:27], s42 offen offset:0 lds
    buffer_load_dwordx4 v11, s[24:27], s42 offen offset:1024 lds
    s_buffer_load_dword s13, s[28:31], s12 offset:768
    s_buffer_load_dword s13, s[28:31], s12 offset:832
    s_waitcnt vmcnt(24)
    s_barrier
    s_add_u32 m0, s43, 0
    s_mov_b32 s41, 3145728
    buffer_load_dwordx4 v8, s[20:23], s41 offen offset:0 lds
    buffer_load_dwordx4 v8, s[20:23], s41 offen offset:1024 lds
    buffer_load_dwordx4 v9, s[20:23], s41 offen offset:2048 lds
    buffer_load_dwordx4 v9, s[20:23], s41 offen offset:3072 lds
    s_mul_i32 s42, s53, 12
    s_add_u32 m0, s40, 98304
    s_nop 0
    buffer_load_dwordx4 v10, s[24:27], s42 offen offset:0 lds
    buffer_load_dwordx4 v11, s[24:27], s42 offen offset:1024 lds
    s_buffer_load_dword s13, s[28:31], s12 offset:896
    s_buffer_load_dword s13, s[28:31], s12 offset:960
    s_waitcnt vmcnt(24)
    s_barrier
    s_add_u32 m0, s43, 16384
    s_mov_b32 s41, 3407872
    buffer_load_dwordx4 v8, s[20:23], s41 offen offset:0 lds
    buffer_load_dwordx4 v8, s[20:23], s41 offen offset:1024 lds
    buffer_load_dwordx4 v9, s[20:23], s41 offen offset:2048 lds
    buffer_load_dwordx4 v9, s[20:23], s41 offen offset:3072 lds
    s_mul_i32 s42, s53, 13
    s_add_u32 m0, s40, 106496
    s_nop 0
    buffer_load_dwordx4 v10, s[24:27], s42 offen offset:0 lds
    buffer_load_dwordx4 v11, s[24:27], s42 offen offset:1024 lds
    s_buffer_load_dword s13, s[28:31], s12 offset:1024
    s_buffer_load_dword s13, s[28:31], s12 offset:1088
    s_waitcnt vmcnt(24)
    s_barrier
    s_add_u32 m0, s43, 32768
    s_mov_b32 s41, 3670016
    buffer_load_dwordx4 v8, s[20:23], s41 offen offset:0 lds
    buffer_load_dwordx4 v8, s[20:23], s41 offen offset:1024 lds
    buffer_load_dwordx4 v9, s[20:23], s41 offen offset:2048 lds
    buffer_load_dwordx4 v9, s[20:23], s41 offen offset:3072 lds
    s_mul_i32 s42, s53, 14
    s_add_u32 m0, s40, 114688
    s_nop 0
    buffer_load_dwordx4 v10, s[24:27], s42 offen offset:0 lds
    buffer_load_dwordx4 v11, s[24:27], s42 offen offset:1024 lds
    s_buffer_load_dword s13, s[28:31], s12 offset:1152
    s_buffer_load_dword s13, s[28:31], s12 offset:1216
    s_waitcnt vmcnt(24)
    s_barrier
    s_add_u32 m0, s43, 49152
    s_mov_b32 s41, 3932160
    buffer_load_dwordx4 v8, s[20:23], s41 offen offset:0 lds
    buffer_load_dwordx4 v8, s[20:23], s41 offen offset:1024 lds
    buffer_load_dwordx4 v9, s[20:23], s41 offen offset:2048 lds
    buffer_load_dwordx4 v9, s[20:23], s41 offen offset:3072 lds
    s_mul_i32 s42, s53, 15
    s_add_u32 m0, s40, 122880
    s_nop 0
    buffer_load_dwordx4 v10, s[24:27], s42 offen offset:0 lds
    buffer_load_dwordx4 v11, s[24:27], s42 offen offset:1024 lds
    s_buffer_load_dword s13, s[28:31], s12 offset:1280
    s_buffer_load_dword s13, s[28:31], s12 offset:1344
    s_waitcnt vmcnt(24)
    s_barrier
    s_buffer_load_dword s13, s[28:31], s12 offset:1408
    s_buffer_load_dword s13, s[28:31], s12 offset:1472
    s_waitcnt vmcnt(18)
    s_getpc_b64 s[48:49]
pfc_5:
    s_add_u32 s48, s48, k3_kernel-pfc_5
    s_addc_u32 s49, s49, 0
    s_lshr_b32 s50, s2, 3
    s_lshl_b32 s50, s50, 2
    s_add_u32 s50, s50, s17
    s_lshl_b32 s50, s50, 8
    v_and_b32 v14, 3, v2
    v_lshlrev_b32 v14, 6, v14
    v_add_u32 v14, s50, v14
    v_min_u32 v14, k3_kernel_end-k3_kernel, v14
    global_load_dword v16, v14, s[48:49]
    v_add_u32 v14, 0x8000, v14
    v_min_u32 v14, k3_kernel_end-k3_kernel, v14
    global_load_dword v17, v14, s[48:49]
    s_barrier
    s_buffer_load_dword s13, s[28:31], s12 offset:1536
    s_buffer_load_dword s13, s[28:31], s12 offset:1600
    s_waitcnt vmcnt(14)
    s_barrier
    s_buffer_load_dword s13, s[28:31], s12 offset:1664
    s_buffer_load_dword s13, s[28:31], s12 offset:1728
    s_waitcnt vmcnt(8)
    s_barrier
    s_buffer_load_dword s13, s[28:31], s12 offset:1792
    s_buffer_load_dword s13, s[28:31], s12 offset:1856
    s_waitcnt vmcnt(2)
    s_barrier
    s_buffer_load_dword s13, s[28:31], s12 offset:1920
    s_buffer_load_dword s13, s[28:31], s12 offset:1984
    s_barrier
k2_kernel_end:
    s_endpgm
.text
.globl k3_kernel
.p2align 8
.type k3_kernel,@function
k3_kernel:
    s_cmp_ge_u32 s2, 256
    s_cbranch_scc1 k3_kernel_end
    v_lshrrev_b32 v1, 6, v0
    s_nop 0
    v_readfirstlane_b32 s16, v1
    s_load_dwordx2 s[4:5], s[0:1], 104
    s_load_dwordx2 s[8:9], s[0:1], 40
    s_load_dwordx2 s[50:51], s[0:1], 48
    s_load_dwordx2 s[52:53], s[0:1], 64
    s_and_b32 s3, s2, 7
    s_lshr_b32 s6, s2, 3
    s_and_b32 s14, s3, 1
    s_lshl_b32 s14, s14, 3
    s_and_b32 s7, s6, 7
    s_add_u32 s14, s14, s7
    s_lshr_b32 s15, s3, 1
    s_lshl_b32 s15, s15, 2
    s_lshr_b32 s7, s6, 3
    s_add_u32 s15, s15, s7
    s_lshr_b32 s13, s15, 1
    s_mul_i32 s12, s13, 7
    s_and_b32 s7, s13, 1
    s_add_u32 s10, s12, s7
    s_mul_i32 s7, s7, 6
    s_sub_u32 s11, s12, s7
    s_add_u32 s11, s11, 6
    s_and_b32 s7, s15, 1
    s_mul_i32 s7, s7, 56
    s_add_u32 s11, s11, s7
    s_add_u32 s13, s10, s7
    s_sub_u32 s10, s10, s7
    s_add_u32 s10, s10, 56
    s_cmp_ge_u32 s16, 4
    s_cbranch_scc1 k3_kernel_prod
    v_and_b32 v2, 63, v0
    v_and_b32 v3, 15, v0
    v_bfe_u32 v4, v0, 4, 2
    v_bfe_u32 v5, v0, 2, 2
    v_and_b32 v6, 3, v0
    s_lshr_b32 s17, s16, 1
    s_and_b32 s18, s16, 1
    s_lshl_b32 s19, s18, 5
    v_xor_b32 v9, s19, v2
    v_lshlrev_b32 v9, 2, v9
    v_lshlrev_b32 v10, 4, v4
    s_lshl_b32 s20, s14, 1
    s_add_u32 s20, s20, s17
    s_lshl_b32 s21, s20, 8
    s_add_u32 s22, s21, 8192
    s_add_u32 s23, s10, s18
    s_lshl_b32 s24, s23, 7
    s_lshl_b32 s25, s11, 7
    s_add_u32 s26, s24, 14336
    s_add_u32 s27, s25, 14336
    s_add_u32 s47, s13, s18
    s_lshl_b32 s56, s47, 7
    s_add_u32 s58, s56, 14336
    s_waitcnt lgkmcnt(0)
    s_add_u32 s28, s4, 65536
    s_addc_u32 s29, s5, 0
    s_and_b32 s29, s29, 0xffff
    s_mov_b32 s30, 16384
    s_mov_b32 s31, 0x00020000
    s_add_u32 s32, s4, 98304
    s_addc_u32 s33, s5, 0
    s_and_b32 s33, s33, 0xffff
    s_mov_b32 s34, 28672
    s_mov_b32 s35, 0x00020000
    s_add_u32 s36, s4, 17825792
    s_addc_u32 s37, s5, 0
    s_and_b32 s37, s37, 0xffff
    s_mov_b32 s38, 14680064
    s_mov_b32 s39, 0x00020000
    s_add_u32 s40, s4, 524288
    s_addc_u32 s41, s5, 0
    s_and_b32 s41, s41, 0xffff
    s_mov_b32 s42, 524288
    s_mov_b32 s43, 0x00020000
    buffer_load_dword v224, v9, s[28:31], s21 offen
    buffer_load_dword v228, v9, s[28:31], s22 offen
    buffer_load_dwordx4 v[12:15], v10, s[32:35], s24 offen offset:0
    buffer_load_dwordx4 v[16:19], v10, s[32:35], s24 offen offset:64
    buffer_load_dwordx4 v[20:23], v10, s[32:35], s24 offen offset:256
    buffer_load_dwordx4 v[24:27], v10, s[32:35], s24 offen offset:320
    buffer_load_dwordx4 v[28:31], v10, s[32:35], s56 offen offset:512
    buffer_load_dwordx4 v[32:35], v10, s[32:35], s56 offen offset:576
    buffer_load_dwordx4 v[36:39], v10, s[32:35], s25 offen offset:0
    buffer_load_dwordx4 v[40:43], v10, s[32:35], s25 offen offset:64
    buffer_load_dwordx4 v[44:47], v10, s[32:35], s26 offen offset:0
    buffer_load_dwordx4 v[48:51], v10, s[32:35], s26 offen offset:64
    buffer_load_dwordx4 v[52:55], v10, s[32:35], s26 offen offset:256
    buffer_load_dwordx4 v[56:59], v10, s[32:35], s26 offen offset:320
    buffer_load_dwordx4 v[60:63], v10, s[32:35], s58 offen offset:512
    buffer_load_dwordx4 v[64:67], v10, s[32:35], s58 offen offset:576
    buffer_load_dwordx4 v[68:71], v10, s[32:35], s27 offen offset:0
    buffer_load_dwordx4 v[72:75], v10, s[32:35], s27 offen offset:64
    v_lshlrev_b32 v232, 11, v4
    v_lshl_add_u32 v232, v3, 4, v232
    s_lshl_b32 s60, s17, 10
    v_add_u32 v232, s60, v232
    s_lshl_b32 s19, s18, 9
    v_add_u32 v232, s19, v232
    v_xor_b32 v233, 512, v232
    v_lshl_add_u32 v236, v4, 2, v5
    v_lshlrev_b32 v236, 7, v236
    v_lshl_add_u32 v236, v6, 3, v236
    v_lshrrev_b32 v7, 1, v5
    v_xor_b32 v7, s18, v7
    v_lshl_add_u32 v236, v7, 6, v236
    v_and_b32 v7, 1, v4
    v_lshl_add_u32 v236, v7, 5, v236
    v_add_u32 v236, 49152, v236
    v_xor_b32 v237, 32, v236
    v_add_u32 v238, 57344, v236
    v_add_u32 v239, 57344, v237
    v_lshl_add_u32 v240, v4, 2, v5
    v_lshlrev_b32 v240, 6, v240
    v_lshl_add_u32 v240, v6, 3, v240
    v_and_b32 v7, 1, v4
    v_lshl_add_u32 v240, v7, 5, v240
    v_add_u32 v240, 73728, v240
    v_xor_b32 v241, 32, v240
    v_add_u32 v242, 57344, v240
    v_add_u32 v243, 57344, v241
    v_lshlrev_b32 v244, 15, v4
    v_lshl_add_u32 v244, v3, 4, v244
    v_add_u32 v244, s19, v244
    v_xor_b32 v245, 512, v244
    s_lshl_b32 s44, s20, 10
    s_lshl_b32 s45, s23, 17
    s_add_u32 s45, s45, s44
    s_lshl_b32 s46, s11, 17
    s_add_u32 s46, s46, s44
    s_add_u32 s49, s45, 262144
    s_lshl_b32 s47, s47, 17
    s_add_u32 s47, s47, s44
    s_add_u32 s47, s47, 524288
    s_waitcnt vmcnt(16)
    v_mul_f32 v224, 0x3a800000, v224
    v_mul_f32 v228, 0x3a800000, v228
    v_fma_f32 v228, -v224, v224, v228
    v_max_f32 v228, 0, v228
    v_cvt_pk_bf16_f32 v228, v228, v228
    v_and_b32 v228, 0xffff0000, v228
    v_add_f32 v228, 0x3727c5ac, v228
    v_cvt_pk_bf16_f32 v228, v228, v228
    v_and_b32 v228, 0xffff0000, v228
    v_sqrt_f32 v220, v228
    s_nop 0
    v_cvt_pk_bf16_f32 v220, v220, v220
    v_and_b32 v220, 0xffff0000, v220
    v_cvt_pk_bf16_f32 v224, v224, v224
    v_and_b32 v224, 0xffff0000, v224
    v_sub_f32 v248, 0, v224
    v_rcp_f32 v7, v220
    s_nop 0
    v_mul_f32 v224, 0xc0135761, v7
    v_mul_f32 v8, v7, v7
    v_mul_f32 v8, v8, v7
    v_mul_f32 v228, 0xbdd2d3e8, v8
    v_mov_b32 v249, v248
    s_nop 1
    v_permlane16_swap_b32 v248, v249
    v_mov_b32 v250, v248
    v_mov_b32 v251, v249
    s_nop 0
    v_permlane32_swap_b32 v248, v250
    v_permlane32_swap_b32 v249, v251
    v_mov_b32 v221, v220
    s_nop 1
    v_permlane16_swap_b32 v220, v221
    v_mov_b32 v222, v220
    v_mov_b32 v223, v221
    s_nop 0
    v_permlane32_swap_b32 v220, v222
    v_permlane32_swap_b32 v221, v223
    v_mov_b32 v225, v224
    s_nop 1
    v_permlane16_swap_b32 v224, v225
    v_mov_b32 v226, v224
    v_mov_b32 v227, v225
    s_nop 0
    v_permlane32_swap_b32 v224, v226
    v_permlane32_swap_b32 v225, v227
    v_mov_b32 v229, v228
    s_nop 1
    v_permlane16_swap_b32 v228, v229
    v_mov_b32 v230, v228
    v_mov_b32 v231, v229
    s_nop 0
    v_permlane32_swap_b32 v228, v230
    v_permlane32_swap_b32 v229, v231
    s_waitcnt vmcnt(6)
    v_pk_mul_f32 v[108:109], v[12:13], v[248:249] op_sel:[0,0] op_sel_hi:[1,0]
    v_pk_mul_f32 v[110:111], v[14:15], v[248:249] op_sel:[0,0] op_sel_hi:[1,0]
    v_pk_mul_f32 v[112:113], v[16:17], v[248:249] op_sel:[0,0] op_sel_hi:[1,0]
    v_pk_mul_f32 v[114:115], v[18:19], v[248:249] op_sel:[0,0] op_sel_hi:[1,0]
    v_pk_fma_f32 v[108:109], v[44:45], v[220:221], v[108:109] op_sel:[0,0,0] op_sel_hi:[1,0,1]
    v_pk_fma_f32 v[110:111], v[46:47], v[220:221], v[110:111] op_sel:[0,0,0] op_sel_hi:[1,0,1]
    v_pk_fma_f32 v[112:113], v[48:49], v[220:221], v[112:113] op_sel:[0,0,0] op_sel_hi:[1,0,1]
    v_pk_fma_f32 v[114:115], v[50:51], v[220:221], v[114:115] op_sel:[0,0,0] op_sel_hi:[1,0,1]
    v_pk_mul_f32 v[116:117], v[12:13], v[248:249] op_sel:[0,1] op_sel_hi:[1,1]
    v_pk_mul_f32 v[118:119], v[14:15], v[248:249] op_sel:[0,1] op_sel_hi:[1,1]
    v_pk_mul_f32 v[120:121], v[16:17], v[248:249] op_sel:[0,1] op_sel_hi:[1,1]
    v_pk_mul_f32 v[122:123], v[18:19], v[248:249] op_sel:[0,1] op_sel_hi:[1,1]
    v_pk_fma_f32 v[116:117], v[44:45], v[220:221], v[116:117] op_sel:[0,1,0] op_sel_hi:[1,1,1]
    v_pk_fma_f32 v[118:119], v[46:47], v[220:221], v[118:119] op_sel:[0,1,0] op_sel_hi:[1,1,1]
    v_pk_fma_f32 v[120:121], v[48:49], v[220:221], v[120:121] op_sel:[0,1,0] op_sel_hi:[1,1,1]
    v_pk_fma_f32 v[122:123], v[50:51], v[220:221], v[122:123] op_sel:[0,1,0] op_sel_hi:[1,1,1]
    v_pk_mul_f32 v[124:125], v[12:13], v[250:251] op_sel:[0,0] op_sel_hi:[1,0]
    v_pk_mul_f32 v[126:127], v[14:15], v[250:251] op_sel:[0,0] op_sel_hi:[1,0]
    v_pk_mul_f32 v[128:129], v[16:17], v[250:251] op_sel:[0,0] op_sel_hi:[1,0]
    v_pk_mul_f32 v[130:131], v[18:19], v[250:251] op_sel:[0,0] op_sel_hi:[1,0]
    v_pk_fma_f32 v[124:125], v[44:45], v[222:223], v[124:125] op_sel:[0,0,0] op_sel_hi:[1,0,1]
    v_pk_fma_f32 v[126:127], v[46:47], v[222:223], v[126:127] op_sel:[0,0,0] op_sel_hi:[1,0,1]
    v_pk_fma_f32 v[128:129], v[48:49], v[222:223], v[128:129] op_sel:[0,0,0] op_sel_hi:[1,0,1]
    v_pk_fma_f32 v[130:131], v[50:51], v[222:223], v[130:131] op_sel:[0,0,0] op_sel_hi:[1,0,1]
    v_pk_mul_f32 v[132:133], v[12:13], v[250:251] op_sel:[0,1] op_sel_hi:[1,1]
    v_pk_mul_f32 v[134:135], v[14:15], v[250:251] op_sel:[0,1] op_sel_hi:[1,1]
    v_pk_mul_f32 v[136:137], v[16:17], v[250:251] op_sel:[0,1] op_sel_hi:[1,1]
    v_pk_mul_f32 v[138:139], v[18:19], v[250:251] op_sel:[0,1] op_sel_hi:[1,1]
    v_pk_fma_f32 v[132:133], v[44:45], v[222:223], v[132:133] op_sel:[0,1,0] op_sel_hi:[1,1,1]
    v_pk_fma_f32 v[134:135], v[46:47], v[222:223], v[134:135] op_sel:[0,1,0] op_sel_hi:[1,1,1]
    v_pk_fma_f32 v[136:137], v[48:49], v[222:223], v[136:137] op_sel:[0,1,0] op_sel_hi:[1,1,1]
    v_pk_fma_f32 v[138:139], v[50:51], v[222:223], v[138:139] op_sel:[0,1,0] op_sel_hi:[1,1,1]
    s_waitcnt vmcnt(4)
    v_pk_mul_f32 v[140:141], v[20:21], v[248:249] op_sel:[0,0] op_sel_hi:[1,0]
    v_pk_mul_f32 v[142:143], v[22:23], v[248:249] op_sel:[0,0] op_sel_hi:[1,0]
    v_pk_mul_f32 v[144:145], v[24:25], v[248:249] op_sel:[0,0] op_sel_hi:[1,0]
    v_pk_mul_f32 v[146:147], v[26:27], v[248:249] op_sel:[0,0] op_sel_hi:[1,0]
    v_pk_fma_f32 v[140:141], v[52:53], v[220:221], v[140:141] op_sel:[0,0,0] op_sel_hi:[1,0,1]
    v_pk_fma_f32 v[142:143], v[54:55], v[220:221], v[142:143] op_sel:[0,0,0] op_sel_hi:[1,0,1]
    v_pk_fma_f32 v[144:145], v[56:57], v[220:221], v[144:145] op_sel:[0,0,0] op_sel_hi:[1,0,1]
    v_pk_fma_f32 v[146:147], v[58:59], v[220:221], v[146:147] op_sel:[0,0,0] op_sel_hi:[1,0,1]
    v_pk_mul_f32 v[148:149], v[20:21], v[248:249] op_sel:[0,1] op_sel_hi:[1,1]
    v_pk_mul_f32 v[150:151], v[22:23], v[248:249] op_sel:[0,1] op_sel_hi:[1,1]
    v_pk_mul_f32 v[152:153], v[24:25], v[248:249] op_sel:[0,1] op_sel_hi:[1,1]
    v_pk_mul_f32 v[154:155], v[26:27], v[248:249] op_sel:[0,1] op_sel_hi:[1,1]
    v_pk_fma_f32 v[148:149], v[52:53], v[220:221], v[148:149] op_sel:[0,1,0] op_sel_hi:[1,1,1]
    v_pk_fma_f32 v[150:151], v[54:55], v[220:221], v[150:151] op_sel:[0,1,0] op_sel_hi:[1,1,1]
    v_pk_fma_f32 v[152:153], v[56:57], v[220:221], v[152:153] op_sel:[0,1,0] op_sel_hi:[1,1,1]
    v_pk_fma_f32 v[154:155], v[58:59], v[220:221], v[154:155] op_sel:[0,1,0] op_sel_hi:[1,1,1]
    v_pk_mul_f32 v[156:157], v[20:21], v[250:251] op_sel:[0,0] op_sel_hi:[1,0]
    v_pk_mul_f32 v[158:159], v[22:23], v[250:251] op_sel:[0,0] op_sel_hi:[1,0]
    v_pk_mul_f32 v[160:161], v[24:25], v[250:251] op_sel:[0,0] op_sel_hi:[1,0]
    v_pk_mul_f32 v[162:163], v[26:27], v[250:251] op_sel:[0,0] op_sel_hi:[1,0]
    v_pk_fma_f32 v[156:157], v[52:53], v[222:223], v[156:157] op_sel:[0,0,0] op_sel_hi:[1,0,1]
    v_pk_fma_f32 v[158:159], v[54:55], v[222:223], v[158:159] op_sel:[0,0,0] op_sel_hi:[1,0,1]
    v_pk_fma_f32 v[160:161], v[56:57], v[222:223], v[160:161] op_sel:[0,0,0] op_sel_hi:[1,0,1]
    v_pk_fma_f32 v[162:163], v[58:59], v[222:223], v[162:163] op_sel:[0,0,0] op_sel_hi:[1,0,1]
    v_pk_mul_f32 v[164:165], v[20:21], v[250:251] op_sel:[0,1] op_sel_hi:[1,1]
    v_pk_mul_f32 v[166:167], v[22:23], v[250:251] op_sel:[0,1] op_sel_hi:[1,1]
    v_pk_mul_f32 v[168:169], v[24:25], v[250:251] op_sel:[0,1] op_sel_hi:[1,1]
    v_pk_mul_f32 v[170:171], v[26:27], v[250:251] op_sel:[0,1] op_sel_hi:[1,1]
    v_pk_fma_f32 v[164:165], v[52:53], v[222:223], v[164:165] op_sel:[0,1,0] op_sel_hi:[1,1,1]
    v_pk_fma_f32 v[166:167], v[54:55], v[222:223], v[166:167] op_sel:[0,1,0] op_sel_hi:[1,1,1]
    v_pk_fma_f32 v[168:169], v[56:57], v[222:223], v[168:169] op_sel:[0,1,0] op_sel_hi:[1,1,1]
    v_pk_fma_f32 v[170:171], v[58:59], v[222:223], v[170:171] op_sel:[0,1,0] op_sel_hi:[1,1,1]
    s_waitcnt vmcnt(2)
    v_pk_mul_f32 v[172:173], v[28:29], v[248:249] op_sel:[0,0] op_sel_hi:[1,0]
    v_pk_mul_f32 v[174:175], v[30:31], v[248:249] op_sel:[0,0] op_sel_hi:[1,0]
    v_pk_mul_f32 v[176:177], v[32:33], v[248:249] op_sel:[0,0] op_sel_hi:[1,0]
    v_pk_mul_f32 v[178:179], v[34:35], v[248:249] op_sel:[0,0] op_sel_hi:[1,0]
    v_pk_fma_f32 v[172:173], v[60:61], v[220:221], v[172:173] op_sel:[0,0,0] op_sel_hi:[1,0,1]
    v_pk_fma_f32 v[174:175], v[62:63], v[220:221], v[174:175] op_sel:[0,0,0] op_sel_hi:[1,0,1]
    v_pk_fma_f32 v[176:177], v[64:65], v[220:221], v[176:177] op_sel:[0,0,0] op_sel_hi:[1,0,1]
    v_pk_fma_f32 v[178:179], v[66:67], v[220:221], v[178:179] op_sel:[0,0,0] op_sel_hi:[1,0,1]
    v_pk_mul_f32 v[180:181], v[28:29], v[248:249] op_sel:[0,1] op_sel_hi:[1,1]
    v_pk_mul_f32 v[182:183], v[30:31], v[248:249] op_sel:[0,1] op_sel_hi:[1,1]
    v_pk_mul_f32 v[184:185], v[32:33], v[248:249] op_sel:[0,1] op_sel_hi:[1,1]
    v_pk_mul_f32 v[186:187], v[34:35], v[248:249] op_sel:[0,1] op_sel_hi:[1,1]
    v_pk_fma_f32 v[180:181], v[60:61], v[220:221], v[180:181] op_sel:[0,1,0] op_sel_hi:[1,1,1]
    v_pk_fma_f32 v[182:183], v[62:63], v[220:221], v[182:183] op_sel:[0,1,0] op_sel_hi:[1,1,1]
    v_pk_fma_f32 v[184:185], v[64:65], v[220:221], v[184:185] op_sel:[0,1,0] op_sel_hi:[1,1,1]
    v_pk_fma_f32 v[186:187], v[66:67], v[220:221], v[186:187] op_sel:[0,1,0] op_sel_hi:[1,1,1]
    v_pk_mul_f32 v[188:189], v[28:29], v[250:251] op_sel:[0,0] op_sel_hi:[1,0]
    v_pk_mul_f32 v[190:191], v[30:31], v[250:251] op_sel:[0,0] op_sel_hi:[1,0]
    v_pk_mul_f32 v[192:193], v[32:33], v[250:251] op_sel:[0,0] op_sel_hi:[1,0]
    v_pk_mul_f32 v[194:195], v[34:35], v[250:251] op_sel:[0,0] op_sel_hi:[1,0]
    v_pk_fma_f32 v[188:189], v[60:61], v[222:223], v[188:189] op_sel:[0,0,0] op_sel_hi:[1,0,1]
    v_pk_fma_f32 v[190:191], v[62:63], v[222:223], v[190:191] op_sel:[0,0,0] op_sel_hi:[1,0,1]
    v_pk_fma_f32 v[192:193], v[64:65], v[222:223], v[192:193] op_sel:[0,0,0] op_sel_hi:[1,0,1]
    v_pk_fma_f32 v[194:195], v[66:67], v[222:223], v[194:195] op_sel:[0,0,0] op_sel_hi:[1,0,1]
    v_pk_mul_f32 v[196:197], v[28:29], v[250:251] op_sel:[0,1] op_sel_hi:[1,1]
    v_pk_mul_f32 v[198:199], v[30:31], v[250:251] op_sel:[0,1] op_sel_hi:[1,1]
    v_pk_mul_f32 v[200:201], v[32:33], v[250:251] op_sel:[0,1] op_sel_hi:[1,1]
    v_pk_mul_f32 v[202:203], v[34:35], v[250:251] op_sel:[0,1] op_sel_hi:[1,1]
    v_pk_fma_f32 v[196:197], v[60:61], v[222:223], v[196:197] op_sel:[0,1,0] op_sel_hi:[1,1,1]
    v_pk_fma_f32 v[198:199], v[62:63], v[222:223], v[198:199] op_sel:[0,1,0] op_sel_hi:[1,1,1]
    v_pk_fma_f32 v[200:201], v[64:65], v[222:223], v[200:201] op_sel:[0,1,0] op_sel_hi:[1,1,1]
    v_pk_fma_f32 v[202:203], v[66:67], v[222:223], v[202:203] op_sel:[0,1,0] op_sel_hi:[1,1,1]
    s_waitcnt vmcnt(0)
    v_pk_mul_f32 v[204:205], v[36:37], v[248:249] op_sel:[0,0] op_sel_hi:[1,0]
    v_pk_mul_f32 v[206:207], v[38:39], v[248:249] op_sel:[0,0] op_sel_hi:[1,0]
    v_pk_mul_f32 v[208:209], v[40:41], v[248:249] op_sel:[0,0] op_sel_hi:[1,0]
    v_pk_mul_f32 v[210:211], v[42:43], v[248:249] op_sel:[0,0] op_sel_hi:[1,0]
    v_pk_fma_f32 v[204:205], v[68:69], v[220:221], v[204:205] op_sel:[0,0,0] op_sel_hi:[1,0,1]
    v_pk_fma_f32 v[206:207], v[70:71], v[220:221], v[206:207] op_sel:[0,0,0] op_sel_hi:[1,0,1]
    v_pk_fma_f32 v[208:209], v[72:73], v[220:221], v[208:209] op_sel:[0,0,0] op_sel_hi:[1,0,1]
    v_pk_fma_f32 v[210:211], v[74:75], v[220:221], v[210:211] op_sel:[0,0,0] op_sel_hi:[1,0,1]
    v_pk_mul_f32 v[212:213], v[36:37], v[248:249] op_sel:[0,1] op_sel_hi:[1,1]
    v_pk_mul_f32 v[214:215], v[38:39], v[248:249] op_sel:[0,1] op_sel_hi:[1,1]
    v_pk_mul_f32 v[216:217], v[40:41], v[248:249] op_sel:[0,1] op_sel_hi:[1,1]
    v_pk_mul_f32 v[218:219], v[42:43], v[248:249] op_sel:[0,1] op_sel_hi:[1,1]
    v_pk_fma_f32 v[212:213], v[68:69], v[220:221], v[212:213] op_sel:[0,1,0] op_sel_hi:[1,1,1]
    v_pk_fma_f32 v[214:215], v[70:71], v[220:221], v[214:215] op_sel:[0,1,0] op_sel_hi:[1,1,1]
    v_pk_fma_f32 v[216:217], v[72:73], v[220:221], v[216:217] op_sel:[0,1,0] op_sel_hi:[1,1,1]
    v_pk_fma_f32 v[218:219], v[74:75], v[220:221], v[218:219] op_sel:[0,1,0] op_sel_hi:[1,1,1]
    v_mov_b32 v60, 0
    v_mov_b32 v61, 0
    v_mov_b32 v62, 0
    v_mov_b32 v63, 0
    v_mov_b32 v64, 0
    v_mov_b32 v65, 0
    v_mov_b32 v66, 0
    v_mov_b32 v67, 0
    v_mov_b32 v68, 0
    v_mov_b32 v69, 0
    v_mov_b32 v70, 0
    v_mov_b32 v71, 0
    v_mov_b32 v72, 0
    v_mov_b32 v73, 0
    v_mov_b32 v74, 0
    v_mov_b32 v75, 0
    v_mov_b32 v76, 0
    v_mov_b32 v77, 0
    v_mov_b32 v78, 0
    v_mov_b32 v79, 0
    v_mov_b32 v80, 0
    v_mov_b32 v81, 0
    v_mov_b32 v82, 0
    v_mov_b32 v83, 0
    v_mov_b32 v84, 0
    v_mov_b32 v85, 0
    v_mov_b32 v86, 0
    v_mov_b32 v87, 0
    v_mov_b32 v88, 0
    v_mov_b32 v89, 0
    v_mov_b32 v90, 0
    v_mov_b32 v91, 0
    v_mov_b32 v92, 0
    v_mov_b32 v93, 0
    v_mov_b32 v94, 0
    v_mov_b32 v95, 0
    v_mov_b32 v96, 0
    v_mov_b32 v97, 0
    v_mov_b32 v98, 0
    v_mov_b32 v99, 0
    v_mov_b32 v100, 0
    v_mov_b32 v101, 0
    v_mov_b32 v102, 0
    v_mov_b32 v103, 0
    v_mov_b32 v104, 0
    v_mov_b32 v105, 0
    v_mov_b32 v106, 0
    v_mov_b32 v107, 0
    s_mov_b32 s48, 1
    s_barrier
k3_kernel_cloop:
    v_mfma_f32_16x16x32_bf16 v[108:111], v[76:79], v[60:63], v[108:111]
    ds_read_b128 v[12:15], v232 offset:0
    v_mfma_f32_16x16x32_bf16 v[116:119], v[76:79], v[64:67], v[116:119]
    ds_read_b64_tr_b16 v[28:29], v236 offset:0
    v_mfma_f32_16x16x32_bf16 v[124:127], v[76:79], v[68:71], v[124:127]
    ds_read_b64_tr_b16 v[30:31], v236 offset:2048
    v_mfma_f32_16x16x32_bf16 v[132:135], v[76:79], v[72:75], v[132:135]
    ds_read_b128 v[16:19], v232 offset:256
    v_mfma_f32_16x16x32_bf16 v[112:115], v[80:83], v[60:63], v[112:115]
    ds_read_b128 v[20:23], v233 offset:0
    v_mfma_f32_16x16x32_bf16 v[120:123], v[80:83], v[64:67], v[120:123]
    ds_read_b128 v[24:27], v233 offset:256
    v_mfma_f32_16x16x32_bf16 v[128:131], v[80:83], v[68:71], v[128:131]
    ds_read_b64_tr_b16 v[32:33], v237 offset:0
    v_mfma_f32_16x16x32_bf16 v[136:139], v[80:83], v[72:75], v[136:139]
    ds_read_b64_tr_b16 v[34:35], v237 offset:2048
    v_mfma_f32_16x16x32_bf16 v[140:143], v[84:87], v[60:63], v[140:143]
    ds_read_b64_tr_b16 v[36:37], v236 offset:8192
    v_mfma_f32_16x16x32_bf16 v[148:151], v[84:87], v[64:67], v[148:151]
    ds_read_b64_tr_b16 v[38:39], v236 offset:10240
    v_mfma_f32_16x16x32_bf16 v[156:159], v[84:87], v[68:71], v[156:159]
    ds_read_b64_tr_b16 v[40:41], v237 offset:8192
    v_mfma_f32_16x16x32_bf16 v[164:167], v[84:87], v[72:75], v[164:167]
    ds_read_b64_tr_b16 v[42:43], v237 offset:10240
    v_mfma_f32_16x16x32_bf16 v[144:147], v[88:91], v[60:63], v[144:147]
    ds_read_b64_tr_b16 v[44:45], v236 offset:16384
    v_mfma_f32_16x16x32_bf16 v[152:155], v[88:91], v[64:67], v[152:155]
    ds_read_b64_tr_b16 v[46:47], v236 offset:18432
    v_mfma_f32_16x16x32_bf16 v[160:163], v[88:91], v[68:71], v[160:163]
    ds_read_b64_tr_b16 v[48:49], v237 offset:16384
    v_mfma_f32_16x16x32_bf16 v[168:171], v[88:91], v[72:75], v[168:171]
    ds_read_b64_tr_b16 v[50:51], v237 offset:18432
    v_mfma_f32_16x16x32_bf16 v[172:175], v[92:95], v[60:63], v[172:175]
    ds_read_b64_tr_b16 v[52:53], v240 offset:0
    v_mfma_f32_16x16x32_bf16 v[180:183], v[92:95], v[64:67], v[180:183]
    ds_read_b64_tr_b16 v[54:55], v240 offset:1024
    v_mfma_f32_16x16x32_bf16 v[188:191], v[92:95], v[68:71], v[188:191]
    ds_read_b64_tr_b16 v[56:57], v241 offset:0
    v_mfma_f32_16x16x32_bf16 v[196:199], v[92:95], v[72:75], v[196:199]
    ds_read_b64_tr_b16 v[58:59], v241 offset:1024
    v_mfma_f32_16x16x32_bf16 v[176:179], v[96:99], v[60:63], v[176:179]
    v_mfma_f32_16x16x32_bf16 v[184:187], v[96:99], v[64:67], v[184:187]
    v_mfma_f32_16x16x32_bf16 v[192:195], v[96:99], v[68:71], v[192:195]
    v_mfma_f32_16x16x32_bf16 v[200:203], v[96:99], v[72:75], v[200:203]
    v_mfma_f32_16x16x32_bf16 v[204:207], v[100:103], v[60:63], v[204:207]
    v_mfma_f32_16x16x32_bf16 v[212:215], v[100:103], v[64:67], v[212:215]
    v_mfma_f32_16x16x32_bf16 v[208:211], v[104:107], v[60:63], v[208:211]
    v_mfma_f32_16x16x32_bf16 v[216:219], v[104:107], v[64:67], v[216:219]
    s_waitcnt lgkmcnt(15)
    v_mfma_f32_16x16x32_bf16 v[108:111], v[28:31], v[12:15], v[108:111]
    ds_read_b128 v[60:63], v232 offset:8192
    ds_read_b64_tr_b16 v[76:77], v236 offset:4096
    v_mfma_f32_16x16x32_bf16 v[116:119], v[28:31], v[16:19], v[116:119]
    ds_read_b64_tr_b16 v[78:79], v236 offset:6144
    v_mfma_f32_16x16x32_bf16 v[124:127], v[28:31], v[20:23], v[124:127]
    ds_read_b128 v[64:67], v232 offset:8448
    s_waitcnt lgkmcnt(15)
    v_mfma_f32_16x16x32_bf16 v[132:135], v[28:31], v[24:27], v[132:135]
    ds_read_b128 v[68:71], v233 offset:8192
    v_mfma_f32_16x16x32_bf16 v[112:115], v[32:35], v[12:15], v[112:115]
    ds_read_b128 v[72:75], v233 offset:8448
    v_mfma_f32_16x16x32_bf16 v[120:123], v[32:35], v[16:19], v[120:123]
    ds_read_b64_tr_b16 v[80:81], v237 offset:4096
    v_mfma_f32_16x16x32_bf16 v[128:131], v[32:35], v[20:23], v[128:131]
    ds_read_b64_tr_b16 v[82:83], v237 offset:6144
    v_mfma_f32_16x16x32_bf16 v[136:139], v[32:35], v[24:27], v[136:139]
    ds_read_b64_tr_b16 v[84:85], v236 offset:12288
    s_waitcnt lgkmcnt(15)
    v_mfma_f32_16x16x32_bf16 v[140:143], v[36:39], v[12:15], v[140:143]
    ds_read_b64_tr_b16 v[86:87], v236 offset:14336
    v_mfma_f32_16x16x32_bf16 v[148:151], v[36:39], v[16:19], v[148:151]
    ds_read_b64_tr_b16 v[88:89], v237 offset:12288
    v_mfma_f32_16x16x32_bf16 v[156:159], v[36:39], v[20:23], v[156:159]
    ds_read_b64_tr_b16 v[90:91], v237 offset:14336
    v_mfma_f32_16x16x32_bf16 v[164:167], v[36:39], v[24:27], v[164:167]
    ds_read_b64_tr_b16 v[92:93], v236 offset:20480
    v_mfma_f32_16x16x32_bf16 v[144:147], v[40:43], v[12:15], v[144:147]
    ds_read_b64_tr_b16 v[94:95], v236 offset:22528
    v_mfma_f32_16x16x32_bf16 v[152:155], v[40:43], v[16:19], v[152:155]
    ds_read_b64_tr_b16 v[96:97], v237 offset:20480
    v_mfma_f32_16x16x32_bf16 v[160:163], v[40:43], v[20:23], v[160:163]
    ds_read_b64_tr_b16 v[98:99], v237 offset:22528
    v_mfma_f32_16x16x32_bf16 v[168:171], v[40:43], v[24:27], v[168:171]
    ds_read_b64_tr_b16 v[100:101], v240 offset:2048
    v_mfma_f32_16x16x32_bf16 v[172:175], v[44:47], v[12:15], v[172:175]
    ds_read_b64_tr_b16 v[102:103], v240 offset:3072
    v_mfma_f32_16x16x32_bf16 v[180:183], v[44:47], v[16:19], v[180:183]
    ds_read_b64_tr_b16 v[104:105], v241 offset:2048
    v_mfma_f32_16x16x32_bf16 v[188:191], v[44:47], v[20:23], v[188:191]
    ds_read_b64_tr_b16 v[106:107], v241 offset:3072
    v_mfma_f32_16x16x32_bf16 v[196:199], v[44:47], v[24:27], v[196:199]
    s_waitcnt lgkmcnt(15)
    v_mfma_f32_16x16x32_bf16 v[176:179], v[48:51], v[12:15], v[176:179]
    v_mfma_f32_16x16x32_bf16 v[184:187], v[48:51], v[16:19], v[184:187]
    v_mfma_f32_16x16x32_bf16 v[192:195], v[48:51], v[20:23], v[192:195]
    v_mfma_f32_16x16x32_bf16 v[200:203], v[48:51], v[24:27], v[200:203]
    v_mfma_f32_16x16x32_bf16 v[204:207], v[52:55], v[12:15], v[204:207]
    v_mfma_f32_16x16x32_bf16 v[212:215], v[52:55], v[16:19], v[212:215]
    v_mfma_f32_16x16x32_bf16 v[208:211], v[56:59], v[12:15], v[208:211]
    v_mfma_f32_16x16x32_bf16 v[216:219], v[56:59], v[16:19], v[216:219]
    s_waitcnt lgkmcnt(0)
    s_barrier
    v_mfma_f32_16x16x32_bf16 v[108:111], v[76:79], v[60:63], v[108:111]
    ds_read_b128 v[12:15], v232 offset:16384
    v_mfma_f32_16x16x32_bf16 v[116:119], v[76:79], v[64:67], v[116:119]
    ds_read_b64_tr_b16 v[28:29], v236 offset:28672
    v_mfma_f32_16x16x32_bf16 v[124:127], v[76:79], v[68:71], v[124:127]
    ds_read_b64_tr_b16 v[30:31], v236 offset:30720
    v_mfma_f32_16x16x32_bf16 v[132:135], v[76:79], v[72:75], v[132:135]
    ds_read_b128 v[16:19], v232 offset:16640
    v_mfma_f32_16x16x32_bf16 v[112:115], v[80:83], v[60:63], v[112:115]
    ds_read_b128 v[20:23], v233 offset:16384
    v_mfma_f32_16x16x32_bf16 v[120:123], v[80:83], v[64:67], v[120:123]
    ds_read_b128 v[24:27], v233 offset:16640
    v_mfma_f32_16x16x32_bf16 v[128:131], v[80:83], v[68:71], v[128:131]
    ds_read_b64_tr_b16 v[32:33], v237 offset:28672
    v_mfma_f32_16x16x32_bf16 v[136:139], v[80:83], v[72:75], v[136:139]
    ds_read_b64_tr_b16 v[34:35], v237 offset:30720
    v_mfma_f32_16x16x32_bf16 v[140:143], v[84:87], v[60:63], v[140:143]
    ds_read_b64_tr_b16 v[36:37], v236 offset:36864
    v_mfma_f32_16x16x32_bf16 v[148:151], v[84:87], v[64:67], v[148:151]
    ds_read_b64_tr_b16 v[38:39], v236 offset:38912
    v_mfma_f32_16x16x32_bf16 v[156:159], v[84:87], v[68:71], v[156:159]
    ds_read_b64_tr_b16 v[40:41], v237 offset:36864
    v_mfma_f32_16x16x32_bf16 v[164:167], v[84:87], v[72:75], v[164:167]
    ds_read_b64_tr_b16 v[42:43], v237 offset:38912
    v_mfma_f32_16x16x32_bf16 v[144:147], v[88:91], v[60:63], v[144:147]
    ds_read_b64_tr_b16 v[44:45], v236 offset:45056
    v_mfma_f32_16x16x32_bf16 v[152:155], v[88:91], v[64:67], v[152:155]
    ds_read_b64_tr_b16 v[46:47], v236 offset:47104
    v_mfma_f32_16x16x32_bf16 v[160:163], v[88:91], v[68:71], v[160:163]
    ds_read_b64_tr_b16 v[48:49], v237 offset:45056
    v_mfma_f32_16x16x32_bf16 v[168:171], v[88:91], v[72:75], v[168:171]
    ds_read_b64_tr_b16 v[50:51], v237 offset:47104
    v_mfma_f32_16x16x32_bf16 v[172:175], v[92:95], v[60:63], v[172:175]
    ds_read_b64_tr_b16 v[52:53], v240 offset:28672
    v_mfma_f32_16x16x32_bf16 v[180:183], v[92:95], v[64:67], v[180:183]
    ds_read_b64_tr_b16 v[54:55], v240 offset:29696
    v_mfma_f32_16x16x32_bf16 v[188:191], v[92:95], v[68:71], v[188:191]
    ds_read_b64_tr_b16 v[56:57], v241 offset:28672
    v_mfma_f32_16x16x32_bf16 v[196:199], v[92:95], v[72:75], v[196:199]
    ds_read_b64_tr_b16 v[58:59], v241 offset:29696
    v_mfma_f32_16x16x32_bf16 v[176:179], v[96:99], v[60:63], v[176:179]
    v_mfma_f32_16x16x32_bf16 v[184:187], v[96:99], v[64:67], v[184:187]
    v_mfma_f32_16x16x32_bf16 v[192:195], v[96:99], v[68:71], v[192:195]
    v_mfma_f32_16x16x32_bf16 v[200:203], v[96:99], v[72:75], v[200:203]
    v_mfma_f32_16x16x32_bf16 v[204:207], v[100:103], v[60:63], v[204:207]
    v_mfma_f32_16x16x32_bf16 v[212:215], v[100:103], v[64:67], v[212:215]
    v_mfma_f32_16x16x32_bf16 v[208:211], v[104:107], v[60:63], v[208:211]
    v_mfma_f32_16x16x32_bf16 v[216:219], v[104:107], v[64:67], v[216:219]
    s_waitcnt lgkmcnt(15)
    v_mfma_f32_16x16x32_bf16 v[108:111], v[28:31], v[12:15], v[108:111]
    ds_read_b128 v[60:63], v232 offset:24576
    ds_read_b64_tr_b16 v[76:77], v236 offset:32768
    v_mfma_f32_16x16x32_bf16 v[116:119], v[28:31], v[16:19], v[116:119]
    ds_read_b64_tr_b16 v[78:79], v236 offset:34816
    v_mfma_f32_16x16x32_bf16 v[124:127], v[28:31], v[20:23], v[124:127]
    ds_read_b128 v[64:67], v232 offset:24832
    s_waitcnt lgkmcnt(15)
    v_mfma_f32_16x16x32_bf16 v[132:135], v[28:31], v[24:27], v[132:135]
    ds_read_b128 v[68:71], v233 offset:24576
    v_mfma_f32_16x16x32_bf16 v[112:115], v[32:35], v[12:15], v[112:115]
    ds_read_b128 v[72:75], v233 offset:24832
    v_mfma_f32_16x16x32_bf16 v[120:123], v[32:35], v[16:19], v[120:123]
    ds_read_b64_tr_b16 v[80:81], v237 offset:32768
    v_mfma_f32_16x16x32_bf16 v[128:131], v[32:35], v[20:23], v[128:131]
    ds_read_b64_tr_b16 v[82:83], v237 offset:34816
    v_mfma_f32_16x16x32_bf16 v[136:139], v[32:35], v[24:27], v[136:139]
    ds_read_b64_tr_b16 v[84:85], v236 offset:40960
    s_waitcnt lgkmcnt(15)
    v_mfma_f32_16x16x32_bf16 v[140:143], v[36:39], v[12:15], v[140:143]
    ds_read_b64_tr_b16 v[86:87], v236 offset:43008
    v_mfma_f32_16x16x32_bf16 v[148:151], v[36:39], v[16:19], v[148:151]
    ds_read_b64_tr_b16 v[88:89], v237 offset:40960
    v_mfma_f32_16x16x32_bf16 v[156:159], v[36:39], v[20:23], v[156:159]
    ds_read_b64_tr_b16 v[90:91], v237 offset:43008
    v_mfma_f32_16x16x32_bf16 v[164:167], v[36:39], v[24:27], v[164:167]
    ds_read_b64_tr_b16 v[92:93], v236 offset:49152
    v_mfma_f32_16x16x32_bf16 v[144:147], v[40:43], v[12:15], v[144:147]
    ds_read_b64_tr_b16 v[94:95], v236 offset:51200
    v_mfma_f32_16x16x32_bf16 v[152:155], v[40:43], v[16:19], v[152:155]
    ds_read_b64_tr_b16 v[96:97], v237 offset:49152
    v_mfma_f32_16x16x32_bf16 v[160:163], v[40:43], v[20:23], v[160:163]
    ds_read_b64_tr_b16 v[98:99], v237 offset:51200
    v_mfma_f32_16x16x32_bf16 v[168:171], v[40:43], v[24:27], v[168:171]
    ds_read_b64_tr_b16 v[100:101], v240 offset:30720
    v_mfma_f32_16x16x32_bf16 v[172:175], v[44:47], v[12:15], v[172:175]
    ds_read_b64_tr_b16 v[102:103], v240 offset:31744
    v_mfma_f32_16x16x32_bf16 v[180:183], v[44:47], v[16:19], v[180:183]
    ds_read_b64_tr_b16 v[104:105], v241 offset:30720
    v_mfma_f32_16x16x32_bf16 v[188:191], v[44:47], v[20:23], v[188:191]
    ds_read_b64_tr_b16 v[106:107], v241 offset:31744
    v_mfma_f32_16x16x32_bf16 v[196:199], v[44:47], v[24:27], v[196:199]
    s_waitcnt lgkmcnt(15)
    v_mfma_f32_16x16x32_bf16 v[176:179], v[48:51], v[12:15], v[176:179]
    v_mfma_f32_16x16x32_bf16 v[184:187], v[48:51], v[16:19], v[184:187]
    v_mfma_f32_16x16x32_bf16 v[192:195], v[48:51], v[20:23], v[192:195]
    v_mfma_f32_16x16x32_bf16 v[200:203], v[48:51], v[24:27], v[200:203]
    v_mfma_f32_16x16x32_bf16 v[204:207], v[52:55], v[12:15], v[204:207]
    v_mfma_f32_16x16x32_bf16 v[212:215], v[52:55], v[16:19], v[212:215]
    v_mfma_f32_16x16x32_bf16 v[208:211], v[56:59], v[12:15], v[208:211]
    v_mfma_f32_16x16x32_bf16 v[216:219], v[56:59], v[16:19], v[216:219]
    s_waitcnt lgkmcnt(0)
    s_barrier
    v_mfma_f32_16x16x32_bf16 v[108:111], v[76:79], v[60:63], v[108:111]
    ds_read_b128 v[12:15], v232 offset:32768
    v_mfma_f32_16x16x32_bf16 v[116:119], v[76:79], v[64:67], v[116:119]
    ds_read_b64_tr_b16 v[28:29], v238 offset:0
    v_mfma_f32_16x16x32_bf16 v[124:127], v[76:79], v[68:71], v[124:127]
    ds_read_b64_tr_b16 v[30:31], v238 offset:2048
    v_mfma_f32_16x16x32_bf16 v[132:135], v[76:79], v[72:75], v[132:135]
    ds_read_b128 v[16:19], v232 offset:33024
    v_mfma_f32_16x16x32_bf16 v[112:115], v[80:83], v[60:63], v[112:115]
    ds_read_b128 v[20:23], v233 offset:32768
    v_mfma_f32_16x16x32_bf16 v[120:123], v[80:83], v[64:67], v[120:123]
    ds_read_b128 v[24:27], v233 offset:33024
    v_mfma_f32_16x16x32_bf16 v[128:131], v[80:83], v[68:71], v[128:131]
    ds_read_b64_tr_b16 v[32:33], v239 offset:0
    v_mfma_f32_16x16x32_bf16 v[136:139], v[80:83], v[72:75], v[136:139]
    ds_read_b64_tr_b16 v[34:35], v239 offset:2048
    v_mfma_f32_16x16x32_bf16 v[140:143], v[84:87], v[60:63], v[140:143]
    ds_read_b64_tr_b16 v[36:37], v238 offset:8192
    v_mfma_f32_16x16x32_bf16 v[148:151], v[84:87], v[64:67], v[148:151]
    ds_read_b64_tr_b16 v[38:39], v238 offset:10240
    v_mfma_f32_16x16x32_bf16 v[156:159], v[84:87], v[68:71], v[156:159]
    ds_read_b64_tr_b16 v[40:41], v239 offset:8192
    v_mfma_f32_16x16x32_bf16 v[164:167], v[84:87], v[72:75], v[164:167]
    ds_read_b64_tr_b16 v[42:43], v239 offset:10240
    v_mfma_f32_16x16x32_bf16 v[144:147], v[88:91], v[60:63], v[144:147]
    ds_read_b64_tr_b16 v[44:45], v238 offset:16384
    v_mfma_f32_16x16x32_bf16 v[152:155], v[88:91], v[64:67], v[152:155]
    ds_read_b64_tr_b16 v[46:47], v238 offset:18432
    v_mfma_f32_16x16x32_bf16 v[160:163], v[88:91], v[68:71], v[160:163]
    ds_read_b64_tr_b16 v[48:49], v239 offset:16384
    v_mfma_f32_16x16x32_bf16 v[168:171], v[88:91], v[72:75], v[168:171]
    ds_read_b64_tr_b16 v[50:51], v239 offset:18432
    v_mfma_f32_16x16x32_bf16 v[172:175], v[92:95], v[60:63], v[172:175]
    ds_read_b64_tr_b16 v[52:53], v242 offset:0
    v_mfma_f32_16x16x32_bf16 v[180:183], v[92:95], v[64:67], v[180:183]
    ds_read_b64_tr_b16 v[54:55], v242 offset:1024
    v_mfma_f32_16x16x32_bf16 v[188:191], v[92:95], v[68:71], v[188:191]
    ds_read_b64_tr_b16 v[56:57], v243 offset:0
    v_mfma_f32_16x16x32_bf16 v[196:199], v[92:95], v[72:75], v[196:199]
    ds_read_b64_tr_b16 v[58:59], v243 offset:1024
    v_mfma_f32_16x16x32_bf16 v[176:179], v[96:99], v[60:63], v[176:179]
    v_mfma_f32_16x16x32_bf16 v[184:187], v[96:99], v[64:67], v[184:187]
    v_mfma_f32_16x16x32_bf16 v[192:195], v[96:99], v[68:71], v[192:195]
    v_mfma_f32_16x16x32_bf16 v[200:203], v[96:99], v[72:75], v[200:203]
    v_mfma_f32_16x16x32_bf16 v[204:207], v[100:103], v[60:63], v[204:207]
    v_mfma_f32_16x16x32_bf16 v[212:215], v[100:103], v[64:67], v[212:215]
    v_mfma_f32_16x16x32_bf16 v[208:211], v[104:107], v[60:63], v[208:211]
    v_mfma_f32_16x16x32_bf16 v[216:219], v[104:107], v[64:67], v[216:219]
    s_waitcnt lgkmcnt(15)
    v_mfma_f32_16x16x32_bf16 v[108:111], v[28:31], v[12:15], v[108:111]
    ds_read_b128 v[60:63], v232 offset:40960
    ds_read_b64_tr_b16 v[76:77], v238 offset:4096
    v_mfma_f32_16x16x32_bf16 v[116:119], v[28:31], v[16:19], v[116:119]
    ds_read_b64_tr_b16 v[78:79], v238 offset:6144
    v_mfma_f32_16x16x32_bf16 v[124:127], v[28:31], v[20:23], v[124:127]
    ds_read_b128 v[64:67], v232 offset:41216
    s_waitcnt lgkmcnt(15)
    v_mfma_f32_16x16x32_bf16 v[132:135], v[28:31], v[24:27], v[132:135]
    ds_read_b128 v[68:71], v233 offset:40960
    v_mfma_f32_16x16x32_bf16 v[112:115], v[32:35], v[12:15], v[112:115]
    ds_read_b128 v[72:75], v233 offset:41216
    v_mfma_f32_16x16x32_bf16 v[120:123], v[32:35], v[16:19], v[120:123]
    ds_read_b64_tr_b16 v[80:81], v239 offset:4096
    v_mfma_f32_16x16x32_bf16 v[128:131], v[32:35], v[20:23], v[128:131]
    ds_read_b64_tr_b16 v[82:83], v239 offset:6144
    v_mfma_f32_16x16x32_bf16 v[136:139], v[32:35], v[24:27], v[136:139]
    ds_read_b64_tr_b16 v[84:85], v238 offset:12288
    s_waitcnt lgkmcnt(15)
    v_mfma_f32_16x16x32_bf16 v[140:143], v[36:39], v[12:15], v[140:143]
    ds_read_b64_tr_b16 v[86:87], v238 offset:14336
    v_mfma_f32_16x16x32_bf16 v[148:151], v[36:39], v[16:19], v[148:151]
    ds_read_b64_tr_b16 v[88:89], v239 offset:12288
    v_mfma_f32_16x16x32_bf16 v[156:159], v[36:39], v[20:23], v[156:159]
    ds_read_b64_tr_b16 v[90:91], v239 offset:14336
    v_mfma_f32_16x16x32_bf16 v[164:167], v[36:39], v[24:27], v[164:167]
    ds_read_b64_tr_b16 v[92:93], v238 offset:20480
    v_mfma_f32_16x16x32_bf16 v[144:147], v[40:43], v[12:15], v[144:147]
    ds_read_b64_tr_b16 v[94:95], v238 offset:22528
    v_mfma_f32_16x16x32_bf16 v[152:155], v[40:43], v[16:19], v[152:155]
    ds_read_b64_tr_b16 v[96:97], v239 offset:20480
    v_mfma_f32_16x16x32_bf16 v[160:163], v[40:43], v[20:23], v[160:163]
    ds_read_b64_tr_b16 v[98:99], v239 offset:22528
    v_mfma_f32_16x16x32_bf16 v[168:171], v[40:43], v[24:27], v[168:171]
    ds_read_b64_tr_b16 v[100:101], v242 offset:2048
    v_mfma_f32_16x16x32_bf16 v[172:175], v[44:47], v[12:15], v[172:175]
    ds_read_b64_tr_b16 v[102:103], v242 offset:3072
    v_mfma_f32_16x16x32_bf16 v[180:183], v[44:47], v[16:19], v[180:183]
    ds_read_b64_tr_b16 v[104:105], v243 offset:2048
    v_mfma_f32_16x16x32_bf16 v[188:191], v[44:47], v[20:23], v[188:191]
    ds_read_b64_tr_b16 v[106:107], v243 offset:3072
    v_mfma_f32_16x16x32_bf16 v[196:199], v[44:47], v[24:27], v[196:199]
    s_waitcnt lgkmcnt(15)
    v_mfma_f32_16x16x32_bf16 v[176:179], v[48:51], v[12:15], v[176:179]
    v_mfma_f32_16x16x32_bf16 v[184:187], v[48:51], v[16:19], v[184:187]
    v_mfma_f32_16x16x32_bf16 v[192:195], v[48:51], v[20:23], v[192:195]
    v_mfma_f32_16x16x32_bf16 v[200:203], v[48:51], v[24:27], v[200:203]
    v_mfma_f32_16x16x32_bf16 v[204:207], v[52:55], v[12:15], v[204:207]
    v_mfma_f32_16x16x32_bf16 v[212:215], v[52:55], v[16:19], v[212:215]
    v_mfma_f32_16x16x32_bf16 v[208:211], v[56:59], v[12:15], v[208:211]
    v_mfma_f32_16x16x32_bf16 v[216:219], v[56:59], v[16:19], v[216:219]
    s_waitcnt lgkmcnt(0)
    s_barrier
    v_mfma_f32_16x16x32_bf16 v[108:111], v[76:79], v[60:63], v[108:111]
    ds_read_b128 v[12:15], v232 offset:0
    v_mfma_f32_16x16x32_bf16 v[116:119], v[76:79], v[64:67], v[116:119]
    ds_read_b64_tr_b16 v[28:29], v238 offset:28672
    v_mfma_f32_16x16x32_bf16 v[124:127], v[76:79], v[68:71], v[124:127]
    ds_read_b64_tr_b16 v[30:31], v238 offset:30720
    v_mfma_f32_16x16x32_bf16 v[132:135], v[76:79], v[72:75], v[132:135]
    ds_read_b128 v[16:19], v232 offset:256
    v_mfma_f32_16x16x32_bf16 v[112:115], v[80:83], v[60:63], v[112:115]
    ds_read_b128 v[20:23], v233 offset:0
    v_mfma_f32_16x16x32_bf16 v[120:123], v[80:83], v[64:67], v[120:123]
    ds_read_b128 v[24:27], v233 offset:256
    v_mfma_f32_16x16x32_bf16 v[128:131], v[80:83], v[68:71], v[128:131]
    ds_read_b64_tr_b16 v[32:33], v239 offset:28672
    v_mfma_f32_16x16x32_bf16 v[136:139], v[80:83], v[72:75], v[136:139]
    ds_read_b64_tr_b16 v[34:35], v239 offset:30720
    v_mfma_f32_16x16x32_bf16 v[140:143], v[84:87], v[60:63], v[140:143]
    ds_read_b64_tr_b16 v[36:37], v238 offset:36864
    v_mfma_f32_16x16x32_bf16 v[148:151], v[84:87], v[64:67], v[148:151]
    ds_read_b64_tr_b16 v[38:39], v238 offset:38912
    v_mfma_f32_16x16x32_bf16 v[156:159], v[84:87], v[68:71], v[156:159]
    ds_read_b64_tr_b16 v[40:41], v239 offset:36864
    v_mfma_f32_16x16x32_bf16 v[164:167], v[84:87], v[72:75], v[164:167]
    ds_read_b64_tr_b16 v[42:43], v239 offset:38912
    v_mfma_f32_16x16x32_bf16 v[144:147], v[88:91], v[60:63], v[144:147]
    ds_read_b64_tr_b16 v[44:45], v238 offset:45056
    v_mfma_f32_16x16x32_bf16 v[152:155], v[88:91], v[64:67], v[152:155]
    ds_read_b64_tr_b16 v[46:47], v238 offset:47104
    v_mfma_f32_16x16x32_bf16 v[160:163], v[88:91], v[68:71], v[160:163]
    ds_read_b64_tr_b16 v[48:49], v239 offset:45056
    v_mfma_f32_16x16x32_bf16 v[168:171], v[88:91], v[72:75], v[168:171]
    ds_read_b64_tr_b16 v[50:51], v239 offset:47104
    v_mfma_f32_16x16x32_bf16 v[172:175], v[92:95], v[60:63], v[172:175]
    ds_read_b64_tr_b16 v[52:53], v242 offset:28672
    v_mfma_f32_16x16x32_bf16 v[180:183], v[92:95], v[64:67], v[180:183]
    ds_read_b64_tr_b16 v[54:55], v242 offset:29696
    v_mfma_f32_16x16x32_bf16 v[188:191], v[92:95], v[68:71], v[188:191]
    ds_read_b64_tr_b16 v[56:57], v243 offset:28672
    v_mfma_f32_16x16x32_bf16 v[196:199], v[92:95], v[72:75], v[196:199]
    ds_read_b64_tr_b16 v[58:59], v243 offset:29696
    v_mfma_f32_16x16x32_bf16 v[176:179], v[96:99], v[60:63], v[176:179]
    v_mfma_f32_16x16x32_bf16 v[184:187], v[96:99], v[64:67], v[184:187]
    v_mfma_f32_16x16x32_bf16 v[192:195], v[96:99], v[68:71], v[192:195]
    v_mfma_f32_16x16x32_bf16 v[200:203], v[96:99], v[72:75], v[200:203]
    v_mfma_f32_16x16x32_bf16 v[204:207], v[100:103], v[60:63], v[204:207]
    v_mfma_f32_16x16x32_bf16 v[212:215], v[100:103], v[64:67], v[212:215]
    v_mfma_f32_16x16x32_bf16 v[208:211], v[104:107], v[60:63], v[208:211]
    v_mfma_f32_16x16x32_bf16 v[216:219], v[104:107], v[64:67], v[216:219]
    s_waitcnt lgkmcnt(15)
    v_mfma_f32_16x16x32_bf16 v[108:111], v[28:31], v[12:15], v[108:111]
    ds_read_b128 v[60:63], v232 offset:8192
    ds_read_b64_tr_b16 v[76:77], v238 offset:32768
    v_mfma_f32_16x16x32_bf16 v[116:119], v[28:31], v[16:19], v[116:119]
    ds_read_b64_tr_b16 v[78:79], v238 offset:34816
    v_mfma_f32_16x16x32_bf16 v[124:127], v[28:31], v[20:23], v[124:127]
    ds_read_b128 v[64:67], v232 offset:8448
    s_waitcnt lgkmcnt(15)
    v_mfma_f32_16x16x32_bf16 v[132:135], v[28:31], v[24:27], v[132:135]
    ds_read_b128 v[68:71], v233 offset:8192
    v_mfma_f32_16x16x32_bf16 v[112:115], v[32:35], v[12:15], v[112:115]
    ds_read_b128 v[72:75], v233 offset:8448
    v_mfma_f32_16x16x32_bf16 v[120:123], v[32:35], v[16:19], v[120:123]
    ds_read_b64_tr_b16 v[80:81], v239 offset:32768
    v_mfma_f32_16x16x32_bf16 v[128:131], v[32:35], v[20:23], v[128:131]
    ds_read_b64_tr_b16 v[82:83], v239 offset:34816
    v_mfma_f32_16x16x32_bf16 v[136:139], v[32:35], v[24:27], v[136:139]
    ds_read_b64_tr_b16 v[84:85], v238 offset:40960
    s_waitcnt lgkmcnt(15)
    v_mfma_f32_16x16x32_bf16 v[140:143], v[36:39], v[12:15], v[140:143]
    ds_read_b64_tr_b16 v[86:87], v238 offset:43008
    v_mfma_f32_16x16x32_bf16 v[148:151], v[36:39], v[16:19], v[148:151]
    ds_read_b64_tr_b16 v[88:89], v239 offset:40960
    v_mfma_f32_16x16x32_bf16 v[156:159], v[36:39], v[20:23], v[156:159]
    ds_read_b64_tr_b16 v[90:91], v239 offset:43008
    v_mfma_f32_16x16x32_bf16 v[164:167], v[36:39], v[24:27], v[164:167]
    ds_read_b64_tr_b16 v[92:93], v238 offset:49152
    v_mfma_f32_16x16x32_bf16 v[144:147], v[40:43], v[12:15], v[144:147]
    ds_read_b64_tr_b16 v[94:95], v238 offset:51200
    v_mfma_f32_16x16x32_bf16 v[152:155], v[40:43], v[16:19], v[152:155]
    ds_read_b64_tr_b16 v[96:97], v239 offset:49152
    v_mfma_f32_16x16x32_bf16 v[160:163], v[40:43], v[20:23], v[160:163]
    ds_read_b64_tr_b16 v[98:99], v239 offset:51200
    v_mfma_f32_16x16x32_bf16 v[168:171], v[40:43], v[24:27], v[168:171]
    ds_read_b64_tr_b16 v[100:101], v242 offset:30720
    v_mfma_f32_16x16x32_bf16 v[172:175], v[44:47], v[12:15], v[172:175]
    ds_read_b64_tr_b16 v[102:103], v242 offset:31744
    v_mfma_f32_16x16x32_bf16 v[180:183], v[44:47], v[16:19], v[180:183]
    ds_read_b64_tr_b16 v[104:105], v243 offset:30720
    v_mfma_f32_16x16x32_bf16 v[188:191], v[44:47], v[20:23], v[188:191]
    ds_read_b64_tr_b16 v[106:107], v243 offset:31744
    v_mfma_f32_16x16x32_bf16 v[196:199], v[44:47], v[24:27], v[196:199]
    s_waitcnt lgkmcnt(15)
    v_mfma_f32_16x16x32_bf16 v[176:179], v[48:51], v[12:15], v[176:179]
    v_mfma_f32_16x16x32_bf16 v[184:187], v[48:51], v[16:19], v[184:187]
    v_mfma_f32_16x16x32_bf16 v[192:195], v[48:51], v[20:23], v[192:195]
    v_mfma_f32_16x16x32_bf16 v[200:203], v[48:51], v[24:27], v[200:203]
    v_mfma_f32_16x16x32_bf16 v[204:207], v[52:55], v[12:15], v[204:207]
    v_mfma_f32_16x16x32_bf16 v[212:215], v[52:55], v[16:19], v[212:215]
    v_mfma_f32_16x16x32_bf16 v[208:211], v[56:59], v[12:15], v[208:211]
    v_mfma_f32_16x16x32_bf16 v[216:219], v[56:59], v[16:19], v[216:219]
    s_waitcnt lgkmcnt(0)
    s_barrier
    v_mfma_f32_16x16x32_bf16 v[108:111], v[76:79], v[60:63], v[108:111]
    ds_read_b128 v[12:15], v232 offset:16384
    v_mfma_f32_16x16x32_bf16 v[116:119], v[76:79], v[64:67], v[116:119]
    ds_read_b64_tr_b16 v[28:29], v236 offset:0
    v_mfma_f32_16x16x32_bf16 v[124:127], v[76:79], v[68:71], v[124:127]
    ds_read_b64_tr_b16 v[30:31], v236 offset:2048
    v_mfma_f32_16x16x32_bf16 v[132:135], v[76:79], v[72:75], v[132:135]
    ds_read_b128 v[16:19], v232 offset:16640
    v_mfma_f32_16x16x32_bf16 v[112:115], v[80:83], v[60:63], v[112:115]
    ds_read_b128 v[20:23], v233 offset:16384
    v_mfma_f32_16x16x32_bf16 v[120:123], v[80:83], v[64:67], v[120:123]
    ds_read_b128 v[24:27], v233 offset:16640
    v_mfma_f32_16x16x32_bf16 v[128:131], v[80:83], v[68:71], v[128:131]
    ds_read_b64_tr_b16 v[32:33], v237 offset:0
    v_mfma_f32_16x16x32_bf16 v[136:139], v[80:83], v[72:75], v[136:139]
    ds_read_b64_tr_b16 v[34:35], v237 offset:2048
    v_mfma_f32_16x16x32_bf16 v[140:143], v[84:87], v[60:63], v[140:143]
    ds_read_b64_tr_b16 v[36:37], v236 offset:8192
    v_mfma_f32_16x16x32_bf16 v[148:151], v[84:87], v[64:67], v[148:151]
    ds_read_b64_tr_b16 v[38:39], v236 offset:10240
    v_mfma_f32_16x16x32_bf16 v[156:159], v[84:87], v[68:71], v[156:159]
    ds_read_b64_tr_b16 v[40:41], v237 offset:8192
    v_mfma_f32_16x16x32_bf16 v[164:167], v[84:87], v[72:75], v[164:167]
    ds_read_b64_tr_b16 v[42:43], v237 offset:10240
    v_mfma_f32_16x16x32_bf16 v[144:147], v[88:91], v[60:63], v[144:147]
    ds_read_b64_tr_b16 v[44:45], v236 offset:16384
    v_mfma_f32_16x16x32_bf16 v[152:155], v[88:91], v[64:67], v[152:155]
    ds_read_b64_tr_b16 v[46:47], v236 offset:18432
    v_mfma_f32_16x16x32_bf16 v[160:163], v[88:91], v[68:71], v[160:163]
    ds_read_b64_tr_b16 v[48:49], v237 offset:16384
    v_mfma_f32_16x16x32_bf16 v[168:171], v[88:91], v[72:75], v[168:171]
    ds_read_b64_tr_b16 v[50:51], v237 offset:18432
    v_mfma_f32_16x16x32_bf16 v[172:175], v[92:95], v[60:63], v[172:175]
    ds_read_b64_tr_b16 v[52:53], v240 offset:0
    v_mfma_f32_16x16x32_bf16 v[180:183], v[92:95], v[64:67], v[180:183]
    ds_read_b64_tr_b16 v[54:55], v240 offset:1024
    v_mfma_f32_16x16x32_bf16 v[188:191], v[92:95], v[68:71], v[188:191]
    ds_read_b64_tr_b16 v[56:57], v241 offset:0
    v_mfma_f32_16x16x32_bf16 v[196:199], v[92:95], v[72:75], v[196:199]
    ds_read_b64_tr_b16 v[58:59], v241 offset:1024
    v_mfma_f32_16x16x32_bf16 v[176:179], v[96:99], v[60:63], v[176:179]
    v_mfma_f32_16x16x32_bf16 v[184:187], v[96:99], v[64:67], v[184:187]
    v_mfma_f32_16x16x32_bf16 v[192:195], v[96:99], v[68:71], v[192:195]
    v_mfma_f32_16x16x32_bf16 v[200:203], v[96:99], v[72:75], v[200:203]
    v_mfma_f32_16x16x32_bf16 v[204:207], v[100:103], v[60:63], v[204:207]
    v_mfma_f32_16x16x32_bf16 v[212:215], v[100:103], v[64:67], v[212:215]
    v_mfma_f32_16x16x32_bf16 v[208:211], v[104:107], v[60:63], v[208:211]
    v_mfma_f32_16x16x32_bf16 v[216:219], v[104:107], v[64:67], v[216:219]
    s_waitcnt lgkmcnt(15)
    v_mfma_f32_16x16x32_bf16 v[108:111], v[28:31], v[12:15], v[108:111]
    ds_read_b128 v[60:63], v232 offset:24576
    ds_read_b64_tr_b16 v[76:77], v236 offset:4096
    v_mfma_f32_16x16x32_bf16 v[116:119], v[28:31], v[16:19], v[116:119]
    ds_read_b64_tr_b16 v[78:79], v236 offset:6144
    v_mfma_f32_16x16x32_bf16 v[124:127], v[28:31], v[20:23], v[124:127]
    ds_read_b128 v[64:67], v232 offset:24832
    s_waitcnt lgkmcnt(15)
    v_mfma_f32_16x16x32_bf16 v[132:135], v[28:31], v[24:27], v[132:135]
    ds_read_b128 v[68:71], v233 offset:24576
    v_mfma_f32_16x16x32_bf16 v[112:115], v[32:35], v[12:15], v[112:115]
    ds_read_b128 v[72:75], v233 offset:24832
    v_mfma_f32_16x16x32_bf16 v[120:123], v[32:35], v[16:19], v[120:123]
    ds_read_b64_tr_b16 v[80:81], v237 offset:4096
    v_mfma_f32_16x16x32_bf16 v[128:131], v[32:35], v[20:23], v[128:131]
    ds_read_b64_tr_b16 v[82:83], v237 offset:6144
    v_mfma_f32_16x16x32_bf16 v[136:139], v[32:35], v[24:27], v[136:139]
    ds_read_b64_tr_b16 v[84:85], v236 offset:12288
    s_waitcnt lgkmcnt(15)
    v_mfma_f32_16x16x32_bf16 v[140:143], v[36:39], v[12:15], v[140:143]
    ds_read_b64_tr_b16 v[86:87], v236 offset:14336
    v_mfma_f32_16x16x32_bf16 v[148:151], v[36:39], v[16:19], v[148:151]
    ds_read_b64_tr_b16 v[88:89], v237 offset:12288
    v_mfma_f32_16x16x32_bf16 v[156:159], v[36:39], v[20:23], v[156:159]
    ds_read_b64_tr_b16 v[90:91], v237 offset:14336
    v_mfma_f32_16x16x32_bf16 v[164:167], v[36:39], v[24:27], v[164:167]
    ds_read_b64_tr_b16 v[92:93], v236 offset:20480
    v_mfma_f32_16x16x32_bf16 v[144:147], v[40:43], v[12:15], v[144:147]
    ds_read_b64_tr_b16 v[94:95], v236 offset:22528
    v_mfma_f32_16x16x32_bf16 v[152:155], v[40:43], v[16:19], v[152:155]
    ds_read_b64_tr_b16 v[96:97], v237 offset:20480
    v_mfma_f32_16x16x32_bf16 v[160:163], v[40:43], v[20:23], v[160:163]
    ds_read_b64_tr_b16 v[98:99], v237 offset:22528
    v_mfma_f32_16x16x32_bf16 v[168:171], v[40:43], v[24:27], v[168:171]
    ds_read_b64_tr_b16 v[100:101], v240 offset:2048
    v_mfma_f32_16x16x32_bf16 v[172:175], v[44:47], v[12:15], v[172:175]
    ds_read_b64_tr_b16 v[102:103], v240 offset:3072
    v_mfma_f32_16x16x32_bf16 v[180:183], v[44:47], v[16:19], v[180:183]
    ds_read_b64_tr_b16 v[104:105], v241 offset:2048
    v_mfma_f32_16x16x32_bf16 v[188:191], v[44:47], v[20:23], v[188:191]
    ds_read_b64_tr_b16 v[106:107], v241 offset:3072
    v_mfma_f32_16x16x32_bf16 v[196:199], v[44:47], v[24:27], v[196:199]
    s_waitcnt lgkmcnt(15)
    v_mfma_f32_16x16x32_bf16 v[176:179], v[48:51], v[12:15], v[176:179]
    v_mfma_f32_16x16x32_bf16 v[184:187], v[48:51], v[16:19], v[184:187]
    v_mfma_f32_16x16x32_bf16 v[192:195], v[48:51], v[20:23], v[192:195]
    v_mfma_f32_16x16x32_bf16 v[200:203], v[48:51], v[24:27], v[200:203]
    v_mfma_f32_16x16x32_bf16 v[204:207], v[52:55], v[12:15], v[204:207]
    v_mfma_f32_16x16x32_bf16 v[212:215], v[52:55], v[16:19], v[212:215]
    v_mfma_f32_16x16x32_bf16 v[208:211], v[56:59], v[12:15], v[208:211]
    v_mfma_f32_16x16x32_bf16 v[216:219], v[56:59], v[16:19], v[216:219]
    s_waitcnt lgkmcnt(0)
    s_barrier
    v_mfma_f32_16x16x32_bf16 v[108:111], v[76:79], v[60:63], v[108:111]
    ds_read_b128 v[12:15], v232 offset:32768
    v_mfma_f32_16x16x32_bf16 v[116:119], v[76:79], v[64:67], v[116:119]
    ds_read_b64_tr_b16 v[28:29], v236 offset:28672
    v_mfma_f32_16x16x32_bf16 v[124:127], v[76:79], v[68:71], v[124:127]
    ds_read_b64_tr_b16 v[30:31], v236 offset:30720
    v_mfma_f32_16x16x32_bf16 v[132:135], v[76:79], v[72:75], v[132:135]
    ds_read_b128 v[16:19], v232 offset:33024
    v_mfma_f32_16x16x32_bf16 v[112:115], v[80:83], v[60:63], v[112:115]
    ds_read_b128 v[20:23], v233 offset:32768
    v_mfma_f32_16x16x32_bf16 v[120:123], v[80:83], v[64:67], v[120:123]
    ds_read_b128 v[24:27], v233 offset:33024
    v_mfma_f32_16x16x32_bf16 v[128:131], v[80:83], v[68:71], v[128:131]
    ds_read_b64_tr_b16 v[32:33], v237 offset:28672
    v_mfma_f32_16x16x32_bf16 v[136:139], v[80:83], v[72:75], v[136:139]
    ds_read_b64_tr_b16 v[34:35], v237 offset:30720
    v_mfma_f32_16x16x32_bf16 v[140:143], v[84:87], v[60:63], v[140:143]
    ds_read_b64_tr_b16 v[36:37], v236 offset:36864
    v_mfma_f32_16x16x32_bf16 v[148:151], v[84:87], v[64:67], v[148:151]
    ds_read_b64_tr_b16 v[38:39], v236 offset:38912
    v_mfma_f32_16x16x32_bf16 v[156:159], v[84:87], v[68:71], v[156:159]
    ds_read_b64_tr_b16 v[40:41], v237 offset:36864
    v_mfma_f32_16x16x32_bf16 v[164:167], v[84:87], v[72:75], v[164:167]
    ds_read_b64_tr_b16 v[42:43], v237 offset:38912
    v_mfma_f32_16x16x32_bf16 v[144:147], v[88:91], v[60:63], v[144:147]
    ds_read_b64_tr_b16 v[44:45], v236 offset:45056
    v_mfma_f32_16x16x32_bf16 v[152:155], v[88:91], v[64:67], v[152:155]
    ds_read_b64_tr_b16 v[46:47], v236 offset:47104
    v_mfma_f32_16x16x32_bf16 v[160:163], v[88:91], v[68:71], v[160:163]
    ds_read_b64_tr_b16 v[48:49], v237 offset:45056
    v_mfma_f32_16x16x32_bf16 v[168:171], v[88:91], v[72:75], v[168:171]
    ds_read_b64_tr_b16 v[50:51], v237 offset:47104
    v_mfma_f32_16x16x32_bf16 v[172:175], v[92:95], v[60:63], v[172:175]
    ds_read_b64_tr_b16 v[52:53], v240 offset:28672
    v_mfma_f32_16x16x32_bf16 v[180:183], v[92:95], v[64:67], v[180:183]
    ds_read_b64_tr_b16 v[54:55], v240 offset:29696
    v_mfma_f32_16x16x32_bf16 v[188:191], v[92:95], v[68:71], v[188:191]
    ds_read_b64_tr_b16 v[56:57], v241 offset:28672
    v_mfma_f32_16x16x32_bf16 v[196:199], v[92:95], v[72:75], v[196:199]
    ds_read_b64_tr_b16 v[58:59], v241 offset:29696
    v_mfma_f32_16x16x32_bf16 v[176:179], v[96:99], v[60:63], v[176:179]
    v_mfma_f32_16x16x32_bf16 v[184:187], v[96:99], v[64:67], v[184:187]
    v_mfma_f32_16x16x32_bf16 v[192:195], v[96:99], v[68:71], v[192:195]
    v_mfma_f32_16x16x32_bf16 v[200:203], v[96:99], v[72:75], v[200:203]
    v_mfma_f32_16x16x32_bf16 v[204:207], v[100:103], v[60:63], v[204:207]
    v_mfma_f32_16x16x32_bf16 v[212:215], v[100:103], v[64:67], v[212:215]
    v_mfma_f32_16x16x32_bf16 v[208:211], v[104:107], v[60:63], v[208:211]
    v_mfma_f32_16x16x32_bf16 v[216:219], v[104:107], v[64:67], v[216:219]
    s_waitcnt lgkmcnt(15)
    v_mfma_f32_16x16x32_bf16 v[108:111], v[28:31], v[12:15], v[108:111]
    ds_read_b128 v[60:63], v232 offset:40960
    ds_read_b64_tr_b16 v[76:77], v236 offset:32768
    v_mfma_f32_16x16x32_bf16 v[116:119], v[28:31], v[16:19], v[116:119]
    ds_read_b64_tr_b16 v[78:79], v236 offset:34816
    v_mfma_f32_16x16x32_bf16 v[124:127], v[28:31], v[20:23], v[124:127]
    ds_read_b128 v[64:67], v232 offset:41216
    s_waitcnt lgkmcnt(15)
    v_mfma_f32_16x16x32_bf16 v[132:135], v[28:31], v[24:27], v[132:135]
    ds_read_b128 v[68:71], v233 offset:40960
    v_mfma_f32_16x16x32_bf16 v[112:115], v[32:35], v[12:15], v[112:115]
    ds_read_b128 v[72:75], v233 offset:41216
    v_mfma_f32_16x16x32_bf16 v[120:123], v[32:35], v[16:19], v[120:123]
    ds_read_b64_tr_b16 v[80:81], v237 offset:32768
    v_mfma_f32_16x16x32_bf16 v[128:131], v[32:35], v[20:23], v[128:131]
    ds_read_b64_tr_b16 v[82:83], v237 offset:34816
    v_mfma_f32_16x16x32_bf16 v[136:139], v[32:35], v[24:27], v[136:139]
    ds_read_b64_tr_b16 v[84:85], v236 offset:40960
    s_waitcnt lgkmcnt(15)
    v_mfma_f32_16x16x32_bf16 v[140:143], v[36:39], v[12:15], v[140:143]
    ds_read_b64_tr_b16 v[86:87], v236 offset:43008
    v_mfma_f32_16x16x32_bf16 v[148:151], v[36:39], v[16:19], v[148:151]
    ds_read_b64_tr_b16 v[88:89], v237 offset:40960
    v_mfma_f32_16x16x32_bf16 v[156:159], v[36:39], v[20:23], v[156:159]
    ds_read_b64_tr_b16 v[90:91], v237 offset:43008
    v_mfma_f32_16x16x32_bf16 v[164:167], v[36:39], v[24:27], v[164:167]
    ds_read_b64_tr_b16 v[92:93], v236 offset:49152
    v_mfma_f32_16x16x32_bf16 v[144:147], v[40:43], v[12:15], v[144:147]
    ds_read_b64_tr_b16 v[94:95], v236 offset:51200
    v_mfma_f32_16x16x32_bf16 v[152:155], v[40:43], v[16:19], v[152:155]
    ds_read_b64_tr_b16 v[96:97], v237 offset:49152
    v_mfma_f32_16x16x32_bf16 v[160:163], v[40:43], v[20:23], v[160:163]
    ds_read_b64_tr_b16 v[98:99], v237 offset:51200
    v_mfma_f32_16x16x32_bf16 v[168:171], v[40:43], v[24:27], v[168:171]
    ds_read_b64_tr_b16 v[100:101], v240 offset:30720
    v_mfma_f32_16x16x32_bf16 v[172:175], v[44:47], v[12:15], v[172:175]
    ds_read_b64_tr_b16 v[102:103], v240 offset:31744
    v_mfma_f32_16x16x32_bf16 v[180:183], v[44:47], v[16:19], v[180:183]
    ds_read_b64_tr_b16 v[104:105], v241 offset:30720
    v_mfma_f32_16x16x32_bf16 v[188:191], v[44:47], v[20:23], v[188:191]
    ds_read_b64_tr_b16 v[106:107], v241 offset:31744
    v_mfma_f32_16x16x32_bf16 v[196:199], v[44:47], v[24:27], v[196:199]
    s_waitcnt lgkmcnt(15)
    v_mfma_f32_16x16x32_bf16 v[176:179], v[48:51], v[12:15], v[176:179]
    v_mfma_f32_16x16x32_bf16 v[184:187], v[48:51], v[16:19], v[184:187]
    v_mfma_f32_16x16x32_bf16 v[192:195], v[48:51], v[20:23], v[192:195]
    v_mfma_f32_16x16x32_bf16 v[200:203], v[48:51], v[24:27], v[200:203]
    v_mfma_f32_16x16x32_bf16 v[204:207], v[52:55], v[12:15], v[204:207]
    v_mfma_f32_16x16x32_bf16 v[212:215], v[52:55], v[16:19], v[212:215]
    v_mfma_f32_16x16x32_bf16 v[208:211], v[56:59], v[12:15], v[208:211]
    v_mfma_f32_16x16x32_bf16 v[216:219], v[56:59], v[16:19], v[216:219]
    s_waitcnt lgkmcnt(0)
    s_barrier
    v_mfma_f32_16x16x32_bf16 v[108:111], v[76:79], v[60:63], v[108:111]
    ds_read_b128 v[12:15], v232 offset:0
    v_mfma_f32_16x16x32_bf16 v[116:119], v[76:79], v[64:67], v[116:119]
    ds_read_b64_tr_b16 v[28:29], v238 offset:0
    v_mfma_f32_16x16x32_bf16 v[124:127], v[76:79], v[68:71], v[124:127]
    ds_read_b64_tr_b16 v[30:31], v238 offset:2048
    v_mfma_f32_16x16x32_bf16 v[132:135], v[76:79], v[72:75], v[132:135]
    ds_read_b128 v[16:19], v232 offset:256
    v_mfma_f32_16x16x32_bf16 v[112:115], v[80:83], v[60:63], v[112:115]
    ds_read_b128 v[20:23], v233 offset:0
    v_mfma_f32_16x16x32_bf16 v[120:123], v[80:83], v[64:67], v[120:123]
    ds_read_b128 v[24:27], v233 offset:256
    v_mfma_f32_16x16x32_bf16 v[128:131], v[80:83], v[68:71], v[128:131]
    ds_read_b64_tr_b16 v[32:33], v239 offset:0
    v_mfma_f32_16x16x32_bf16 v[136:139], v[80:83], v[72:75], v[136:139]
    ds_read_b64_tr_b16 v[34:35], v239 offset:2048
    v_mfma_f32_16x16x32_bf16 v[140:143], v[84:87], v[60:63], v[140:143]
    ds_read_b64_tr_b16 v[36:37], v238 offset:8192
    v_mfma_f32_16x16x32_bf16 v[148:151], v[84:87], v[64:67], v[148:151]
    ds_read_b64_tr_b16 v[38:39], v238 offset:10240
    v_mfma_f32_16x16x32_bf16 v[156:159], v[84:87], v[68:71], v[156:159]
    ds_read_b64_tr_b16 v[40:41], v239 offset:8192
    v_mfma_f32_16x16x32_bf16 v[164:167], v[84:87], v[72:75], v[164:167]
    ds_read_b64_tr_b16 v[42:43], v239 offset:10240
    v_mfma_f32_16x16x32_bf16 v[144:147], v[88:91], v[60:63], v[144:147]
    ds_read_b64_tr_b16 v[44:45], v238 offset:16384
    v_mfma_f32_16x16x32_bf16 v[152:155], v[88:91], v[64:67], v[152:155]
    ds_read_b64_tr_b16 v[46:47], v238 offset:18432
    v_mfma_f32_16x16x32_bf16 v[160:163], v[88:91], v[68:71], v[160:163]
    ds_read_b64_tr_b16 v[48:49], v239 offset:16384
    v_mfma_f32_16x16x32_bf16 v[168:171], v[88:91], v[72:75], v[168:171]
    ds_read_b64_tr_b16 v[50:51], v239 offset:18432
    v_mfma_f32_16x16x32_bf16 v[172:175], v[92:95], v[60:63], v[172:175]
    ds_read_b64_tr_b16 v[52:53], v242 offset:0
    v_mfma_f32_16x16x32_bf16 v[180:183], v[92:95], v[64:67], v[180:183]
    ds_read_b64_tr_b16 v[54:55], v242 offset:1024
    v_mfma_f32_16x16x32_bf16 v[188:191], v[92:95], v[68:71], v[188:191]
    ds_read_b64_tr_b16 v[56:57], v243 offset:0
    v_mfma_f32_16x16x32_bf16 v[196:199], v[92:95], v[72:75], v[196:199]
    ds_read_b64_tr_b16 v[58:59], v243 offset:1024
    v_mfma_f32_16x16x32_bf16 v[176:179], v[96:99], v[60:63], v[176:179]
    v_mfma_f32_16x16x32_bf16 v[184:187], v[96:99], v[64:67], v[184:187]
    v_mfma_f32_16x16x32_bf16 v[192:195], v[96:99], v[68:71], v[192:195]
    v_mfma_f32_16x16x32_bf16 v[200:203], v[96:99], v[72:75], v[200:203]
    v_mfma_f32_16x16x32_bf16 v[204:207], v[100:103], v[60:63], v[204:207]
    v_mfma_f32_16x16x32_bf16 v[212:215], v[100:103], v[64:67], v[212:215]
    v_mfma_f32_16x16x32_bf16 v[208:211], v[104:107], v[60:63], v[208:211]
    v_mfma_f32_16x16x32_bf16 v[216:219], v[104:107], v[64:67], v[216:219]
    s_waitcnt lgkmcnt(15)
    v_mfma_f32_16x16x32_bf16 v[108:111], v[28:31], v[12:15], v[108:111]
    ds_read_b128 v[60:63], v232 offset:8192
    ds_read_b64_tr_b16 v[76:77], v238 offset:4096
    v_mfma_f32_16x16x32_bf16 v[116:119], v[28:31], v[16:19], v[116:119]
    ds_read_b64_tr_b16 v[78:79], v238 offset:6144
    v_mfma_f32_16x16x32_bf16 v[124:127], v[28:31], v[20:23], v[124:127]
    ds_read_b128 v[64:67], v232 offset:8448
    s_waitcnt lgkmcnt(15)
    v_mfma_f32_16x16x32_bf16 v[132:135], v[28:31], v[24:27], v[132:135]
    ds_read_b128 v[68:71], v233 offset:8192
    v_mfma_f32_16x16x32_bf16 v[112:115], v[32:35], v[12:15], v[112:115]
    ds_read_b128 v[72:75], v233 offset:8448
    v_mfma_f32_16x16x32_bf16 v[120:123], v[32:35], v[16:19], v[120:123]
    ds_read_b64_tr_b16 v[80:81], v239 offset:4096
    v_mfma_f32_16x16x32_bf16 v[128:131], v[32:35], v[20:23], v[128:131]
    ds_read_b64_tr_b16 v[82:83], v239 offset:6144
    v_mfma_f32_16x16x32_bf16 v[136:139], v[32:35], v[24:27], v[136:139]
    ds_read_b64_tr_b16 v[84:85], v238 offset:12288
    s_waitcnt lgkmcnt(15)
    v_mfma_f32_16x16x32_bf16 v[140:143], v[36:39], v[12:15], v[140:143]
    ds_read_b64_tr_b16 v[86:87], v238 offset:14336
    v_mfma_f32_16x16x32_bf16 v[148:151], v[36:39], v[16:19], v[148:151]
    ds_read_b64_tr_b16 v[88:89], v239 offset:12288
    v_mfma_f32_16x16x32_bf16 v[156:159], v[36:39], v[20:23], v[156:159]
    ds_read_b64_tr_b16 v[90:91], v239 offset:14336
    v_mfma_f32_16x16x32_bf16 v[164:167], v[36:39], v[24:27], v[164:167]
    ds_read_b64_tr_b16 v[92:93], v238 offset:20480
    v_mfma_f32_16x16x32_bf16 v[144:147], v[40:43], v[12:15], v[144:147]
    ds_read_b64_tr_b16 v[94:95], v238 offset:22528
    v_mfma_f32_16x16x32_bf16 v[152:155], v[40:43], v[16:19], v[152:155]
    ds_read_b64_tr_b16 v[96:97], v239 offset:20480
    v_mfma_f32_16x16x32_bf16 v[160:163], v[40:43], v[20:23], v[160:163]
    ds_read_b64_tr_b16 v[98:99], v239 offset:22528
    v_mfma_f32_16x16x32_bf16 v[168:171], v[40:43], v[24:27], v[168:171]
    ds_read_b64_tr_b16 v[100:101], v242 offset:2048
    v_mfma_f32_16x16x32_bf16 v[172:175], v[44:47], v[12:15], v[172:175]
    ds_read_b64_tr_b16 v[102:103], v242 offset:3072
    v_mfma_f32_16x16x32_bf16 v[180:183], v[44:47], v[16:19], v[180:183]
    ds_read_b64_tr_b16 v[104:105], v243 offset:2048
    v_mfma_f32_16x16x32_bf16 v[188:191], v[44:47], v[20:23], v[188:191]
    ds_read_b64_tr_b16 v[106:107], v243 offset:3072
    v_mfma_f32_16x16x32_bf16 v[196:199], v[44:47], v[24:27], v[196:199]
    s_waitcnt lgkmcnt(15)
    v_mfma_f32_16x16x32_bf16 v[176:179], v[48:51], v[12:15], v[176:179]
    v_mfma_f32_16x16x32_bf16 v[184:187], v[48:51], v[16:19], v[184:187]
    v_mfma_f32_16x16x32_bf16 v[192:195], v[48:51], v[20:23], v[192:195]
    v_mfma_f32_16x16x32_bf16 v[200:203], v[48:51], v[24:27], v[200:203]
    v_mfma_f32_16x16x32_bf16 v[204:207], v[52:55], v[12:15], v[204:207]
    v_mfma_f32_16x16x32_bf16 v[212:215], v[52:55], v[16:19], v[212:215]
    v_mfma_f32_16x16x32_bf16 v[208:211], v[56:59], v[12:15], v[208:211]
    v_mfma_f32_16x16x32_bf16 v[216:219], v[56:59], v[16:19], v[216:219]
    s_waitcnt lgkmcnt(0)
    s_barrier
    v_mfma_f32_16x16x32_bf16 v[108:111], v[76:79], v[60:63], v[108:111]
    ds_read_b128 v[12:15], v232 offset:16384
    v_mfma_f32_16x16x32_bf16 v[116:119], v[76:79], v[64:67], v[116:119]
    ds_read_b64_tr_b16 v[28:29], v238 offset:28672
    v_mfma_f32_16x16x32_bf16 v[124:127], v[76:79], v[68:71], v[124:127]
    ds_read_b64_tr_b16 v[30:31], v238 offset:30720
    v_mfma_f32_16x16x32_bf16 v[132:135], v[76:79], v[72:75], v[132:135]
    ds_read_b128 v[16:19], v232 offset:16640
    v_mfma_f32_16x16x32_bf16 v[112:115], v[80:83], v[60:63], v[112:115]
    ds_read_b128 v[20:23], v233 offset:16384
    v_mfma_f32_16x16x32_bf16 v[120:123], v[80:83], v[64:67], v[120:123]
    ds_read_b128 v[24:27], v233 offset:16640
    v_mfma_f32_16x16x32_bf16 v[128:131], v[80:83], v[68:71], v[128:131]
    ds_read_b64_tr_b16 v[32:33], v239 offset:28672
    v_mfma_f32_16x16x32_bf16 v[136:139], v[80:83], v[72:75], v[136:139]
    ds_read_b64_tr_b16 v[34:35], v239 offset:30720
    v_mfma_f32_16x16x32_bf16 v[140:143], v[84:87], v[60:63], v[140:143]
    ds_read_b64_tr_b16 v[36:37], v238 offset:36864
    v_mfma_f32_16x16x32_bf16 v[148:151], v[84:87], v[64:67], v[148:151]
    ds_read_b64_tr_b16 v[38:39], v238 offset:38912
    v_mfma_f32_16x16x32_bf16 v[156:159], v[84:87], v[68:71], v[156:159]
    ds_read_b64_tr_b16 v[40:41], v239 offset:36864
    v_mfma_f32_16x16x32_bf16 v[164:167], v[84:87], v[72:75], v[164:167]
    ds_read_b64_tr_b16 v[42:43], v239 offset:38912
    v_mfma_f32_16x16x32_bf16 v[144:147], v[88:91], v[60:63], v[144:147]
    ds_read_b64_tr_b16 v[44:45], v238 offset:45056
    v_mfma_f32_16x16x32_bf16 v[152:155], v[88:91], v[64:67], v[152:155]
    ds_read_b64_tr_b16 v[46:47], v238 offset:47104
    v_mfma_f32_16x16x32_bf16 v[160:163], v[88:91], v[68:71], v[160:163]
    ds_read_b64_tr_b16 v[48:49], v239 offset:45056
    v_mfma_f32_16x16x32_bf16 v[168:171], v[88:91], v[72:75], v[168:171]
    ds_read_b64_tr_b16 v[50:51], v239 offset:47104
    v_mfma_f32_16x16x32_bf16 v[172:175], v[92:95], v[60:63], v[172:175]
    ds_read_b64_tr_b16 v[52:53], v242 offset:28672
    v_mfma_f32_16x16x32_bf16 v[180:183], v[92:95], v[64:67], v[180:183]
    ds_read_b64_tr_b16 v[54:55], v242 offset:29696
    v_mfma_f32_16x16x32_bf16 v[188:191], v[92:95], v[68:71], v[188:191]
    ds_read_b64_tr_b16 v[56:57], v243 offset:28672
    v_mfma_f32_16x16x32_bf16 v[196:199], v[92:95], v[72:75], v[196:199]
    ds_read_b64_tr_b16 v[58:59], v243 offset:29696
    v_mfma_f32_16x16x32_bf16 v[176:179], v[96:99], v[60:63], v[176:179]
    v_mfma_f32_16x16x32_bf16 v[184:187], v[96:99], v[64:67], v[184:187]
    v_mfma_f32_16x16x32_bf16 v[192:195], v[96:99], v[68:71], v[192:195]
    v_mfma_f32_16x16x32_bf16 v[200:203], v[96:99], v[72:75], v[200:203]
    v_mfma_f32_16x16x32_bf16 v[204:207], v[100:103], v[60:63], v[204:207]
    v_mfma_f32_16x16x32_bf16 v[212:215], v[100:103], v[64:67], v[212:215]
    v_mfma_f32_16x16x32_bf16 v[208:211], v[104:107], v[60:63], v[208:211]
    v_mfma_f32_16x16x32_bf16 v[216:219], v[104:107], v[64:67], v[216:219]
    s_waitcnt lgkmcnt(15)
    v_mfma_f32_16x16x32_bf16 v[108:111], v[28:31], v[12:15], v[108:111]
    ds_read_b128 v[60:63], v232 offset:24576
    ds_read_b64_tr_b16 v[76:77], v238 offset:32768
    v_mfma_f32_16x16x32_bf16 v[116:119], v[28:31], v[16:19], v[116:119]
    ds_read_b64_tr_b16 v[78:79], v238 offset:34816
    v_mfma_f32_16x16x32_bf16 v[124:127], v[28:31], v[20:23], v[124:127]
    ds_read_b128 v[64:67], v232 offset:24832
    s_waitcnt lgkmcnt(15)
    v_mfma_f32_16x16x32_bf16 v[132:135], v[28:31], v[24:27], v[132:135]
    ds_read_b128 v[68:71], v233 offset:24576
    v_mfma_f32_16x16x32_bf16 v[112:115], v[32:35], v[12:15], v[112:115]
    ds_read_b128 v[72:75], v233 offset:24832
    v_mfma_f32_16x16x32_bf16 v[120:123], v[32:35], v[16:19], v[120:123]
    ds_read_b64_tr_b16 v[80:81], v239 offset:32768
    v_mfma_f32_16x16x32_bf16 v[128:131], v[32:35], v[20:23], v[128:131]
    ds_read_b64_tr_b16 v[82:83], v239 offset:34816
    v_mfma_f32_16x16x32_bf16 v[136:139], v[32:35], v[24:27], v[136:139]
    ds_read_b64_tr_b16 v[84:85], v238 offset:40960
    s_waitcnt lgkmcnt(15)
    v_mfma_f32_16x16x32_bf16 v[140:143], v[36:39], v[12:15], v[140:143]
    ds_read_b64_tr_b16 v[86:87], v238 offset:43008
    v_mfma_f32_16x16x32_bf16 v[148:151], v[36:39], v[16:19], v[148:151]
    ds_read_b64_tr_b16 v[88:89], v239 offset:40960
    v_mfma_f32_16x16x32_bf16 v[156:159], v[36:39], v[20:23], v[156:159]
    ds_read_b64_tr_b16 v[90:91], v239 offset:43008
    v_mfma_f32_16x16x32_bf16 v[164:167], v[36:39], v[24:27], v[164:167]
    ds_read_b64_tr_b16 v[92:93], v238 offset:49152
    v_mfma_f32_16x16x32_bf16 v[144:147], v[40:43], v[12:15], v[144:147]
    ds_read_b64_tr_b16 v[94:95], v238 offset:51200
    v_mfma_f32_16x16x32_bf16 v[152:155], v[40:43], v[16:19], v[152:155]
    ds_read_b64_tr_b16 v[96:97], v239 offset:49152
    v_mfma_f32_16x16x32_bf16 v[160:163], v[40:43], v[20:23], v[160:163]
    ds_read_b64_tr_b16 v[98:99], v239 offset:51200
    v_mfma_f32_16x16x32_bf16 v[168:171], v[40:43], v[24:27], v[168:171]
    ds_read_b64_tr_b16 v[100:101], v242 offset:30720
    v_mfma_f32_16x16x32_bf16 v[172:175], v[44:47], v[12:15], v[172:175]
    ds_read_b64_tr_b16 v[102:103], v242 offset:31744
    v_mfma_f32_16x16x32_bf16 v[180:183], v[44:47], v[16:19], v[180:183]
    ds_read_b64_tr_b16 v[104:105], v243 offset:30720
    v_mfma_f32_16x16x32_bf16 v[188:191], v[44:47], v[20:23], v[188:191]
    ds_read_b64_tr_b16 v[106:107], v243 offset:31744
    v_mfma_f32_16x16x32_bf16 v[196:199], v[44:47], v[24:27], v[196:199]
    s_waitcnt lgkmcnt(15)
    v_mfma_f32_16x16x32_bf16 v[176:179], v[48:51], v[12:15], v[176:179]
    v_mfma_f32_16x16x32_bf16 v[184:187], v[48:51], v[16:19], v[184:187]
    v_mfma_f32_16x16x32_bf16 v[192:195], v[48:51], v[20:23], v[192:195]
    v_mfma_f32_16x16x32_bf16 v[200:203], v[48:51], v[24:27], v[200:203]
    v_mfma_f32_16x16x32_bf16 v[204:207], v[52:55], v[12:15], v[204:207]
    v_mfma_f32_16x16x32_bf16 v[212:215], v[52:55], v[16:19], v[212:215]
    v_mfma_f32_16x16x32_bf16 v[208:211], v[56:59], v[12:15], v[208:211]
    v_mfma_f32_16x16x32_bf16 v[216:219], v[56:59], v[16:19], v[216:219]
    s_waitcnt lgkmcnt(0)
    s_barrier
    v_mfma_f32_16x16x32_bf16 v[108:111], v[76:79], v[60:63], v[108:111]
    ds_read_b128 v[12:15], v232 offset:32768
    v_mfma_f32_16x16x32_bf16 v[116:119], v[76:79], v[64:67], v[116:119]
    ds_read_b64_tr_b16 v[28:29], v236 offset:0
    v_mfma_f32_16x16x32_bf16 v[124:127], v[76:79], v[68:71], v[124:127]
    ds_read_b64_tr_b16 v[30:31], v236 offset:2048
    v_mfma_f32_16x16x32_bf16 v[132:135], v[76:79], v[72:75], v[132:135]
    ds_read_b128 v[16:19], v232 offset:33024
    v_mfma_f32_16x16x32_bf16 v[112:115], v[80:83], v[60:63], v[112:115]
    ds_read_b128 v[20:23], v233 offset:32768
    v_mfma_f32_16x16x32_bf16 v[120:123], v[80:83], v[64:67], v[120:123]
    ds_read_b128 v[24:27], v233 offset:33024
    v_mfma_f32_16x16x32_bf16 v[128:131], v[80:83], v[68:71], v[128:131]
    ds_read_b64_tr_b16 v[32:33], v237 offset:0
    v_mfma_f32_16x16x32_bf16 v[136:139], v[80:83], v[72:75], v[136:139]
    ds_read_b64_tr_b16 v[34:35], v237 offset:2048
    v_mfma_f32_16x16x32_bf16 v[140:143], v[84:87], v[60:63], v[140:143]
    ds_read_b64_tr_b16 v[36:37], v236 offset:8192
    v_mfma_f32_16x16x32_bf16 v[148:151], v[84:87], v[64:67], v[148:151]
    ds_read_b64_tr_b16 v[38:39], v236 offset:10240
    v_mfma_f32_16x16x32_bf16 v[156:159], v[84:87], v[68:71], v[156:159]
    ds_read_b64_tr_b16 v[40:41], v237 offset:8192
    v_mfma_f32_16x16x32_bf16 v[164:167], v[84:87], v[72:75], v[164:167]
    ds_read_b64_tr_b16 v[42:43], v237 offset:10240
    v_mfma_f32_16x16x32_bf16 v[144:147], v[88:91], v[60:63], v[144:147]
    ds_read_b64_tr_b16 v[44:45], v236 offset:16384
    v_mfma_f32_16x16x32_bf16 v[152:155], v[88:91], v[64:67], v[152:155]
    ds_read_b64_tr_b16 v[46:47], v236 offset:18432
    v_mfma_f32_16x16x32_bf16 v[160:163], v[88:91], v[68:71], v[160:163]
    ds_read_b64_tr_b16 v[48:49], v237 offset:16384
    v_mfma_f32_16x16x32_bf16 v[168:171], v[88:91], v[72:75], v[168:171]
    ds_read_b64_tr_b16 v[50:51], v237 offset:18432
    v_mfma_f32_16x16x32_bf16 v[172:175], v[92:95], v[60:63], v[172:175]
    ds_read_b64_tr_b16 v[52:53], v240 offset:0
    v_mfma_f32_16x16x32_bf16 v[180:183], v[92:95], v[64:67], v[180:183]
    ds_read_b64_tr_b16 v[54:55], v240 offset:1024
    v_mfma_f32_16x16x32_bf16 v[188:191], v[92:95], v[68:71], v[188:191]
    ds_read_b64_tr_b16 v[56:57], v241 offset:0
    v_mfma_f32_16x16x32_bf16 v[196:199], v[92:95], v[72:75], v[196:199]
    ds_read_b64_tr_b16 v[58:59], v241 offset:1024
    v_mfma_f32_16x16x32_bf16 v[176:179], v[96:99], v[60:63], v[176:179]
    v_mfma_f32_16x16x32_bf16 v[184:187], v[96:99], v[64:67], v[184:187]
    v_mfma_f32_16x16x32_bf16 v[192:195], v[96:99], v[68:71], v[192:195]
    v_mfma_f32_16x16x32_bf16 v[200:203], v[96:99], v[72:75], v[200:203]
    v_mfma_f32_16x16x32_bf16 v[204:207], v[100:103], v[60:63], v[204:207]
    v_mfma_f32_16x16x32_bf16 v[212:215], v[100:103], v[64:67], v[212:215]
    v_mfma_f32_16x16x32_bf16 v[208:211], v[104:107], v[60:63], v[208:211]
    v_mfma_f32_16x16x32_bf16 v[216:219], v[104:107], v[64:67], v[216:219]
    s_waitcnt lgkmcnt(15)
    v_mfma_f32_16x16x32_bf16 v[108:111], v[28:31], v[12:15], v[108:111]
    ds_read_b128 v[60:63], v232 offset:40960
    ds_read_b64_tr_b16 v[76:77], v236 offset:4096
    v_mfma_f32_16x16x32_bf16 v[116:119], v[28:31], v[16:19], v[116:119]
    ds_read_b64_tr_b16 v[78:79], v236 offset:6144
    v_mfma_f32_16x16x32_bf16 v[124:127], v[28:31], v[20:23], v[124:127]
    ds_read_b128 v[64:67], v232 offset:41216
    s_waitcnt lgkmcnt(15)
    v_mfma_f32_16x16x32_bf16 v[132:135], v[28:31], v[24:27], v[132:135]
    ds_read_b128 v[68:71], v233 offset:40960
    v_mfma_f32_16x16x32_bf16 v[112:115], v[32:35], v[12:15], v[112:115]
    ds_read_b128 v[72:75], v233 offset:41216
    v_mfma_f32_16x16x32_bf16 v[120:123], v[32:35], v[16:19], v[120:123]
    ds_read_b64_tr_b16 v[80:81], v237 offset:4096
    v_mfma_f32_16x16x32_bf16 v[128:131], v[32:35], v[20:23], v[128:131]
    ds_read_b64_tr_b16 v[82:83], v237 offset:6144
    v_mfma_f32_16x16x32_bf16 v[136:139], v[32:35], v[24:27], v[136:139]
    ds_read_b64_tr_b16 v[84:85], v236 offset:12288
    s_waitcnt lgkmcnt(15)
    v_mfma_f32_16x16x32_bf16 v[140:143], v[36:39], v[12:15], v[140:143]
    ds_read_b64_tr_b16 v[86:87], v236 offset:14336
    v_mfma_f32_16x16x32_bf16 v[148:151], v[36:39], v[16:19], v[148:151]
    ds_read_b64_tr_b16 v[88:89], v237 offset:12288
    v_mfma_f32_16x16x32_bf16 v[156:159], v[36:39], v[20:23], v[156:159]
    ds_read_b64_tr_b16 v[90:91], v237 offset:14336
    v_mfma_f32_16x16x32_bf16 v[164:167], v[36:39], v[24:27], v[164:167]
    ds_read_b64_tr_b16 v[92:93], v236 offset:20480
    v_mfma_f32_16x16x32_bf16 v[144:147], v[40:43], v[12:15], v[144:147]
    ds_read_b64_tr_b16 v[94:95], v236 offset:22528
    v_mfma_f32_16x16x32_bf16 v[152:155], v[40:43], v[16:19], v[152:155]
    ds_read_b64_tr_b16 v[96:97], v237 offset:20480
    v_mfma_f32_16x16x32_bf16 v[160:163], v[40:43], v[20:23], v[160:163]
    ds_read_b64_tr_b16 v[98:99], v237 offset:22528
    v_mfma_f32_16x16x32_bf16 v[168:171], v[40:43], v[24:27], v[168:171]
    ds_read_b64_tr_b16 v[100:101], v240 offset:2048
    v_mfma_f32_16x16x32_bf16 v[172:175], v[44:47], v[12:15], v[172:175]
    ds_read_b64_tr_b16 v[102:103], v240 offset:3072
    v_mfma_f32_16x16x32_bf16 v[180:183], v[44:47], v[16:19], v[180:183]
    ds_read_b64_tr_b16 v[104:105], v241 offset:2048
    v_mfma_f32_16x16x32_bf16 v[188:191], v[44:47], v[20:23], v[188:191]
    ds_read_b64_tr_b16 v[106:107], v241 offset:3072
    v_mfma_f32_16x16x32_bf16 v[196:199], v[44:47], v[24:27], v[196:199]
    s_waitcnt lgkmcnt(15)
    v_mfma_f32_16x16x32_bf16 v[176:179], v[48:51], v[12:15], v[176:179]
    v_mfma_f32_16x16x32_bf16 v[184:187], v[48:51], v[16:19], v[184:187]
    v_mfma_f32_16x16x32_bf16 v[192:195], v[48:51], v[20:23], v[192:195]
    v_mfma_f32_16x16x32_bf16 v[200:203], v[48:51], v[24:27], v[200:203]
    v_mfma_f32_16x16x32_bf16 v[204:207], v[52:55], v[12:15], v[204:207]
    v_mfma_f32_16x16x32_bf16 v[212:215], v[52:55], v[16:19], v[212:215]
    v_mfma_f32_16x16x32_bf16 v[208:211], v[56:59], v[12:15], v[208:211]
    v_mfma_f32_16x16x32_bf16 v[216:219], v[56:59], v[16:19], v[216:219]
    s_waitcnt lgkmcnt(0)
    s_barrier
    v_mfma_f32_16x16x32_bf16 v[108:111], v[76:79], v[60:63], v[108:111]
    ds_read_b128 v[12:15], v232 offset:0
    v_mfma_f32_16x16x32_bf16 v[116:119], v[76:79], v[64:67], v[116:119]
    ds_read_b64_tr_b16 v[28:29], v236 offset:28672
    v_mfma_f32_16x16x32_bf16 v[124:127], v[76:79], v[68:71], v[124:127]
    ds_read_b64_tr_b16 v[30:31], v236 offset:30720
    v_mfma_f32_16x16x32_bf16 v[132:135], v[76:79], v[72:75], v[132:135]
    ds_read_b128 v[16:19], v232 offset:256
    v_mfma_f32_16x16x32_bf16 v[112:115], v[80:83], v[60:63], v[112:115]
    ds_read_b128 v[20:23], v233 offset:0
    v_mfma_f32_16x16x32_bf16 v[120:123], v[80:83], v[64:67], v[120:123]
    ds_read_b128 v[24:27], v233 offset:256
    v_mfma_f32_16x16x32_bf16 v[128:131], v[80:83], v[68:71], v[128:131]
    ds_read_b64_tr_b16 v[32:33], v237 offset:28672
    v_mfma_f32_16x16x32_bf16 v[136:139], v[80:83], v[72:75], v[136:139]
    ds_read_b64_tr_b16 v[34:35], v237 offset:30720
    v_mfma_f32_16x16x32_bf16 v[140:143], v[84:87], v[60:63], v[140:143]
    ds_read_b64_tr_b16 v[36:37], v236 offset:36864
    v_mfma_f32_16x16x32_bf16 v[148:151], v[84:87], v[64:67], v[148:151]
    ds_read_b64_tr_b16 v[38:39], v236 offset:38912
    v_mfma_f32_16x16x32_bf16 v[156:159], v[84:87], v[68:71], v[156:159]
    ds_read_b64_tr_b16 v[40:41], v237 offset:36864
    v_mfma_f32_16x16x32_bf16 v[164:167], v[84:87], v[72:75], v[164:167]
    ds_read_b64_tr_b16 v[42:43], v237 offset:38912
    v_mfma_f32_16x16x32_bf16 v[144:147], v[88:91], v[60:63], v[144:147]
    ds_read_b64_tr_b16 v[44:45], v236 offset:45056
    v_mfma_f32_16x16x32_bf16 v[152:155], v[88:91], v[64:67], v[152:155]
    ds_read_b64_tr_b16 v[46:47], v236 offset:47104
    v_mfma_f32_16x16x32_bf16 v[160:163], v[88:91], v[68:71], v[160:163]
    ds_read_b64_tr_b16 v[48:49], v237 offset:45056
    v_mfma_f32_16x16x32_bf16 v[168:171], v[88:91], v[72:75], v[168:171]
    ds_read_b64_tr_b16 v[50:51], v237 offset:47104
    v_mfma_f32_16x16x32_bf16 v[172:175], v[92:95], v[60:63], v[172:175]
    ds_read_b64_tr_b16 v[52:53], v240 offset:28672
    v_mfma_f32_16x16x32_bf16 v[180:183], v[92:95], v[64:67], v[180:183]
    ds_read_b64_tr_b16 v[54:55], v240 offset:29696
    v_mfma_f32_16x16x32_bf16 v[188:191], v[92:95], v[68:71], v[188:191]
    ds_read_b64_tr_b16 v[56:57], v241 offset:28672
    v_mfma_f32_16x16x32_bf16 v[196:199], v[92:95], v[72:75], v[196:199]
    ds_read_b64_tr_b16 v[58:59], v241 offset:29696
    v_mfma_f32_16x16x32_bf16 v[176:179], v[96:99], v[60:63], v[176:179]
    v_mfma_f32_16x16x32_bf16 v[184:187], v[96:99], v[64:67], v[184:187]
    v_mfma_f32_16x16x32_bf16 v[192:195], v[96:99], v[68:71], v[192:195]
    v_mfma_f32_16x16x32_bf16 v[200:203], v[96:99], v[72:75], v[200:203]
    v_mfma_f32_16x16x32_bf16 v[204:207], v[100:103], v[60:63], v[204:207]
    v_mfma_f32_16x16x32_bf16 v[212:215], v[100:103], v[64:67], v[212:215]
    v_mfma_f32_16x16x32_bf16 v[208:211], v[104:107], v[60:63], v[208:211]
    v_mfma_f32_16x16x32_bf16 v[216:219], v[104:107], v[64:67], v[216:219]
    s_waitcnt lgkmcnt(15)
    v_mfma_f32_16x16x32_bf16 v[108:111], v[28:31], v[12:15], v[108:111]
    ds_read_b128 v[60:63], v232 offset:8192
    ds_read_b64_tr_b16 v[76:77], v236 offset:32768
    v_mfma_f32_16x16x32_bf16 v[116:119], v[28:31], v[16:19], v[116:119]
    ds_read_b64_tr_b16 v[78:79], v236 offset:34816
    v_mfma_f32_16x16x32_bf16 v[124:127], v[28:31], v[20:23], v[124:127]
    ds_read_b128 v[64:67], v232 offset:8448
    s_waitcnt lgkmcnt(15)
    v_mfma_f32_16x16x32_bf16 v[132:135], v[28:31], v[24:27], v[132:135]
    ds_read_b128 v[68:71], v233 offset:8192
    v_mfma_f32_16x16x32_bf16 v[112:115], v[32:35], v[12:15], v[112:115]
    ds_read_b128 v[72:75], v233 offset:8448
    v_mfma_f32_16x16x32_bf16 v[120:123], v[32:35], v[16:19], v[120:123]
    ds_read_b64_tr_b16 v[80:81], v237 offset:32768
    v_mfma_f32_16x16x32_bf16 v[128:131], v[32:35], v[20:23], v[128:131]
    ds_read_b64_tr_b16 v[82:83], v237 offset:34816
    v_mfma_f32_16x16x32_bf16 v[136:139], v[32:35], v[24:27], v[136:139]
    ds_read_b64_tr_b16 v[84:85], v236 offset:40960
    s_waitcnt lgkmcnt(15)
    v_mfma_f32_16x16x32_bf16 v[140:143], v[36:39], v[12:15], v[140:143]
    ds_read_b64_tr_b16 v[86:87], v236 offset:43008
    v_mfma_f32_16x16x32_bf16 v[148:151], v[36:39], v[16:19], v[148:151]
    ds_read_b64_tr_b16 v[88:89], v237 offset:40960
    v_mfma_f32_16x16x32_bf16 v[156:159], v[36:39], v[20:23], v[156:159]
    ds_read_b64_tr_b16 v[90:91], v237 offset:43008
    v_mfma_f32_16x16x32_bf16 v[164:167], v[36:39], v[24:27], v[164:167]
    ds_read_b64_tr_b16 v[92:93], v236 offset:49152
    v_mfma_f32_16x16x32_bf16 v[144:147], v[40:43], v[12:15], v[144:147]
    ds_read_b64_tr_b16 v[94:95], v236 offset:51200
    v_mfma_f32_16x16x32_bf16 v[152:155], v[40:43], v[16:19], v[152:155]
    ds_read_b64_tr_b16 v[96:97], v237 offset:49152
    v_mfma_f32_16x16x32_bf16 v[160:163], v[40:43], v[20:23], v[160:163]
    ds_read_b64_tr_b16 v[98:99], v237 offset:51200
    v_mfma_f32_16x16x32_bf16 v[168:171], v[40:43], v[24:27], v[168:171]
    ds_read_b64_tr_b16 v[100:101], v240 offset:30720
    v_mfma_f32_16x16x32_bf16 v[172:175], v[44:47], v[12:15], v[172:175]
    ds_read_b64_tr_b16 v[102:103], v240 offset:31744
    v_mfma_f32_16x16x32_bf16 v[180:183], v[44:47], v[16:19], v[180:183]
    ds_read_b64_tr_b16 v[104:105], v241 offset:30720
    v_mfma_f32_16x16x32_bf16 v[188:191], v[44:47], v[20:23], v[188:191]
    ds_read_b64_tr_b16 v[106:107], v241 offset:31744
    v_mfma_f32_16x16x32_bf16 v[196:199], v[44:47], v[24:27], v[196:199]
    s_waitcnt lgkmcnt(15)
    v_mfma_f32_16x16x32_bf16 v[176:179], v[48:51], v[12:15], v[176:179]
    v_mfma_f32_16x16x32_bf16 v[184:187], v[48:51], v[16:19], v[184:187]
    v_mfma_f32_16x16x32_bf16 v[192:195], v[48:51], v[20:23], v[192:195]
    v_mfma_f32_16x16x32_bf16 v[200:203], v[48:51], v[24:27], v[200:203]
    v_mfma_f32_16x16x32_bf16 v[204:207], v[52:55], v[12:15], v[204:207]
    v_mfma_f32_16x16x32_bf16 v[212:215], v[52:55], v[16:19], v[212:215]
    v_mfma_f32_16x16x32_bf16 v[208:211], v[56:59], v[12:15], v[208:211]
    v_mfma_f32_16x16x32_bf16 v[216:219], v[56:59], v[16:19], v[216:219]
    s_waitcnt lgkmcnt(0)
    s_barrier
    v_mfma_f32_16x16x32_bf16 v[108:111], v[76:79], v[60:63], v[108:111]
    ds_read_b128 v[12:15], v232 offset:16384
    v_mfma_f32_16x16x32_bf16 v[116:119], v[76:79], v[64:67], v[116:119]
    ds_read_b64_tr_b16 v[28:29], v238 offset:0
    v_mfma_f32_16x16x32_bf16 v[124:127], v[76:79], v[68:71], v[124:127]
    ds_read_b64_tr_b16 v[30:31], v238 offset:2048
    v_mfma_f32_16x16x32_bf16 v[132:135], v[76:79], v[72:75], v[132:135]
    ds_read_b128 v[16:19], v232 offset:16640
    v_mfma_f32_16x16x32_bf16 v[112:115], v[80:83], v[60:63], v[112:115]
    ds_read_b128 v[20:23], v233 offset:16384
    v_mfma_f32_16x16x32_bf16 v[120:123], v[80:83], v[64:67], v[120:123]
    ds_read_b128 v[24:27], v233 offset:16640
    v_mfma_f32_16x16x32_bf16 v[128:131], v[80:83], v[68:71], v[128:131]
    ds_read_b64_tr_b16 v[32:33], v239 offset:0
    v_mfma_f32_16x16x32_bf16 v[136:139], v[80:83], v[72:75], v[136:139]
    ds_read_b64_tr_b16 v[34:35], v239 offset:2048
    v_mfma_f32_16x16x32_bf16 v[140:143], v[84:87], v[60:63], v[140:143]
    ds_read_b64_tr_b16 v[36:37], v238 offset:8192
    v_mfma_f32_16x16x32_bf16 v[148:151], v[84:87], v[64:67], v[148:151]
    ds_read_b64_tr_b16 v[38:39], v238 offset:10240
    v_mfma_f32_16x16x32_bf16 v[156:159], v[84:87], v[68:71], v[156:159]
    ds_read_b64_tr_b16 v[40:41], v239 offset:8192
    v_mfma_f32_16x16x32_bf16 v[164:167], v[84:87], v[72:75], v[164:167]
    ds_read_b64_tr_b16 v[42:43], v239 offset:10240
    v_mfma_f32_16x16x32_bf16 v[144:147], v[88:91], v[60:63], v[144:147]
    ds_read_b64_tr_b16 v[44:45], v238 offset:16384
    v_mfma_f32_16x16x32_bf16 v[152:155], v[88:91], v[64:67], v[152:155]
    ds_read_b64_tr_b16 v[46:47], v238 offset:18432
    v_mfma_f32_16x16x32_bf16 v[160:163], v[88:91], v[68:71], v[160:163]
    ds_read_b64_tr_b16 v[48:49], v239 offset:16384
    v_mfma_f32_16x16x32_bf16 v[168:171], v[88:91], v[72:75], v[168:171]
    ds_read_b64_tr_b16 v[50:51], v239 offset:18432
    v_mfma_f32_16x16x32_bf16 v[172:175], v[92:95], v[60:63], v[172:175]
    ds_read_b64_tr_b16 v[52:53], v242 offset:0
    v_mfma_f32_16x16x32_bf16 v[180:183], v[92:95], v[64:67], v[180:183]
    ds_read_b64_tr_b16 v[54:55], v242 offset:1024
    v_mfma_f32_16x16x32_bf16 v[188:191], v[92:95], v[68:71], v[188:191]
    ds_read_b64_tr_b16 v[56:57], v243 offset:0
    v_mfma_f32_16x16x32_bf16 v[196:199], v[92:95], v[72:75], v[196:199]
    ds_read_b64_tr_b16 v[58:59], v243 offset:1024
    v_mfma_f32_16x16x32_bf16 v[176:179], v[96:99], v[60:63], v[176:179]
    v_mfma_f32_16x16x32_bf16 v[184:187], v[96:99], v[64:67], v[184:187]
    v_mfma_f32_16x16x32_bf16 v[192:195], v[96:99], v[68:71], v[192:195]
    v_mfma_f32_16x16x32_bf16 v[200:203], v[96:99], v[72:75], v[200:203]
    v_mfma_f32_16x16x32_bf16 v[204:207], v[100:103], v[60:63], v[204:207]
    v_mfma_f32_16x16x32_bf16 v[212:215], v[100:103], v[64:67], v[212:215]
    v_mfma_f32_16x16x32_bf16 v[208:211], v[104:107], v[60:63], v[208:211]
    v_mfma_f32_16x16x32_bf16 v[216:219], v[104:107], v[64:67], v[216:219]
    s_waitcnt lgkmcnt(15)
    v_mfma_f32_16x16x32_bf16 v[108:111], v[28:31], v[12:15], v[108:111]
    ds_read_b128 v[60:63], v232 offset:24576
    ds_read_b64_tr_b16 v[76:77], v238 offset:4096
    v_mfma_f32_16x16x32_bf16 v[116:119], v[28:31], v[16:19], v[116:119]
    ds_read_b64_tr_b16 v[78:79], v238 offset:6144
    v_mfma_f32_16x16x32_bf16 v[124:127], v[28:31], v[20:23], v[124:127]
    ds_read_b128 v[64:67], v232 offset:24832
    s_waitcnt lgkmcnt(15)
    v_mfma_f32_16x16x32_bf16 v[132:135], v[28:31], v[24:27], v[132:135]
    ds_read_b128 v[68:71], v233 offset:24576
    v_mfma_f32_16x16x32_bf16 v[112:115], v[32:35], v[12:15], v[112:115]
    ds_read_b128 v[72:75], v233 offset:24832
    v_mfma_f32_16x16x32_bf16 v[120:123], v[32:35], v[16:19], v[120:123]
    ds_read_b64_tr_b16 v[80:81], v239 offset:4096
    v_mfma_f32_16x16x32_bf16 v[128:131], v[32:35], v[20:23], v[128:131]
    ds_read_b64_tr_b16 v[82:83], v239 offset:6144
    v_mfma_f32_16x16x32_bf16 v[136:139], v[32:35], v[24:27], v[136:139]
    ds_read_b64_tr_b16 v[84:85], v238 offset:12288
    s_waitcnt lgkmcnt(15)
    v_mfma_f32_16x16x32_bf16 v[140:143], v[36:39], v[12:15], v[140:143]
    ds_read_b64_tr_b16 v[86:87], v238 offset:14336
    v_mfma_f32_16x16x32_bf16 v[148:151], v[36:39], v[16:19], v[148:151]
    ds_read_b64_tr_b16 v[88:89], v239 offset:12288
    v_mfma_f32_16x16x32_bf16 v[156:159], v[36:39], v[20:23], v[156:159]
    ds_read_b64_tr_b16 v[90:91], v239 offset:14336
    v_mfma_f32_16x16x32_bf16 v[164:167], v[36:39], v[24:27], v[164:167]
    ds_read_b64_tr_b16 v[92:93], v238 offset:20480
    v_mfma_f32_16x16x32_bf16 v[144:147], v[40:43], v[12:15], v[144:147]
    ds_read_b64_tr_b16 v[94:95], v238 offset:22528
    v_mfma_f32_16x16x32_bf16 v[152:155], v[40:43], v[16:19], v[152:155]
    ds_read_b64_tr_b16 v[96:97], v239 offset:20480
    v_mfma_f32_16x16x32_bf16 v[160:163], v[40:43], v[20:23], v[160:163]
    ds_read_b64_tr_b16 v[98:99], v239 offset:22528
    v_mfma_f32_16x16x32_bf16 v[168:171], v[40:43], v[24:27], v[168:171]
    ds_read_b64_tr_b16 v[100:101], v242 offset:2048
    v_mfma_f32_16x16x32_bf16 v[172:175], v[44:47], v[12:15], v[172:175]
    ds_read_b64_tr_b16 v[102:103], v242 offset:3072
    v_mfma_f32_16x16x32_bf16 v[180:183], v[44:47], v[16:19], v[180:183]
    ds_read_b64_tr_b16 v[104:105], v243 offset:2048
    v_mfma_f32_16x16x32_bf16 v[188:191], v[44:47], v[20:23], v[188:191]
    ds_read_b64_tr_b16 v[106:107], v243 offset:3072
    v_mfma_f32_16x16x32_bf16 v[196:199], v[44:47], v[24:27], v[196:199]
    s_waitcnt lgkmcnt(15)
    v_mfma_f32_16x16x32_bf16 v[176:179], v[48:51], v[12:15], v[176:179]
    v_mfma_f32_16x16x32_bf16 v[184:187], v[48:51], v[16:19], v[184:187]
    v_mfma_f32_16x16x32_bf16 v[192:195], v[48:51], v[20:23], v[192:195]
    v_mfma_f32_16x16x32_bf16 v[200:203], v[48:51], v[24:27], v[200:203]
    v_mfma_f32_16x16x32_bf16 v[204:207], v[52:55], v[12:15], v[204:207]
    v_mfma_f32_16x16x32_bf16 v[212:215], v[52:55], v[16:19], v[212:215]
    v_mfma_f32_16x16x32_bf16 v[208:211], v[56:59], v[12:15], v[208:211]
    v_mfma_f32_16x16x32_bf16 v[216:219], v[56:59], v[16:19], v[216:219]
    s_waitcnt lgkmcnt(0)
    s_barrier
    v_mfma_f32_16x16x32_bf16 v[108:111], v[76:79], v[60:63], v[108:111]
    ds_read_b128 v[12:15], v232 offset:32768
    v_mfma_f32_16x16x32_bf16 v[116:119], v[76:79], v[64:67], v[116:119]
    ds_read_b64_tr_b16 v[28:29], v238 offset:28672
    v_mfma_f32_16x16x32_bf16 v[124:127], v[76:79], v[68:71], v[124:127]
    ds_read_b64_tr_b16 v[30:31], v238 offset:30720
    v_mfma_f32_16x16x32_bf16 v[132:135], v[76:79], v[72:75], v[132:135]
    ds_read_b128 v[16:19], v232 offset:33024
    v_mfma_f32_16x16x32_bf16 v[112:115], v[80:83], v[60:63], v[112:115]
    ds_read_b128 v[20:23], v233 offset:32768
    v_mfma_f32_16x16x32_bf16 v[120:123], v[80:83], v[64:67], v[120:123]
    ds_read_b128 v[24:27], v233 offset:33024
    v_mfma_f32_16x16x32_bf16 v[128:131], v[80:83], v[68:71], v[128:131]
    ds_read_b64_tr_b16 v[32:33], v239 offset:28672
    v_mfma_f32_16x16x32_bf16 v[136:139], v[80:83], v[72:75], v[136:139]
    ds_read_b64_tr_b16 v[34:35], v239 offset:30720
    v_mfma_f32_16x16x32_bf16 v[140:143], v[84:87], v[60:63], v[140:143]
    ds_read_b64_tr_b16 v[36:37], v238 offset:36864
    v_mfma_f32_16x16x32_bf16 v[148:151], v[84:87], v[64:67], v[148:151]
    ds_read_b64_tr_b16 v[38:39], v238 offset:38912
    v_mfma_f32_16x16x32_bf16 v[156:159], v[84:87], v[68:71], v[156:159]
    ds_read_b64_tr_b16 v[40:41], v239 offset:36864
    v_mfma_f32_16x16x32_bf16 v[164:167], v[84:87], v[72:75], v[164:167]
    ds_read_b64_tr_b16 v[42:43], v239 offset:38912
    v_mfma_f32_16x16x32_bf16 v[144:147], v[88:91], v[60:63], v[144:147]
    ds_read_b64_tr_b16 v[44:45], v238 offset:45056
    v_mfma_f32_16x16x32_bf16 v[152:155], v[88:91], v[64:67], v[152:155]
    ds_read_b64_tr_b16 v[46:47], v238 offset:47104
    v_mfma_f32_16x16x32_bf16 v[160:163], v[88:91], v[68:71], v[160:163]
    ds_read_b64_tr_b16 v[48:49], v239 offset:45056
    v_mfma_f32_16x16x32_bf16 v[168:171], v[88:91], v[72:75], v[168:171]
    ds_read_b64_tr_b16 v[50:51], v239 offset:47104
    v_mfma_f32_16x16x32_bf16 v[172:175], v[92:95], v[60:63], v[172:175]
    ds_read_b64_tr_b16 v[52:53], v242 offset:28672
    v_mfma_f32_16x16x32_bf16 v[180:183], v[92:95], v[64:67], v[180:183]
    ds_read_b64_tr_b16 v[54:55], v242 offset:29696
    v_mfma_f32_16x16x32_bf16 v[188:191], v[92:95], v[68:71], v[188:191]
    ds_read_b64_tr_b16 v[56:57], v243 offset:28672
    v_mfma_f32_16x16x32_bf16 v[196:199], v[92:95], v[72:75], v[196:199]
    ds_read_b64_tr_b16 v[58:59], v243 offset:29696
    v_mfma_f32_16x16x32_bf16 v[176:179], v[96:99], v[60:63], v[176:179]
    v_mfma_f32_16x16x32_bf16 v[184:187], v[96:99], v[64:67], v[184:187]
    v_mfma_f32_16x16x32_bf16 v[192:195], v[96:99], v[68:71], v[192:195]
    v_mfma_f32_16x16x32_bf16 v[200:203], v[96:99], v[72:75], v[200:203]
    v_mfma_f32_16x16x32_bf16 v[204:207], v[100:103], v[60:63], v[204:207]
    v_mfma_f32_16x16x32_bf16 v[212:215], v[100:103], v[64:67], v[212:215]
    v_mfma_f32_16x16x32_bf16 v[208:211], v[104:107], v[60:63], v[208:211]
    v_mfma_f32_16x16x32_bf16 v[216:219], v[104:107], v[64:67], v[216:219]
    s_waitcnt lgkmcnt(15)
    v_mfma_f32_16x16x32_bf16 v[108:111], v[28:31], v[12:15], v[108:111]
    ds_read_b128 v[60:63], v232 offset:40960
    ds_read_b64_tr_b16 v[76:77], v238 offset:32768
    v_mfma_f32_16x16x32_bf16 v[116:119], v[28:31], v[16:19], v[116:119]
    ds_read_b64_tr_b16 v[78:79], v238 offset:34816
    v_mfma_f32_16x16x32_bf16 v[124:127], v[28:31], v[20:23], v[124:127]
    ds_read_b128 v[64:67], v232 offset:41216
    s_waitcnt lgkmcnt(15)
    v_mfma_f32_16x16x32_bf16 v[132:135], v[28:31], v[24:27], v[132:135]
    ds_read_b128 v[68:71], v233 offset:40960
    v_mfma_f32_16x16x32_bf16 v[112:115], v[32:35], v[12:15], v[112:115]
    ds_read_b128 v[72:75], v233 offset:41216
    v_mfma_f32_16x16x32_bf16 v[120:123], v[32:35], v[16:19], v[120:123]
    ds_read_b64_tr_b16 v[80:81], v239 offset:32768
    v_mfma_f32_16x16x32_bf16 v[128:131], v[32:35], v[20:23], v[128:131]
    ds_read_b64_tr_b16 v[82:83], v239 offset:34816
    v_mfma_f32_16x16x32_bf16 v[136:139], v[32:35], v[24:27], v[136:139]
    ds_read_b64_tr_b16 v[84:85], v238 offset:40960
    s_waitcnt lgkmcnt(15)
    v_mfma_f32_16x16x32_bf16 v[140:143], v[36:39], v[12:15], v[140:143]
    ds_read_b64_tr_b16 v[86:87], v238 offset:43008
    v_mfma_f32_16x16x32_bf16 v[148:151], v[36:39], v[16:19], v[148:151]
    ds_read_b64_tr_b16 v[88:89], v239 offset:40960
    v_mfma_f32_16x16x32_bf16 v[156:159], v[36:39], v[20:23], v[156:159]
    ds_read_b64_tr_b16 v[90:91], v239 offset:43008
    v_mfma_f32_16x16x32_bf16 v[164:167], v[36:39], v[24:27], v[164:167]
    ds_read_b64_tr_b16 v[92:93], v238 offset:49152
    v_mfma_f32_16x16x32_bf16 v[144:147], v[40:43], v[12:15], v[144:147]
    ds_read_b64_tr_b16 v[94:95], v238 offset:51200
    v_mfma_f32_16x16x32_bf16 v[152:155], v[40:43], v[16:19], v[152:155]
    ds_read_b64_tr_b16 v[96:97], v239 offset:49152
    v_mfma_f32_16x16x32_bf16 v[160:163], v[40:43], v[20:23], v[160:163]
    ds_read_b64_tr_b16 v[98:99], v239 offset:51200
    v_mfma_f32_16x16x32_bf16 v[168:171], v[40:43], v[24:27], v[168:171]
    ds_read_b64_tr_b16 v[100:101], v242 offset:30720
    v_mfma_f32_16x16x32_bf16 v[172:175], v[44:47], v[12:15], v[172:175]
    ds_read_b64_tr_b16 v[102:103], v242 offset:31744
    v_mfma_f32_16x16x32_bf16 v[180:183], v[44:47], v[16:19], v[180:183]
    ds_read_b64_tr_b16 v[104:105], v243 offset:30720
    v_mfma_f32_16x16x32_bf16 v[188:191], v[44:47], v[20:23], v[188:191]
    ds_read_b64_tr_b16 v[106:107], v243 offset:31744
    v_mfma_f32_16x16x32_bf16 v[196:199], v[44:47], v[24:27], v[196:199]
    s_waitcnt lgkmcnt(15)
    v_mfma_f32_16x16x32_bf16 v[176:179], v[48:51], v[12:15], v[176:179]
    v_mfma_f32_16x16x32_bf16 v[184:187], v[48:51], v[16:19], v[184:187]
    v_mfma_f32_16x16x32_bf16 v[192:195], v[48:51], v[20:23], v[192:195]
    v_mfma_f32_16x16x32_bf16 v[200:203], v[48:51], v[24:27], v[200:203]
    v_mfma_f32_16x16x32_bf16 v[204:207], v[52:55], v[12:15], v[204:207]
    v_mfma_f32_16x16x32_bf16 v[212:215], v[52:55], v[16:19], v[212:215]
    v_mfma_f32_16x16x32_bf16 v[208:211], v[56:59], v[12:15], v[208:211]
    v_mfma_f32_16x16x32_bf16 v[216:219], v[56:59], v[16:19], v[216:219]
    s_waitcnt lgkmcnt(0)
    s_barrier
    v_mfma_f32_16x16x32_bf16 v[108:111], v[76:79], v[60:63], v[108:111]
    ds_read_b128 v[12:15], v232 offset:0
    v_mfma_f32_16x16x32_bf16 v[116:119], v[76:79], v[64:67], v[116:119]
    ds_read_b64_tr_b16 v[28:29], v236 offset:0
    v_mfma_f32_16x16x32_bf16 v[124:127], v[76:79], v[68:71], v[124:127]
    ds_read_b64_tr_b16 v[30:31], v236 offset:2048
    v_mfma_f32_16x16x32_bf16 v[132:135], v[76:79], v[72:75], v[132:135]
    ds_read_b128 v[16:19], v232 offset:256
    v_mfma_f32_16x16x32_bf16 v[112:115], v[80:83], v[60:63], v[112:115]
    ds_read_b128 v[20:23], v233 offset:0
    v_mfma_f32_16x16x32_bf16 v[120:123], v[80:83], v[64:67], v[120:123]
    ds_read_b128 v[24:27], v233 offset:256
    v_mfma_f32_16x16x32_bf16 v[128:131], v[80:83], v[68:71], v[128:131]
    ds_read_b64_tr_b16 v[32:33], v237 offset:0
    v_mfma_f32_16x16x32_bf16 v[136:139], v[80:83], v[72:75], v[136:139]
    ds_read_b64_tr_b16 v[34:35], v237 offset:2048
    v_mfma_f32_16x16x32_bf16 v[140:143], v[84:87], v[60:63], v[140:143]
    ds_read_b64_tr_b16 v[36:37], v236 offset:8192
    v_mfma_f32_16x16x32_bf16 v[148:151], v[84:87], v[64:67], v[148:151]
    ds_read_b64_tr_b16 v[38:39], v236 offset:10240
    v_mfma_f32_16x16x32_bf16 v[156:159], v[84:87], v[68:71], v[156:159]
    ds_read_b64_tr_b16 v[40:41], v237 offset:8192
    v_mfma_f32_16x16x32_bf16 v[164:167], v[84:87], v[72:75], v[164:167]
    ds_read_b64_tr_b16 v[42:43], v237 offset:10240
    v_mfma_f32_16x16x32_bf16 v[144:147], v[88:91], v[60:63], v[144:147]
    ds_read_b64_tr_b16 v[44:45], v236 offset:16384
    v_mfma_f32_16x16x32_bf16 v[152:155], v[88:91], v[64:67], v[152:155]
    ds_read_b64_tr_b16 v[46:47], v236 offset:18432
    v_mfma_f32_16x16x32_bf16 v[160:163], v[88:91], v[68:71], v[160:163]
    ds_read_b64_tr_b16 v[48:49], v237 offset:16384
    v_mfma_f32_16x16x32_bf16 v[168:171], v[88:91], v[72:75], v[168:171]
    ds_read_b64_tr_b16 v[50:51], v237 offset:18432
    v_mfma_f32_16x16x32_bf16 v[172:175], v[92:95], v[60:63], v[172:175]
    ds_read_b64_tr_b16 v[52:53], v240 offset:0
    v_mfma_f32_16x16x32_bf16 v[180:183], v[92:95], v[64:67], v[180:183]
    ds_read_b64_tr_b16 v[54:55], v240 offset:1024
    v_mfma_f32_16x16x32_bf16 v[188:191], v[92:95], v[68:71], v[188:191]
    ds_read_b64_tr_b16 v[56:57], v241 offset:0
    v_mfma_f32_16x16x32_bf16 v[196:199], v[92:95], v[72:75], v[196:199]
    ds_read_b64_tr_b16 v[58:59], v241 offset:1024
    v_mfma_f32_16x16x32_bf16 v[176:179], v[96:99], v[60:63], v[176:179]
    v_mfma_f32_16x16x32_bf16 v[184:187], v[96:99], v[64:67], v[184:187]
    v_mfma_f32_16x16x32_bf16 v[192:195], v[96:99], v[68:71], v[192:195]
    v_mfma_f32_16x16x32_bf16 v[200:203], v[96:99], v[72:75], v[200:203]
    v_mfma_f32_16x16x32_bf16 v[204:207], v[100:103], v[60:63], v[204:207]
    v_mfma_f32_16x16x32_bf16 v[212:215], v[100:103], v[64:67], v[212:215]
    v_mfma_f32_16x16x32_bf16 v[208:211], v[104:107], v[60:63], v[208:211]
    v_mfma_f32_16x16x32_bf16 v[216:219], v[104:107], v[64:67], v[216:219]
    s_waitcnt lgkmcnt(15)
    v_mfma_f32_16x16x32_bf16 v[108:111], v[28:31], v[12:15], v[108:111]
    ds_read_b128 v[60:63], v232 offset:8192
    ds_read_b64_tr_b16 v[76:77], v236 offset:4096
    v_mfma_f32_16x16x32_bf16 v[116:119], v[28:31], v[16:19], v[116:119]
    ds_read_b64_tr_b16 v[78:79], v236 offset:6144
    v_mfma_f32_16x16x32_bf16 v[124:127], v[28:31], v[20:23], v[124:127]
    ds_read_b128 v[64:67], v232 offset:8448
    s_waitcnt lgkmcnt(15)
    v_mfma_f32_16x16x32_bf16 v[132:135], v[28:31], v[24:27], v[132:135]
    ds_read_b128 v[68:71], v233 offset:8192
    v_mfma_f32_16x16x32_bf16 v[112:115], v[32:35], v[12:15], v[112:115]
    ds_read_b128 v[72:75], v233 offset:8448
    v_mfma_f32_16x16x32_bf16 v[120:123], v[32:35], v[16:19], v[120:123]
    ds_read_b64_tr_b16 v[80:81], v237 offset:4096
    v_mfma_f32_16x16x32_bf16 v[128:131], v[32:35], v[20:23], v[128:131]
    ds_read_b64_tr_b16 v[82:83], v237 offset:6144
    v_mfma_f32_16x16x32_bf16 v[136:139], v[32:35], v[24:27], v[136:139]
    ds_read_b64_tr_b16 v[84:85], v236 offset:12288
    s_waitcnt lgkmcnt(15)
    v_mfma_f32_16x16x32_bf16 v[140:143], v[36:39], v[12:15], v[140:143]
    ds_read_b64_tr_b16 v[86:87], v236 offset:14336
    v_mfma_f32_16x16x32_bf16 v[148:151], v[36:39], v[16:19], v[148:151]
    ds_read_b64_tr_b16 v[88:89], v237 offset:12288
    v_mfma_f32_16x16x32_bf16 v[156:159], v[36:39], v[20:23], v[156:159]
    ds_read_b64_tr_b16 v[90:91], v237 offset:14336
    v_mfma_f32_16x16x32_bf16 v[164:167], v[36:39], v[24:27], v[164:167]
    ds_read_b64_tr_b16 v[92:93], v236 offset:20480
    v_mfma_f32_16x16x32_bf16 v[144:147], v[40:43], v[12:15], v[144:147]
    ds_read_b64_tr_b16 v[94:95], v236 offset:22528
    v_mfma_f32_16x16x32_bf16 v[152:155], v[40:43], v[16:19], v[152:155]
    ds_read_b64_tr_b16 v[96:97], v237 offset:20480
    v_mfma_f32_16x16x32_bf16 v[160:163], v[40:43], v[20:23], v[160:163]
    ds_read_b64_tr_b16 v[98:99], v237 offset:22528
    v_mfma_f32_16x16x32_bf16 v[168:171], v[40:43], v[24:27], v[168:171]
    ds_read_b64_tr_b16 v[100:101], v240 offset:2048
    v_mfma_f32_16x16x32_bf16 v[172:175], v[44:47], v[12:15], v[172:175]
    ds_read_b64_tr_b16 v[102:103], v240 offset:3072
    v_mfma_f32_16x16x32_bf16 v[180:183], v[44:47], v[16:19], v[180:183]
    ds_read_b64_tr_b16 v[104:105], v241 offset:2048
    v_mfma_f32_16x16x32_bf16 v[188:191], v[44:47], v[20:23], v[188:191]
    ds_read_b64_tr_b16 v[106:107], v241 offset:3072
    v_mfma_f32_16x16x32_bf16 v[196:199], v[44:47], v[24:27], v[196:199]
    s_waitcnt lgkmcnt(15)
    v_mfma_f32_16x16x32_bf16 v[176:179], v[48:51], v[12:15], v[176:179]
    v_mfma_f32_16x16x32_bf16 v[184:187], v[48:51], v[16:19], v[184:187]
    v_mfma_f32_16x16x32_bf16 v[192:195], v[48:51], v[20:23], v[192:195]
    v_mfma_f32_16x16x32_bf16 v[200:203], v[48:51], v[24:27], v[200:203]
    v_mfma_f32_16x16x32_bf16 v[204:207], v[52:55], v[12:15], v[204:207]
    v_mfma_f32_16x16x32_bf16 v[212:215], v[52:55], v[16:19], v[212:215]
    v_mfma_f32_16x16x32_bf16 v[208:211], v[56:59], v[12:15], v[208:211]
    v_mfma_f32_16x16x32_bf16 v[216:219], v[56:59], v[16:19], v[216:219]
    s_waitcnt lgkmcnt(0)
    s_barrier
    v_mfma_f32_16x16x32_bf16 v[108:111], v[76:79], v[60:63], v[108:111]
    ds_read_b128 v[12:15], v232 offset:16384
    v_mfma_f32_16x16x32_bf16 v[116:119], v[76:79], v[64:67], v[116:119]
    ds_read_b64_tr_b16 v[28:29], v236 offset:28672
    v_mfma_f32_16x16x32_bf16 v[124:127], v[76:79], v[68:71], v[124:127]
    ds_read_b64_tr_b16 v[30:31], v236 offset:30720
    v_mfma_f32_16x16x32_bf16 v[132:135], v[76:79], v[72:75], v[132:135]
    ds_read_b128 v[16:19], v232 offset:16640
    v_mfma_f32_16x16x32_bf16 v[112:115], v[80:83], v[60:63], v[112:115]
    ds_read_b128 v[20:23], v233 offset:16384
    v_mfma_f32_16x16x32_bf16 v[120:123], v[80:83], v[64:67], v[120:123]
    ds_read_b128 v[24:27], v233 offset:16640
    v_mfma_f32_16x16x32_bf16 v[128:131], v[80:83], v[68:71], v[128:131]
    ds_read_b64_tr_b16 v[32:33], v237 offset:28672
    v_mfma_f32_16x16x32_bf16 v[136:139], v[80:83], v[72:75], v[136:139]
    ds_read_b64_tr_b16 v[34:35], v237 offset:30720
    v_mfma_f32_16x16x32_bf16 v[140:143], v[84:87], v[60:63], v[140:143]
    ds_read_b64_tr_b16 v[36:37], v236 offset:36864
    v_mfma_f32_16x16x32_bf16 v[148:151], v[84:87], v[64:67], v[148:151]
    ds_read_b64_tr_b16 v[38:39], v236 offset:38912
    v_mfma_f32_16x16x32_bf16 v[156:159], v[84:87], v[68:71], v[156:159]
    ds_read_b64_tr_b16 v[40:41], v237 offset:36864
    v_mfma_f32_16x16x32_bf16 v[164:167], v[84:87], v[72:75], v[164:167]
    ds_read_b64_tr_b16 v[42:43], v237 offset:38912
    v_mfma_f32_16x16x32_bf16 v[144:147], v[88:91], v[60:63], v[144:147]
    ds_read_b64_tr_b16 v[44:45], v236 offset:45056
    v_mfma_f32_16x16x32_bf16 v[152:155], v[88:91], v[64:67], v[152:155]
    ds_read_b64_tr_b16 v[46:47], v236 offset:47104
    v_mfma_f32_16x16x32_bf16 v[160:163], v[88:91], v[68:71], v[160:163]
    ds_read_b64_tr_b16 v[48:49], v237 offset:45056
    v_mfma_f32_16x16x32_bf16 v[168:171], v[88:91], v[72:75], v[168:171]
    ds_read_b64_tr_b16 v[50:51], v237 offset:47104
    v_mfma_f32_16x16x32_bf16 v[172:175], v[92:95], v[60:63], v[172:175]
    ds_read_b64_tr_b16 v[52:53], v240 offset:28672
    v_mfma_f32_16x16x32_bf16 v[180:183], v[92:95], v[64:67], v[180:183]
    ds_read_b64_tr_b16 v[54:55], v240 offset:29696
    v_mfma_f32_16x16x32_bf16 v[188:191], v[92:95], v[68:71], v[188:191]
    ds_read_b64_tr_b16 v[56:57], v241 offset:28672
    v_mfma_f32_16x16x32_bf16 v[196:199], v[92:95], v[72:75], v[196:199]
    ds_read_b64_tr_b16 v[58:59], v241 offset:29696
    v_mfma_f32_16x16x32_bf16 v[176:179], v[96:99], v[60:63], v[176:179]
    v_mfma_f32_16x16x32_bf16 v[184:187], v[96:99], v[64:67], v[184:187]
    v_mfma_f32_16x16x32_bf16 v[192:195], v[96:99], v[68:71], v[192:195]
    v_mfma_f32_16x16x32_bf16 v[200:203], v[96:99], v[72:75], v[200:203]
    v_mfma_f32_16x16x32_bf16 v[204:207], v[100:103], v[60:63], v[204:207]
    v_mfma_f32_16x16x32_bf16 v[212:215], v[100:103], v[64:67], v[212:215]
    v_mfma_f32_16x16x32_bf16 v[208:211], v[104:107], v[60:63], v[208:211]
    v_mfma_f32_16x16x32_bf16 v[216:219], v[104:107], v[64:67], v[216:219]
    s_waitcnt lgkmcnt(15)
    v_mfma_f32_16x16x32_bf16 v[108:111], v[28:31], v[12:15], v[108:111]
    ds_read_b128 v[60:63], v232 offset:24576
    ds_read_b64_tr_b16 v[76:77], v236 offset:32768
    v_mfma_f32_16x16x32_bf16 v[116:119], v[28:31], v[16:19], v[116:119]
    ds_read_b64_tr_b16 v[78:79], v236 offset:34816
    v_mfma_f32_16x16x32_bf16 v[124:127], v[28:31], v[20:23], v[124:127]
    ds_read_b128 v[64:67], v232 offset:24832
    s_waitcnt lgkmcnt(15)
    v_mfma_f32_16x16x32_bf16 v[132:135], v[28:31], v[24:27], v[132:135]
    ds_read_b128 v[68:71], v233 offset:24576
    v_mfma_f32_16x16x32_bf16 v[112:115], v[32:35], v[12:15], v[112:115]
    ds_read_b128 v[72:75], v233 offset:24832
    v_mfma_f32_16x16x32_bf16 v[120:123], v[32:35], v[16:19], v[120:123]
    ds_read_b64_tr_b16 v[80:81], v237 offset:32768
    v_mfma_f32_16x16x32_bf16 v[128:131], v[32:35], v[20:23], v[128:131]
    ds_read_b64_tr_b16 v[82:83], v237 offset:34816
    v_mfma_f32_16x16x32_bf16 v[136:139], v[32:35], v[24:27], v[136:139]
    ds_read_b64_tr_b16 v[84:85], v236 offset:40960
    s_waitcnt lgkmcnt(15)
    v_mfma_f32_16x16x32_bf16 v[140:143], v[36:39], v[12:15], v[140:143]
    ds_read_b64_tr_b16 v[86:87], v236 offset:43008
    v_mfma_f32_16x16x32_bf16 v[148:151], v[36:39], v[16:19], v[148:151]
    ds_read_b64_tr_b16 v[88:89], v237 offset:40960
    v_mfma_f32_16x16x32_bf16 v[156:159], v[36:39], v[20:23], v[156:159]
    ds_read_b64_tr_b16 v[90:91], v237 offset:43008
    v_mfma_f32_16x16x32_bf16 v[164:167], v[36:39], v[24:27], v[164:167]
    ds_read_b64_tr_b16 v[92:93], v236 offset:49152
    v_mfma_f32_16x16x32_bf16 v[144:147], v[40:43], v[12:15], v[144:147]
    ds_read_b64_tr_b16 v[94:95], v236 offset:51200
    v_mfma_f32_16x16x32_bf16 v[152:155], v[40:43], v[16:19], v[152:155]
    ds_read_b64_tr_b16 v[96:97], v237 offset:49152
    v_mfma_f32_16x16x32_bf16 v[160:163], v[40:43], v[20:23], v[160:163]
    ds_read_b64_tr_b16 v[98:99], v237 offset:51200
    v_mfma_f32_16x16x32_bf16 v[168:171], v[40:43], v[24:27], v[168:171]
    ds_read_b64_tr_b16 v[100:101], v240 offset:30720
    v_mfma_f32_16x16x32_bf16 v[172:175], v[44:47], v[12:15], v[172:175]
    ds_read_b64_tr_b16 v[102:103], v240 offset:31744
    v_mfma_f32_16x16x32_bf16 v[180:183], v[44:47], v[16:19], v[180:183]
    ds_read_b64_tr_b16 v[104:105], v241 offset:30720
    v_mfma_f32_16x16x32_bf16 v[188:191], v[44:47], v[20:23], v[188:191]
    ds_read_b64_tr_b16 v[106:107], v241 offset:31744
    v_mfma_f32_16x16x32_bf16 v[196:199], v[44:47], v[24:27], v[196:199]
    s_waitcnt lgkmcnt(15)
    v_mfma_f32_16x16x32_bf16 v[176:179], v[48:51], v[12:15], v[176:179]
    v_mfma_f32_16x16x32_bf16 v[184:187], v[48:51], v[16:19], v[184:187]
    v_mfma_f32_16x16x32_bf16 v[192:195], v[48:51], v[20:23], v[192:195]
    v_mfma_f32_16x16x32_bf16 v[200:203], v[48:51], v[24:27], v[200:203]
    v_mfma_f32_16x16x32_bf16 v[204:207], v[52:55], v[12:15], v[204:207]
    v_mfma_f32_16x16x32_bf16 v[212:215], v[52:55], v[16:19], v[212:215]
    v_mfma_f32_16x16x32_bf16 v[208:211], v[56:59], v[12:15], v[208:211]
    v_mfma_f32_16x16x32_bf16 v[216:219], v[56:59], v[16:19], v[216:219]
    s_waitcnt lgkmcnt(0)
    s_barrier
    v_mfma_f32_16x16x32_bf16 v[108:111], v[76:79], v[60:63], v[108:111]
    ds_read_b128 v[12:15], v232 offset:32768
    v_mfma_f32_16x16x32_bf16 v[116:119], v[76:79], v[64:67], v[116:119]
    ds_read_b64_tr_b16 v[28:29], v238 offset:0
    v_mfma_f32_16x16x32_bf16 v[124:127], v[76:79], v[68:71], v[124:127]
    ds_read_b64_tr_b16 v[30:31], v238 offset:2048
    v_mfma_f32_16x16x32_bf16 v[132:135], v[76:79], v[72:75], v[132:135]
    ds_read_b128 v[16:19], v232 offset:33024
    v_mfma_f32_16x16x32_bf16 v[112:115], v[80:83], v[60:63], v[112:115]
    ds_read_b128 v[20:23], v233 offset:32768
    v_mfma_f32_16x16x32_bf16 v[120:123], v[80:83], v[64:67], v[120:123]
    ds_read_b128 v[24:27], v233 offset:33024
    v_mfma_f32_16x16x32_bf16 v[128:131], v[80:83], v[68:71], v[128:131]
    ds_read_b64_tr_b16 v[32:33], v239 offset:0
    v_mfma_f32_16x16x32_bf16 v[136:139], v[80:83], v[72:75], v[136:139]
    ds_read_b64_tr_b16 v[34:35], v239 offset:2048
    v_mfma_f32_16x16x32_bf16 v[140:143], v[84:87], v[60:63], v[140:143]
    ds_read_b64_tr_b16 v[36:37], v238 offset:8192
    v_mfma_f32_16x16x32_bf16 v[148:151], v[84:87], v[64:67], v[148:151]
    ds_read_b64_tr_b16 v[38:39], v238 offset:10240
    v_mfma_f32_16x16x32_bf16 v[156:159], v[84:87], v[68:71], v[156:159]
    ds_read_b64_tr_b16 v[40:41], v239 offset:8192
    v_mfma_f32_16x16x32_bf16 v[164:167], v[84:87], v[72:75], v[164:167]
    ds_read_b64_tr_b16 v[42:43], v239 offset:10240
    v_mfma_f32_16x16x32_bf16 v[144:147], v[88:91], v[60:63], v[144:147]
    ds_read_b64_tr_b16 v[44:45], v238 offset:16384
    v_mfma_f32_16x16x32_bf16 v[152:155], v[88:91], v[64:67], v[152:155]
    ds_read_b64_tr_b16 v[46:47], v238 offset:18432
    v_mfma_f32_16x16x32_bf16 v[160:163], v[88:91], v[68:71], v[160:163]
    ds_read_b64_tr_b16 v[48:49], v239 offset:16384
    v_mfma_f32_16x16x32_bf16 v[168:171], v[88:91], v[72:75], v[168:171]
    ds_read_b64_tr_b16 v[50:51], v239 offset:18432
    v_mfma_f32_16x16x32_bf16 v[172:175], v[92:95], v[60:63], v[172:175]
    ds_read_b64_tr_b16 v[52:53], v242 offset:0
    v_mfma_f32_16x16x32_bf16 v[180:183], v[92:95], v[64:67], v[180:183]
    ds_read_b64_tr_b16 v[54:55], v242 offset:1024
    v_mfma_f32_16x16x32_bf16 v[188:191], v[92:95], v[68:71], v[188:191]
    ds_read_b64_tr_b16 v[56:57], v243 offset:0
    v_mfma_f32_16x16x32_bf16 v[196:199], v[92:95], v[72:75], v[196:199]
    ds_read_b64_tr_b16 v[58:59], v243 offset:1024
    v_mfma_f32_16x16x32_bf16 v[176:179], v[96:99], v[60:63], v[176:179]
    v_mfma_f32_16x16x32_bf16 v[184:187], v[96:99], v[64:67], v[184:187]
    v_mfma_f32_16x16x32_bf16 v[192:195], v[96:99], v[68:71], v[192:195]
    v_mfma_f32_16x16x32_bf16 v[200:203], v[96:99], v[72:75], v[200:203]
    v_mfma_f32_16x16x32_bf16 v[204:207], v[100:103], v[60:63], v[204:207]
    v_mfma_f32_16x16x32_bf16 v[212:215], v[100:103], v[64:67], v[212:215]
    v_mfma_f32_16x16x32_bf16 v[208:211], v[104:107], v[60:63], v[208:211]
    v_mfma_f32_16x16x32_bf16 v[216:219], v[104:107], v[64:67], v[216:219]
    s_waitcnt lgkmcnt(15)
    v_mfma_f32_16x16x32_bf16 v[108:111], v[28:31], v[12:15], v[108:111]
    ds_read_b128 v[60:63], v232 offset:40960
    ds_read_b64_tr_b16 v[76:77], v238 offset:4096
    v_mfma_f32_16x16x32_bf16 v[116:119], v[28:31], v[16:19], v[116:119]
    ds_read_b64_tr_b16 v[78:79], v238 offset:6144
    v_mfma_f32_16x16x32_bf16 v[124:127], v[28:31], v[20:23], v[124:127]
    ds_read_b128 v[64:67], v232 offset:41216
    s_waitcnt lgkmcnt(15)
    v_mfma_f32_16x16x32_bf16 v[132:135], v[28:31], v[24:27], v[132:135]
    ds_read_b128 v[68:71], v233 offset:40960
    v_mfma_f32_16x16x32_bf16 v[112:115], v[32:35], v[12:15], v[112:115]
    ds_read_b128 v[72:75], v233 offset:41216
    v_mfma_f32_16x16x32_bf16 v[120:123], v[32:35], v[16:19], v[120:123]
    ds_read_b64_tr_b16 v[80:81], v239 offset:4096
    v_mfma_f32_16x16x32_bf16 v[128:131], v[32:35], v[20:23], v[128:131]
    ds_read_b64_tr_b16 v[82:83], v239 offset:6144
    v_mfma_f32_16x16x32_bf16 v[136:139], v[32:35], v[24:27], v[136:139]
    ds_read_b64_tr_b16 v[84:85], v238 offset:12288
    s_waitcnt lgkmcnt(15)
    v_mfma_f32_16x16x32_bf16 v[140:143], v[36:39], v[12:15], v[140:143]
    ds_read_b64_tr_b16 v[86:87], v238 offset:14336
    v_mfma_f32_16x16x32_bf16 v[148:151], v[36:39], v[16:19], v[148:151]
    ds_read_b64_tr_b16 v[88:89], v239 offset:12288
    v_mfma_f32_16x16x32_bf16 v[156:159], v[36:39], v[20:23], v[156:159]
    ds_read_b64_tr_b16 v[90:91], v239 offset:14336
    v_mfma_f32_16x16x32_bf16 v[164:167], v[36:39], v[24:27], v[164:167]
    ds_read_b64_tr_b16 v[92:93], v238 offset:20480
    v_mfma_f32_16x16x32_bf16 v[144:147], v[40:43], v[12:15], v[144:147]
    ds_read_b64_tr_b16 v[94:95], v238 offset:22528
    v_mfma_f32_16x16x32_bf16 v[152:155], v[40:43], v[16:19], v[152:155]
    ds_read_b64_tr_b16 v[96:97], v239 offset:20480
    v_mfma_f32_16x16x32_bf16 v[160:163], v[40:43], v[20:23], v[160:163]
    ds_read_b64_tr_b16 v[98:99], v239 offset:22528
    v_mfma_f32_16x16x32_bf16 v[168:171], v[40:43], v[24:27], v[168:171]
    ds_read_b64_tr_b16 v[100:101], v242 offset:2048
    v_mfma_f32_16x16x32_bf16 v[172:175], v[44:47], v[12:15], v[172:175]
    ds_read_b64_tr_b16 v[102:103], v242 offset:3072
    v_mfma_f32_16x16x32_bf16 v[180:183], v[44:47], v[16:19], v[180:183]
    ds_read_b64_tr_b16 v[104:105], v243 offset:2048
    v_mfma_f32_16x16x32_bf16 v[188:191], v[44:47], v[20:23], v[188:191]
    ds_read_b64_tr_b16 v[106:107], v243 offset:3072
    v_mfma_f32_16x16x32_bf16 v[196:199], v[44:47], v[24:27], v[196:199]
    s_waitcnt lgkmcnt(15)
    v_mfma_f32_16x16x32_bf16 v[176:179], v[48:51], v[12:15], v[176:179]
    v_mfma_f32_16x16x32_bf16 v[184:187], v[48:51], v[16:19], v[184:187]
    v_mfma_f32_16x16x32_bf16 v[192:195], v[48:51], v[20:23], v[192:195]
    v_mfma_f32_16x16x32_bf16 v[200:203], v[48:51], v[24:27], v[200:203]
    v_mfma_f32_16x16x32_bf16 v[204:207], v[52:55], v[12:15], v[204:207]
    v_mfma_f32_16x16x32_bf16 v[212:215], v[52:55], v[16:19], v[212:215]
    v_mfma_f32_16x16x32_bf16 v[208:211], v[56:59], v[12:15], v[208:211]
    v_mfma_f32_16x16x32_bf16 v[216:219], v[56:59], v[16:19], v[216:219]
    s_waitcnt lgkmcnt(0)
    s_barrier
    v_mfma_f32_16x16x32_bf16 v[108:111], v[76:79], v[60:63], v[108:111]
    ds_read_b128 v[12:15], v232 offset:0
    v_mfma_f32_16x16x32_bf16 v[116:119], v[76:79], v[64:67], v[116:119]
    ds_read_b64_tr_b16 v[28:29], v238 offset:28672
    v_mfma_f32_16x16x32_bf16 v[124:127], v[76:79], v[68:71], v[124:127]
    ds_read_b64_tr_b16 v[30:31], v238 offset:30720
    v_mfma_f32_16x16x32_bf16 v[132:135], v[76:79], v[72:75], v[132:135]
    ds_read_b128 v[16:19], v232 offset:256
    v_mfma_f32_16x16x32_bf16 v[112:115], v[80:83], v[60:63], v[112:115]
    ds_read_b128 v[20:23], v233 offset:0
    v_mfma_f32_16x16x32_bf16 v[120:123], v[80:83], v[64:67], v[120:123]
    ds_read_b128 v[24:27], v233 offset:256
    v_mfma_f32_16x16x32_bf16 v[128:131], v[80:83], v[68:71], v[128:131]
    ds_read_b64_tr_b16 v[32:33], v239 offset:28672
    v_mfma_f32_16x16x32_bf16 v[136:139], v[80:83], v[72:75], v[136:139]
    ds_read_b64_tr_b16 v[34:35], v239 offset:30720
    v_mfma_f32_16x16x32_bf16 v[140:143], v[84:87], v[60:63], v[140:143]
    ds_read_b64_tr_b16 v[36:37], v238 offset:36864
    v_mfma_f32_16x16x32_bf16 v[148:151], v[84:87], v[64:67], v[148:151]
    ds_read_b64_tr_b16 v[38:39], v238 offset:38912
    v_mfma_f32_16x16x32_bf16 v[156:159], v[84:87], v[68:71], v[156:159]
    ds_read_b64_tr_b16 v[40:41], v239 offset:36864
    v_mfma_f32_16x16x32_bf16 v[164:167], v[84:87], v[72:75], v[164:167]
    ds_read_b64_tr_b16 v[42:43], v239 offset:38912
    v_mfma_f32_16x16x32_bf16 v[144:147], v[88:91], v[60:63], v[144:147]
    ds_read_b64_tr_b16 v[44:45], v238 offset:45056
    v_mfma_f32_16x16x32_bf16 v[152:155], v[88:91], v[64:67], v[152:155]
    ds_read_b64_tr_b16 v[46:47], v238 offset:47104
    v_mfma_f32_16x16x32_bf16 v[160:163], v[88:91], v[68:71], v[160:163]
    ds_read_b64_tr_b16 v[48:49], v239 offset:45056
    v_mfma_f32_16x16x32_bf16 v[168:171], v[88:91], v[72:75], v[168:171]
    ds_read_b64_tr_b16 v[50:51], v239 offset:47104
    v_mfma_f32_16x16x32_bf16 v[172:175], v[92:95], v[60:63], v[172:175]
    ds_read_b64_tr_b16 v[52:53], v242 offset:28672
    v_mfma_f32_16x16x32_bf16 v[180:183], v[92:95], v[64:67], v[180:183]
    ds_read_b64_tr_b16 v[54:55], v242 offset:29696
    v_mfma_f32_16x16x32_bf16 v[188:191], v[92:95], v[68:71], v[188:191]
    ds_read_b64_tr_b16 v[56:57], v243 offset:28672
    v_mfma_f32_16x16x32_bf16 v[196:199], v[92:95], v[72:75], v[196:199]
    ds_read_b64_tr_b16 v[58:59], v243 offset:29696
    v_mfma_f32_16x16x32_bf16 v[176:179], v[96:99], v[60:63], v[176:179]
    v_mfma_f32_16x16x32_bf16 v[184:187], v[96:99], v[64:67], v[184:187]
    v_mfma_f32_16x16x32_bf16 v[192:195], v[96:99], v[68:71], v[192:195]
    v_mfma_f32_16x16x32_bf16 v[200:203], v[96:99], v[72:75], v[200:203]
    v_mfma_f32_16x16x32_bf16 v[204:207], v[100:103], v[60:63], v[204:207]
    v_mfma_f32_16x16x32_bf16 v[212:215], v[100:103], v[64:67], v[212:215]
    v_mfma_f32_16x16x32_bf16 v[208:211], v[104:107], v[60:63], v[208:211]
    v_mfma_f32_16x16x32_bf16 v[216:219], v[104:107], v[64:67], v[216:219]
    s_waitcnt lgkmcnt(15)
    v_mfma_f32_16x16x32_bf16 v[108:111], v[28:31], v[12:15], v[108:111]
    ds_read_b128 v[60:63], v232 offset:8192
    ds_read_b64_tr_b16 v[76:77], v238 offset:32768
    v_mfma_f32_16x16x32_bf16 v[116:119], v[28:31], v[16:19], v[116:119]
    ds_read_b64_tr_b16 v[78:79], v238 offset:34816
    v_mfma_f32_16x16x32_bf16 v[124:127], v[28:31], v[20:23], v[124:127]
    ds_read_b128 v[64:67], v232 offset:8448
    s_waitcnt lgkmcnt(15)
    v_mfma_f32_16x16x32_bf16 v[132:135], v[28:31], v[24:27], v[132:135]
    ds_read_b128 v[68:71], v233 offset:8192
    v_mfma_f32_16x16x32_bf16 v[112:115], v[32:35], v[12:15], v[112:115]
    ds_read_b128 v[72:75], v233 offset:8448
    v_mfma_f32_16x16x32_bf16 v[120:123], v[32:35], v[16:19], v[120:123]
    ds_read_b64_tr_b16 v[80:81], v239 offset:32768
    v_mfma_f32_16x16x32_bf16 v[128:131], v[32:35], v[20:23], v[128:131]
    ds_read_b64_tr_b16 v[82:83], v239 offset:34816
    v_mfma_f32_16x16x32_bf16 v[136:139], v[32:35], v[24:27], v[136:139]
    ds_read_b64_tr_b16 v[84:85], v238 offset:40960
    s_waitcnt lgkmcnt(15)
    v_mfma_f32_16x16x32_bf16 v[140:143], v[36:39], v[12:15], v[140:143]
    ds_read_b64_tr_b16 v[86:87], v238 offset:43008
    v_mfma_f32_16x16x32_bf16 v[148:151], v[36:39], v[16:19], v[148:151]
    ds_read_b64_tr_b16 v[88:89], v239 offset:40960
    v_mfma_f32_16x16x32_bf16 v[156:159], v[36:39], v[20:23], v[156:159]
    ds_read_b64_tr_b16 v[90:91], v239 offset:43008
    v_mfma_f32_16x16x32_bf16 v[164:167], v[36:39], v[24:27], v[164:167]
    ds_read_b64_tr_b16 v[92:93], v238 offset:49152
    v_mfma_f32_16x16x32_bf16 v[144:147], v[40:43], v[12:15], v[144:147]
    ds_read_b64_tr_b16 v[94:95], v238 offset:51200
    v_mfma_f32_16x16x32_bf16 v[152:155], v[40:43], v[16:19], v[152:155]
    ds_read_b64_tr_b16 v[96:97], v239 offset:49152
    v_mfma_f32_16x16x32_bf16 v[160:163], v[40:43], v[20:23], v[160:163]
    ds_read_b64_tr_b16 v[98:99], v239 offset:51200
    v_mfma_f32_16x16x32_bf16 v[168:171], v[40:43], v[24:27], v[168:171]
    ds_read_b64_tr_b16 v[100:101], v242 offset:30720
    v_mfma_f32_16x16x32_bf16 v[172:175], v[44:47], v[12:15], v[172:175]
    ds_read_b64_tr_b16 v[102:103], v242 offset:31744
    v_mfma_f32_16x16x32_bf16 v[180:183], v[44:47], v[16:19], v[180:183]
    ds_read_b64_tr_b16 v[104:105], v243 offset:30720
    v_mfma_f32_16x16x32_bf16 v[188:191], v[44:47], v[20:23], v[188:191]
    ds_read_b64_tr_b16 v[106:107], v243 offset:31744
    v_mfma_f32_16x16x32_bf16 v[196:199], v[44:47], v[24:27], v[196:199]
    s_sub_u32 s48, s48, 1
    s_waitcnt lgkmcnt(15)
    v_mfma_f32_16x16x32_bf16 v[176:179], v[48:51], v[12:15], v[176:179]
    s_cmp_lg_u32 s48, 0
    v_mfma_f32_16x16x32_bf16 v[184:187], v[48:51], v[16:19], v[184:187]
    v_mfma_f32_16x16x32_bf16 v[192:195], v[48:51], v[20:23], v[192:195]
    v_mfma_f32_16x16x32_bf16 v[200:203], v[48:51], v[24:27], v[200:203]
    v_mfma_f32_16x16x32_bf16 v[204:207], v[52:55], v[12:15], v[204:207]
    v_mfma_f32_16x16x32_bf16 v[212:215], v[52:55], v[16:19], v[212:215]
    v_mfma_f32_16x16x32_bf16 v[208:211], v[56:59], v[12:15], v[208:211]
    v_mfma_f32_16x16x32_bf16 v[216:219], v[56:59], v[16:19], v[216:219]
    s_waitcnt lgkmcnt(0)
    s_barrier
    s_cbranch_scc1 k3_kernel_cloop
    s_waitcnt vmcnt(0)
    v_mfma_f32_16x16x32_bf16 v[108:111], v[76:79], v[60:63], v[108:111]
    v_mfma_f32_16x16x32_bf16 v[116:119], v[76:79], v[64:67], v[116:119]
    v_mfma_f32_16x16x32_bf16 v[124:127], v[76:79], v[68:71], v[124:127]
    v_mfma_f32_16x16x32_bf16 v[132:135], v[76:79], v[72:75], v[132:135]
    v_mfma_f32_16x16x32_bf16 v[112:115], v[80:83], v[60:63], v[112:115]
    v_mfma_f32_16x16x32_bf16 v[120:123], v[80:83], v[64:67], v[120:123]
    v_mfma_f32_16x16x32_bf16 v[128:131], v[80:83], v[68:71], v[128:131]
    v_mfma_f32_16x16x32_bf16 v[136:139], v[80:83], v[72:75], v[136:139]
    v_mfma_f32_16x16x32_bf16 v[140:143], v[84:87], v[60:63], v[140:143]
    v_mfma_f32_16x16x32_bf16 v[148:151], v[84:87], v[64:67], v[148:151]
    v_mfma_f32_16x16x32_bf16 v[156:159], v[84:87], v[68:71], v[156:159]
    v_mfma_f32_16x16x32_bf16 v[164:167], v[84:87], v[72:75], v[164:167]
    v_mfma_f32_16x16x32_bf16 v[144:147], v[88:91], v[60:63], v[144:147]
    v_mfma_f32_16x16x32_bf16 v[152:155], v[88:91], v[64:67], v[152:155]
    v_mfma_f32_16x16x32_bf16 v[160:163], v[88:91], v[68:71], v[160:163]
    v_mfma_f32_16x16x32_bf16 v[168:171], v[88:91], v[72:75], v[168:171]
    v_mfma_f32_16x16x32_bf16 v[172:175], v[92:95], v[60:63], v[172:175]
    v_mfma_f32_16x16x32_bf16 v[180:183], v[92:95], v[64:67], v[180:183]
    v_mfma_f32_16x16x32_bf16 v[188:191], v[92:95], v[68:71], v[188:191]
    v_mfma_f32_16x16x32_bf16 v[196:199], v[92:95], v[72:75], v[196:199]
    v_mfma_f32_16x16x32_bf16 v[176:179], v[96:99], v[60:63], v[176:179]
    v_mfma_f32_16x16x32_bf16 v[184:187], v[96:99], v[64:67], v[184:187]
    v_mfma_f32_16x16x32_bf16 v[192:195], v[96:99], v[68:71], v[192:195]
    v_mfma_f32_16x16x32_bf16 v[200:203], v[96:99], v[72:75], v[200:203]
    v_mfma_f32_16x16x32_bf16 v[204:207], v[100:103], v[60:63], v[204:207]
    v_mfma_f32_16x16x32_bf16 v[212:215], v[100:103], v[64:67], v[212:215]
    v_mfma_f32_16x16x32_bf16 v[208:211], v[104:107], v[60:63], v[208:211]
    v_mfma_f32_16x16x32_bf16 v[216:219], v[104:107], v[64:67], v[216:219]
    v_lshlrev_b32 v9, 1, v9
    s_lshl_b32 s21, s20, 14
    s_lshl_b32 s22, s15, 1
    s_add_u32 s22, s22, s18
    s_lshl_b32 s22, s22, 9
    s_add_u32 s22, s22, s21
    s_add_u32 s24, s21, 4096
    s_add_u32 s25, s21, 8192
    s_add_u32 s26, s21, 12288
    s_bitcmp1_b32 s15, 0
    s_cbranch_scc1 k3_kernel_e1
    v_pk_mul_f32 v[12:13], v[108:109], v[108:109]
    v_pk_mul_f32 v[14:15], v[110:111], v[110:111]
    v_pk_mul_f32 v[16:17], v[112:113], v[112:113]
    v_pk_mul_f32 v[18:19], v[114:115], v[114:115]
    v_pk_fma_f32 v[12:13], v[12:13], v[228:229], v[224:225] op_sel:[0,0,0] op_sel_hi:[1,0,0]
    v_pk_fma_f32 v[14:15], v[14:15], v[228:229], v[224:225] op_sel:[0,0,0] op_sel_hi:[1,0,0]
    v_pk_fma_f32 v[16:17], v[16:17], v[228:229], v[224:225] op_sel:[0,0,0] op_sel_hi:[1,0,0]
    v_pk_fma_f32 v[18:19], v[18:19], v[228:229], v[224:225] op_sel:[0,0,0] op_sel_hi:[1,0,0]
    v_pk_mul_f32 v[12:13], v[12:13], v[108:109]
    v_pk_mul_f32 v[14:15], v[14:15], v[110:111]
    v_pk_mul_f32 v[16:17], v[16:17], v[112:113]
    v_pk_mul_f32 v[18:19], v[18:19], v[114:115]
    v_exp_f32 v12, v12
    v_exp_f32 v13, v13
    v_exp_f32 v14, v14
    v_exp_f32 v15, v15
    v_exp_f32 v16, v16
    v_exp_f32 v17, v17
    v_exp_f32 v18, v18
    v_exp_f32 v19, v19
    v_pk_fma_f32 v[12:13], v[12:13], v[220:221], v[220:221] op_sel:[0,0,0] op_sel_hi:[1,0,0]
    v_pk_fma_f32 v[14:15], v[14:15], v[220:221], v[220:221] op_sel:[0,0,0] op_sel_hi:[1,0,0]
    v_pk_fma_f32 v[16:17], v[16:17], v[220:221], v[220:221] op_sel:[0,0,0] op_sel_hi:[1,0,0]
    v_pk_fma_f32 v[18:19], v[18:19], v[220:221], v[220:221] op_sel:[0,0,0] op_sel_hi:[1,0,0]
    v_rcp_f32 v12, v12
    v_rcp_f32 v13, v13
    v_rcp_f32 v14, v14
    v_rcp_f32 v15, v15
    v_rcp_f32 v16, v16
    v_rcp_f32 v17, v17
    v_rcp_f32 v18, v18
    v_rcp_f32 v19, v19
    v_pk_mul_f32 v[108:109], v[12:13], v[108:109]
    v_pk_mul_f32 v[110:111], v[14:15], v[110:111]
    v_pk_mul_f32 v[112:113], v[16:17], v[112:113]
    v_pk_mul_f32 v[114:115], v[18:19], v[114:115]
    v_pk_mul_f32 v[68:69], v[108:109], v[108:109]
    v_pk_fma_f32 v[68:69], v[110:111], v[110:111], v[68:69]
    v_pk_add_f32 v[60:61], v[108:109], v[110:111]
    v_pk_fma_f32 v[68:69], v[112:113], v[112:113], v[68:69]
    v_pk_add_f32 v[60:61], v[60:61], v[112:113]
    v_pk_fma_f32 v[68:69], v[114:115], v[114:115], v[68:69]
    v_pk_add_f32 v[60:61], v[60:61], v[114:115]
    v_pk_mul_f32 v[20:21], v[116:117], v[116:117]
    v_pk_mul_f32 v[22:23], v[118:119], v[118:119]
    v_pk_mul_f32 v[24:25], v[120:121], v[120:121]
    v_pk_mul_f32 v[26:27], v[122:123], v[122:123]
    v_pk_fma_f32 v[20:21], v[20:21], v[228:229], v[224:225] op_sel:[0,1,1] op_sel_hi:[1,1,1]
    v_pk_fma_f32 v[22:23], v[22:23], v[228:229], v[224:225] op_sel:[0,1,1] op_sel_hi:[1,1,1]
    v_pk_fma_f32 v[24:25], v[24:25], v[228:229], v[224:225] op_sel:[0,1,1] op_sel_hi:[1,1,1]
    v_pk_fma_f32 v[26:27], v[26:27], v[228:229], v[224:225] op_sel:[0,1,1] op_sel_hi:[1,1,1]
    v_pk_mul_f32 v[20:21], v[20:21], v[116:117]
    v_pk_mul_f32 v[22:23], v[22:23], v[118:119]
    v_pk_mul_f32 v[24:25], v[24:25], v[120:121]
    v_pk_mul_f32 v[26:27], v[26:27], v[122:123]
    v_exp_f32 v20, v20
    v_exp_f32 v21, v21
    v_exp_f32 v22, v22
    v_exp_f32 v23, v23
    v_exp_f32 v24, v24
    v_exp_f32 v25, v25
    v_exp_f32 v26, v26
    v_exp_f32 v27, v27
    v_pk_fma_f32 v[20:21], v[20:21], v[220:221], v[220:221] op_sel:[0,1,1] op_sel_hi:[1,1,1]
    v_pk_fma_f32 v[22:23], v[22:23], v[220:221], v[220:221] op_sel:[0,1,1] op_sel_hi:[1,1,1]
    v_pk_fma_f32 v[24:25], v[24:25], v[220:221], v[220:221] op_sel:[0,1,1] op_sel_hi:[1,1,1]
    v_pk_fma_f32 v[26:27], v[26:27], v[220:221], v[220:221] op_sel:[0,1,1] op_sel_hi:[1,1,1]
    v_rcp_f32 v20, v20
    v_rcp_f32 v21, v21
    v_rcp_f32 v22, v22
    v_rcp_f32 v23, v23
    v_rcp_f32 v24, v24
    v_rcp_f32 v25, v25
    v_rcp_f32 v26, v26
    v_rcp_f32 v27, v27
    v_pk_mul_f32 v[116:117], v[20:21], v[116:117]
    v_pk_mul_f32 v[118:119], v[22:23], v[118:119]
    v_pk_mul_f32 v[120:121], v[24:25], v[120:121]
    v_pk_mul_f32 v[122:123], v[26:27], v[122:123]
    v_pk_mul_f32 v[70:71], v[116:117], v[116:117]
    v_pk_fma_f32 v[70:71], v[118:119], v[118:119], v[70:71]
    v_pk_add_f32 v[62:63], v[116:117], v[118:119]
    v_pk_fma_f32 v[70:71], v[120:121], v[120:121], v[70:71]
    v_pk_add_f32 v[62:63], v[62:63], v[120:121]
    v_pk_fma_f32 v[70:71], v[122:123], v[122:123], v[70:71]
    v_pk_add_f32 v[62:63], v[62:63], v[122:123]
    v_pk_mul_f32 v[12:13], v[124:125], v[124:125]
    v_pk_mul_f32 v[14:15], v[126:127], v[126:127]
    v_pk_mul_f32 v[16:17], v[128:129], v[128:129]
    v_pk_mul_f32 v[18:19], v[130:131], v[130:131]
    v_pk_fma_f32 v[12:13], v[12:13], v[230:231], v[226:227] op_sel:[0,0,0] op_sel_hi:[1,0,0]
    v_pk_fma_f32 v[14:15], v[14:15], v[230:231], v[226:227] op_sel:[0,0,0] op_sel_hi:[1,0,0]
    v_pk_fma_f32 v[16:17], v[16:17], v[230:231], v[226:227] op_sel:[0,0,0] op_sel_hi:[1,0,0]
    v_pk_fma_f32 v[18:19], v[18:19], v[230:231], v[226:227] op_sel:[0,0,0] op_sel_hi:[1,0,0]
    v_pk_mul_f32 v[12:13], v[12:13], v[124:125]
    v_pk_mul_f32 v[14:15], v[14:15], v[126:127]
    v_pk_mul_f32 v[16:17], v[16:17], v[128:129]
    v_pk_mul_f32 v[18:19], v[18:19], v[130:131]
    v_exp_f32 v12, v12
    v_exp_f32 v13, v13
    v_exp_f32 v14, v14
    v_exp_f32 v15, v15
    v_exp_f32 v16, v16
    v_exp_f32 v17, v17
    v_exp_f32 v18, v18
    v_exp_f32 v19, v19
    v_pk_fma_f32 v[12:13], v[12:13], v[222:223], v[222:223] op_sel:[0,0,0] op_sel_hi:[1,0,0]
    v_pk_fma_f32 v[14:15], v[14:15], v[222:223], v[222:223] op_sel:[0,0,0] op_sel_hi:[1,0,0]
    v_pk_fma_f32 v[16:17], v[16:17], v[222:223], v[222:223] op_sel:[0,0,0] op_sel_hi:[1,0,0]
    v_pk_fma_f32 v[18:19], v[18:19], v[222:223], v[222:223] op_sel:[0,0,0] op_sel_hi:[1,0,0]
    v_rcp_f32 v12, v12
    v_rcp_f32 v13, v13
    v_rcp_f32 v14, v14
    v_rcp_f32 v15, v15
    v_rcp_f32 v16, v16
    v_rcp_f32 v17, v17
    v_rcp_f32 v18, v18
    v_rcp_f32 v19, v19
    v_pk_mul_f32 v[124:125], v[12:13], v[124:125]
    v_pk_mul_f32 v[126:127], v[14:15], v[126:127]
    v_pk_mul_f32 v[128:129], v[16:17], v[128:129]
    v_pk_mul_f32 v[130:131], v[18:19], v[130:131]
    v_pk_mul_f32 v[72:73], v[124:125], v[124:125]
    v_pk_fma_f32 v[72:73], v[126:127], v[126:127], v[72:73]
    v_pk_add_f32 v[64:65], v[124:125], v[126:127]
    v_pk_fma_f32 v[72:73], v[128:129], v[128:129], v[72:73]
    v_pk_add_f32 v[64:65], v[64:65], v[128:129]
    v_pk_fma_f32 v[72:73], v[130:131], v[130:131], v[72:73]
    v_pk_add_f32 v[64:65], v[64:65], v[130:131]
    v_pk_mul_f32 v[20:21], v[132:133], v[132:133]
    v_pk_mul_f32 v[22:23], v[134:135], v[134:135]
    v_pk_mul_f32 v[24:25], v[136:137], v[136:137]
    v_pk_mul_f32 v[26:27], v[138:139], v[138:139]
    v_pk_fma_f32 v[20:21], v[20:21], v[230:231], v[226:227] op_sel:[0,1,1] op_sel_hi:[1,1,1]
    v_pk_fma_f32 v[22:23], v[22:23], v[230:231], v[226:227] op_sel:[0,1,1] op_sel_hi:[1,1,1]
    v_pk_fma_f32 v[24:25], v[24:25], v[230:231], v[226:227] op_sel:[0,1,1] op_sel_hi:[1,1,1]
    v_pk_fma_f32 v[26:27], v[26:27], v[230:231], v[226:227] op_sel:[0,1,1] op_sel_hi:[1,1,1]
    v_pk_mul_f32 v[20:21], v[20:21], v[132:133]
    v_pk_mul_f32 v[22:23], v[22:23], v[134:135]
    v_pk_mul_f32 v[24:25], v[24:25], v[136:137]
    v_pk_mul_f32 v[26:27], v[26:27], v[138:139]
    v_exp_f32 v20, v20
    v_exp_f32 v21, v21
    v_exp_f32 v22, v22
    v_exp_f32 v23, v23
    v_exp_f32 v24, v24
    v_exp_f32 v25, v25
    v_exp_f32 v26, v26
    v_exp_f32 v27, v27
    v_pk_fma_f32 v[20:21], v[20:21], v[222:223], v[222:223] op_sel:[0,1,1] op_sel_hi:[1,1,1]
    v_pk_fma_f32 v[22:23], v[22:23], v[222:223], v[222:223] op_sel:[0,1,1] op_sel_hi:[1,1,1]
    v_pk_fma_f32 v[24:25], v[24:25], v[222:223], v[222:223] op_sel:[0,1,1] op_sel_hi:[1,1,1]
    v_pk_fma_f32 v[26:27], v[26:27], v[222:223], v[222:223] op_sel:[0,1,1] op_sel_hi:[1,1,1]
    v_rcp_f32 v20, v20
    v_rcp_f32 v21, v21
    v_rcp_f32 v22, v22
    v_rcp_f32 v23, v23
    v_rcp_f32 v24, v24
    v_rcp_f32 v25, v25
    v_rcp_f32 v26, v26
    v_rcp_f32 v27, v27
    v_pk_mul_f32 v[132:133], v[20:21], v[132:133]
    v_pk_mul_f32 v[134:135], v[22:23], v[134:135]
    v_pk_mul_f32 v[136:137], v[24:25], v[136:137]
    v_pk_mul_f32 v[138:139], v[26:27], v[138:139]
    v_pk_mul_f32 v[74:75], v[132:133], v[132:133]
    v_pk_fma_f32 v[74:75], v[134:135], v[134:135], v[74:75]
    v_pk_add_f32 v[66:67], v[132:133], v[134:135]
    v_pk_fma_f32 v[74:75], v[136:137], v[136:137], v[74:75]
    v_pk_add_f32 v[66:67], v[66:67], v[136:137]
    v_pk_fma_f32 v[74:75], v[138:139], v[138:139], v[74:75]
    v_pk_add_f32 v[66:67], v[66:67], v[138:139]
    v_pk_mul_f32 v[12:13], v[140:141], v[140:141]
    v_pk_mul_f32 v[14:15], v[142:143], v[142:143]
    v_pk_mul_f32 v[16:17], v[144:145], v[144:145]
    v_pk_mul_f32 v[18:19], v[146:147], v[146:147]
    v_pk_fma_f32 v[12:13], v[12:13], v[228:229], v[224:225] op_sel:[0,0,0] op_sel_hi:[1,0,0]
    v_pk_fma_f32 v[14:15], v[14:15], v[228:229], v[224:225] op_sel:[0,0,0] op_sel_hi:[1,0,0]
    v_pk_fma_f32 v[16:17], v[16:17], v[228:229], v[224:225] op_sel:[0,0,0] op_sel_hi:[1,0,0]
    v_pk_fma_f32 v[18:19], v[18:19], v[228:229], v[224:225] op_sel:[0,0,0] op_sel_hi:[1,0,0]
    v_pk_mul_f32 v[12:13], v[12:13], v[140:141]
    v_pk_mul_f32 v[14:15], v[14:15], v[142:143]
    v_pk_mul_f32 v[16:17], v[16:17], v[144:145]
    v_pk_mul_f32 v[18:19], v[18:19], v[146:147]
    v_exp_f32 v12, v12
    v_exp_f32 v13, v13
    v_exp_f32 v14, v14
    v_exp_f32 v15, v15
    v_exp_f32 v16, v16
    v_exp_f32 v17, v17
    v_exp_f32 v18, v18
    v_exp_f32 v19, v19
    v_pk_fma_f32 v[12:13], v[12:13], v[220:221], v[220:221] op_sel:[0,0,0] op_sel_hi:[1,0,0]
    v_pk_fma_f32 v[14:15], v[14:15], v[220:221], v[220:221] op_sel:[0,0,0] op_sel_hi:[1,0,0]
    v_pk_fma_f32 v[16:17], v[16:17], v[220:221], v[220:221] op_sel:[0,0,0] op_sel_hi:[1,0,0]
    v_pk_fma_f32 v[18:19], v[18:19], v[220:221], v[220:221] op_sel:[0,0,0] op_sel_hi:[1,0,0]
    v_rcp_f32 v12, v12
    v_rcp_f32 v13, v13
    v_rcp_f32 v14, v14
    v_rcp_f32 v15, v15
    v_rcp_f32 v16, v16
    v_rcp_f32 v17, v17
    v_rcp_f32 v18, v18
    v_rcp_f32 v19, v19
    v_pk_mul_f32 v[140:141], v[12:13], v[140:141]
    v_pk_mul_f32 v[142:143], v[14:15], v[142:143]
    v_pk_mul_f32 v[144:145], v[16:17], v[144:145]
    v_pk_mul_f32 v[146:147], v[18:19], v[146:147]
    v_pk_fma_f32 v[68:69], v[140:141], v[140:141], v[68:69]
    v_pk_add_f32 v[60:61], v[60:61], v[140:141]
    v_pk_fma_f32 v[68:69], v[142:143], v[142:143], v[68:69]
    v_pk_add_f32 v[60:61], v[60:61], v[142:143]
    v_pk_fma_f32 v[68:69], v[144:145], v[144:145], v[68:69]
    v_pk_add_f32 v[60:61], v[60:61], v[144:145]
    v_pk_fma_f32 v[68:69], v[146:147], v[146:147], v[68:69]
    v_pk_add_f32 v[60:61], v[60:61], v[146:147]
    v_pk_mul_f32 v[20:21], v[148:149], v[148:149]
    v_pk_mul_f32 v[22:23], v[150:151], v[150:151]
    v_pk_mul_f32 v[24:25], v[152:153], v[152:153]
    v_pk_mul_f32 v[26:27], v[154:155], v[154:155]
    v_pk_fma_f32 v[20:21], v[20:21], v[228:229], v[224:225] op_sel:[0,1,1] op_sel_hi:[1,1,1]
    v_pk_fma_f32 v[22:23], v[22:23], v[228:229], v[224:225] op_sel:[0,1,1] op_sel_hi:[1,1,1]
    v_pk_fma_f32 v[24:25], v[24:25], v[228:229], v[224:225] op_sel:[0,1,1] op_sel_hi:[1,1,1]
    v_pk_fma_f32 v[26:27], v[26:27], v[228:229], v[224:225] op_sel:[0,1,1] op_sel_hi:[1,1,1]
    v_pk_mul_f32 v[20:21], v[20:21], v[148:149]
    v_pk_mul_f32 v[22:23], v[22:23], v[150:151]
    v_pk_mul_f32 v[24:25], v[24:25], v[152:153]
    v_pk_mul_f32 v[26:27], v[26:27], v[154:155]
    v_exp_f32 v20, v20
    v_exp_f32 v21, v21
    v_exp_f32 v22, v22
    v_exp_f32 v23, v23
    v_exp_f32 v24, v24
    v_exp_f32 v25, v25
    v_exp_f32 v26, v26
    v_exp_f32 v27, v27
    v_pk_fma_f32 v[20:21], v[20:21], v[220:221], v[220:221] op_sel:[0,1,1] op_sel_hi:[1,1,1]
    v_pk_fma_f32 v[22:23], v[22:23], v[220:221], v[220:221] op_sel:[0,1,1] op_sel_hi:[1,1,1]
    v_pk_fma_f32 v[24:25], v[24:25], v[220:221], v[220:221] op_sel:[0,1,1] op_sel_hi:[1,1,1]
    v_pk_fma_f32 v[26:27], v[26:27], v[220:221], v[220:221] op_sel:[0,1,1] op_sel_hi:[1,1,1]
    v_rcp_f32 v20, v20
    v_rcp_f32 v21, v21
    v_rcp_f32 v22, v22
    v_rcp_f32 v23, v23
    v_rcp_f32 v24, v24
    v_rcp_f32 v25, v25
    v_rcp_f32 v26, v26
    v_rcp_f32 v27, v27
    v_pk_mul_f32 v[148:149], v[20:21], v[148:149]
    v_pk_mul_f32 v[150:151], v[22:23], v[150:151]
    v_pk_mul_f32 v[152:153], v[24:25], v[152:153]
    v_pk_mul_f32 v[154:155], v[26:27], v[154:155]
    v_pk_fma_f32 v[70:71], v[148:149], v[148:149], v[70:71]
    v_pk_add_f32 v[62:63], v[62:63], v[148:149]
    v_pk_fma_f32 v[70:71], v[150:151], v[150:151], v[70:71]
    v_pk_add_f32 v[62:63], v[62:63], v[150:151]
    v_pk_fma_f32 v[70:71], v[152:153], v[152:153], v[70:71]
    v_pk_add_f32 v[62:63], v[62:63], v[152:153]
    v_pk_fma_f32 v[70:71], v[154:155], v[154:155], v[70:71]
    v_pk_add_f32 v[62:63], v[62:63], v[154:155]
    v_pk_mul_f32 v[12:13], v[156:157], v[156:157]
    v_pk_mul_f32 v[14:15], v[158:159], v[158:159]
    v_pk_mul_f32 v[16:17], v[160:161], v[160:161]
    v_pk_mul_f32 v[18:19], v[162:163], v[162:163]
    v_pk_fma_f32 v[12:13], v[12:13], v[230:231], v[226:227] op_sel:[0,0,0] op_sel_hi:[1,0,0]
    v_pk_fma_f32 v[14:15], v[14:15], v[230:231], v[226:227] op_sel:[0,0,0] op_sel_hi:[1,0,0]
    v_pk_fma_f32 v[16:17], v[16:17], v[230:231], v[226:227] op_sel:[0,0,0] op_sel_hi:[1,0,0]
    v_pk_fma_f32 v[18:19], v[18:19], v[230:231], v[226:227] op_sel:[0,0,0] op_sel_hi:[1,0,0]
    v_pk_mul_f32 v[12:13], v[12:13], v[156:157]
    v_pk_mul_f32 v[14:15], v[14:15], v[158:159]
    v_pk_mul_f32 v[16:17], v[16:17], v[160:161]
    v_pk_mul_f32 v[18:19], v[18:19], v[162:163]
    v_exp_f32 v12, v12
    v_exp_f32 v13, v13
    v_exp_f32 v14, v14
    v_exp_f32 v15, v15
    v_exp_f32 v16, v16
    v_exp_f32 v17, v17
    v_exp_f32 v18, v18
    v_exp_f32 v19, v19
    v_pk_fma_f32 v[12:13], v[12:13], v[222:223], v[222:223] op_sel:[0,0,0] op_sel_hi:[1,0,0]
    v_pk_fma_f32 v[14:15], v[14:15], v[222:223], v[222:223] op_sel:[0,0,0] op_sel_hi:[1,0,0]
    v_pk_fma_f32 v[16:17], v[16:17], v[222:223], v[222:223] op_sel:[0,0,0] op_sel_hi:[1,0,0]
    v_pk_fma_f32 v[18:19], v[18:19], v[222:223], v[222:223] op_sel:[0,0,0] op_sel_hi:[1,0,0]
    v_rcp_f32 v12, v12
    v_rcp_f32 v13, v13
    v_rcp_f32 v14, v14
    v_rcp_f32 v15, v15
    v_rcp_f32 v16, v16
    v_rcp_f32 v17, v17
    v_rcp_f32 v18, v18
    v_rcp_f32 v19, v19
    v_pk_mul_f32 v[156:157], v[12:13], v[156:157]
    v_pk_mul_f32 v[158:159], v[14:15], v[158:159]
    v_pk_mul_f32 v[160:161], v[16:17], v[160:161]
    v_pk_mul_f32 v[162:163], v[18:19], v[162:163]
    v_pk_fma_f32 v[72:73], v[156:157], v[156:157], v[72:73]
    v_pk_add_f32 v[64:65], v[64:65], v[156:157]
    v_pk_fma_f32 v[72:73], v[158:159], v[158:159], v[72:73]
    v_pk_add_f32 v[64:65], v[64:65], v[158:159]
    v_pk_fma_f32 v[72:73], v[160:161], v[160:161], v[72:73]
    v_pk_add_f32 v[64:65], v[64:65], v[160:161]
    v_pk_fma_f32 v[72:73], v[162:163], v[162:163], v[72:73]
    v_pk_add_f32 v[64:65], v[64:65], v[162:163]
    v_pk_mul_f32 v[20:21], v[164:165], v[164:165]
    v_pk_mul_f32 v[22:23], v[166:167], v[166:167]
    v_pk_mul_f32 v[24:25], v[168:169], v[168:169]
    v_pk_mul_f32 v[26:27], v[170:171], v[170:171]
    v_pk_fma_f32 v[20:21], v[20:21], v[230:231], v[226:227] op_sel:[0,1,1] op_sel_hi:[1,1,1]
    v_pk_fma_f32 v[22:23], v[22:23], v[230:231], v[226:227] op_sel:[0,1,1] op_sel_hi:[1,1,1]
    v_pk_fma_f32 v[24:25], v[24:25], v[230:231], v[226:227] op_sel:[0,1,1] op_sel_hi:[1,1,1]
    v_pk_fma_f32 v[26:27], v[26:27], v[230:231], v[226:227] op_sel:[0,1,1] op_sel_hi:[1,1,1]
    v_pk_mul_f32 v[20:21], v[20:21], v[164:165]
    v_pk_mul_f32 v[22:23], v[22:23], v[166:167]
    v_pk_mul_f32 v[24:25], v[24:25], v[168:169]
    v_pk_mul_f32 v[26:27], v[26:27], v[170:171]
    v_exp_f32 v20, v20
    v_exp_f32 v21, v21
    v_exp_f32 v22, v22
    v_exp_f32 v23, v23
    v_exp_f32 v24, v24
    v_exp_f32 v25, v25
    v_exp_f32 v26, v26
    v_exp_f32 v27, v27
    v_pk_fma_f32 v[20:21], v[20:21], v[222:223], v[222:223] op_sel:[0,1,1] op_sel_hi:[1,1,1]
    v_pk_fma_f32 v[22:23], v[22:23], v[222:223], v[222:223] op_sel:[0,1,1] op_sel_hi:[1,1,1]
    v_pk_fma_f32 v[24:25], v[24:25], v[222:223], v[222:223] op_sel:[0,1,1] op_sel_hi:[1,1,1]
    v_pk_fma_f32 v[26:27], v[26:27], v[222:223], v[222:223] op_sel:[0,1,1] op_sel_hi:[1,1,1]
    v_rcp_f32 v20, v20
    v_rcp_f32 v21, v21
    v_rcp_f32 v22, v22
    v_rcp_f32 v23, v23
    v_rcp_f32 v24, v24
    v_rcp_f32 v25, v25
    v_rcp_f32 v26, v26
    v_rcp_f32 v27, v27
    v_pk_mul_f32 v[164:165], v[20:21], v[164:165]
    v_pk_mul_f32 v[166:167], v[22:23], v[166:167]
    v_pk_mul_f32 v[168:169], v[24:25], v[168:169]
    v_pk_mul_f32 v[170:171], v[26:27], v[170:171]
    v_pk_fma_f32 v[74:75], v[164:165], v[164:165], v[74:75]
    v_pk_add_f32 v[66:67], v[66:67], v[164:165]
    v_pk_fma_f32 v[74:75], v[166:167], v[166:167], v[74:75]
    v_pk_add_f32 v[66:67], v[66:67], v[166:167]
    v_pk_fma_f32 v[74:75], v[168:169], v[168:169], v[74:75]
    v_pk_add_f32 v[66:67], v[66:67], v[168:169]
    v_pk_fma_f32 v[74:75], v[170:171], v[170:171], v[74:75]
    v_pk_add_f32 v[66:67], v[66:67], v[170:171]
    v_add_f32 v12, v60, v61
    v_add_f32 v13, v62, v63
    v_add_f32 v14, v64, v65
    v_add_f32 v15, v66, v67
    v_add_f32 v16, v68, v69
    v_add_f32 v17, v70, v71
    v_add_f32 v18, v72, v73
    v_add_f32 v19, v74, v75
    v_permlane32_swap_b32 v12, v14
    v_permlane32_swap_b32 v13, v15
    v_permlane32_swap_b32 v16, v18
    v_permlane32_swap_b32 v17, v19
    v_add_f32 v12, v12, v14
    v_add_f32 v13, v13, v15
    v_add_f32 v16, v16, v18
    v_add_f32 v17, v17, v19
    v_permlane16_swap_b32 v12, v13
    s_nop 0
    v_permlane16_swap_b32 v16, v17
    v_add_f32 v60, v12, v13
    v_add_f32 v61, v16, v17
    buffer_store_dwordx2 v[60:61], v9, s[40:43], s22 offen sc1
    v_pk_mul_f32 v[12:13], v[172:173], v[172:173]
    v_pk_mul_f32 v[14:15], v[174:175], v[174:175]
    v_pk_mul_f32 v[16:17], v[176:177], v[176:177]
    v_pk_mul_f32 v[18:19], v[178:179], v[178:179]
    v_pk_fma_f32 v[12:13], v[12:13], v[228:229], v[224:225] op_sel:[0,0,0] op_sel_hi:[1,0,0]
    v_pk_fma_f32 v[14:15], v[14:15], v[228:229], v[224:225] op_sel:[0,0,0] op_sel_hi:[1,0,0]
    v_pk_fma_f32 v[16:17], v[16:17], v[228:229], v[224:225] op_sel:[0,0,0] op_sel_hi:[1,0,0]
    v_pk_fma_f32 v[18:19], v[18:19], v[228:229], v[224:225] op_sel:[0,0,0] op_sel_hi:[1,0,0]
    v_pk_mul_f32 v[12:13], v[12:13], v[172:173]
    v_pk_mul_f32 v[14:15], v[14:15], v[174:175]
    v_pk_mul_f32 v[16:17], v[16:17], v[176:177]
    v_pk_mul_f32 v[18:19], v[18:19], v[178:179]
    v_exp_f32 v12, v12
    v_exp_f32 v13, v13
    v_exp_f32 v14, v14
    v_exp_f32 v15, v15
    v_exp_f32 v16, v16
    v_exp_f32 v17, v17
    v_exp_f32 v18, v18
    v_exp_f32 v19, v19
    v_pk_fma_f32 v[12:13], v[12:13], v[220:221], v[220:221] op_sel:[0,0,0] op_sel_hi:[1,0,0]
    v_pk_fma_f32 v[14:15], v[14:15], v[220:221], v[220:221] op_sel:[0,0,0] op_sel_hi:[1,0,0]
    v_pk_fma_f32 v[16:17], v[16:17], v[220:221], v[220:221] op_sel:[0,0,0] op_sel_hi:[1,0,0]
    v_pk_fma_f32 v[18:19], v[18:19], v[220:221], v[220:221] op_sel:[0,0,0] op_sel_hi:[1,0,0]
    v_rcp_f32 v12, v12
    v_rcp_f32 v13, v13
    v_rcp_f32 v14, v14
    v_rcp_f32 v15, v15
    v_rcp_f32 v16, v16
    v_rcp_f32 v17, v17
    v_rcp_f32 v18, v18
    v_rcp_f32 v19, v19
    v_pk_mul_f32 v[172:173], v[12:13], v[172:173]
    v_pk_mul_f32 v[174:175], v[14:15], v[174:175]
    v_pk_mul_f32 v[176:177], v[16:17], v[176:177]
    v_pk_mul_f32 v[178:179], v[18:19], v[178:179]
    v_cvt_pk_bf16_f32 v28, v172, v173
    v_cvt_pk_bf16_f32 v29, v174, v175
    v_cvt_pk_bf16_f32 v30, v176, v177
    v_cvt_pk_bf16_f32 v31, v178, v179
    buffer_store_dwordx4 v[28:31], v244, s[36:39], s47 offen offset:0 sc1
    v_pk_mul_f32 v[20:21], v[180:181], v[180:181]
    v_pk_mul_f32 v[22:23], v[182:183], v[182:183]
    v_pk_mul_f32 v[24:25], v[184:185], v[184:185]
    v_pk_mul_f32 v[26:27], v[186:187], v[186:187]
    v_pk_fma_f32 v[20:21], v[20:21], v[228:229], v[224:225] op_sel:[0,1,1] op_sel_hi:[1,1,1]
    v_pk_fma_f32 v[22:23], v[22:23], v[228:229], v[224:225] op_sel:[0,1,1] op_sel_hi:[1,1,1]
    v_pk_fma_f32 v[24:25], v[24:25], v[228:229], v[224:225] op_sel:[0,1,1] op_sel_hi:[1,1,1]
    v_pk_fma_f32 v[26:27], v[26:27], v[228:229], v[224:225] op_sel:[0,1,1] op_sel_hi:[1,1,1]
    v_pk_mul_f32 v[20:21], v[20:21], v[180:181]
    v_pk_mul_f32 v[22:23], v[22:23], v[182:183]
    v_pk_mul_f32 v[24:25], v[24:25], v[184:185]
    v_pk_mul_f32 v[26:27], v[26:27], v[186:187]
    v_exp_f32 v20, v20
    v_exp_f32 v21, v21
    v_exp_f32 v22, v22
    v_exp_f32 v23, v23
    v_exp_f32 v24, v24
    v_exp_f32 v25, v25
    v_exp_f32 v26, v26
    v_exp_f32 v27, v27
    v_pk_fma_f32 v[20:21], v[20:21], v[220:221], v[220:221] op_sel:[0,1,1] op_sel_hi:[1,1,1]
    v_pk_fma_f32 v[22:23], v[22:23], v[220:221], v[220:221] op_sel:[0,1,1] op_sel_hi:[1,1,1]
    v_pk_fma_f32 v[24:25], v[24:25], v[220:221], v[220:221] op_sel:[0,1,1] op_sel_hi:[1,1,1]
    v_pk_fma_f32 v[26:27], v[26:27], v[220:221], v[220:221] op_sel:[0,1,1] op_sel_hi:[1,1,1]
    v_rcp_f32 v20, v20
    v_rcp_f32 v21, v21
    v_rcp_f32 v22, v22
    v_rcp_f32 v23, v23
    v_rcp_f32 v24, v24
    v_rcp_f32 v25, v25
    v_rcp_f32 v26, v26
    v_rcp_f32 v27, v27
    v_pk_mul_f32 v[180:181], v[20:21], v[180:181]
    v_pk_mul_f32 v[182:183], v[22:23], v[182:183]
    v_pk_mul_f32 v[184:185], v[24:25], v[184:185]
    v_pk_mul_f32 v[186:187], v[26:27], v[186:187]
    v_cvt_pk_bf16_f32 v32, v180, v181
    v_cvt_pk_bf16_f32 v33, v182, v183
    v_cvt_pk_bf16_f32 v34, v184, v185
    v_cvt_pk_bf16_f32 v35, v186, v187
    buffer_store_dwordx4 v[32:35], v244, s[36:39], s47 offen offset:256 sc1
    v_pk_mul_f32 v[12:13], v[188:189], v[188:189]
    v_pk_mul_f32 v[14:15], v[190:191], v[190:191]
    v_pk_mul_f32 v[16:17], v[192:193], v[192:193]
    v_pk_mul_f32 v[18:19], v[194:195], v[194:195]
    v_pk_fma_f32 v[12:13], v[12:13], v[230:231], v[226:227] op_sel:[0,0,0] op_sel_hi:[1,0,0]
    v_pk_fma_f32 v[14:15], v[14:15], v[230:231], v[226:227] op_sel:[0,0,0] op_sel_hi:[1,0,0]
    v_pk_fma_f32 v[16:17], v[16:17], v[230:231], v[226:227] op_sel:[0,0,0] op_sel_hi:[1,0,0]
    v_pk_fma_f32 v[18:19], v[18:19], v[230:231], v[226:227] op_sel:[0,0,0] op_sel_hi:[1,0,0]
    v_pk_mul_f32 v[12:13], v[12:13], v[188:189]
    v_pk_mul_f32 v[14:15], v[14:15], v[190:191]
    v_pk_mul_f32 v[16:17], v[16:17], v[192:193]
    v_pk_mul_f32 v[18:19], v[18:19], v[194:195]
    v_exp_f32 v12, v12
    v_exp_f32 v13, v13
    v_exp_f32 v14, v14
    v_exp_f32 v15, v15
    v_exp_f32 v16, v16
    v_exp_f32 v17, v17
    v_exp_f32 v18, v18
    v_exp_f32 v19, v19
    v_pk_fma_f32 v[12:13], v[12:13], v[222:223], v[222:223] op_sel:[0,0,0] op_sel_hi:[1,0,0]
    v_pk_fma_f32 v[14:15], v[14:15], v[222:223], v[222:223] op_sel:[0,0,0] op_sel_hi:[1,0,0]
    v_pk_fma_f32 v[16:17], v[16:17], v[222:223], v[222:223] op_sel:[0,0,0] op_sel_hi:[1,0,0]
    v_pk_fma_f32 v[18:19], v[18:19], v[222:223], v[222:223] op_sel:[0,0,0] op_sel_hi:[1,0,0]
    v_rcp_f32 v12, v12
    v_rcp_f32 v13, v13
    v_rcp_f32 v14, v14
    v_rcp_f32 v15, v15
    v_rcp_f32 v16, v16
    v_rcp_f32 v17, v17
    v_rcp_f32 v18, v18
    v_rcp_f32 v19, v19
    v_pk_mul_f32 v[188:189], v[12:13], v[188:189]
    v_pk_mul_f32 v[190:191], v[14:15], v[190:191]
    v_pk_mul_f32 v[192:193], v[16:17], v[192:193]
    v_pk_mul_f32 v[194:195], v[18:19], v[194:195]
    v_cvt_pk_bf16_f32 v36, v188, v189
    v_cvt_pk_bf16_f32 v37, v190, v191
    v_cvt_pk_bf16_f32 v38, v192, v193
    v_cvt_pk_bf16_f32 v39, v194, v195
    buffer_store_dwordx4 v[36:39], v245, s[36:39], s47 offen offset:0 sc1
    buffer_load_dwordx2 v[76:77], v9, s[40:43], s21 offen offset:0 sc1
    buffer_load_dwordx2 v[78:79], v9, s[40:43], s21 offen offset:512 sc1
    buffer_load_dwordx2 v[80:81], v9, s[40:43], s21 offen offset:1024 sc1
    buffer_load_dwordx2 v[82:83], v9, s[40:43], s21 offen offset:1536 sc1
    buffer_load_dwordx2 v[84:85], v9, s[40:43], s21 offen offset:2048 sc1
    buffer_load_dwordx2 v[86:87], v9, s[40:43], s21 offen offset:2560 sc1
    buffer_load_dwordx2 v[88:89], v9, s[40:43], s21 offen offset:3072 sc1
    buffer_load_dwordx2 v[90:91], v9, s[40:43], s21 offen offset:3584 sc1
    buffer_load_dwordx2 v[92:93], v9, s[40:43], s24 offen offset:0 sc1
    buffer_load_dwordx2 v[94:95], v9, s[40:43], s24 offen offset:512 sc1
    buffer_load_dwordx2 v[96:97], v9, s[40:43], s24 offen offset:1024 sc1
    buffer_load_dwordx2 v[98:99], v9, s[40:43], s24 offen offset:1536 sc1
    buffer_load_dwordx2 v[100:101], v9, s[40:43], s24 offen offset:2048 sc1
    buffer_load_dwordx2 v[102:103], v9, s[40:43], s24 offen offset:2560 sc1
    buffer_load_dwordx2 v[104:105], v9, s[40:43], s24 offen offset:3072 sc1
    buffer_load_dwordx2 v[106:107], v9, s[40:43], s24 offen offset:3584 sc1
    buffer_load_dwordx2 v[44:45], v9, s[40:43], s25 offen offset:0 sc1
    buffer_load_dwordx2 v[46:47], v9, s[40:43], s25 offen offset:512 sc1
    buffer_load_dwordx2 v[48:49], v9, s[40:43], s25 offen offset:1024 sc1
    buffer_load_dwordx2 v[50:51], v9, s[40:43], s25 offen offset:1536 sc1
    buffer_load_dwordx2 v[52:53], v9, s[40:43], s25 offen offset:2048 sc1
    buffer_load_dwordx2 v[54:55], v9, s[40:43], s25 offen offset:2560 sc1
    buffer_load_dwordx2 v[56:57], v9, s[40:43], s25 offen offset:3072 sc1
    buffer_load_dwordx2 v[58:59], v9, s[40:43], s25 offen offset:3584 sc1
    buffer_load_dwordx2 v[172:173], v9, s[40:43], s26 offen offset:0 sc1
    buffer_load_dwordx2 v[174:175], v9, s[40:43], s26 offen offset:512 sc1
    buffer_load_dwordx2 v[176:177], v9, s[40:43], s26 offen offset:1024 sc1
    buffer_load_dwordx2 v[178:179], v9, s[40:43], s26 offen offset:1536 sc1
    buffer_load_dwordx2 v[180:181], v9, s[40:43], s26 offen offset:2048 sc1
    buffer_load_dwordx2 v[182:183], v9, s[40:43], s26 offen offset:2560 sc1
    buffer_load_dwordx2 v[184:185], v9, s[40:43], s26 offen offset:3072 sc1
    buffer_load_dwordx2 v[186:187], v9, s[40:43], s26 offen offset:3584 sc1
    v_pk_mul_f32 v[20:21], v[196:197], v[196:197]
    v_pk_mul_f32 v[22:23], v[198:199], v[198:199]
    v_pk_mul_f32 v[24:25], v[200:201], v[200:201]
    v_pk_mul_f32 v[26:27], v[202:203], v[202:203]
    v_pk_fma_f32 v[20:21], v[20:21], v[230:231], v[226:227] op_sel:[0,1,1] op_sel_hi:[1,1,1]
    v_pk_fma_f32 v[22:23], v[22:23], v[230:231], v[226:227] op_sel:[0,1,1] op_sel_hi:[1,1,1]
    v_pk_fma_f32 v[24:25], v[24:25], v[230:231], v[226:227] op_sel:[0,1,1] op_sel_hi:[1,1,1]
    v_pk_fma_f32 v[26:27], v[26:27], v[230:231], v[226:227] op_sel:[0,1,1] op_sel_hi:[1,1,1]
    v_pk_mul_f32 v[20:21], v[20:21], v[196:197]
    v_pk_mul_f32 v[22:23], v[22:23], v[198:199]
    v_pk_mul_f32 v[24:25], v[24:25], v[200:201]
    v_pk_mul_f32 v[26:27], v[26:27], v[202:203]
    v_exp_f32 v20, v20
    v_exp_f32 v21, v21
    v_exp_f32 v22, v22
    v_exp_f32 v23, v23
    v_exp_f32 v24, v24
    v_exp_f32 v25, v25
    v_exp_f32 v26, v26
    v_exp_f32 v27, v27
    v_pk_fma_f32 v[20:21], v[20:21], v[222:223], v[222:223] op_sel:[0,1,1] op_sel_hi:[1,1,1]
    v_pk_fma_f32 v[22:23], v[22:23], v[222:223], v[222:223] op_sel:[0,1,1] op_sel_hi:[1,1,1]
    v_pk_fma_f32 v[24:25], v[24:25], v[222:223], v[222:223] op_sel:[0,1,1] op_sel_hi:[1,1,1]
    v_pk_fma_f32 v[26:27], v[26:27], v[222:223], v[222:223] op_sel:[0,1,1] op_sel_hi:[1,1,1]
    v_rcp_f32 v20, v20
    v_rcp_f32 v21, v21
    v_rcp_f32 v22, v22
    v_rcp_f32 v23, v23
    v_rcp_f32 v24, v24
    v_rcp_f32 v25, v25
    v_rcp_f32 v26, v26
    v_rcp_f32 v27, v27
    v_pk_mul_f32 v[196:197], v[20:21], v[196:197]
    v_pk_mul_f32 v[198:199], v[22:23], v[198:199]
    v_pk_mul_f32 v[200:201], v[24:25], v[200:201]
    v_pk_mul_f32 v[202:203], v[26:27], v[202:203]
    v_cvt_pk_bf16_f32 v40, v196, v197
    v_cvt_pk_bf16_f32 v41, v198, v199
    v_cvt_pk_bf16_f32 v42, v200, v201
    v_cvt_pk_bf16_f32 v43, v202, v203
    buffer_store_dwordx4 v[40:43], v245, s[36:39], s47 offen offset:256 sc1
    v_pk_mul_f32 v[12:13], v[204:205], v[204:205]
    v_pk_mul_f32 v[14:15], v[206:207], v[206:207]
    v_pk_mul_f32 v[16:17], v[208:209], v[208:209]
    v_pk_mul_f32 v[18:19], v[210:211], v[210:211]
    v_pk_fma_f32 v[12:13], v[12:13], v[228:229], v[224:225] op_sel:[0,0,0] op_sel_hi:[1,0,0]
    v_pk_fma_f32 v[14:15], v[14:15], v[228:229], v[224:225] op_sel:[0,0,0] op_sel_hi:[1,0,0]
    v_pk_fma_f32 v[16:17], v[16:17], v[228:229], v[224:225] op_sel:[0,0,0] op_sel_hi:[1,0,0]
    v_pk_fma_f32 v[18:19], v[18:19], v[228:229], v[224:225] op_sel:[0,0,0] op_sel_hi:[1,0,0]
    v_pk_mul_f32 v[12:13], v[12:13], v[204:205]
    v_pk_mul_f32 v[14:15], v[14:15], v[206:207]
    v_pk_mul_f32 v[16:17], v[16:17], v[208:209]
    v_pk_mul_f32 v[18:19], v[18:19], v[210:211]
    v_exp_f32 v12, v12
    v_exp_f32 v13, v13
    v_exp_f32 v14, v14
    v_exp_f32 v15, v15
    v_exp_f32 v16, v16
    v_exp_f32 v17, v17
    v_exp_f32 v18, v18
    v_exp_f32 v19, v19
    v_pk_fma_f32 v[12:13], v[12:13], v[220:221], v[220:221] op_sel:[0,0,0] op_sel_hi:[1,0,0]
    v_pk_fma_f32 v[14:15], v[14:15], v[220:221], v[220:221] op_sel:[0,0,0] op_sel_hi:[1,0,0]
    v_pk_fma_f32 v[16:17], v[16:17], v[220:221], v[220:221] op_sel:[0,0,0] op_sel_hi:[1,0,0]
    v_pk_fma_f32 v[18:19], v[18:19], v[220:221], v[220:221] op_sel:[0,0,0] op_sel_hi:[1,0,0]
    v_rcp_f32 v12, v12
    v_rcp_f32 v13, v13
    v_rcp_f32 v14, v14
    v_rcp_f32 v15, v15
    v_rcp_f32 v16, v16
    v_rcp_f32 v17, v17
    v_rcp_f32 v18, v18
    v_rcp_f32 v19, v19
    v_pk_mul_f32 v[204:205], v[12:13], v[204:205]
    v_pk_mul_f32 v[206:207], v[14:15], v[206:207]
    v_pk_mul_f32 v[208:209], v[16:17], v[208:209]
    v_pk_mul_f32 v[210:211], v[18:19], v[210:211]
    v_cvt_pk_bf16_f32 v28, v204, v205
    v_cvt_pk_bf16_f32 v29, v206, v207
    v_cvt_pk_bf16_f32 v30, v208, v209
    v_cvt_pk_bf16_f32 v31, v210, v211
    buffer_store_dwordx4 v[28:31], v244, s[36:39], s46 offen offset:0 sc1
    v_pk_mul_f32 v[20:21], v[212:213], v[212:213]
    v_pk_mul_f32 v[22:23], v[214:215], v[214:215]
    v_pk_mul_f32 v[24:25], v[216:217], v[216:217]
    v_pk_mul_f32 v[26:27], v[218:219], v[218:219]
    v_pk_fma_f32 v[20:21], v[20:21], v[228:229], v[224:225] op_sel:[0,1,1] op_sel_hi:[1,1,1]
    v_pk_fma_f32 v[22:23], v[22:23], v[228:229], v[224:225] op_sel:[0,1,1] op_sel_hi:[1,1,1]
    v_pk_fma_f32 v[24:25], v[24:25], v[228:229], v[224:225] op_sel:[0,1,1] op_sel_hi:[1,1,1]
    v_pk_fma_f32 v[26:27], v[26:27], v[228:229], v[224:225] op_sel:[0,1,1] op_sel_hi:[1,1,1]
    v_pk_mul_f32 v[20:21], v[20:21], v[212:213]
    v_pk_mul_f32 v[22:23], v[22:23], v[214:215]
    v_pk_mul_f32 v[24:25], v[24:25], v[216:217]
    v_pk_mul_f32 v[26:27], v[26:27], v[218:219]
    v_exp_f32 v20, v20
    v_exp_f32 v21, v21
    v_exp_f32 v22, v22
    v_exp_f32 v23, v23
    v_exp_f32 v24, v24
    v_exp_f32 v25, v25
    v_exp_f32 v26, v26
    v_exp_f32 v27, v27
    v_pk_fma_f32 v[20:21], v[20:21], v[220:221], v[220:221] op_sel:[0,1,1] op_sel_hi:[1,1,1]
    v_pk_fma_f32 v[22:23], v[22:23], v[220:221], v[220:221] op_sel:[0,1,1] op_sel_hi:[1,1,1]
    v_pk_fma_f32 v[24:25], v[24:25], v[220:221], v[220:221] op_sel:[0,1,1] op_sel_hi:[1,1,1]
    v_pk_fma_f32 v[26:27], v[26:27], v[220:221], v[220:221] op_sel:[0,1,1] op_sel_hi:[1,1,1]
    v_rcp_f32 v20, v20
    v_rcp_f32 v21, v21
    v_rcp_f32 v22, v22
    v_rcp_f32 v23, v23
    v_rcp_f32 v24, v24
    v_rcp_f32 v25, v25
    v_rcp_f32 v26, v26
    v_rcp_f32 v27, v27
    v_pk_mul_f32 v[212:213], v[20:21], v[212:213]
    v_pk_mul_f32 v[214:215], v[22:23], v[214:215]
    v_pk_mul_f32 v[216:217], v[24:25], v[216:217]
    v_pk_mul_f32 v[218:219], v[26:27], v[218:219]
    v_cvt_pk_bf16_f32 v32, v212, v213
    v_cvt_pk_bf16_f32 v33, v214, v215
    v_cvt_pk_bf16_f32 v34, v216, v217
    v_cvt_pk_bf16_f32 v35, v218, v219
    buffer_store_dwordx4 v[32:35], v244, s[36:39], s46 offen offset:256 sc1
    s_mov_b32 s23, 200000
    s_waitcnt vmcnt(31)
    v_max_u32 v64, v76, v78
    v_pk_add_f32 v[66:67], v[76:77], v[78:79]
    v_max3_u32 v64, v64, v80, v82
    v_pk_add_f32 v[68:69], v[80:81], v[82:83]
    s_waitcnt vmcnt(27)
    v_max3_u32 v64, v64, v84, v86
    v_pk_add_f32 v[66:67], v[66:67], v[84:85]
    v_pk_add_f32 v[68:69], v[68:69], v[86:87]
    v_max3_u32 v64, v64, v88, v90
    v_pk_add_f32 v[66:67], v[66:67], v[88:89]
    v_pk_add_f32 v[68:69], v[68:69], v[90:91]
    s_waitcnt vmcnt(23)
    v_max3_u32 v64, v64, v92, v94
    v_pk_add_f32 v[66:67], v[66:67], v[92:93]
    v_pk_add_f32 v[68:69], v[68:69], v[94:95]
    v_max3_u32 v64, v64, v96, v98
    v_pk_add_f32 v[66:67], v[66:67], v[96:97]
    v_pk_add_f32 v[68:69], v[68:69], v[98:99]
    s_waitcnt vmcnt(19)
    v_max3_u32 v64, v64, v100, v102
    v_pk_add_f32 v[66:67], v[66:67], v[100:101]
    v_pk_add_f32 v[68:69], v[68:69], v[102:103]
    v_max3_u32 v64, v64, v104, v106
    v_pk_add_f32 v[66:67], v[66:67], v[104:105]
    v_pk_add_f32 v[68:69], v[68:69], v[106:107]
    s_waitcnt vmcnt(15)
    v_max3_u32 v64, v64, v44, v46
    v_pk_add_f32 v[66:67], v[66:67], v[44:45]
    v_pk_add_f32 v[68:69], v[68:69], v[46:47]
    v_max3_u32 v64, v64, v48, v50
    v_pk_add_f32 v[66:67], v[66:67], v[48:49]
    v_pk_add_f32 v[68:69], v[68:69], v[50:51]
    s_waitcnt vmcnt(11)
    v_max3_u32 v64, v64, v52, v54
    v_pk_add_f32 v[66:67], v[66:67], v[52:53]
    v_pk_add_f32 v[68:69], v[68:69], v[54:55]
    v_max3_u32 v64, v64, v56, v58
    v_pk_add_f32 v[66:67], v[66:67], v[56:57]
    v_pk_add_f32 v[68:69], v[68:69], v[58:59]
    s_waitcnt vmcnt(7)
    v_max3_u32 v64, v64, v172, v174
    v_pk_add_f32 v[66:67], v[66:67], v[172:173]
    v_pk_add_f32 v[68:69], v[68:69], v[174:175]
    v_max3_u32 v64, v64, v176, v178
    v_pk_add_f32 v[66:67], v[66:67], v[176:177]
    v_pk_add_f32 v[68:69], v[68:69], v[178:179]
    s_waitcnt vmcnt(3)
    v_max3_u32 v64, v64, v180, v182
    v_pk_add_f32 v[66:67], v[66:67], v[180:181]
    v_pk_add_f32 v[68:69], v[68:69], v[182:183]
    v_max3_u32 v64, v64, v184, v186
    v_pk_add_f32 v[66:67], v[66:67], v[184:185]
    v_pk_add_f32 v[68:69], v[68:69], v[186:187]
    v_cmp_eq_u32 vcc, -1, v64
    s_sub_u32 s23, s23, 1
    v_pk_add_f32 v[66:67], v[66:67], v[68:69]
    s_nop 2
    s_cbranch_vccz k3done_7
k3poll_6:
    buffer_load_dwordx2 v[76:77], v9, s[40:43], s21 offen offset:0 sc1
    buffer_load_dwordx2 v[78:79], v9, s[40:43], s21 offen offset:512 sc1
    buffer_load_dwordx2 v[80:81], v9, s[40:43], s21 offen offset:1024 sc1
    buffer_load_dwordx2 v[82:83], v9, s[40:43], s21 offen offset:1536 sc1
    buffer_load_dwordx2 v[84:85], v9, s[40:43], s21 offen offset:2048 sc1
    buffer_load_dwordx2 v[86:87], v9, s[40:43], s21 offen offset:2560 sc1
    buffer_load_dwordx2 v[88:89], v9, s[40:43], s21 offen offset:3072 sc1
    buffer_load_dwordx2 v[90:91], v9, s[40:43], s21 offen offset:3584 sc1
    buffer_load_dwordx2 v[92:93], v9, s[40:43], s24 offen offset:0 sc1
    buffer_load_dwordx2 v[94:95], v9, s[40:43], s24 offen offset:512 sc1
    buffer_load_dwordx2 v[96:97], v9, s[40:43], s24 offen offset:1024 sc1
    buffer_load_dwordx2 v[98:99], v9, s[40:43], s24 offen offset:1536 sc1
    buffer_load_dwordx2 v[100:101], v9, s[40:43], s24 offen offset:2048 sc1
    buffer_load_dwordx2 v[102:103], v9, s[40:43], s24 offen offset:2560 sc1
    buffer_load_dwordx2 v[104:105], v9, s[40:43], s24 offen offset:3072 sc1
    buffer_load_dwordx2 v[106:107], v9, s[40:43], s24 offen offset:3584 sc1
    buffer_load_dwordx2 v[44:45], v9, s[40:43], s25 offen offset:0 sc1
    buffer_load_dwordx2 v[46:47], v9, s[40:43], s25 offen offset:512 sc1
    buffer_load_dwordx2 v[48:49], v9, s[40:43], s25 offen offset:1024 sc1
    buffer_load_dwordx2 v[50:51], v9, s[40:43], s25 offen offset:1536 sc1
    buffer_load_dwordx2 v[52:53], v9, s[40:43], s25 offen offset:2048 sc1
    buffer_load_dwordx2 v[54:55], v9, s[40:43], s25 offen offset:2560 sc1
    buffer_load_dwordx2 v[56:57], v9, s[40:43], s25 offen offset:3072 sc1
    buffer_load_dwordx2 v[58:59], v9, s[40:43], s25 offen offset:3584 sc1
    buffer_load_dwordx2 v[172:173], v9, s[40:43], s26 offen offset:0 sc1
    buffer_load_dwordx2 v[174:175], v9, s[40:43], s26 offen offset:512 sc1
    buffer_load_dwordx2 v[176:177], v9, s[40:43], s26 offen offset:1024 sc1
    buffer_load_dwordx2 v[178:179], v9, s[40:43], s26 offen offset:1536 sc1
    buffer_load_dwordx2 v[180:181], v9, s[40:43], s26 offen offset:2048 sc1
    buffer_load_dwordx2 v[182:183], v9, s[40:43], s26 offen offset:2560 sc1
    buffer_load_dwordx2 v[184:185], v9, s[40:43], s26 offen offset:3072 sc1
    buffer_load_dwordx2 v[186:187], v9, s[40:43], s26 offen offset:3584 sc1
    s_waitcnt vmcnt(28)
    v_max_u32 v64, v76, v78
    v_pk_add_f32 v[66:67], v[76:77], v[78:79]
    v_max3_u32 v64, v64, v80, v82
    v_pk_add_f32 v[68:69], v[80:81], v[82:83]
    s_waitcnt vmcnt(24)
    v_max3_u32 v64, v64, v84, v86
    v_pk_add_f32 v[66:67], v[66:67], v[84:85]
    v_pk_add_f32 v[68:69], v[68:69], v[86:87]
    v_max3_u32 v64, v64, v88, v90
    v_pk_add_f32 v[66:67], v[66:67], v[88:89]
    v_pk_add_f32 v[68:69], v[68:69], v[90:91]
    s_waitcnt vmcnt(20)
    v_max3_u32 v64, v64, v92, v94
    v_pk_add_f32 v[66:67], v[66:67], v[92:93]
    v_pk_add_f32 v[68:69], v[68:69], v[94:95]
    v_max3_u32 v64, v64, v96, v98
    v_pk_add_f32 v[66:67], v[66:67], v[96:97]
    v_pk_add_f32 v[68:69], v[68:69], v[98:99]
    s_waitcnt vmcnt(16)
    v_max3_u32 v64, v64, v100, v102
    v_pk_add_f32 v[66:67], v[66:67], v[100:101]
    v_pk_add_f32 v[68:69], v[68:69], v[102:103]
    v_max3_u32 v64, v64, v104, v106
    v_pk_add_f32 v[66:67], v[66:67], v[104:105]
    v_pk_add_f32 v[68:69], v[68:69], v[106:107]
    s_waitcnt vmcnt(12)
    v_max3_u32 v64, v64, v44, v46
    v_pk_add_f32 v[66:67], v[66:67], v[44:45]
    v_pk_add_f32 v[68:69], v[68:69], v[46:47]
    v_max3_u32 v64, v64, v48, v50
    v_pk_add_f32 v[66:67], v[66:67], v[48:49]
    v_pk_add_f32 v[68:69], v[68:69], v[50:51]
    s_waitcnt vmcnt(8)
    v_max3_u32 v64, v64, v52, v54
    v_pk_add_f32 v[66:67], v[66:67], v[52:53]
    v_pk_add_f32 v[68:69], v[68:69], v[54:55]
    v_max3_u32 v64, v64, v56, v58
    v_pk_add_f32 v[66:67], v[66:67], v[56:57]
    v_pk_add_f32 v[68:69], v[68:69], v[58:59]
    s_waitcnt vmcnt(4)
    v_max3_u32 v64, v64, v172, v174
    v_pk_add_f32 v[66:67], v[66:67], v[172:173]
    v_pk_add_f32 v[68:69], v[68:69], v[174:175]
    v_max3_u32 v64, v64, v176, v178
    v_pk_add_f32 v[66:67], v[66:67], v[176:177]
    v_pk_add_f32 v[68:69], v[68:69], v[178:179]
    s_waitcnt vmcnt(0)
    v_max3_u32 v64, v64, v180, v182
    v_pk_add_f32 v[66:67], v[66:67], v[180:181]
    v_pk_add_f32 v[68:69], v[68:69], v[182:183]
    v_max3_u32 v64, v64, v184, v186
    v_pk_add_f32 v[66:67], v[66:67], v[184:185]
    v_pk_add_f32 v[68:69], v[68:69], v[186:187]
    v_cmp_eq_u32 vcc, -1, v64
    s_sub_u32 s23, s23, 1
    v_pk_add_f32 v[66:67], v[66:67], v[68:69]
    s_cmp_eq_u32 s23, 0
    s_cbranch_scc1 k3done_7
    s_nop 0
    s_cbranch_vccnz k3poll_6
k3done_7:
    v_mul_f32 v66, 0x3a124925, v66
    v_mul_f32 v67, 0x3a124925, v67
    v_fma_f32 v67, -v66, v66, v67
    v_max_f32 v67, 0, v67
    v_cvt_pk_bf16_f32 v67, v67, v67
    v_and_b32 v67, 0xffff0000, v67
    v_add_f32 v67, 0x3727c5ac, v67
    v_cvt_pk_bf16_f32 v67, v67, v67
    v_and_b32 v67, 0xffff0000, v67
    v_sqrt_f32 v67, v67
    s_nop 0
    v_cvt_pk_bf16_f32 v67, v67, v67
    v_and_b32 v67, 0xffff0000, v67
    v_rcp_f32 v224, v67
    v_cvt_pk_bf16_f32 v66, v66, v66
    v_and_b32 v66, 0xffff0000, v66
    v_mul_f32 v228, v66, v224
    v_sub_f32 v228, 0, v228
    v_mov_b32 v225, v224
    s_nop 1
    v_permlane16_swap_b32 v224, v225
    v_mov_b32 v226, v224
    v_mov_b32 v227, v225
    s_nop 0
    v_permlane32_swap_b32 v224, v226
    v_permlane32_swap_b32 v225, v227
    v_mov_b32 v229, v228
    s_nop 1
    v_permlane16_swap_b32 v228, v229
    v_mov_b32 v230, v228
    v_mov_b32 v231, v229
    s_nop 0
    v_permlane32_swap_b32 v228, v230
    v_permlane32_swap_b32 v229, v231
    v_pk_fma_f32 v[108:109], v[108:109], v[224:225], v[228:229] op_sel:[0,0,0] op_sel_hi:[1,0,0]
    v_pk_fma_f32 v[110:111], v[110:111], v[224:225], v[228:229] op_sel:[0,0,0] op_sel_hi:[1,0,0]
    v_pk_fma_f32 v[112:113], v[112:113], v[224:225], v[228:229] op_sel:[0,0,0] op_sel_hi:[1,0,0]
    v_pk_fma_f32 v[114:115], v[114:115], v[224:225], v[228:229] op_sel:[0,0,0] op_sel_hi:[1,0,0]
    v_cvt_pk_bf16_f32 v36, v108, v109
    v_cvt_pk_bf16_f32 v37, v110, v111
    v_cvt_pk_bf16_f32 v38, v112, v113
    v_cvt_pk_bf16_f32 v39, v114, v115
    buffer_store_dwordx4 v[36:39], v244, s[36:39], s45 offen offset:0 sc0 sc1
    v_pk_fma_f32 v[116:117], v[116:117], v[224:225], v[228:229] op_sel:[0,1,1] op_sel_hi:[1,1,1]
    v_pk_fma_f32 v[118:119], v[118:119], v[224:225], v[228:229] op_sel:[0,1,1] op_sel_hi:[1,1,1]
    v_pk_fma_f32 v[120:121], v[120:121], v[224:225], v[228:229] op_sel:[0,1,1] op_sel_hi:[1,1,1]
    v_pk_fma_f32 v[122:123], v[122:123], v[224:225], v[228:229] op_sel:[0,1,1] op_sel_hi:[1,1,1]
    v_cvt_pk_bf16_f32 v40, v116, v117
    v_cvt_pk_bf16_f32 v41, v118, v119
    v_cvt_pk_bf16_f32 v42, v120, v121
    v_cvt_pk_bf16_f32 v43, v122, v123
    buffer_store_dwordx4 v[40:43], v244, s[36:39], s45 offen offset:256 sc0 sc1
    v_pk_fma_f32 v[124:125], v[124:125], v[226:227], v[230:231] op_sel:[0,0,0] op_sel_hi:[1,0,0]
    v_pk_fma_f32 v[126:127], v[126:127], v[226:227], v[230:231] op_sel:[0,0,0] op_sel_hi:[1,0,0]
    v_pk_fma_f32 v[128:129], v[128:129], v[226:227], v[230:231] op_sel:[0,0,0] op_sel_hi:[1,0,0]
    v_pk_fma_f32 v[130:131], v[130:131], v[226:227], v[230:231] op_sel:[0,0,0] op_sel_hi:[1,0,0]
    v_cvt_pk_bf16_f32 v28, v124, v125
    v_cvt_pk_bf16_f32 v29, v126, v127
    v_cvt_pk_bf16_f32 v30, v128, v129
    v_cvt_pk_bf16_f32 v31, v130, v131
    buffer_store_dwordx4 v[28:31], v245, s[36:39], s45 offen offset:0 sc0 sc1
    v_pk_fma_f32 v[132:133], v[132:133], v[226:227], v[230:231] op_sel:[0,1,1] op_sel_hi:[1,1,1]
    v_pk_fma_f32 v[134:135], v[134:135], v[226:227], v[230:231] op_sel:[0,1,1] op_sel_hi:[1,1,1]
    v_pk_fma_f32 v[136:137], v[136:137], v[226:227], v[230:231] op_sel:[0,1,1] op_sel_hi:[1,1,1]
    v_pk_fma_f32 v[138:139], v[138:139], v[226:227], v[230:231] op_sel:[0,1,1] op_sel_hi:[1,1,1]
    v_cvt_pk_bf16_f32 v32, v132, v133
    v_cvt_pk_bf16_f32 v33, v134, v135
    v_cvt_pk_bf16_f32 v34, v136, v137
    v_cvt_pk_bf16_f32 v35, v138, v139
    buffer_store_dwordx4 v[32:35], v245, s[36:39], s45 offen offset:256 sc0 sc1
    v_pk_fma_f32 v[140:141], v[140:141], v[224:225], v[228:229] op_sel:[0,0,0] op_sel_hi:[1,0,0]
    v_pk_fma_f32 v[142:143], v[142:143], v[224:225], v[228:229] op_sel:[0,0,0] op_sel_hi:[1,0,0]
    v_pk_fma_f32 v[144:145], v[144:145], v[224:225], v[228:229] op_sel:[0,0,0] op_sel_hi:[1,0,0]
    v_pk_fma_f32 v[146:147], v[146:147], v[224:225], v[228:229] op_sel:[0,0,0] op_sel_hi:[1,0,0]
    v_cvt_pk_bf16_f32 v36, v140, v141
    v_cvt_pk_bf16_f32 v37, v142, v143
    v_cvt_pk_bf16_f32 v38, v144, v145
    v_cvt_pk_bf16_f32 v39, v146, v147
    buffer_store_dwordx4 v[36:39], v244, s[36:39], s49 offen offset:0 sc0 sc1
    v_pk_fma_f32 v[148:149], v[148:149], v[224:225], v[228:229] op_sel:[0,1,1] op_sel_hi:[1,1,1]
    v_pk_fma_f32 v[150:151], v[150:151], v[224:225], v[228:229] op_sel:[0,1,1] op_sel_hi:[1,1,1]
    v_pk_fma_f32 v[152:153], v[152:153], v[224:225], v[228:229] op_sel:[0,1,1] op_sel_hi:[1,1,1]
    v_pk_fma_f32 v[154:155], v[154:155], v[224:225], v[228:229] op_sel:[0,1,1] op_sel_hi:[1,1,1]
    v_cvt_pk_bf16_f32 v40, v148, v149
    v_cvt_pk_bf16_f32 v41, v150, v151
    v_cvt_pk_bf16_f32 v42, v152, v153
    v_cvt_pk_bf16_f32 v43, v154, v155
    buffer_store_dwordx4 v[40:43], v244, s[36:39], s49 offen offset:256 sc0 sc1
    v_pk_fma_f32 v[156:157], v[156:157], v[226:227], v[230:231] op_sel:[0,0,0] op_sel_hi:[1,0,0]
    v_pk_fma_f32 v[158:159], v[158:159], v[226:227], v[230:231] op_sel:[0,0,0] op_sel_hi:[1,0,0]
    v_pk_fma_f32 v[160:161], v[160:161], v[226:227], v[230:231] op_sel:[0,0,0] op_sel_hi:[1,0,0]
    v_pk_fma_f32 v[162:163], v[162:163], v[226:227], v[230:231] op_sel:[0,0,0] op_sel_hi:[1,0,0]
    v_cvt_pk_bf16_f32 v28, v156, v157
    v_cvt_pk_bf16_f32 v29, v158, v159
    v_cvt_pk_bf16_f32 v30, v160, v161
    v_cvt_pk_bf16_f32 v31, v162, v163
    buffer_store_dwordx4 v[28:31], v245, s[36:39], s49 offen offset:0 sc0 sc1
    v_pk_fma_f32 v[164:165], v[164:165], v[226:227], v[230:231] op_sel:[0,1,1] op_sel_hi:[1,1,1]
    v_pk_fma_f32 v[166:167], v[166:167], v[226:227], v[230:231] op_sel:[0,1,1] op_sel_hi:[1,1,1]
    v_pk_fma_f32 v[168:169], v[168:169], v[226:227], v[230:231] op_sel:[0,1,1] op_sel_hi:[1,1,1]
    v_pk_fma_f32 v[170:171], v[170:171], v[226:227], v[230:231] op_sel:[0,1,1] op_sel_hi:[1,1,1]
    v_cvt_pk_bf16_f32 v32, v164, v165
    v_cvt_pk_bf16_f32 v33, v166, v167
    v_cvt_pk_bf16_f32 v34, v168, v169
    v_cvt_pk_bf16_f32 v35, v170, v171
    buffer_store_dwordx4 v[32:35], v245, s[36:39], s49 offen offset:256 sc0 sc1
    s_branch k3_kernel_fin
k3_kernel_e1:
    v_pk_mul_f32 v[12:13], v[172:173], v[172:173]
    v_pk_mul_f32 v[14:15], v[174:175], v[174:175]
    v_pk_mul_f32 v[16:17], v[176:177], v[176:177]
    v_pk_mul_f32 v[18:19], v[178:179], v[178:179]
    v_pk_fma_f32 v[12:13], v[12:13], v[228:229], v[224:225] op_sel:[0,0,0] op_sel_hi:[1,0,0]
    v_pk_fma_f32 v[14:15], v[14:15], v[228:229], v[224:225] op_sel:[0,0,0] op_sel_hi:[1,0,0]
    v_pk_fma_f32 v[16:17], v[16:17], v[228:229], v[224:225] op_sel:[0,0,0] op_sel_hi:[1,0,0]
    v_pk_fma_f32 v[18:19], v[18:19], v[228:229], v[224:225] op_sel:[0,0,0] op_sel_hi:[1,0,0]
    v_pk_mul_f32 v[12:13], v[12:13], v[172:173]
    v_pk_mul_f32 v[14:15], v[14:15], v[174:175]
    v_pk_mul_f32 v[16:17], v[16:17], v[176:177]
    v_pk_mul_f32 v[18:19], v[18:19], v[178:179]
    v_exp_f32 v12, v12
    v_exp_f32 v13, v13
    v_exp_f32 v14, v14
    v_exp_f32 v15, v15
    v_exp_f32 v16, v16
    v_exp_f32 v17, v17
    v_exp_f32 v18, v18
    v_exp_f32 v19, v19
    v_pk_fma_f32 v[12:13], v[12:13], v[220:221], v[220:221] op_sel:[0,0,0] op_sel_hi:[1,0,0]
    v_pk_fma_f32 v[14:15], v[14:15], v[220:221], v[220:221] op_sel:[0,0,0] op_sel_hi:[1,0,0]
    v_pk_fma_f32 v[16:17], v[16:17], v[220:221], v[220:221] op_sel:[0,0,0] op_sel_hi:[1,0,0]
    v_pk_fma_f32 v[18:19], v[18:19], v[220:221], v[220:221] op_sel:[0,0,0] op_sel_hi:[1,0,0]
    v_rcp_f32 v12, v12
    v_rcp_f32 v13, v13
    v_rcp_f32 v14, v14
    v_rcp_f32 v15, v15
    v_rcp_f32 v16, v16
    v_rcp_f32 v17, v17
    v_rcp_f32 v18, v18
    v_rcp_f32 v19, v19
    v_pk_mul_f32 v[172:173], v[12:13], v[172:173]
    v_pk_mul_f32 v[174:175], v[14:15], v[174:175]
    v_pk_mul_f32 v[176:177], v[16:17], v[176:177]
    v_pk_mul_f32 v[178:179], v[18:19], v[178:179]
    v_pk_mul_f32 v[68:69], v[172:173], v[172:173]
    v_pk_fma_f32 v[68:69], v[174:175], v[174:175], v[68:69]
    v_pk_add_f32 v[60:61], v[172:173], v[174:175]
    v_pk_fma_f32 v[68:69], v[176:177], v[176:177], v[68:69]
    v_pk_add_f32 v[60:61], v[60:61], v[176:177]
    v_pk_fma_f32 v[68:69], v[178:179], v[178:179], v[68:69]
    v_pk_add_f32 v[60:61], v[60:61], v[178:179]
    v_pk_mul_f32 v[20:21], v[180:181], v[180:181]
    v_pk_mul_f32 v[22:23], v[182:183], v[182:183]
    v_pk_mul_f32 v[24:25], v[184:185], v[184:185]
    v_pk_mul_f32 v[26:27], v[186:187], v[186:187]
    v_pk_fma_f32 v[20:21], v[20:21], v[228:229], v[224:225] op_sel:[0,1,1] op_sel_hi:[1,1,1]
    v_pk_fma_f32 v[22:23], v[22:23], v[228:229], v[224:225] op_sel:[0,1,1] op_sel_hi:[1,1,1]
    v_pk_fma_f32 v[24:25], v[24:25], v[228:229], v[224:225] op_sel:[0,1,1] op_sel_hi:[1,1,1]
    v_pk_fma_f32 v[26:27], v[26:27], v[228:229], v[224:225] op_sel:[0,1,1] op_sel_hi:[1,1,1]
    v_pk_mul_f32 v[20:21], v[20:21], v[180:181]
    v_pk_mul_f32 v[22:23], v[22:23], v[182:183]
    v_pk_mul_f32 v[24:25], v[24:25], v[184:185]
    v_pk_mul_f32 v[26:27], v[26:27], v[186:187]
    v_exp_f32 v20, v20
    v_exp_f32 v21, v21
    v_exp_f32 v22, v22
    v_exp_f32 v23, v23
    v_exp_f32 v24, v24
    v_exp_f32 v25, v25
    v_exp_f32 v26, v26
    v_exp_f32 v27, v27
    v_pk_fma_f32 v[20:21], v[20:21], v[220:221], v[220:221] op_sel:[0,1,1] op_sel_hi:[1,1,1]
    v_pk_fma_f32 v[22:23], v[22:23], v[220:221], v[220:221] op_sel:[0,1,1] op_sel_hi:[1,1,1]
    v_pk_fma_f32 v[24:25], v[24:25], v[220:221], v[220:221] op_sel:[0,1,1] op_sel_hi:[1,1,1]
    v_pk_fma_f32 v[26:27], v[26:27], v[220:221], v[220:221] op_sel:[0,1,1] op_sel_hi:[1,1,1]
    v_rcp_f32 v20, v20
    v_rcp_f32 v21, v21
    v_rcp_f32 v22, v22
    v_rcp_f32 v23, v23
    v_rcp_f32 v24, v24
    v_rcp_f32 v25, v25
    v_rcp_f32 v26, v26
    v_rcp_f32 v27, v27
    v_pk_mul_f32 v[180:181], v[20:21], v[180:181]
    v_pk_mul_f32 v[182:183], v[22:23], v[182:183]
    v_pk_mul_f32 v[184:185], v[24:25], v[184:185]
    v_pk_mul_f32 v[186:187], v[26:27], v[186:187]
    v_pk_mul_f32 v[70:71], v[180:181], v[180:181]
    v_pk_fma_f32 v[70:71], v[182:183], v[182:183], v[70:71]
    v_pk_add_f32 v[62:63], v[180:181], v[182:183]
    v_pk_fma_f32 v[70:71], v[184:185], v[184:185], v[70:71]
    v_pk_add_f32 v[62:63], v[62:63], v[184:185]
    v_pk_fma_f32 v[70:71], v[186:187], v[186:187], v[70:71]
    v_pk_add_f32 v[62:63], v[62:63], v[186:187]
    v_pk_mul_f32 v[12:13], v[188:189], v[188:189]
    v_pk_mul_f32 v[14:15], v[190:191], v[190:191]
    v_pk_mul_f32 v[16:17], v[192:193], v[192:193]
    v_pk_mul_f32 v[18:19], v[194:195], v[194:195]
    v_pk_fma_f32 v[12:13], v[12:13], v[230:231], v[226:227] op_sel:[0,0,0] op_sel_hi:[1,0,0]
    v_pk_fma_f32 v[14:15], v[14:15], v[230:231], v[226:227] op_sel:[0,0,0] op_sel_hi:[1,0,0]
    v_pk_fma_f32 v[16:17], v[16:17], v[230:231], v[226:227] op_sel:[0,0,0] op_sel_hi:[1,0,0]
    v_pk_fma_f32 v[18:19], v[18:19], v[230:231], v[226:227] op_sel:[0,0,0] op_sel_hi:[1,0,0]
    v_pk_mul_f32 v[12:13], v[12:13], v[188:189]
    v_pk_mul_f32 v[14:15], v[14:15], v[190:191]
    v_pk_mul_f32 v[16:17], v[16:17], v[192:193]
    v_pk_mul_f32 v[18:19], v[18:19], v[194:195]
    v_exp_f32 v12, v12
    v_exp_f32 v13, v13
    v_exp_f32 v14, v14
    v_exp_f32 v15, v15
    v_exp_f32 v16, v16
    v_exp_f32 v17, v17
    v_exp_f32 v18, v18
    v_exp_f32 v19, v19
    v_pk_fma_f32 v[12:13], v[12:13], v[222:223], v[222:223] op_sel:[0,0,0] op_sel_hi:[1,0,0]
    v_pk_fma_f32 v[14:15], v[14:15], v[222:223], v[222:223] op_sel:[0,0,0] op_sel_hi:[1,0,0]
    v_pk_fma_f32 v[16:17], v[16:17], v[222:223], v[222:223] op_sel:[0,0,0] op_sel_hi:[1,0,0]
    v_pk_fma_f32 v[18:19], v[18:19], v[222:223], v[222:223] op_sel:[0,0,0] op_sel_hi:[1,0,0]
    v_rcp_f32 v12, v12
    v_rcp_f32 v13, v13
    v_rcp_f32 v14, v14
    v_rcp_f32 v15, v15
    v_rcp_f32 v16, v16
    v_rcp_f32 v17, v17
    v_rcp_f32 v18, v18
    v_rcp_f32 v19, v19
    v_pk_mul_f32 v[188:189], v[12:13], v[188:189]
    v_pk_mul_f32 v[190:191], v[14:15], v[190:191]
    v_pk_mul_f32 v[192:193], v[16:17], v[192:193]
    v_pk_mul_f32 v[194:195], v[18:19], v[194:195]
    v_pk_mul_f32 v[72:73], v[188:189], v[188:189]
    v_pk_fma_f32 v[72:73], v[190:191], v[190:191], v[72:73]
    v_pk_add_f32 v[64:65], v[188:189], v[190:191]
    v_pk_fma_f32 v[72:73], v[192:193], v[192:193], v[72:73]
    v_pk_add_f32 v[64:65], v[64:65], v[192:193]
    v_pk_fma_f32 v[72:73], v[194:195], v[194:195], v[72:73]
    v_pk_add_f32 v[64:65], v[64:65], v[194:195]
    v_pk_mul_f32 v[20:21], v[196:197], v[196:197]
    v_pk_mul_f32 v[22:23], v[198:199], v[198:199]
    v_pk_mul_f32 v[24:25], v[200:201], v[200:201]
    v_pk_mul_f32 v[26:27], v[202:203], v[202:203]
    v_pk_fma_f32 v[20:21], v[20:21], v[230:231], v[226:227] op_sel:[0,1,1] op_sel_hi:[1,1,1]
    v_pk_fma_f32 v[22:23], v[22:23], v[230:231], v[226:227] op_sel:[0,1,1] op_sel_hi:[1,1,1]
    v_pk_fma_f32 v[24:25], v[24:25], v[230:231], v[226:227] op_sel:[0,1,1] op_sel_hi:[1,1,1]
    v_pk_fma_f32 v[26:27], v[26:27], v[230:231], v[226:227] op_sel:[0,1,1] op_sel_hi:[1,1,1]
    v_pk_mul_f32 v[20:21], v[20:21], v[196:197]
    v_pk_mul_f32 v[22:23], v[22:23], v[198:199]
    v_pk_mul_f32 v[24:25], v[24:25], v[200:201]
    v_pk_mul_f32 v[26:27], v[26:27], v[202:203]
    v_exp_f32 v20, v20
    v_exp_f32 v21, v21
    v_exp_f32 v22, v22
    v_exp_f32 v23, v23
    v_exp_f32 v24, v24
    v_exp_f32 v25, v25
    v_exp_f32 v26, v26
    v_exp_f32 v27, v27
    v_pk_fma_f32 v[20:21], v[20:21], v[222:223], v[222:223] op_sel:[0,1,1] op_sel_hi:[1,1,1]
    v_pk_fma_f32 v[22:23], v[22:23], v[222:223], v[222:223] op_sel:[0,1,1] op_sel_hi:[1,1,1]
    v_pk_fma_f32 v[24:25], v[24:25], v[222:223], v[222:223] op_sel:[0,1,1] op_sel_hi:[1,1,1]
    v_pk_fma_f32 v[26:27], v[26:27], v[222:223], v[222:223] op_sel:[0,1,1] op_sel_hi:[1,1,1]
    v_rcp_f32 v20, v20
    v_rcp_f32 v21, v21
    v_rcp_f32 v22, v22
    v_rcp_f32 v23, v23
    v_rcp_f32 v24, v24
    v_rcp_f32 v25, v25
    v_rcp_f32 v26, v26
    v_rcp_f32 v27, v27
    v_pk_mul_f32 v[196:197], v[20:21], v[196:197]
    v_pk_mul_f32 v[198:199], v[22:23], v[198:199]
    v_pk_mul_f32 v[200:201], v[24:25], v[200:201]
    v_pk_mul_f32 v[202:203], v[26:27], v[202:203]
    v_pk_mul_f32 v[74:75], v[196:197], v[196:197]
    v_pk_fma_f32 v[74:75], v[198:199], v[198:199], v[74:75]
    v_pk_add_f32 v[66:67], v[196:197], v[198:199]
    v_pk_fma_f32 v[74:75], v[200:201], v[200:201], v[74:75]
    v_pk_add_f32 v[66:67], v[66:67], v[200:201]
    v_pk_fma_f32 v[74:75], v[202:203], v[202:203], v[74:75]
    v_pk_add_f32 v[66:67], v[66:67], v[202:203]
    v_pk_mul_f32 v[12:13], v[204:205], v[204:205]
    v_pk_mul_f32 v[14:15], v[206:207], v[206:207]
    v_pk_mul_f32 v[16:17], v[208:209], v[208:209]
    v_pk_mul_f32 v[18:19], v[210:211], v[210:211]
    v_pk_fma_f32 v[12:13], v[12:13], v[228:229], v[224:225] op_sel:[0,0,0] op_sel_hi:[1,0,0]
    v_pk_fma_f32 v[14:15], v[14:15], v[228:229], v[224:225] op_sel:[0,0,0] op_sel_hi:[1,0,0]
    v_pk_fma_f32 v[16:17], v[16:17], v[228:229], v[224:225] op_sel:[0,0,0] op_sel_hi:[1,0,0]
    v_pk_fma_f32 v[18:19], v[18:19], v[228:229], v[224:225] op_sel:[0,0,0] op_sel_hi:[1,0,0]
    v_pk_mul_f32 v[12:13], v[12:13], v[204:205]
    v_pk_mul_f32 v[14:15], v[14:15], v[206:207]
    v_pk_mul_f32 v[16:17], v[16:17], v[208:209]
    v_pk_mul_f32 v[18:19], v[18:19], v[210:211]
    v_exp_f32 v12, v12
    v_exp_f32 v13, v13
    v_exp_f32 v14, v14
    v_exp_f32 v15, v15
    v_exp_f32 v16, v16
    v_exp_f32 v17, v17
    v_exp_f32 v18, v18
    v_exp_f32 v19, v19
    v_pk_fma_f32 v[12:13], v[12:13], v[220:221], v[220:221] op_sel:[0,0,0] op_sel_hi:[1,0,0]
    v_pk_fma_f32 v[14:15], v[14:15], v[220:221], v[220:221] op_sel:[0,0,0] op_sel_hi:[1,0,0]
    v_pk_fma_f32 v[16:17], v[16:17], v[220:221], v[220:221] op_sel:[0,0,0] op_sel_hi:[1,0,0]
    v_pk_fma_f32 v[18:19], v[18:19], v[220:221], v[220:221] op_sel:[0,0,0] op_sel_hi:[1,0,0]
    v_rcp_f32 v12, v12
    v_rcp_f32 v13, v13
    v_rcp_f32 v14, v14
    v_rcp_f32 v15, v15
    v_rcp_f32 v16, v16
    v_rcp_f32 v17, v17
    v_rcp_f32 v18, v18
    v_rcp_f32 v19, v19
    v_pk_mul_f32 v[204:205], v[12:13], v[204:205]
    v_pk_mul_f32 v[206:207], v[14:15], v[206:207]
    v_pk_mul_f32 v[208:209], v[16:17], v[208:209]
    v_pk_mul_f32 v[210:211], v[18:19], v[210:211]
    v_pk_fma_f32 v[68:69], v[204:205], v[204:205], v[68:69]
    v_pk_add_f32 v[60:61], v[60:61], v[204:205]
    v_pk_fma_f32 v[68:69], v[206:207], v[206:207], v[68:69]
    v_pk_add_f32 v[60:61], v[60:61], v[206:207]
    v_pk_fma_f32 v[68:69], v[208:209], v[208:209], v[68:69]
    v_pk_add_f32 v[60:61], v[60:61], v[208:209]
    v_pk_fma_f32 v[68:69], v[210:211], v[210:211], v[68:69]
    v_pk_add_f32 v[60:61], v[60:61], v[210:211]
    v_pk_mul_f32 v[20:21], v[212:213], v[212:213]
    v_pk_mul_f32 v[22:23], v[214:215], v[214:215]
    v_pk_mul_f32 v[24:25], v[216:217], v[216:217]
    v_pk_mul_f32 v[26:27], v[218:219], v[218:219]
    v_pk_fma_f32 v[20:21], v[20:21], v[228:229], v[224:225] op_sel:[0,1,1] op_sel_hi:[1,1,1]
    v_pk_fma_f32 v[22:23], v[22:23], v[228:229], v[224:225] op_sel:[0,1,1] op_sel_hi:[1,1,1]
    v_pk_fma_f32 v[24:25], v[24:25], v[228:229], v[224:225] op_sel:[0,1,1] op_sel_hi:[1,1,1]
    v_pk_fma_f32 v[26:27], v[26:27], v[228:229], v[224:225] op_sel:[0,1,1] op_sel_hi:[1,1,1]
    v_pk_mul_f32 v[20:21], v[20:21], v[212:213]
    v_pk_mul_f32 v[22:23], v[22:23], v[214:215]
    v_pk_mul_f32 v[24:25], v[24:25], v[216:217]
    v_pk_mul_f32 v[26:27], v[26:27], v[218:219]
    v_exp_f32 v20, v20
    v_exp_f32 v21, v21
    v_exp_f32 v22, v22
    v_exp_f32 v23, v23
    v_exp_f32 v24, v24
    v_exp_f32 v25, v25
    v_exp_f32 v26, v26
    v_exp_f32 v27, v27
    v_pk_fma_f32 v[20:21], v[20:21], v[220:221], v[220:221] op_sel:[0,1,1] op_sel_hi:[1,1,1]
    v_pk_fma_f32 v[22:23], v[22:23], v[220:221], v[220:221] op_sel:[0,1,1] op_sel_hi:[1,1,1]
    v_pk_fma_f32 v[24:25], v[24:25], v[220:221], v[220:221] op_sel:[0,1,1] op_sel_hi:[1,1,1]
    v_pk_fma_f32 v[26:27], v[26:27], v[220:221], v[220:221] op_sel:[0,1,1] op_sel_hi:[1,1,1]
    v_rcp_f32 v20, v20
    v_rcp_f32 v21, v21
    v_rcp_f32 v22, v22
    v_rcp_f32 v23, v23
    v_rcp_f32 v24, v24
    v_rcp_f32 v25, v25
    v_rcp_f32 v26, v26
    v_rcp_f32 v27, v27
    v_pk_mul_f32 v[212:213], v[20:21], v[212:213]
    v_pk_mul_f32 v[214:215], v[22:23], v[214:215]
    v_pk_mul_f32 v[216:217], v[24:25], v[216:217]
    v_pk_mul_f32 v[218:219], v[26:27], v[218:219]
    v_pk_fma_f32 v[70:71], v[212:213], v[212:213], v[70:71]
    v_pk_add_f32 v[62:63], v[62:63], v[212:213]
    v_pk_fma_f32 v[70:71], v[214:215], v[214:215], v[70:71]
    v_pk_add_f32 v[62:63], v[62:63], v[214:215]
    v_pk_fma_f32 v[70:71], v[216:217], v[216:217], v[70:71]
    v_pk_add_f32 v[62:63], v[62:63], v[216:217]
    v_pk_fma_f32 v[70:71], v[218:219], v[218:219], v[70:71]
    v_pk_add_f32 v[62:63], v[62:63], v[218:219]
    v_add_f32 v12, v60, v61
    v_add_f32 v13, v62, v63
    v_add_f32 v14, v64, v65
    v_add_f32 v15, v66, v67
    v_add_f32 v16, v68, v69
    v_add_f32 v17, v70, v71
    v_add_f32 v18, v72, v73
    v_add_f32 v19, v74, v75
    v_permlane32_swap_b32 v12, v14
    v_permlane32_swap_b32 v13, v15
    v_permlane32_swap_b32 v16, v18
    v_permlane32_swap_b32 v17, v19
    v_add_f32 v12, v12, v14
    v_add_f32 v13, v13, v15
    v_add_f32 v16, v16, v18
    v_add_f32 v17, v17, v19
    v_permlane16_swap_b32 v12, v13
    s_nop 0
    v_permlane16_swap_b32 v16, v17
    v_add_f32 v60, v12, v13
    v_add_f32 v61, v16, v17
    buffer_store_dwordx2 v[60:61], v9, s[40:43], s22 offen sc1
    v_pk_mul_f32 v[12:13], v[108:109], v[108:109]
    v_pk_mul_f32 v[14:15], v[110:111], v[110:111]
    v_pk_mul_f32 v[16:17], v[112:113], v[112:113]
    v_pk_mul_f32 v[18:19], v[114:115], v[114:115]
    v_pk_fma_f32 v[12:13], v[12:13], v[228:229], v[224:225] op_sel:[0,0,0] op_sel_hi:[1,0,0]
    v_pk_fma_f32 v[14:15], v[14:15], v[228:229], v[224:225] op_sel:[0,0,0] op_sel_hi:[1,0,0]
    v_pk_fma_f32 v[16:17], v[16:17], v[228:229], v[224:225] op_sel:[0,0,0] op_sel_hi:[1,0,0]
    v_pk_fma_f32 v[18:19], v[18:19], v[228:229], v[224:225] op_sel:[0,0,0] op_sel_hi:[1,0,0]
    v_pk_mul_f32 v[12:13], v[12:13], v[108:109]
    v_pk_mul_f32 v[14:15], v[14:15], v[110:111]
    v_pk_mul_f32 v[16:17], v[16:17], v[112:113]
    v_pk_mul_f32 v[18:19], v[18:19], v[114:115]
    v_exp_f32 v12, v12
    v_exp_f32 v13, v13
    v_exp_f32 v14, v14
    v_exp_f32 v15, v15
    v_exp_f32 v16, v16
    v_exp_f32 v17, v17
    v_exp_f32 v18, v18
    v_exp_f32 v19, v19
    v_pk_fma_f32 v[12:13], v[12:13], v[220:221], v[220:221] op_sel:[0,0,0] op_sel_hi:[1,0,0]
    v_pk_fma_f32 v[14:15], v[14:15], v[220:221], v[220:221] op_sel:[0,0,0] op_sel_hi:[1,0,0]
    v_pk_fma_f32 v[16:17], v[16:17], v[220:221], v[220:221] op_sel:[0,0,0] op_sel_hi:[1,0,0]
    v_pk_fma_f32 v[18:19], v[18:19], v[220:221], v[220:221] op_sel:[0,0,0] op_sel_hi:[1,0,0]
    v_rcp_f32 v12, v12
    v_rcp_f32 v13, v13
    v_rcp_f32 v14, v14
    v_rcp_f32 v15, v15
    v_rcp_f32 v16, v16
    v_rcp_f32 v17, v17
    v_rcp_f32 v18, v18
    v_rcp_f32 v19, v19
    v_pk_mul_f32 v[108:109], v[12:13], v[108:109]
    v_pk_mul_f32 v[110:111], v[14:15], v[110:111]
    v_pk_mul_f32 v[112:113], v[16:17], v[112:113]
    v_pk_mul_f32 v[114:115], v[18:19], v[114:115]
    v_cvt_pk_bf16_f32 v36, v108, v109
    v_cvt_pk_bf16_f32 v37, v110, v111
    v_cvt_pk_bf16_f32 v38, v112, v113
    v_cvt_pk_bf16_f32 v39, v114, v115
    buffer_store_dwordx4 v[36:39], v244, s[36:39], s45 offen offset:0 sc1
    v_pk_mul_f32 v[20:21], v[116:117], v[116:117]
    v_pk_mul_f32 v[22:23], v[118:119], v[118:119]
    v_pk_mul_f32 v[24:25], v[120:121], v[120:121]
    v_pk_mul_f32 v[26:27], v[122:123], v[122:123]
    v_pk_fma_f32 v[20:21], v[20:21], v[228:229], v[224:225] op_sel:[0,1,1] op_sel_hi:[1,1,1]
    v_pk_fma_f32 v[22:23], v[22:23], v[228:229], v[224:225] op_sel:[0,1,1] op_sel_hi:[1,1,1]
    v_pk_fma_f32 v[24:25], v[24:25], v[228:229], v[224:225] op_sel:[0,1,1] op_sel_hi:[1,1,1]
    v_pk_fma_f32 v[26:27], v[26:27], v[228:229], v[224:225] op_sel:[0,1,1] op_sel_hi:[1,1,1]
    v_pk_mul_f32 v[20:21], v[20:21], v[116:117]
    v_pk_mul_f32 v[22:23], v[22:23], v[118:119]
    v_pk_mul_f32 v[24:25], v[24:25], v[120:121]
    v_pk_mul_f32 v[26:27], v[26:27], v[122:123]
    v_exp_f32 v20, v20
    v_exp_f32 v21, v21
    v_exp_f32 v22, v22
    v_exp_f32 v23, v23
    v_exp_f32 v24, v24
    v_exp_f32 v25, v25
    v_exp_f32 v26, v26
    v_exp_f32 v27, v27
    v_pk_fma_f32 v[20:21], v[20:21], v[220:221], v[220:221] op_sel:[0,1,1] op_sel_hi:[1,1,1]
    v_pk_fma_f32 v[22:23], v[22:23], v[220:221], v[220:221] op_sel:[0,1,1] op_sel_hi:[1,1,1]
    v_pk_fma_f32 v[24:25], v[24:25], v[220:221], v[220:221] op_sel:[0,1,1] op_sel_hi:[1,1,1]
    v_pk_fma_f32 v[26:27], v[26:27], v[220:221], v[220:221] op_sel:[0,1,1] op_sel_hi:[1,1,1]
    v_rcp_f32 v20, v20
    v_rcp_f32 v21, v21
    v_rcp_f32 v22, v22
    v_rcp_f32 v23, v23
    v_rcp_f32 v24, v24
    v_rcp_f32 v25, v25
    v_rcp_f32 v26, v26
    v_rcp_f32 v27, v27
    v_pk_mul_f32 v[116:117], v[20:21], v[116:117]
    v_pk_mul_f32 v[118:119], v[22:23], v[118:119]
    v_pk_mul_f32 v[120:121], v[24:25], v[120:121]
    v_pk_mul_f32 v[122:123], v[26:27], v[122:123]
    v_cvt_pk_bf16_f32 v40, v116, v117
    v_cvt_pk_bf16_f32 v41, v118, v119
    v_cvt_pk_bf16_f32 v42, v120, v121
    v_cvt_pk_bf16_f32 v43, v122, v123
    buffer_store_dwordx4 v[40:43], v244, s[36:39], s45 offen offset:256 sc1
    v_pk_mul_f32 v[12:13], v[124:125], v[124:125]
    v_pk_mul_f32 v[14:15], v[126:127], v[126:127]
    v_pk_mul_f32 v[16:17], v[128:129], v[128:129]
    v_pk_mul_f32 v[18:19], v[130:131], v[130:131]
    v_pk_fma_f32 v[12:13], v[12:13], v[230:231], v[226:227] op_sel:[0,0,0] op_sel_hi:[1,0,0]
    v_pk_fma_f32 v[14:15], v[14:15], v[230:231], v[226:227] op_sel:[0,0,0] op_sel_hi:[1,0,0]
    v_pk_fma_f32 v[16:17], v[16:17], v[230:231], v[226:227] op_sel:[0,0,0] op_sel_hi:[1,0,0]
    v_pk_fma_f32 v[18:19], v[18:19], v[230:231], v[226:227] op_sel:[0,0,0] op_sel_hi:[1,0,0]
    v_pk_mul_f32 v[12:13], v[12:13], v[124:125]
    v_pk_mul_f32 v[14:15], v[14:15], v[126:127]
    v_pk_mul_f32 v[16:17], v[16:17], v[128:129]
    v_pk_mul_f32 v[18:19], v[18:19], v[130:131]
    v_exp_f32 v12, v12
    v_exp_f32 v13, v13
    v_exp_f32 v14, v14
    v_exp_f32 v15, v15
    v_exp_f32 v16, v16
    v_exp_f32 v17, v17
    v_exp_f32 v18, v18
    v_exp_f32 v19, v19
    v_pk_fma_f32 v[12:13], v[12:13], v[222:223], v[222:223] op_sel:[0,0,0] op_sel_hi:[1,0,0]
    v_pk_fma_f32 v[14:15], v[14:15], v[222:223], v[222:223] op_sel:[0,0,0] op_sel_hi:[1,0,0]
    v_pk_fma_f32 v[16:17], v[16:17], v[222:223], v[222:223] op_sel:[0,0,0] op_sel_hi:[1,0,0]
    v_pk_fma_f32 v[18:19], v[18:19], v[222:223], v[222:223] op_sel:[0,0,0] op_sel_hi:[1,0,0]
    v_rcp_f32 v12, v12
    v_rcp_f32 v13, v13
    v_rcp_f32 v14, v14
    v_rcp_f32 v15, v15
    v_rcp_f32 v16, v16
    v_rcp_f32 v17, v17
    v_rcp_f32 v18, v18
    v_rcp_f32 v19, v19
    v_pk_mul_f32 v[124:125], v[12:13], v[124:125]
    v_pk_mul_f32 v[126:127], v[14:15], v[126:127]
    v_pk_mul_f32 v[128:129], v[16:17], v[128:129]
    v_pk_mul_f32 v[130:131], v[18:19], v[130:131]
    v_cvt_pk_bf16_f32 v28, v124, v125
    v_cvt_pk_bf16_f32 v29, v126, v127
    v_cvt_pk_bf16_f32 v30, v128, v129
    v_cvt_pk_bf16_f32 v31, v130, v131
    buffer_store_dwordx4 v[28:31], v245, s[36:39], s45 offen offset:0 sc1
    v_pk_mul_f32 v[20:21], v[132:133], v[132:133]
    v_pk_mul_f32 v[22:23], v[134:135], v[134:135]
    v_pk_mul_f32 v[24:25], v[136:137], v[136:137]
    v_pk_mul_f32 v[26:27], v[138:139], v[138:139]
    v_pk_fma_f32 v[20:21], v[20:21], v[230:231], v[226:227] op_sel:[0,1,1] op_sel_hi:[1,1,1]
    v_pk_fma_f32 v[22:23], v[22:23], v[230:231], v[226:227] op_sel:[0,1,1] op_sel_hi:[1,1,1]
    v_pk_fma_f32 v[24:25], v[24:25], v[230:231], v[226:227] op_sel:[0,1,1] op_sel_hi:[1,1,1]
    v_pk_fma_f32 v[26:27], v[26:27], v[230:231], v[226:227] op_sel:[0,1,1] op_sel_hi:[1,1,1]
    v_pk_mul_f32 v[20:21], v[20:21], v[132:133]
    v_pk_mul_f32 v[22:23], v[22:23], v[134:135]
    v_pk_mul_f32 v[24:25], v[24:25], v[136:137]
    v_pk_mul_f32 v[26:27], v[26:27], v[138:139]
    v_exp_f32 v20, v20
    v_exp_f32 v21, v21
    v_exp_f32 v22, v22
    v_exp_f32 v23, v23
    v_exp_f32 v24, v24
    v_exp_f32 v25, v25
    v_exp_f32 v26, v26
    v_exp_f32 v27, v27
    v_pk_fma_f32 v[20:21], v[20:21], v[222:223], v[222:223] op_sel:[0,1,1] op_sel_hi:[1,1,1]
    v_pk_fma_f32 v[22:23], v[22:23], v[222:223], v[222:223] op_sel:[0,1,1] op_sel_hi:[1,1,1]
    v_pk_fma_f32 v[24:25], v[24:25], v[222:223], v[222:223] op_sel:[0,1,1] op_sel_hi:[1,1,1]
    v_pk_fma_f32 v[26:27], v[26:27], v[222:223], v[222:223] op_sel:[0,1,1] op_sel_hi:[1,1,1]
    v_rcp_f32 v20, v20
    v_rcp_f32 v21, v21
    v_rcp_f32 v22, v22
    v_rcp_f32 v23, v23
    v_rcp_f32 v24, v24
    v_rcp_f32 v25, v25
    v_rcp_f32 v26, v26
    v_rcp_f32 v27, v27
    v_pk_mul_f32 v[132:133], v[20:21], v[132:133]
    v_pk_mul_f32 v[134:135], v[22:23], v[134:135]
    v_pk_mul_f32 v[136:137], v[24:25], v[136:137]
    v_pk_mul_f32 v[138:139], v[26:27], v[138:139]
    v_cvt_pk_bf16_f32 v32, v132, v133
    v_cvt_pk_bf16_f32 v33, v134, v135
    v_cvt_pk_bf16_f32 v34, v136, v137
    v_cvt_pk_bf16_f32 v35, v138, v139
    buffer_store_dwordx4 v[32:35], v245, s[36:39], s45 offen offset:256 sc1
    v_pk_mul_f32 v[12:13], v[140:141], v[140:141]
    v_pk_mul_f32 v[14:15], v[142:143], v[142:143]
    v_pk_mul_f32 v[16:17], v[144:145], v[144:145]
    v_pk_mul_f32 v[18:19], v[146:147], v[146:147]
    v_pk_fma_f32 v[12:13], v[12:13], v[228:229], v[224:225] op_sel:[0,0,0] op_sel_hi:[1,0,0]
    v_pk_fma_f32 v[14:15], v[14:15], v[228:229], v[224:225] op_sel:[0,0,0] op_sel_hi:[1,0,0]
    v_pk_fma_f32 v[16:17], v[16:17], v[228:229], v[224:225] op_sel:[0,0,0] op_sel_hi:[1,0,0]
    v_pk_fma_f32 v[18:19], v[18:19], v[228:229], v[224:225] op_sel:[0,0,0] op_sel_hi:[1,0,0]
    v_pk_mul_f32 v[12:13], v[12:13], v[140:141]
    v_pk_mul_f32 v[14:15], v[14:15], v[142:143]
    v_pk_mul_f32 v[16:17], v[16:17], v[144:145]
    v_pk_mul_f32 v[18:19], v[18:19], v[146:147]
    v_exp_f32 v12, v12
    v_exp_f32 v13, v13
    v_exp_f32 v14, v14
    v_exp_f32 v15, v15
    v_exp_f32 v16, v16
    v_exp_f32 v17, v17
    v_exp_f32 v18, v18
    v_exp_f32 v19, v19
    v_pk_fma_f32 v[12:13], v[12:13], v[220:221], v[220:221] op_sel:[0,0,0] op_sel_hi:[1,0,0]
    v_pk_fma_f32 v[14:15], v[14:15], v[220:221], v[220:221] op_sel:[0,0,0] op_sel_hi:[1,0,0]
    v_pk_fma_f32 v[16:17], v[16:17], v[220:221], v[220:221] op_sel:[0,0,0] op_sel_hi:[1,0,0]
    v_pk_fma_f32 v[18:19], v[18:19], v[220:221], v[220:221] op_sel:[0,0,0] op_sel_hi:[1,0,0]
    v_rcp_f32 v12, v12
    v_rcp_f32 v13, v13
    v_rcp_f32 v14, v14
    v_rcp_f32 v15, v15
    v_rcp_f32 v16, v16
    v_rcp_f32 v17, v17
    v_rcp_f32 v18, v18
    v_rcp_f32 v19, v19
    v_pk_mul_f32 v[140:141], v[12:13], v[140:141]
    v_pk_mul_f32 v[142:143], v[14:15], v[142:143]
    v_pk_mul_f32 v[144:145], v[16:17], v[144:145]
    v_pk_mul_f32 v[146:147], v[18:19], v[146:147]
    v_cvt_pk_bf16_f32 v36, v140, v141
    v_cvt_pk_bf16_f32 v37, v142, v143
    v_cvt_pk_bf16_f32 v38, v144, v145
    v_cvt_pk_bf16_f32 v39, v146, v147
    buffer_store_dwordx4 v[36:39], v244, s[36:39], s49 offen offset:0 sc1
    buffer_load_dwordx2 v[76:77], v9, s[40:43], s21 offen offset:0 sc1
    buffer_load_dwordx2 v[78:79], v9, s[40:43], s21 offen offset:512 sc1
    buffer_load_dwordx2 v[80:81], v9, s[40:43], s21 offen offset:1024 sc1
    buffer_load_dwordx2 v[82:83], v9, s[40:43], s21 offen offset:1536 sc1
    buffer_load_dwordx2 v[84:85], v9, s[40:43], s21 offen offset:2048 sc1
    buffer_load_dwordx2 v[86:87], v9, s[40:43], s21 offen offset:2560 sc1
    buffer_load_dwordx2 v[88:89], v9, s[40:43], s21 offen offset:3072 sc1
    buffer_load_dwordx2 v[90:91], v9, s[40:43], s21 offen offset:3584 sc1
    buffer_load_dwordx2 v[92:93], v9, s[40:43], s24 offen offset:0 sc1
    buffer_load_dwordx2 v[94:95], v9, s[40:43], s24 offen offset:512 sc1
    buffer_load_dwordx2 v[96:97], v9, s[40:43], s24 offen offset:1024 sc1
    buffer_load_dwordx2 v[98:99], v9, s[40:43], s24 offen offset:1536 sc1
    buffer_load_dwordx2 v[100:101], v9, s[40:43], s24 offen offset:2048 sc1
    buffer_load_dwordx2 v[102:103], v9, s[40:43], s24 offen offset:2560 sc1
    buffer_load_dwordx2 v[104:105], v9, s[40:43], s24 offen offset:3072 sc1
    buffer_load_dwordx2 v[106:107], v9, s[40:43], s24 offen offset:3584 sc1
    buffer_load_dwordx2 v[44:45], v9, s[40:43], s25 offen offset:0 sc1
    buffer_load_dwordx2 v[46:47], v9, s[40:43], s25 offen offset:512 sc1
    buffer_load_dwordx2 v[48:49], v9, s[40:43], s25 offen offset:1024 sc1
    buffer_load_dwordx2 v[50:51], v9, s[40:43], s25 offen offset:1536 sc1
    buffer_load_dwordx2 v[52:53], v9, s[40:43], s25 offen offset:2048 sc1
    buffer_load_dwordx2 v[54:55], v9, s[40:43], s25 offen offset:2560 sc1
    buffer_load_dwordx2 v[56:57], v9, s[40:43], s25 offen offset:3072 sc1
    buffer_load_dwordx2 v[58:59], v9, s[40:43], s25 offen offset:3584 sc1
    buffer_load_dwordx2 v[108:109], v9, s[40:43], s26 offen offset:0 sc1
    buffer_load_dwordx2 v[110:111], v9, s[40:43], s26 offen offset:512 sc1
    buffer_load_dwordx2 v[112:113], v9, s[40:43], s26 offen offset:1024 sc1
    buffer_load_dwordx2 v[114:115], v9, s[40:43], s26 offen offset:1536 sc1
    buffer_load_dwordx2 v[116:117], v9, s[40:43], s26 offen offset:2048 sc1
    buffer_load_dwordx2 v[118:119], v9, s[40:43], s26 offen offset:2560 sc1
    buffer_load_dwordx2 v[120:121], v9, s[40:43], s26 offen offset:3072 sc1
    buffer_load_dwordx2 v[122:123], v9, s[40:43], s26 offen offset:3584 sc1
    v_pk_mul_f32 v[20:21], v[148:149], v[148:149]
    v_pk_mul_f32 v[22:23], v[150:151], v[150:151]
    v_pk_mul_f32 v[24:25], v[152:153], v[152:153]
    v_pk_mul_f32 v[26:27], v[154:155], v[154:155]
    v_pk_fma_f32 v[20:21], v[20:21], v[228:229], v[224:225] op_sel:[0,1,1] op_sel_hi:[1,1,1]
    v_pk_fma_f32 v[22:23], v[22:23], v[228:229], v[224:225] op_sel:[0,1,1] op_sel_hi:[1,1,1]
    v_pk_fma_f32 v[24:25], v[24:25], v[228:229], v[224:225] op_sel:[0,1,1] op_sel_hi:[1,1,1]
    v_pk_fma_f32 v[26:27], v[26:27], v[228:229], v[224:225] op_sel:[0,1,1] op_sel_hi:[1,1,1]
    v_pk_mul_f32 v[20:21], v[20:21], v[148:149]
    v_pk_mul_f32 v[22:23], v[22:23], v[150:151]
    v_pk_mul_f32 v[24:25], v[24:25], v[152:153]
    v_pk_mul_f32 v[26:27], v[26:27], v[154:155]
    v_exp_f32 v20, v20
    v_exp_f32 v21, v21
    v_exp_f32 v22, v22
    v_exp_f32 v23, v23
    v_exp_f32 v24, v24
    v_exp_f32 v25, v25
    v_exp_f32 v26, v26
    v_exp_f32 v27, v27
    v_pk_fma_f32 v[20:21], v[20:21], v[220:221], v[220:221] op_sel:[0,1,1] op_sel_hi:[1,1,1]
    v_pk_fma_f32 v[22:23], v[22:23], v[220:221], v[220:221] op_sel:[0,1,1] op_sel_hi:[1,1,1]
    v_pk_fma_f32 v[24:25], v[24:25], v[220:221], v[220:221] op_sel:[0,1,1] op_sel_hi:[1,1,1]
    v_pk_fma_f32 v[26:27], v[26:27], v[220:221], v[220:221] op_sel:[0,1,1] op_sel_hi:[1,1,1]
    v_rcp_f32 v20, v20
    v_rcp_f32 v21, v21
    v_rcp_f32 v22, v22
    v_rcp_f32 v23, v23
    v_rcp_f32 v24, v24
    v_rcp_f32 v25, v25
    v_rcp_f32 v26, v26
    v_rcp_f32 v27, v27
    v_pk_mul_f32 v[148:149], v[20:21], v[148:149]
    v_pk_mul_f32 v[150:151], v[22:23], v[150:151]
    v_pk_mul_f32 v[152:153], v[24:25], v[152:153]
    v_pk_mul_f32 v[154:155], v[26:27], v[154:155]
    v_cvt_pk_bf16_f32 v40, v148, v149
    v_cvt_pk_bf16_f32 v41, v150, v151
    v_cvt_pk_bf16_f32 v42, v152, v153
    v_cvt_pk_bf16_f32 v43, v154, v155
    buffer_store_dwordx4 v[40:43], v244, s[36:39], s49 offen offset:256 sc1
    v_pk_mul_f32 v[12:13], v[156:157], v[156:157]
    v_pk_mul_f32 v[14:15], v[158:159], v[158:159]
    v_pk_mul_f32 v[16:17], v[160:161], v[160:161]
    v_pk_mul_f32 v[18:19], v[162:163], v[162:163]
    v_pk_fma_f32 v[12:13], v[12:13], v[230:231], v[226:227] op_sel:[0,0,0] op_sel_hi:[1,0,0]
    v_pk_fma_f32 v[14:15], v[14:15], v[230:231], v[226:227] op_sel:[0,0,0] op_sel_hi:[1,0,0]
    v_pk_fma_f32 v[16:17], v[16:17], v[230:231], v[226:227] op_sel:[0,0,0] op_sel_hi:[1,0,0]
    v_pk_fma_f32 v[18:19], v[18:19], v[230:231], v[226:227] op_sel:[0,0,0] op_sel_hi:[1,0,0]
    v_pk_mul_f32 v[12:13], v[12:13], v[156:157]
    v_pk_mul_f32 v[14:15], v[14:15], v[158:159]
    v_pk_mul_f32 v[16:17], v[16:17], v[160:161]
    v_pk_mul_f32 v[18:19], v[18:19], v[162:163]
    v_exp_f32 v12, v12
    v_exp_f32 v13, v13
    v_exp_f32 v14, v14
    v_exp_f32 v15, v15
    v_exp_f32 v16, v16
    v_exp_f32 v17, v17
    v_exp_f32 v18, v18
    v_exp_f32 v19, v19
    v_pk_fma_f32 v[12:13], v[12:13], v[222:223], v[222:223] op_sel:[0,0,0] op_sel_hi:[1,0,0]
    v_pk_fma_f32 v[14:15], v[14:15], v[222:223], v[222:223] op_sel:[0,0,0] op_sel_hi:[1,0,0]
    v_pk_fma_f32 v[16:17], v[16:17], v[222:223], v[222:223] op_sel:[0,0,0] op_sel_hi:[1,0,0]
    v_pk_fma_f32 v[18:19], v[18:19], v[222:223], v[222:223] op_sel:[0,0,0] op_sel_hi:[1,0,0]
    v_rcp_f32 v12, v12
    v_rcp_f32 v13, v13
    v_rcp_f32 v14, v14
    v_rcp_f32 v15, v15
    v_rcp_f32 v16, v16
    v_rcp_f32 v17, v17
    v_rcp_f32 v18, v18
    v_rcp_f32 v19, v19
    v_pk_mul_f32 v[156:157], v[12:13], v[156:157]
    v_pk_mul_f32 v[158:159], v[14:15], v[158:159]
    v_pk_mul_f32 v[160:161], v[16:17], v[160:161]
    v_pk_mul_f32 v[162:163], v[18:19], v[162:163]
    v_cvt_pk_bf16_f32 v28, v156, v157
    v_cvt_pk_bf16_f32 v29, v158, v159
    v_cvt_pk_bf16_f32 v30, v160, v161
    v_cvt_pk_bf16_f32 v31, v162, v163
    buffer_store_dwordx4 v[28:31], v245, s[36:39], s49 offen offset:0 sc1
    v_pk_mul_f32 v[20:21], v[164:165], v[164:165]
    v_pk_mul_f32 v[22:23], v[166:167], v[166:167]
    v_pk_mul_f32 v[24:25], v[168:169], v[168:169]
    v_pk_mul_f32 v[26:27], v[170:171], v[170:171]
    v_pk_fma_f32 v[20:21], v[20:21], v[230:231], v[226:227] op_sel:[0,1,1] op_sel_hi:[1,1,1]
    v_pk_fma_f32 v[22:23], v[22:23], v[230:231], v[226:227] op_sel:[0,1,1] op_sel_hi:[1,1,1]
    v_pk_fma_f32 v[24:25], v[24:25], v[230:231], v[226:227] op_sel:[0,1,1] op_sel_hi:[1,1,1]
    v_pk_fma_f32 v[26:27], v[26:27], v[230:231], v[226:227] op_sel:[0,1,1] op_sel_hi:[1,1,1]
    v_pk_mul_f32 v[20:21], v[20:21], v[164:165]
    v_pk_mul_f32 v[22:23], v[22:23], v[166:167]
    v_pk_mul_f32 v[24:25], v[24:25], v[168:169]
    v_pk_mul_f32 v[26:27], v[26:27], v[170:171]
    v_exp_f32 v20, v20
    v_exp_f32 v21, v21
    v_exp_f32 v22, v22
    v_exp_f32 v23, v23
    v_exp_f32 v24, v24
    v_exp_f32 v25, v25
    v_exp_f32 v26, v26
    v_exp_f32 v27, v27
    v_pk_fma_f32 v[20:21], v[20:21], v[222:223], v[222:223] op_sel:[0,1,1] op_sel_hi:[1,1,1]
    v_pk_fma_f32 v[22:23], v[22:23], v[222:223], v[222:223] op_sel:[0,1,1] op_sel_hi:[1,1,1]
    v_pk_fma_f32 v[24:25], v[24:25], v[222:223], v[222:223] op_sel:[0,1,1] op_sel_hi:[1,1,1]
    v_pk_fma_f32 v[26:27], v[26:27], v[222:223], v[222:223] op_sel:[0,1,1] op_sel_hi:[1,1,1]
    v_rcp_f32 v20, v20
    v_rcp_f32 v21, v21
    v_rcp_f32 v22, v22
    v_rcp_f32 v23, v23
    v_rcp_f32 v24, v24
    v_rcp_f32 v25, v25
    v_rcp_f32 v26, v26
    v_rcp_f32 v27, v27
    v_pk_mul_f32 v[164:165], v[20:21], v[164:165]
    v_pk_mul_f32 v[166:167], v[22:23], v[166:167]
    v_pk_mul_f32 v[168:169], v[24:25], v[168:169]
    v_pk_mul_f32 v[170:171], v[26:27], v[170:171]
    v_cvt_pk_bf16_f32 v32, v164, v165
    v_cvt_pk_bf16_f32 v33, v166, v167
    v_cvt_pk_bf16_f32 v34, v168, v169
    v_cvt_pk_bf16_f32 v35, v170, v171
    buffer_store_dwordx4 v[32:35], v245, s[36:39], s49 offen offset:256 sc1
    s_mov_b32 s23, 200000
    s_waitcnt vmcnt(31)
    v_max_u32 v64, v76, v78
    v_pk_add_f32 v[66:67], v[76:77], v[78:79]
    v_max3_u32 v64, v64, v80, v82
    v_pk_add_f32 v[68:69], v[80:81], v[82:83]
    s_waitcnt vmcnt(27)
    v_max3_u32 v64, v64, v84, v86
    v_pk_add_f32 v[66:67], v[66:67], v[84:85]
    v_pk_add_f32 v[68:69], v[68:69], v[86:87]
    v_max3_u32 v64, v64, v88, v90
    v_pk_add_f32 v[66:67], v[66:67], v[88:89]
    v_pk_add_f32 v[68:69], v[68:69], v[90:91]
    s_waitcnt vmcnt(23)
    v_max3_u32 v64, v64, v92, v94
    v_pk_add_f32 v[66:67], v[66:67], v[92:93]
    v_pk_add_f32 v[68:69], v[68:69], v[94:95]
    v_max3_u32 v64, v64, v96, v98
    v_pk_add_f32 v[66:67], v[66:67], v[96:97]
    v_pk_add_f32 v[68:69], v[68:69], v[98:99]
    s_waitcnt vmcnt(19)
    v_max3_u32 v64, v64, v100, v102
    v_pk_add_f32 v[66:67], v[66:67], v[100:101]
    v_pk_add_f32 v[68:69], v[68:69], v[102:103]
    v_max3_u32 v64, v64, v104, v106
    v_pk_add_f32 v[66:67], v[66:67], v[104:105]
    v_pk_add_f32 v[68:69], v[68:69], v[106:107]
    s_waitcnt vmcnt(15)
    v_max3_u32 v64, v64, v44, v46
    v_pk_add_f32 v[66:67], v[66:67], v[44:45]
    v_pk_add_f32 v[68:69], v[68:69], v[46:47]
    v_max3_u32 v64, v64, v48, v50
    v_pk_add_f32 v[66:67], v[66:67], v[48:49]
    v_pk_add_f32 v[68:69], v[68:69], v[50:51]
    s_waitcnt vmcnt(11)
    v_max3_u32 v64, v64, v52, v54
    v_pk_add_f32 v[66:67], v[66:67], v[52:53]
    v_pk_add_f32 v[68:69], v[68:69], v[54:55]
    v_max3_u32 v64, v64, v56, v58
    v_pk_add_f32 v[66:67], v[66:67], v[56:57]
    v_pk_add_f32 v[68:69], v[68:69], v[58:59]
    s_waitcnt vmcnt(7)
    v_max3_u32 v64, v64, v108, v110
    v_pk_add_f32 v[66:67], v[66:67], v[108:109]
    v_pk_add_f32 v[68:69], v[68:69], v[110:111]
    v_max3_u32 v64, v64, v112, v114
    v_pk_add_f32 v[66:67], v[66:67], v[112:113]
    v_pk_add_f32 v[68:69], v[68:69], v[114:115]
    s_waitcnt vmcnt(3)
    v_max3_u32 v64, v64, v116, v118
    v_pk_add_f32 v[66:67], v[66:67], v[116:117]
    v_pk_add_f32 v[68:69], v[68:69], v[118:119]
    v_max3_u32 v64, v64, v120, v122
    v_pk_add_f32 v[66:67], v[66:67], v[120:121]
    v_pk_add_f32 v[68:69], v[68:69], v[122:123]
    v_cmp_eq_u32 vcc, -1, v64
    s_sub_u32 s23, s23, 1
    v_pk_add_f32 v[66:67], v[66:67], v[68:69]
    s_nop 2
    s_cbranch_vccz k3done_9
k3poll_8:
    buffer_load_dwordx2 v[76:77], v9, s[40:43], s21 offen offset:0 sc1
    buffer_load_dwordx2 v[78:79], v9, s[40:43], s21 offen offset:512 sc1
    buffer_load_dwordx2 v[80:81], v9, s[40:43], s21 offen offset:1024 sc1
    buffer_load_dwordx2 v[82:83], v9, s[40:43], s21 offen offset:1536 sc1
    buffer_load_dwordx2 v[84:85], v9, s[40:43], s21 offen offset:2048 sc1
    buffer_load_dwordx2 v[86:87], v9, s[40:43], s21 offen offset:2560 sc1
    buffer_load_dwordx2 v[88:89], v9, s[40:43], s21 offen offset:3072 sc1
    buffer_load_dwordx2 v[90:91], v9, s[40:43], s21 offen offset:3584 sc1
    buffer_load_dwordx2 v[92:93], v9, s[40:43], s24 offen offset:0 sc1
    buffer_load_dwordx2 v[94:95], v9, s[40:43], s24 offen offset:512 sc1
    buffer_load_dwordx2 v[96:97], v9, s[40:43], s24 offen offset:1024 sc1
    buffer_load_dwordx2 v[98:99], v9, s[40:43], s24 offen offset:1536 sc1
    buffer_load_dwordx2 v[100:101], v9, s[40:43], s24 offen offset:2048 sc1
    buffer_load_dwordx2 v[102:103], v9, s[40:43], s24 offen offset:2560 sc1
    buffer_load_dwordx2 v[104:105], v9, s[40:43], s24 offen offset:3072 sc1
    buffer_load_dwordx2 v[106:107], v9, s[40:43], s24 offen offset:3584 sc1
    buffer_load_dwordx2 v[44:45], v9, s[40:43], s25 offen offset:0 sc1
    buffer_load_dwordx2 v[46:47], v9, s[40:43], s25 offen offset:512 sc1
    buffer_load_dwordx2 v[48:49], v9, s[40:43], s25 offen offset:1024 sc1
    buffer_load_dwordx2 v[50:51], v9, s[40:43], s25 offen offset:1536 sc1
    buffer_load_dwordx2 v[52:53], v9, s[40:43], s25 offen offset:2048 sc1
    buffer_load_dwordx2 v[54:55], v9, s[40:43], s25 offen offset:2560 sc1
    buffer_load_dwordx2 v[56:57], v9, s[40:43], s25 offen offset:3072 sc1
    buffer_load_dwordx2 v[58:59], v9, s[40:43], s25 offen offset:3584 sc1
    buffer_load_dwordx2 v[108:109], v9, s[40:43], s26 offen offset:0 sc1
    buffer_load_dwordx2 v[110:111], v9, s[40:43], s26 offen offset:512 sc1
    buffer_load_dwordx2 v[112:113], v9, s[40:43], s26 offen offset:1024 sc1
    buffer_load_dwordx2 v[114:115], v9, s[40:43], s26 offen offset:1536 sc1
    buffer_load_dwordx2 v[116:117], v9, s[40:43], s26 offen offset:2048 sc1
    buffer_load_dwordx2 v[118:119], v9, s[40:43], s26 offen offset:2560 sc1
    buffer_load_dwordx2 v[120:121], v9, s[40:43], s26 offen offset:3072 sc1
    buffer_load_dwordx2 v[122:123], v9, s[40:43], s26 offen offset:3584 sc1
    s_waitcnt vmcnt(28)
    v_max_u32 v64, v76, v78
    v_pk_add_f32 v[66:67], v[76:77], v[78:79]
    v_max3_u32 v64, v64, v80, v82
    v_pk_add_f32 v[68:69], v[80:81], v[82:83]
    s_waitcnt vmcnt(24)
    v_max3_u32 v64, v64, v84, v86
    v_pk_add_f32 v[66:67], v[66:67], v[84:85]
    v_pk_add_f32 v[68:69], v[68:69], v[86:87]
    v_max3_u32 v64, v64, v88, v90
    v_pk_add_f32 v[66:67], v[66:67], v[88:89]
    v_pk_add_f32 v[68:69], v[68:69], v[90:91]
    s_waitcnt vmcnt(20)
    v_max3_u32 v64, v64, v92, v94
    v_pk_add_f32 v[66:67], v[66:67], v[92:93]
    v_pk_add_f32 v[68:69], v[68:69], v[94:95]
    v_max3_u32 v64, v64, v96, v98
    v_pk_add_f32 v[66:67], v[66:67], v[96:97]
    v_pk_add_f32 v[68:69], v[68:69], v[98:99]
    s_waitcnt vmcnt(16)
    v_max3_u32 v64, v64, v100, v102
    v_pk_add_f32 v[66:67], v[66:67], v[100:101]
    v_pk_add_f32 v[68:69], v[68:69], v[102:103]
    v_max3_u32 v64, v64, v104, v106
    v_pk_add_f32 v[66:67], v[66:67], v[104:105]
    v_pk_add_f32 v[68:69], v[68:69], v[106:107]
    s_waitcnt vmcnt(12)
    v_max3_u32 v64, v64, v44, v46
    v_pk_add_f32 v[66:67], v[66:67], v[44:45]
    v_pk_add_f32 v[68:69], v[68:69], v[46:47]
    v_max3_u32 v64, v64, v48, v50
    v_pk_add_f32 v[66:67], v[66:67], v[48:49]
    v_pk_add_f32 v[68:69], v[68:69], v[50:51]
    s_waitcnt vmcnt(8)
    v_max3_u32 v64, v64, v52, v54
    v_pk_add_f32 v[66:67], v[66:67], v[52:53]
    v_pk_add_f32 v[68:69], v[68:69], v[54:55]
    v_max3_u32 v64, v64, v56, v58
    v_pk_add_f32 v[66:67], v[66:67], v[56:57]
    v_pk_add_f32 v[68:69], v[68:69], v[58:59]
    s_waitcnt vmcnt(4)
    v_max3_u32 v64, v64, v108, v110
    v_pk_add_f32 v[66:67], v[66:67], v[108:109]
    v_pk_add_f32 v[68:69], v[68:69], v[110:111]
    v_max3_u32 v64, v64, v112, v114
    v_pk_add_f32 v[66:67], v[66:67], v[112:113]
    v_pk_add_f32 v[68:69], v[68:69], v[114:115]
    s_waitcnt vmcnt(0)
    v_max3_u32 v64, v64, v116, v118
    v_pk_add_f32 v[66:67], v[66:67], v[116:117]
    v_pk_add_f32 v[68:69], v[68:69], v[118:119]
    v_max3_u32 v64, v64, v120, v122
    v_pk_add_f32 v[66:67], v[66:67], v[120:121]
    v_pk_add_f32 v[68:69], v[68:69], v[122:123]
    v_cmp_eq_u32 vcc, -1, v64
    s_sub_u32 s23, s23, 1
    v_pk_add_f32 v[66:67], v[66:67], v[68:69]
    s_cmp_eq_u32 s23, 0
    s_cbranch_scc1 k3done_9
    s_nop 0
    s_cbranch_vccnz k3poll_8
k3done_9:
    v_mul_f32 v66, 0x3a124925, v66
    v_mul_f32 v67, 0x3a124925, v67
    v_fma_f32 v67, -v66, v66, v67
    v_max_f32 v67, 0, v67
    v_cvt_pk_bf16_f32 v67, v67, v67
    v_and_b32 v67, 0xffff0000, v67
    v_add_f32 v67, 0x3727c5ac, v67
    v_cvt_pk_bf16_f32 v67, v67, v67
    v_and_b32 v67, 0xffff0000, v67
    v_sqrt_f32 v67, v67
    s_nop 0
    v_cvt_pk_bf16_f32 v67, v67, v67
    v_and_b32 v67, 0xffff0000, v67
    v_rcp_f32 v224, v67
    v_cvt_pk_bf16_f32 v66, v66, v66
    v_and_b32 v66, 0xffff0000, v66
    v_mul_f32 v228, v66, v224
    v_sub_f32 v228, 0, v228
    v_mov_b32 v225, v224
    s_nop 1
    v_permlane16_swap_b32 v224, v225
    v_mov_b32 v226, v224
    v_mov_b32 v227, v225
    s_nop 0
    v_permlane32_swap_b32 v224, v226
    v_permlane32_swap_b32 v225, v227
    v_mov_b32 v229, v228
    s_nop 1
    v_permlane16_swap_b32 v228, v229
    v_mov_b32 v230, v228
    v_mov_b32 v231, v229
    s_nop 0
    v_permlane32_swap_b32 v228, v230
    v_permlane32_swap_b32 v229, v231
    v_pk_fma_f32 v[172:173], v[172:173], v[224:225], v[228:229] op_sel:[0,0,0] op_sel_hi:[1,0,0]
    v_pk_fma_f32 v[174:175], v[174:175], v[224:225], v[228:229] op_sel:[0,0,0] op_sel_hi:[1,0,0]
    v_pk_fma_f32 v[176:177], v[176:177], v[224:225], v[228:229] op_sel:[0,0,0] op_sel_hi:[1,0,0]
    v_pk_fma_f32 v[178:179], v[178:179], v[224:225], v[228:229] op_sel:[0,0,0] op_sel_hi:[1,0,0]
    v_cvt_pk_bf16_f32 v36, v172, v173
    v_cvt_pk_bf16_f32 v37, v174, v175
    v_cvt_pk_bf16_f32 v38, v176, v177
    v_cvt_pk_bf16_f32 v39, v178, v179
    buffer_store_dwordx4 v[36:39], v244, s[36:39], s47 offen offset:0 sc0 sc1
    v_pk_fma_f32 v[180:181], v[180:181], v[224:225], v[228:229] op_sel:[0,1,1] op_sel_hi:[1,1,1]
    v_pk_fma_f32 v[182:183], v[182:183], v[224:225], v[228:229] op_sel:[0,1,1] op_sel_hi:[1,1,1]
    v_pk_fma_f32 v[184:185], v[184:185], v[224:225], v[228:229] op_sel:[0,1,1] op_sel_hi:[1,1,1]
    v_pk_fma_f32 v[186:187], v[186:187], v[224:225], v[228:229] op_sel:[0,1,1] op_sel_hi:[1,1,1]
    v_cvt_pk_bf16_f32 v40, v180, v181
    v_cvt_pk_bf16_f32 v41, v182, v183
    v_cvt_pk_bf16_f32 v42, v184, v185
    v_cvt_pk_bf16_f32 v43, v186, v187
    buffer_store_dwordx4 v[40:43], v244, s[36:39], s47 offen offset:256 sc0 sc1
    v_pk_fma_f32 v[188:189], v[188:189], v[226:227], v[230:231] op_sel:[0,0,0] op_sel_hi:[1,0,0]
    v_pk_fma_f32 v[190:191], v[190:191], v[226:227], v[230:231] op_sel:[0,0,0] op_sel_hi:[1,0,0]
    v_pk_fma_f32 v[192:193], v[192:193], v[226:227], v[230:231] op_sel:[0,0,0] op_sel_hi:[1,0,0]
    v_pk_fma_f32 v[194:195], v[194:195], v[226:227], v[230:231] op_sel:[0,0,0] op_sel_hi:[1,0,0]
    v_cvt_pk_bf16_f32 v28, v188, v189
    v_cvt_pk_bf16_f32 v29, v190, v191
    v_cvt_pk_bf16_f32 v30, v192, v193
    v_cvt_pk_bf16_f32 v31, v194, v195
    buffer_store_dwordx4 v[28:31], v245, s[36:39], s47 offen offset:0 sc0 sc1
    v_pk_fma_f32 v[196:197], v[196:197], v[226:227], v[230:231] op_sel:[0,1,1] op_sel_hi:[1,1,1]
    v_pk_fma_f32 v[198:199], v[198:199], v[226:227], v[230:231] op_sel:[0,1,1] op_sel_hi:[1,1,1]
    v_pk_fma_f32 v[200:201], v[200:201], v[226:227], v[230:231] op_sel:[0,1,1] op_sel_hi:[1,1,1]
    v_pk_fma_f32 v[202:203], v[202:203], v[226:227], v[230:231] op_sel:[0,1,1] op_sel_hi:[1,1,1]
    v_cvt_pk_bf16_f32 v32, v196, v197
    v_cvt_pk_bf16_f32 v33, v198, v199
    v_cvt_pk_bf16_f32 v34, v200, v201
    v_cvt_pk_bf16_f32 v35, v202, v203
    buffer_store_dwordx4 v[32:35], v245, s[36:39], s47 offen offset:256 sc0 sc1
    v_pk_fma_f32 v[204:205], v[204:205], v[224:225], v[228:229] op_sel:[0,0,0] op_sel_hi:[1,0,0]
    v_pk_fma_f32 v[206:207], v[206:207], v[224:225], v[228:229] op_sel:[0,0,0] op_sel_hi:[1,0,0]
    v_pk_fma_f32 v[208:209], v[208:209], v[224:225], v[228:229] op_sel:[0,0,0] op_sel_hi:[1,0,0]
    v_pk_fma_f32 v[210:211], v[210:211], v[224:225], v[228:229] op_sel:[0,0,0] op_sel_hi:[1,0,0]
    v_cvt_pk_bf16_f32 v36, v204, v205
    v_cvt_pk_bf16_f32 v37, v206, v207
    v_cvt_pk_bf16_f32 v38, v208, v209
    v_cvt_pk_bf16_f32 v39, v210, v211
    buffer_store_dwordx4 v[36:39], v244, s[36:39], s46 offen offset:0 sc0 sc1
    v_pk_fma_f32 v[212:213], v[212:213], v[224:225], v[228:229] op_sel:[0,1,1] op_sel_hi:[1,1,1]
    v_pk_fma_f32 v[214:215], v[214:215], v[224:225], v[228:229] op_sel:[0,1,1] op_sel_hi:[1,1,1]
    v_pk_fma_f32 v[216:217], v[216:217], v[224:225], v[228:229] op_sel:[0,1,1] op_sel_hi:[1,1,1]
    v_pk_fma_f32 v[218:219], v[218:219], v[224:225], v[228:229] op_sel:[0,1,1] op_sel_hi:[1,1,1]
    v_cvt_pk_bf16_f32 v40, v212, v213
    v_cvt_pk_bf16_f32 v41, v214, v215
    v_cvt_pk_bf16_f32 v42, v216, v217
    v_cvt_pk_bf16_f32 v43, v218, v219
    buffer_store_dwordx4 v[40:43], v244, s[36:39], s46 offen offset:256 sc0 sc1
k3_kernel_fin:
    s_endpgm
k3_kernel_prod:
    v_and_b32 v2, 63, v0
    v_lshrrev_b32 v3, 3, v2
    v_and_b32 v4, 7, v2
    s_sub_u32 s17, s16, 4
    s_lshl_b32 s18, s14, 7
    s_lshl_b32 s60, s17, 16
    s_lshl_b32 s61, s18, 4
    s_add_u32 s60, s60, s61
    v_lshlrev_b32 v8, 4, v2
    v_add_u32 v8, s60, v8
    v_add_u32 v9, 30720, v8
    s_lshl_b32 s19, s10, 6
    s_lshl_b32 s60, s17, 4
    v_add_u32 v5, s60, v3
    s_mov_b32 s61, 7168
    v_mul_lo_u32 v10, v5, s61
    v_add_u32 v10, s19, v10
    v_bfe_u32 v6, v5, 1, 1
    v_lshlrev_b32 v6, 2, v6
    v_bfe_u32 v5, v5, 2, 1
    v_lshl_or_b32 v6, v5, 1, v6
    v_xor_b32 v6, v6, v4
    v_lshl_add_u32 v10, v6, 4, v10
    v_add_u32 v11, 56320, v10
    s_sub_u32 s19, s13, s10
    s_lshl_b32 s19, s19, 6
    s_add_u32 s19, s19, 256
    v_add_u32 v12, 128, v10
    v_add_u32 v14, s19, v10
    v_add_u32 v13, 128, v11
    v_add_u32 v15, s19, v11
    v_lshrrev_b32 v5, 2, v2
    s_lshl_b32 s60, s17, 4
    v_add_u32 v5, s60, v5
    s_mov_b32 s61, 7168
    v_mul_lo_u32 v16, v5, s61
    v_bfe_u32 v5, v2, 4, 1
    v_lshlrev_b32 v5, 1, v5
    v_and_b32 v6, 3, v2
    v_xor_b32 v5, v5, v6
    v_lshl_add_u32 v16, v5, 4, v16
    s_lshl_b32 s19, s11, 6
    v_add_u32 v16, s19, v16
    s_lshl_b32 s40, s17, 11
    s_lshl_b32 s43, s17, 12
    s_lshl_b32 s44, s17, 10
    s_waitcnt lgkmcnt(0)
    s_add_u32 s20, s4, 44040192
    s_addc_u32 s21, s5, 0
    s_and_b32 s21, s21, 0xffff
    s_mov_b32 s22, 4194304
    s_mov_b32 s23, 0x00020000
    s_mov_b32 s24, s8
    s_and_b32 s25, s9, 0xffff
    s_mov_b32 s26, 7340032
    s_mov_b32 s27, 0x00020000
    s_mov_b32 s28, s50
    s_and_b32 s29, s51, 0xffff
    s_mov_b32 s30, 8388608
    s_mov_b32 s31, 0x00020000
    s_mov_b32 s32, s52
    s_and_b32 s33, s53, 0xffff
    s_mov_b32 s34, 3670016
    s_mov_b32 s35, 0x00020000
    v_lshlrev_b32 v17, 6, v2
    s_lshl_b32 s46, s2, 2
    s_add_u32 s46, s46, s17
    s_lshl_b32 s46, s46, 12
    s_lshl_b32 s12, s2, 2
    s_add_u32 s12, s12, s17
    s_mul_i32 s12, s12, 4096
    s_add_u32 s12, s12, 2097152
    s_mov_b32 s42, 0
    s_add_u32 m0, s40, 49152
    s_nop 0
    buffer_load_dwordx4 v10, s[24:27], s42 offen offset:0 lds
    buffer_load_dwordx4 v11, s[24:27], s42 offen offset:1024 lds
    s_add_u32 m0, s40, 57344
    s_nop 0
    buffer_load_dwordx4 v12, s[24:27], s42 offen offset:0 lds
    buffer_load_dwordx4 v13, s[24:27], s42 offen offset:1024 lds
    s_add_u32 m0, s40, 65536
    s_nop 0
    buffer_load_dwordx4 v14, s[24:27], s42 offen offset:0 lds
    buffer_load_dwordx4 v15, s[24:27], s42 offen offset:1024 lds
    s_add_u32 m0, s44, 73728
    s_nop 0
    buffer_load_dwordx4 v16, s[24:27], s42 offen lds
    s_add_u32 m0, s43, 0
    s_mov_b32 s41, 0
    buffer_load_dwordx4 v8, s[20:23], s41 offen offset:0 lds
    buffer_load_dwordx4 v8, s[20:23], s41 offen offset:1024 lds
    buffer_load_dwordx4 v9, s[20:23], s41 offen offset:2048 lds
    buffer_load_dwordx4 v9, s[20:23], s41 offen offset:3072 lds
    s_mov_b32 s42, 458752
    s_add_u32 m0, s40, 77824
    s_nop 0
    buffer_load_dwordx4 v10, s[24:27], s42 offen offset:0 lds
    buffer_load_dwordx4 v11, s[24:27], s42 offen offset:1024 lds
    s_add_u32 m0, s40, 86016
    s_nop 0
    buffer_load_dwordx4 v12, s[24:27], s42 offen offset:0 lds
    buffer_load_dwordx4 v13, s[24:27], s42 offen offset:1024 lds
    s_add_u32 m0, s40, 94208
    s_nop 0
    buffer_load_dwordx4 v14, s[24:27], s42 offen offset:0 lds
    buffer_load_dwordx4 v15, s[24:27], s42 offen offset:1024 lds
    s_add_u32 m0, s44, 102400
    s_nop 0
    buffer_load_dwordx4 v16, s[24:27], s42 offen lds
    s_add_u32 m0, s43, 16384
    s_mov_b32 s41, 262144
    buffer_load_dwordx4 v8, s[20:23], s41 offen offset:0 lds
    buffer_load_dwordx4 v8, s[20:23], s41 offen offset:1024 lds
    buffer_load_dwordx4 v9, s[20:23], s41 offen offset:2048 lds
    buffer_load_dwordx4 v9, s[20:23], s41 offen offset:3072 lds
    s_waitcnt vmcnt(11)
    s_barrier
    s_mov_b32 s42, 917504
    s_add_u32 m0, s40, 106496
    s_nop 0
    buffer_load_dwordx4 v10, s[24:27], s42 offen offset:0 lds
    buffer_load_dwordx4 v11, s[24:27], s42 offen offset:1024 lds
    s_add_u32 m0, s40, 114688
    s_nop 0
    buffer_load_dwordx4 v12, s[24:27], s42 offen offset:0 lds
    buffer_load_dwordx4 v13, s[24:27], s42 offen offset:1024 lds
    s_add_u32 m0, s40, 122880
    s_nop 0
    buffer_load_dwordx4 v14, s[24:27], s42 offen offset:0 lds
    buffer_load_dwordx4 v15, s[24:27], s42 offen offset:1024 lds
    s_add_u32 m0, s44, 131072
    s_nop 0
    buffer_load_dwordx4 v16, s[24:27], s42 offen lds
    s_add_u32 m0, s43, 32768
    s_mov_b32 s41, 524288
    buffer_load_dwordx4 v8, s[20:23], s41 offen offset:0 lds
    buffer_load_dwordx4 v8, s[20:23], s41 offen offset:1024 lds
    buffer_load_dwordx4 v9, s[20:23], s41 offen offset:2048 lds
    buffer_load_dwordx4 v9, s[20:23], s41 offen offset:3072 lds
    s_mov_b32 s42, 1376256
    s_add_u32 m0, s40, 135168
    s_nop 0
    buffer_load_dwordx4 v10, s[24:27], s42 offen offset:0 lds
    buffer_load_dwordx4 v11, s[24:27], s42 offen offset:1024 lds
    s_add_u32 m0, s40, 143360
    s_nop 0
    buffer_load_dwordx4 v12, s[24:27], s42 offen offset:0 lds
    buffer_load_dwordx4 v13, s[24:27], s42 offen offset:1024 lds
    s_add_u32 m0, s40, 151552
    s_nop 0
    buffer_load_dwordx4 v14, s[24:27], s42 offen offset:0 lds
    buffer_load_dwordx4 v15, s[24:27], s42 offen offset:1024 lds
    s_add_u32 m0, s44, 159744
    s_nop 0
    buffer_load_dwordx4 v16, s[24:27], s42 offen lds
    s_buffer_load_dword s13, s[28:31], s12 offset:0
    s_buffer_load_dword s13, s[28:31], s12 offset:64
    s_buffer_load_dword s13, s[28:31], s12 offset:128
    s_buffer_load_dword s13, s[28:31], s12 offset:192
    s_waitcnt vmcnt(18)
    s_barrier
    s_add_u32 m0, s43, 0
    s_mov_b32 s41, 786432
    buffer_load_dwordx4 v8, s[20:23], s41 offen offset:0 lds
    buffer_load_dwordx4 v8, s[20:23], s41 offen offset:1024 lds
    buffer_load_dwordx4 v9, s[20:23], s41 offen offset:2048 lds
    buffer_load_dwordx4 v9, s[20:23], s41 offen offset:3072 lds
    s_mov_b32 s42, 1835008
    s_add_u32 m0, s40, 49152
    s_nop 0
    buffer_load_dwordx4 v10, s[24:27], s42 offen offset:0 lds
    buffer_load_dwordx4 v11, s[24:27], s42 offen offset:1024 lds
    s_add_u32 m0, s40, 57344
    s_nop 0
    buffer_load_dwordx4 v12, s[24:27], s42 offen offset:0 lds
    buffer_load_dwordx4 v13, s[24:27], s42 offen offset:1024 lds
    s_add_u32 m0, s40, 65536
    s_nop 0
    buffer_load_dwordx4 v14, s[24:27], s42 offen offset:0 lds
    buffer_load_dwordx4 v15, s[24:27], s42 offen offset:1024 lds
    s_add_u32 m0, s44, 73728
    s_nop 0
    buffer_load_dwordx4 v16, s[24:27], s42 offen lds
    s_buffer_load_dword s13, s[28:31], s12 offset:256
    s_buffer_load_dword s13, s[28:31], s12 offset:320
    s_buffer_load_dword s13, s[28:31], s12 offset:384
    s_buffer_load_dword s13, s[28:31], s12 offset:448
    s_waitcnt vmcnt(18)
    s_barrier
    s_add_u32 m0, s43, 16384
    s_mov_b32 s41, 1048576
    buffer_load_dwordx4 v8, s[20:23], s41 offen offset:0 lds
    buffer_load_dwordx4 v8, s[20:23], s41 offen offset:1024 lds
    buffer_load_dwordx4 v9, s[20:23], s41 offen offset:2048 lds
    buffer_load_dwordx4 v9, s[20:23], s41 offen offset:3072 lds
    s_mov_b32 s42, 2293760
    s_add_u32 m0, s40, 77824
    s_nop 0
    buffer_load_dwordx4 v10, s[24:27], s42 offen offset:0 lds
    buffer_load_dwordx4 v11, s[24:27], s42 offen offset:1024 lds
    s_add_u32 m0, s40, 86016
    s_nop 0
    buffer_load_dwordx4 v12, s[24:27], s42 offen offset:0 lds
    buffer_load_dwordx4 v13, s[24:27], s42 offen offset:1024 lds
    s_add_u32 m0, s40, 94208
    s_nop 0
    buffer_load_dwordx4 v14, s[24:27], s42 offen offset:0 lds
    buffer_load_dwordx4 v15, s[24:27], s42 offen offset:1024 lds
    s_add_u32 m0, s44, 102400
    s_nop 0
    buffer_load_dwordx4 v16, s[24:27], s42 offen lds
    s_buffer_load_dword s13, s[28:31], s12 offset:512
    s_buffer_load_dword s13, s[28:31], s12 offset:576
    s_buffer_load_dword s13, s[28:31], s12 offset:640
    s_buffer_load_dword s13, s[28:31], s12 offset:704
    s_waitcnt vmcnt(18)
    s_barrier
    s_add_u32 m0, s43, 32768
    s_mov_b32 s41, 1310720
    buffer_load_dwordx4 v8, s[20:23], s41 offen offset:0 lds
    buffer_load_dwordx4 v8, s[20:23], s41 offen offset:1024 lds
    buffer_load_dwordx4 v9, s[20:23], s41 offen offset:2048 lds
    buffer_load_dwordx4 v9, s[20:23], s41 offen offset:3072 lds
    s_mov_b32 s42, 2752512
    s_add_u32 m0, s40, 106496
    s_nop 0
    buffer_load_dwordx4 v10, s[24:27], s42 offen offset:0 lds
    buffer_load_dwordx4 v11, s[24:27], s42 offen offset:1024 lds
    s_add_u32 m0, s40, 114688
    s_nop 0
    buffer_load_dwordx4 v12, s[24:27], s42 offen offset:0 lds
    buffer_load_dwordx4 v13, s[24:27], s42 offen offset:1024 lds
    s_add_u32 m0, s40, 122880
    s_nop 0
    buffer_load_dwordx4 v14, s[24:27], s42 offen offset:0 lds
    buffer_load_dwordx4 v15, s[24:27], s42 offen offset:1024 lds
    s_add_u32 m0, s44, 131072
    s_nop 0
    buffer_load_dwordx4 v16, s[24:27], s42 offen lds
    s_buffer_load_dword s13, s[28:31], s12 offset:768
    s_buffer_load_dword s13, s[28:31], s12 offset:832
    s_buffer_load_dword s13, s[28:31], s12 offset:896
    s_buffer_load_dword s13, s[28:31], s12 offset:960
    s_waitcnt vmcnt(18)
    s_barrier
    s_add_u32 m0, s43, 0
    s_mov_b32 s41, 1572864
    buffer_load_dwordx4 v8, s[20:23], s41 offen offset:0 lds
    buffer_load_dwordx4 v8, s[20:23], s41 offen offset:1024 lds
    buffer_load_dwordx4 v9, s[20:23], s41 offen offset:2048 lds
    buffer_load_dwordx4 v9, s[20:23], s41 offen offset:3072 lds
    s_mov_b32 s42, 3211264
    s_add_u32 m0, s40, 135168
    s_nop 0
    buffer_load_dwordx4 v10, s[24:27], s42 offen offset:0 lds
    buffer_load_dwordx4 v11, s[24:27], s42 offen offset:1024 lds
    s_add_u32 m0, s40, 143360
    s_nop 0
    buffer_load_dwordx4 v12, s[24:27], s42 offen offset:0 lds
    buffer_load_dwordx4 v13, s[24:27], s42 offen offset:1024 lds
    s_add_u32 m0, s40, 151552
    s_nop 0
    buffer_load_dwordx4 v14, s[24:27], s42 offen offset:0 lds
    buffer_load_dwordx4 v15, s[24:27], s42 offen offset:1024 lds
    s_add_u32 m0, s44, 159744
    s_nop 0
    buffer_load_dwordx4 v16, s[24:27], s42 offen lds
    s_buffer_load_dword s13, s[28:31], s12 offset:1024
    s_buffer_load_dword s13, s[28:31], s12 offset:1088
    s_buffer_load_dword s13, s[28:31], s12 offset:1152
    s_buffer_load_dword s13, s[28:31], s12 offset:1216
    s_waitcnt vmcnt(18)
    s_barrier
    s_add_u32 m0, s43, 16384
    s_mov_b32 s41, 1835008
    buffer_load_dwordx4 v8, s[20:23], s41 offen offset:0 lds
    buffer_load_dwordx4 v8, s[20:23], s41 offen offset:1024 lds
    buffer_load_dwordx4 v9, s[20:23], s41 offen offset:2048 lds
    buffer_load_dwordx4 v9, s[20:23], s41 offen offset:3072 lds
    s_mov_b32 s42, 3670016
    s_add_u32 m0, s40, 49152
    s_nop 0
    buffer_load_dwordx4 v10, s[24:27], s42 offen offset:0 lds
    buffer_load_dwordx4 v11, s[24:27], s42 offen offset:1024 lds
    s_add_u32 m0, s40, 57344
    s_nop 0
    buffer_load_dwordx4 v12, s[24:27], s42 offen offset:0 lds
    buffer_load_dwordx4 v13, s[24:27], s42 offen offset:1024 lds
    s_add_u32 m0, s40, 65536
    s_nop 0
    buffer_load_dwordx4 v14, s[24:27], s42 offen offset:0 lds
    buffer_load_dwordx4 v15, s[24:27], s42 offen offset:1024 lds
    s_add_u32 m0, s44, 73728
    s_nop 0
    buffer_load_dwordx4 v16, s[24:27], s42 offen lds
    s_buffer_load_dword s13, s[28:31], s12 offset:1280
    s_buffer_load_dword s13, s[28:31], s12 offset:1344
    s_buffer_load_dword s13, s[28:31], s12 offset:1408
    s_buffer_load_dword s13, s[28:31], s12 offset:1472
    s_waitcnt vmcnt(18)
    s_barrier
    s_add_u32 m0, s43, 32768
    s_mov_b32 s41, 2097152
    buffer_load_dwordx4 v8, s[20:23], s41 offen offset:0 lds
    buffer_load_dwordx4 v8, s[20:23], s41 offen offset:1024 lds
    buffer_load_dwordx4 v9, s[20:23], s41 offen offset:2048 lds
    buffer_load_dwordx4 v9, s[20:23], s41 offen offset:3072 lds
    s_mov_b32 s42, 4128768
    s_add_u32 m0, s40, 77824
    s_nop 0
    buffer_load_dwordx4 v10, s[24:27], s42 offen offset:0 lds
    buffer_load_dwordx4 v11, s[24:27], s42 offen offset:1024 lds
    s_add_u32 m0, s40, 86016
    s_nop 0
    buffer_load_dwordx4 v12, s[24:27], s42 offen offset:0 lds
    buffer_load_dwordx4 v13, s[24:27], s42 offen offset:1024 lds
    s_add_u32 m0, s40, 94208
    s_nop 0
    buffer_load_dwordx4 v14, s[24:27], s42 offen offset:0 lds
    buffer_load_dwordx4 v15, s[24:27], s42 offen offset:1024 lds
    s_add_u32 m0, s44, 102400
    s_nop 0
    buffer_load_dwordx4 v16, s[24:27], s42 offen lds
    s_buffer_load_dword s13, s[28:31], s12 offset:1536
    s_buffer_load_dword s13, s[28:31], s12 offset:1600
    s_buffer_load_dword s13, s[28:31], s12 offset:1664
    s_buffer_load_dword s13, s[28:31], s12 offset:1728
    s_waitcnt vmcnt(18)
    s_barrier
    s_add_u32 m0, s43, 0
    s_mov_b32 s41, 2359296
    buffer_load_dwordx4 v8, s[20:23], s41 offen offset:0 lds
    buffer_load_dwordx4 v8, s[20:23], s41 offen offset:1024 lds
    buffer_load_dwordx4 v9, s[20:23], s41 offen offset:2048 lds
    buffer_load_dwordx4 v9, s[20:23], s41 offen offset:3072 lds
    s_mov_b32 s42, 4587520
    s_add_u32 m0, s40, 106496
    s_nop 0
    buffer_load_dwordx4 v10, s[24:27], s42 offen offset:0 lds
    buffer_load_dwordx4 v11, s[24:27], s42 offen offset:1024 lds
    s_add_u32 m0, s40, 114688
    s_nop 0
    buffer_load_dwordx4 v12, s[24:27], s42 offen offset:0 lds
    buffer_load_dwordx4 v13, s[24:27], s42 offen offset:1024 lds
    s_add_u32 m0, s40, 122880
    s_nop 0
    buffer_load_dwordx4 v14, s[24:27], s42 offen offset:0 lds
    buffer_load_dwordx4 v15, s[24:27], s42 offen offset:1024 lds
    s_add_u32 m0, s44, 131072
    s_nop 0
    buffer_load_dwordx4 v16, s[24:27], s42 offen lds
    s_buffer_load_dword s13, s[28:31], s12 offset:1792
    s_buffer_load_dword s13, s[28:31], s12 offset:1856
    s_buffer_load_dword s13, s[28:31], s12 offset:1920
    s_buffer_load_dword s13, s[28:31], s12 offset:1984
    s_waitcnt vmcnt(18)
    s_barrier
    s_add_u32 m0, s43, 16384
    s_mov_b32 s41, 2621440
    buffer_load_dwordx4 v8, s[20:23], s41 offen offset:0 lds
    buffer_load_dwordx4 v8, s[20:23], s41 offen offset:1024 lds
    buffer_load_dwordx4 v9, s[20:23], s41 offen offset:2048 lds
    buffer_load_dwordx4 v9, s[20:23], s41 offen offset:3072 lds
    s_mov_b32 s42, 5046272
    s_add_u32 m0, s40, 135168
    s_nop 0
    buffer_load_dwordx4 v10, s[24:27], s42 offen offset:0 lds
    buffer_load_dwordx4 v11, s[24:27], s42 offen offset:1024 lds
    s_add_u32 m0, s40, 143360
    s_nop 0
    buffer_load_dwordx4 v12, s[24:27], s42 offen offset:0 lds
    buffer_load_dwordx4 v13, s[24:27], s42 offen offset:1024 lds
    s_add_u32 m0, s40, 151552
    s_nop 0
    buffer_load_dwordx4 v14, s[24:27], s42 offen offset:0 lds
    buffer_load_dwordx4 v15, s[24:27], s42 offen offset:1024 lds
    s_add_u32 m0, s44, 159744
    s_nop 0
    buffer_load_dwordx4 v16, s[24:27], s42 offen lds
    s_buffer_load_dword s13, s[28:31], s12 offset:2048
    s_buffer_load_dword s13, s[28:31], s12 offset:2112
    s_buffer_load_dword s13, s[28:31], s12 offset:2176
    s_buffer_load_dword s13, s[28:31], s12 offset:2240
    s_waitcnt vmcnt(18)
    s_barrier
    s_add_u32 m0, s43, 32768
    s_mov_b32 s41, 2883584
    buffer_load_dwordx4 v8, s[20:23], s41 offen offset:0 lds
    buffer_load_dwordx4 v8, s[20:23], s41 offen offset:1024 lds
    buffer_load_dwordx4 v9, s[20:23], s41 offen offset:2048 lds
    buffer_load_dwordx4 v9, s[20:23], s41 offen offset:3072 lds
    s_mov_b32 s42, 5505024
    s_add_u32 m0, s40, 49152
    s_nop 0
    buffer_load_dwordx4 v10, s[24:27], s42 offen offset:0 lds
    buffer_load_dwordx4 v11, s[24:27], s42 offen offset:1024 lds
    s_add_u32 m0, s40, 57344
    s_nop 0
    buffer_load_dwordx4 v12, s[24:27], s42 offen offset:0 lds
    buffer_load_dwordx4 v13, s[24:27], s42 offen offset:1024 lds
    s_add_u32 m0, s40, 65536
    s_nop 0
    buffer_load_dwordx4 v14, s[24:27], s42 offen offset:0 lds
    buffer_load_dwordx4 v15, s[24:27], s42 offen offset:1024 lds
    s_add_u32 m0, s44, 73728
    s_nop 0
    buffer_load_dwordx4 v16, s[24:27], s42 offen lds
    s_buffer_load_dword s13, s[28:31], s12 offset:2304
    s_buffer_load_dword s13, s[28:31], s12 offset:2368
    s_buffer_load_dword s13, s[28:31], s12 offset:2432
    s_buffer_load_dword s13, s[28:31], s12 offset:2496
    s_waitcnt vmcnt(18)
    s_barrier
    s_add_u32 m0, s43, 0
    s_mov_b32 s41, 3145728
    buffer_load_dwordx4 v8, s[20:23], s41 offen offset:0 lds
    buffer_load_dwordx4 v8, s[20:23], s41 offen offset:1024 lds
    buffer_load_dwordx4 v9, s[20:23], s41 offen offset:2048 lds
    buffer_load_dwordx4 v9, s[20:23], s41 offen offset:3072 lds
    s_mov_b32 s42, 5963776
    s_add_u32 m0, s40, 77824
    s_nop 0
    buffer_load_dwordx4 v10, s[24:27], s42 offen offset:0 lds
    buffer_load_dwordx4 v11, s[24:27], s42 offen offset:1024 lds
    s_add_u32 m0, s40, 86016
    s_nop 0
    buffer_load_dwordx4 v12, s[24:27], s42 offen offset:0 lds
    buffer_load_dwordx4 v13, s[24:27], s42 offen offset:1024 lds
    s_add_u32 m0, s40, 94208
    s_nop 0
    buffer_load_dwordx4 v14, s[24:27], s42 offen offset:0 lds
    buffer_load_dwordx4 v15, s[24:27], s42 offen offset:1024 lds
    s_add_u32 m0, s44, 102400
    s_nop 0
    buffer_load_dwordx4 v16, s[24:27], s42 offen lds
    s_buffer_load_dword s13, s[28:31], s12 offset:2560
    s_buffer_load_dword s13, s[28:31], s12 offset:2624
    s_buffer_load_dword s13, s[28:31], s12 offset:2688
    s_buffer_load_dword s13, s[28:31], s12 offset:2752
    s_waitcnt vmcnt(18)
    s_barrier
    s_add_u32 m0, s43, 16384
    s_mov_b32 s41, 3407872
    buffer_load_dwordx4 v8, s[20:23], s41 offen offset:0 lds
    buffer_load_dwordx4 v8, s[20:23], s41 offen offset:1024 lds
    buffer_load_dwordx4 v9, s[20:23], s41 offen offset:2048 lds
    buffer_load_dwordx4 v9, s[20:23], s41 offen offset:3072 lds
    s_mov_b32 s42, 6422528
    s_add_u32 m0, s40, 106496
    s_nop 0
    buffer_load_dwordx4 v10, s[24:27], s42 offen offset:0 lds
    buffer_load_dwordx4 v11, s[24:27], s42 offen offset:1024 lds
    s_add_u32 m0, s40, 114688
    s_nop 0
    buffer_load_dwordx4 v12, s[24:27], s42 offen offset:0 lds
    buffer_load_dwordx4 v13, s[24:27], s42 offen offset:1024 lds
    s_add_u32 m0, s40, 122880
    s_nop 0
    buffer_load_dwordx4 v14, s[24:27], s42 offen offset:0 lds
    buffer_load_dwordx4 v15, s[24:27], s42 offen offset:1024 lds
    s_add_u32 m0, s44, 131072
    s_nop 0
    buffer_load_dwordx4 v16, s[24:27], s42 offen lds
    s_buffer_load_dword s13, s[28:31], s12 offset:2816
    s_buffer_load_dword s13, s[28:31], s12 offset:2880
    s_buffer_load_dword s13, s[28:31], s12 offset:2944
    s_buffer_load_dword s13, s[28:31], s12 offset:3008
    s_waitcnt vmcnt(18)
    s_barrier
    s_add_u32 m0, s43, 32768
    s_mov_b32 s41, 3670016
    buffer_load_dwordx4 v8, s[20:23], s41 offen offset:0 lds
    buffer_load_dwordx4 v8, s[20:23], s41 offen offset:1024 lds
    buffer_load_dwordx4 v9, s[20:23], s41 offen offset:2048 lds
    buffer_load_dwordx4 v9, s[20:23], s41 offen offset:3072 lds
    s_mov_b32 s42, 6881280
    s_add_u32 m0, s40, 135168
    s_nop 0
    buffer_load_dwordx4 v10, s[24:27], s42 offen offset:0 lds
    buffer_load_dwordx4 v11, s[24:27], s42 offen offset:1024 lds
    s_add_u32 m0, s40, 143360
    s_nop 0
    buffer_load_dwordx4 v12, s[24:27], s42 offen offset:0 lds
    buffer_load_dwordx4 v13, s[24:27], s42 offen offset:1024 lds
    s_add_u32 m0, s40, 151552
    s_nop 0
    buffer_load_dwordx4 v14, s[24:27], s42 offen offset:0 lds
    buffer_load_dwordx4 v15, s[24:27], s42 offen offset:1024 lds
    s_add_u32 m0, s44, 159744
    s_nop 0
    buffer_load_dwordx4 v16, s[24:27], s42 offen lds
    s_buffer_load_dword s13, s[28:31], s12 offset:3072
    s_buffer_load_dword s13, s[28:31], s12 offset:3136
    s_buffer_load_dword s13, s[28:31], s12 offset:3200
    s_buffer_load_dword s13, s[28:31], s12 offset:3264
    s_waitcnt vmcnt(18)
    s_barrier
    s_add_u32 m0, s43, 0
    s_mov_b32 s41, 3932160
    buffer_load_dwordx4 v8, s[20:23], s41 offen offset:0 lds
    buffer_load_dwordx4 v8, s[20:23], s41 offen offset:1024 lds
    buffer_load_dwordx4 v9, s[20:23], s41 offen offset:2048 lds
    buffer_load_dwordx4 v9, s[20:23], s41 offen offset:3072 lds
    s_buffer_load_dword s13, s[28:31], s12 offset:3328
    s_buffer_load_dword s13, s[28:31], s12 offset:3392
    s_buffer_load_dword s13, s[28:31], s12 offset:3456
    s_buffer_load_dword s13, s[28:31], s12 offset:3520
    s_waitcnt vmcnt(11)
    s_getpc_b64 s[36:37]
pfc_10:
    s_add_u32 s36, s36, k4_kernel-pfc_10
    s_addc_u32 s37, s37, 0
    s_lshr_b32 s38, s2, 3
    s_lshl_b32 s38, s38, 2
    s_add_u32 s38, s38, s17
    s_lshl_b32 s38, s38, 8
    v_and_b32 v18, 3, v2
    v_lshlrev_b32 v18, 6, v18
    v_add_u32 v18, s38, v18
    v_min_u32 v18, k4_kernel_end-k4_kernel, v18
    global_load_dword v18, v18, s[36:37]
    s_add_u32 s47, s46, 6291456
    buffer_load_dword v18, v17, s[28:31], s47 offen
    s_barrier
    s_buffer_load_dword s13, s[28:31], s12 offset:3584
    s_buffer_load_dword s13, s[28:31], s12 offset:3648
    s_buffer_load_dword s13, s[28:31], s12 offset:3712
    s_buffer_load_dword s13, s[28:31], s12 offset:3776
    s_waitcnt vmcnt(2)
    s_barrier
    s_buffer_load_dword s13, s[28:31], s12 offset:3840
    s_buffer_load_dword s13, s[28:31], s12 offset:3904
    s_buffer_load_dword s13, s[28:31], s12 offset:3968
    s_buffer_load_dword s13, s[28:31], s12 offset:4032
    s_barrier
k3_kernel_end:
    s_endpgm
.text
.globl k4_kernel
.p2align 8
.type k4_kernel,@function
k4_kernel:
    s_cmp_ge_u32 s2, 256
    s_cbranch_scc1 k4_kernel_end
    v_lshrrev_b32 v1, 6, v0
    s_nop 0
    v_readfirstlane_b32 s16, v1
    s_load_dwordx2 s[4:5], s[0:1], 104
    s_load_dwordx4 s[8:11], s[0:1], 48
    s_load_dwordx2 s[50:51], s[0:1], 64
    s_and_b32 s3, s2, 7
    s_lshr_b32 s6, s2, 3
    s_and_b32 s14, s3, 1
    s_lshl_b32 s14, s14, 3
    s_and_b32 s7, s6, 7
    s_add_u32 s14, s14, s7
    s_lshr_b32 s15, s3, 1
    s_lshl_b32 s15, s15, 2
    s_lshr_b32 s7, s6, 3
    s_add_u32 s15, s15, s7
    s_mul_i32 s12, s15, 14
    s_and_b32 s7, s15, 1
    s_lshl_b32 s13, s7, 1
    s_add_u32 s13, s13, s12
    s_mul_i32 s6, s7, 12
    s_sub_u32 s12, s12, s6
    s_add_u32 s12, s12, 12
    s_cmp_ge_u32 s16, 4
    s_cbranch_scc1 k4_kernel_prod
    v_and_b32 v2, 63, v0
    v_and_b32 v3, 15, v0
    v_bfe_u32 v4, v0, 4, 2
    v_bfe_u32 v5, v0, 2, 2
    v_and_b32 v6, 3, v0
    v_lshrrev_b32 v7, 1, v4
    v_lshlrev_b32 v9, 15, v7
    v_lshl_add_u32 v9, v3, 4, v9
    v_and_b32 v7, 1, v4
    v_lshl_add_u32 v9, v7, 3, v9
    v_lshlrev_b32 v10, 1, v3
    s_lshl_b32 s17, s14, 2
    s_add_u32 s17, s17, s16
    s_lshl_b32 s18, s17, 6
    s_lshl_b32 s19, s17, 9
    s_lshl_b32 s20, s13, 15
    s_add_u32 s20, s20, s19
    s_lshl_b32 s21, s12, 15
    s_add_u32 s21, s21, s19
    s_mul_i32 s22, s7, 65528
    s_sub_u32 s22, s21, s22
    s_waitcnt lgkmcnt(0)
    s_mov_b32 s24, s10
    s_and_b32 s25, s11, 0xffff
    s_mov_b32 s26, 4096
    s_mov_b32 s27, 0x00020000
    s_add_u32 s28, s4, 17825792
    s_addc_u32 s29, s5, 0
    s_and_b32 s29, s29, 0xffff
    s_mov_b32 s30, 7340032
    s_mov_b32 s31, 0x00020000
    s_add_u32 s32, s4, 32505856
    s_addc_u32 s33, s5, 0
    s_and_b32 s33, s33, 0xffff
    s_mov_b32 s34, 7340032
    s_mov_b32 s35, 0x00020000
    buffer_load_ushort v168, v10, s[24:27], s18 offen offset:0
    buffer_load_ushort v169, v10, s[24:27], s18 offen offset:32
    v_lshrrev_b32 v7, 1, v3
    v_xor_b32 v7, v7, v4
    v_lshlrev_b32 v170, 4, v7
    v_lshl_add_u32 v170, v3, 7, v170
    s_lshl_b32 s60, s16, 12
    v_add_u32 v170, s60, v170
    v_xor_b32 v171, 64, v170
    v_lshrrev_b32 v7, 1, v6
    v_mul_u32_u24 v172, 1088, v7
    v_lshl_add_u32 v7, v4, 3, v5
    v_lshl_add_u32 v172, v7, 4, v172
    v_and_b32 v7, 1, v6
    v_lshl_add_u32 v172, v7, 3, v172
    v_add_u32 v172, 65536, v172
    v_add_u32 v173, 34816, v172
    v_lshlrev_b32 v11, 15, v4
    v_lshl_add_u32 v11, v3, 4, v11
    v_mov_b32 v48, 0
    v_mov_b32 v49, 0
    v_mov_b32 v50, 0
    v_mov_b32 v51, 0
    v_mov_b32 v52, 0
    v_mov_b32 v53, 0
    v_mov_b32 v54, 0
    v_mov_b32 v55, 0
    v_mov_b32 v56, 0
    v_mov_b32 v57, 0
    v_mov_b32 v58, 0
    v_mov_b32 v59, 0
    v_mov_b32 v60, 0
    v_mov_b32 v61, 0
    v_mov_b32 v62, 0
    v_mov_b32 v63, 0
    v_mov_b32 v64, 0
    v_mov_b32 v65, 0
    v_mov_b32 v66, 0
    v_mov_b32 v67, 0
    v_mov_b32 v68, 0
    v_mov_b32 v69, 0
    v_mov_b32 v70, 0
    v_mov_b32 v71, 0
    v_mov_b32 v72, 0
    v_mov_b32 v73, 0
    v_mov_b32 v74, 0
    v_mov_b32 v75, 0
    v_mov_b32 v76, 0
    v_mov_b32 v77, 0
    v_mov_b32 v78, 0
    v_mov_b32 v79, 0
    v_mov_b32 v80, 0
    v_mov_b32 v81, 0
    v_mov_b32 v82, 0
    v_mov_b32 v83, 0
    s_waitcnt vmcnt(0)
    v_lshlrev_b32 v84, 16, v168
    v_lshlrev_b32 v85, 16, v168
    v_lshlrev_b32 v86, 16, v168
    v_lshlrev_b32 v87, 16, v168
    v_lshlrev_b32 v88, 16, v168
    v_lshlrev_b32 v89, 16, v168
    v_lshlrev_b32 v90, 16, v168
    v_lshlrev_b32 v91, 16, v168
    v_lshlrev_b32 v92, 16, v168
    v_lshlrev_b32 v93, 16, v168
    v_lshlrev_b32 v94, 16, v168
    v_lshlrev_b32 v95, 16, v168
    v_lshlrev_b32 v96, 16, v168
    v_lshlrev_b32 v97, 16, v168
    v_lshlrev_b32 v98, 16, v168
    v_lshlrev_b32 v99, 16, v168
    v_lshlrev_b32 v100, 16, v168
    v_lshlrev_b32 v101, 16, v168
    v_lshlrev_b32 v102, 16, v168
    v_lshlrev_b32 v103, 16, v168
    v_lshlrev_b32 v104, 16, v168
    v_lshlrev_b32 v105, 16, v168
    v_lshlrev_b32 v106, 16, v168
    v_lshlrev_b32 v107, 16, v168
    v_lshlrev_b32 v108, 16, v168
    v_lshlrev_b32 v109, 16, v168
    v_lshlrev_b32 v110, 16, v168
    v_lshlrev_b32 v111, 16, v168
    v_lshlrev_b32 v112, 16, v169
    v_lshlrev_b32 v113, 16, v169
    v_lshlrev_b32 v114, 16, v169
    v_lshlrev_b32 v115, 16, v169
    v_lshlrev_b32 v116, 16, v169
    v_lshlrev_b32 v117, 16, v169
    v_lshlrev_b32 v118, 16, v169
    v_lshlrev_b32 v119, 16, v169
    v_lshlrev_b32 v120, 16, v169
    v_lshlrev_b32 v121, 16, v169
    v_lshlrev_b32 v122, 16, v169
    v_lshlrev_b32 v123, 16, v169
    v_lshlrev_b32 v124, 16, v169
    v_lshlrev_b32 v125, 16, v169
    v_lshlrev_b32 v126, 16, v169
    v_lshlrev_b32 v127, 16, v169
    v_lshlrev_b32 v128, 16, v169
    v_lshlrev_b32 v129, 16, v169
    v_lshlrev_b32 v130, 16, v169
    v_lshlrev_b32 v131, 16, v169
    v_lshlrev_b32 v132, 16, v169
    v_lshlrev_b32 v133, 16, v169
    v_lshlrev_b32 v134, 16, v169
    v_lshlrev_b32 v135, 16, v169
    v_lshlrev_b32 v136, 16, v169
    v_lshlrev_b32 v137, 16, v169
    v_lshlrev_b32 v138, 16, v169
    v_lshlrev_b32 v139, 16, v169
    s_mov_b32 s50, 0xffff0000
    s_mov_b32 s48, 8
    s_barrier
k4_kernel_cloop:
    v_mfma_f32_16x16x32_bf16 v[84:87], v[56:59], v[48:51], v[84:87]
    ds_read_b128 v[12:15], v170 offset:0
    ds_read_b64_tr_b16 v[20:21], v172 offset:0
    v_mfma_f32_16x16x32_bf16 v[112:115], v[56:59], v[52:55], v[112:115]
    ds_read_b64_tr_b16 v[22:23], v172 offset:64
    ds_read_b128 v[16:19], v170 offset:2048
    v_mfma_f32_16x16x32_bf16 v[88:91], v[60:63], v[48:51], v[88:91]
    ds_read_b64_tr_b16 v[24:25], v172 offset:2176
    v_mfma_f32_16x16x32_bf16 v[116:119], v[60:63], v[52:55], v[116:119]
    ds_read_b64_tr_b16 v[26:27], v172 offset:2240
    v_mfma_f32_16x16x32_bf16 v[92:95], v[64:67], v[48:51], v[92:95]
    ds_read_b64_tr_b16 v[28:29], v172 offset:4352
    v_mfma_f32_16x16x32_bf16 v[120:123], v[64:67], v[52:55], v[120:123]
    ds_read_b64_tr_b16 v[30:31], v172 offset:4416
    v_mfma_f32_16x16x32_bf16 v[96:99], v[68:71], v[48:51], v[96:99]
    ds_read_b64_tr_b16 v[32:33], v172 offset:6528
    v_mfma_f32_16x16x32_bf16 v[124:127], v[68:71], v[52:55], v[124:127]
    ds_read_b64_tr_b16 v[34:35], v172 offset:6592
    v_mfma_f32_16x16x32_bf16 v[100:103], v[72:75], v[48:51], v[100:103]
    ds_read_b64_tr_b16 v[36:37], v172 offset:8704
    v_mfma_f32_16x16x32_bf16 v[128:131], v[72:75], v[52:55], v[128:131]
    ds_read_b64_tr_b16 v[38:39], v172 offset:8768
    v_mfma_f32_16x16x32_bf16 v[104:107], v[76:79], v[48:51], v[104:107]
    ds_read_b64_tr_b16 v[40:41], v172 offset:10880
    v_mfma_f32_16x16x32_bf16 v[132:135], v[76:79], v[52:55], v[132:135]
    ds_read_b64_tr_b16 v[42:43], v172 offset:10944
    v_mfma_f32_16x16x32_bf16 v[108:111], v[80:83], v[48:51], v[108:111]
    ds_read_b64_tr_b16 v[44:45], v172 offset:13056
    v_mfma_f32_16x16x32_bf16 v[136:139], v[80:83], v[52:55], v[136:139]
    ds_read_b64_tr_b16 v[46:47], v172 offset:13120
    s_waitcnt lgkmcnt(13)
    v_mfma_f32_16x16x32_bf16 v[84:87], v[20:23], v[12:15], v[84:87]
    ds_read_b128 v[48:51], v171 offset:0
    ds_read_b64_tr_b16 v[56:57], v172 offset:512
    s_waitcnt lgkmcnt(14)
    v_mfma_f32_16x16x32_bf16 v[112:115], v[20:23], v[16:19], v[112:115]
    ds_read_b64_tr_b16 v[58:59], v172 offset:576
    ds_read_b128 v[52:55], v171 offset:2048
    s_waitcnt lgkmcnt(14)
    v_mfma_f32_16x16x32_bf16 v[88:91], v[24:27], v[12:15], v[88:91]
    ds_read_b64_tr_b16 v[60:61], v172 offset:2688
    ds_read_b64_tr_b16 v[62:63], v172 offset:2752
    v_mfma_f32_16x16x32_bf16 v[116:119], v[24:27], v[16:19], v[116:119]
    ds_read_b64_tr_b16 v[64:65], v172 offset:4864
    s_waitcnt lgkmcnt(15)
    v_mfma_f32_16x16x32_bf16 v[92:95], v[28:31], v[12:15], v[92:95]
    ds_read_b64_tr_b16 v[66:67], v172 offset:4928
    v_mfma_f32_16x16x32_bf16 v[120:123], v[28:31], v[16:19], v[120:123]
    ds_read_b64_tr_b16 v[68:69], v172 offset:7040
    s_waitcnt lgkmcnt(15)
    v_mfma_f32_16x16x32_bf16 v[96:99], v[32:35], v[12:15], v[96:99]
    ds_read_b64_tr_b16 v[70:71], v172 offset:7104
    v_mfma_f32_16x16x32_bf16 v[124:127], v[32:35], v[16:19], v[124:127]
    ds_read_b64_tr_b16 v[72:73], v172 offset:9216
    s_waitcnt lgkmcnt(15)
    v_mfma_f32_16x16x32_bf16 v[100:103], v[36:39], v[12:15], v[100:103]
    ds_read_b64_tr_b16 v[74:75], v172 offset:9280
    v_mfma_f32_16x16x32_bf16 v[128:131], v[36:39], v[16:19], v[128:131]
    ds_read_b64_tr_b16 v[76:77], v172 offset:11392
    s_waitcnt lgkmcnt(15)
    v_mfma_f32_16x16x32_bf16 v[104:107], v[40:43], v[12:15], v[104:107]
    ds_read_b64_tr_b16 v[78:79], v172 offset:11456
    v_mfma_f32_16x16x32_bf16 v[132:135], v[40:43], v[16:19], v[132:135]
    ds_read_b64_tr_b16 v[80:81], v172 offset:15232
    s_waitcnt lgkmcnt(15)
    v_mfma_f32_16x16x32_bf16 v[108:111], v[44:47], v[12:15], v[108:111]
    ds_read_b64_tr_b16 v[82:83], v172 offset:15296
    v_mfma_f32_16x16x32_bf16 v[136:139], v[44:47], v[16:19], v[136:139]
    s_waitcnt lgkmcnt(0)
    s_barrier
    v_mfma_f32_16x16x32_bf16 v[84:87], v[56:59], v[48:51], v[84:87]
    ds_read_b128 v[12:15], v170 offset:16384
    ds_read_b64_tr_b16 v[20:21], v172 offset:17408
    v_mfma_f32_16x16x32_bf16 v[112:115], v[56:59], v[52:55], v[112:115]
    ds_read_b64_tr_b16 v[22:23], v172 offset:17472
    ds_read_b128 v[16:19], v170 offset:18432
    v_mfma_f32_16x16x32_bf16 v[88:91], v[60:63], v[48:51], v[88:91]
    ds_read_b64_tr_b16 v[24:25], v172 offset:19584
    v_mfma_f32_16x16x32_bf16 v[116:119], v[60:63], v[52:55], v[116:119]
    ds_read_b64_tr_b16 v[26:27], v172 offset:19648
    v_mfma_f32_16x16x32_bf16 v[92:95], v[64:67], v[48:51], v[92:95]
    ds_read_b64_tr_b16 v[28:29], v172 offset:21760
    v_mfma_f32_16x16x32_bf16 v[120:123], v[64:67], v[52:55], v[120:123]
    ds_read_b64_tr_b16 v[30:31], v172 offset:21824
    v_mfma_f32_16x16x32_bf16 v[96:99], v[68:71], v[48:51], v[96:99]
    ds_read_b64_tr_b16 v[32:33], v172 offset:23936
    v_mfma_f32_16x16x32_bf16 v[124:127], v[68:71], v[52:55], v[124:127]
    ds_read_b64_tr_b16 v[34:35], v172 offset:24000
    v_mfma_f32_16x16x32_bf16 v[100:103], v[72:75], v[48:51], v[100:103]
    ds_read_b64_tr_b16 v[36:37], v172 offset:26112
    v_mfma_f32_16x16x32_bf16 v[128:131], v[72:75], v[52:55], v[128:131]
    ds_read_b64_tr_b16 v[38:39], v172 offset:26176
    v_mfma_f32_16x16x32_bf16 v[104:107], v[76:79], v[48:51], v[104:107]
    ds_read_b64_tr_b16 v[40:41], v172 offset:28288
    v_mfma_f32_16x16x32_bf16 v[132:135], v[76:79], v[52:55], v[132:135]
    ds_read_b64_tr_b16 v[42:43], v172 offset:28352
    v_mfma_f32_16x16x32_bf16 v[108:111], v[80:83], v[48:51], v[108:111]
    ds_read_b64_tr_b16 v[44:45], v172 offset:30464
    v_mfma_f32_16x16x32_bf16 v[136:139], v[80:83], v[52:55], v[136:139]
    ds_read_b64_tr_b16 v[46:47], v172 offset:30528
    s_cmp_eq_u32 s48, 1
    s_cbranch_scc0 k4_lskip
    buffer_load_dwordx2 v[140:141], v9, s[28:31], s20 offen offset:0
    buffer_load_dwordx2 v[142:143], v9, s[28:31], s20 offen offset:256
    s_add_u32 s23, s20, 65536
    buffer_load_dwordx2 v[144:145], v9, s[28:31], s23 offen offset:0
    buffer_load_dwordx2 v[146:147], v9, s[28:31], s23 offen offset:256
    s_add_u32 s23, s20, 131072
    buffer_load_dwordx2 v[148:149], v9, s[28:31], s23 offen offset:0
    buffer_load_dwordx2 v[150:151], v9, s[28:31], s23 offen offset:256
    s_add_u32 s23, s20, 196608
    buffer_load_dwordx2 v[152:153], v9, s[28:31], s23 offen offset:0
    buffer_load_dwordx2 v[154:155], v9, s[28:31], s23 offen offset:256
    s_add_u32 s23, s20, 262144
    buffer_load_dwordx2 v[156:157], v9, s[28:31], s23 offen offset:0
    buffer_load_dwordx2 v[158:159], v9, s[28:31], s23 offen offset:256
    s_add_u32 s23, s20, 327680
    buffer_load_dwordx2 v[160:161], v9, s[28:31], s23 offen offset:0
    buffer_load_dwordx2 v[162:163], v9, s[28:31], s23 offen offset:256
    buffer_load_dwordx2 v[164:165], v9, s[28:31], s21 offen offset:0
    buffer_load_dwordx2 v[166:167], v9, s[28:31], s21 offen offset:256
k4_lskip:
    s_waitcnt lgkmcnt(13)
    v_mfma_f32_16x16x32_bf16 v[84:87], v[20:23], v[12:15], v[84:87]
    ds_read_b128 v[48:51], v171 offset:16384
    ds_read_b64_tr_b16 v[56:57], v172 offset:17920
    s_waitcnt lgkmcnt(14)
    v_mfma_f32_16x16x32_bf16 v[112:115], v[20:23], v[16:19], v[112:115]
    ds_read_b64_tr_b16 v[58:59], v172 offset:17984
    ds_read_b128 v[52:55], v171 offset:18432
    s_waitcnt lgkmcnt(14)
    v_mfma_f32_16x16x32_bf16 v[88:91], v[24:27], v[12:15], v[88:91]
    ds_read_b64_tr_b16 v[60:61], v172 offset:20096
    ds_read_b64_tr_b16 v[62:63], v172 offset:20160
    v_mfma_f32_16x16x32_bf16 v[116:119], v[24:27], v[16:19], v[116:119]
    ds_read_b64_tr_b16 v[64:65], v172 offset:22272
    s_waitcnt lgkmcnt(15)
    v_mfma_f32_16x16x32_bf16 v[92:95], v[28:31], v[12:15], v[92:95]
    ds_read_b64_tr_b16 v[66:67], v172 offset:22336
    v_mfma_f32_16x16x32_bf16 v[120:123], v[28:31], v[16:19], v[120:123]
    ds_read_b64_tr_b16 v[68:69], v172 offset:24448
    s_waitcnt lgkmcnt(15)
    v_mfma_f32_16x16x32_bf16 v[96:99], v[32:35], v[12:15], v[96:99]
    ds_read_b64_tr_b16 v[70:71], v172 offset:24512
    v_mfma_f32_16x16x32_bf16 v[124:127], v[32:35], v[16:19], v[124:127]
    ds_read_b64_tr_b16 v[72:73], v172 offset:26624
    s_waitcnt lgkmcnt(15)
    v_mfma_f32_16x16x32_bf16 v[100:103], v[36:39], v[12:15], v[100:103]
    ds_read_b64_tr_b16 v[74:75], v172 offset:26688
    v_mfma_f32_16x16x32_bf16 v[128:131], v[36:39], v[16:19], v[128:131]
    ds_read_b64_tr_b16 v[76:77], v172 offset:28800
    s_waitcnt lgkmcnt(15)
    v_mfma_f32_16x16x32_bf16 v[104:107], v[40:43], v[12:15], v[104:107]
    ds_read_b64_tr_b16 v[78:79], v172 offset:28864
    v_mfma_f32_16x16x32_bf16 v[132:135], v[40:43], v[16:19], v[132:135]
    ds_read_b64_tr_b16 v[80:81], v172 offset:32640
    s_waitcnt lgkmcnt(15)
    v_mfma_f32_16x16x32_bf16 v[108:111], v[44:47], v[12:15], v[108:111]
    ds_read_b64_tr_b16 v[82:83], v172 offset:32704
    v_mfma_f32_16x16x32_bf16 v[136:139], v[44:47], v[16:19], v[136:139]
    s_waitcnt lgkmcnt(0)
    s_barrier
    v_mfma_f32_16x16x32_bf16 v[84:87], v[56:59], v[48:51], v[84:87]
    ds_read_b128 v[12:15], v170 offset:32768
    ds_read_b64_tr_b16 v[20:21], v173 offset:0
    v_mfma_f32_16x16x32_bf16 v[112:115], v[56:59], v[52:55], v[112:115]
    ds_read_b64_tr_b16 v[22:23], v173 offset:64
    ds_read_b128 v[16:19], v170 offset:34816
    v_mfma_f32_16x16x32_bf16 v[88:91], v[60:63], v[48:51], v[88:91]
    ds_read_b64_tr_b16 v[24:25], v173 offset:2176
    v_mfma_f32_16x16x32_bf16 v[116:119], v[60:63], v[52:55], v[116:119]
    ds_read_b64_tr_b16 v[26:27], v173 offset:2240
    v_mfma_f32_16x16x32_bf16 v[92:95], v[64:67], v[48:51], v[92:95]
    ds_read_b64_tr_b16 v[28:29], v173 offset:4352
    v_mfma_f32_16x16x32_bf16 v[120:123], v[64:67], v[52:55], v[120:123]
    ds_read_b64_tr_b16 v[30:31], v173 offset:4416
    v_mfma_f32_16x16x32_bf16 v[96:99], v[68:71], v[48:51], v[96:99]
    ds_read_b64_tr_b16 v[32:33], v173 offset:6528
    v_mfma_f32_16x16x32_bf16 v[124:127], v[68:71], v[52:55], v[124:127]
    ds_read_b64_tr_b16 v[34:35], v173 offset:6592
    v_mfma_f32_16x16x32_bf16 v[100:103], v[72:75], v[48:51], v[100:103]
    ds_read_b64_tr_b16 v[36:37], v173 offset:8704
    v_mfma_f32_16x16x32_bf16 v[128:131], v[72:75], v[52:55], v[128:131]
    ds_read_b64_tr_b16 v[38:39], v173 offset:8768
    v_mfma_f32_16x16x32_bf16 v[104:107], v[76:79], v[48:51], v[104:107]
    ds_read_b64_tr_b16 v[40:41], v173 offset:10880
    v_mfma_f32_16x16x32_bf16 v[132:135], v[76:79], v[52:55], v[132:135]
    ds_read_b64_tr_b16 v[42:43], v173 offset:10944
    v_mfma_f32_16x16x32_bf16 v[108:111], v[80:83], v[48:51], v[108:111]
    ds_read_b64_tr_b16 v[44:45], v173 offset:13056
    v_mfma_f32_16x16x32_bf16 v[136:139], v[80:83], v[52:55], v[136:139]
    ds_read_b64_tr_b16 v[46:47], v173 offset:13120
    s_waitcnt lgkmcnt(13)
    v_mfma_f32_16x16x32_bf16 v[84:87], v[20:23], v[12:15], v[84:87]
    ds_read_b128 v[48:51], v171 offset:32768
    ds_read_b64_tr_b16 v[56:57], v173 offset:512
    s_waitcnt lgkmcnt(14)
    v_mfma_f32_16x16x32_bf16 v[112:115], v[20:23], v[16:19], v[112:115]
    ds_read_b64_tr_b16 v[58:59], v173 offset:576
    ds_read_b128 v[52:55], v171 offset:34816
    s_waitcnt lgkmcnt(14)
    v_mfma_f32_16x16x32_bf16 v[88:91], v[24:27], v[12:15], v[88:91]
    ds_read_b64_tr_b16 v[60:61], v173 offset:2688
    ds_read_b64_tr_b16 v[62:63], v173 offset:2752
    v_mfma_f32_16x16x32_bf16 v[116:119], v[24:27], v[16:19], v[116:119]
    ds_read_b64_tr_b16 v[64:65], v173 offset:4864
    s_waitcnt lgkmcnt(15)
    v_mfma_f32_16x16x32_bf16 v[92:95], v[28:31], v[12:15], v[92:95]
    ds_read_b64_tr_b16 v[66:67], v173 offset:4928
    v_mfma_f32_16x16x32_bf16 v[120:123], v[28:31], v[16:19], v[120:123]
    ds_read_b64_tr_b16 v[68:69], v173 offset:7040
    s_waitcnt lgkmcnt(15)
    v_mfma_f32_16x16x32_bf16 v[96:99], v[32:35], v[12:15], v[96:99]
    ds_read_b64_tr_b16 v[70:71], v173 offset:7104
    v_mfma_f32_16x16x32_bf16 v[124:127], v[32:35], v[16:19], v[124:127]
    ds_read_b64_tr_b16 v[72:73], v173 offset:9216
    s_waitcnt lgkmcnt(15)
    v_mfma_f32_16x16x32_bf16 v[100:103], v[36:39], v[12:15], v[100:103]
    ds_read_b64_tr_b16 v[74:75], v173 offset:9280
    v_mfma_f32_16x16x32_bf16 v[128:131], v[36:39], v[16:19], v[128:131]
    ds_read_b64_tr_b16 v[76:77], v173 offset:11392
    s_waitcnt lgkmcnt(15)
    v_mfma_f32_16x16x32_bf16 v[104:107], v[40:43], v[12:15], v[104:107]
    ds_read_b64_tr_b16 v[78:79], v173 offset:11456
    v_mfma_f32_16x16x32_bf16 v[132:135], v[40:43], v[16:19], v[132:135]
    ds_read_b64_tr_b16 v[80:81], v173 offset:15232
    s_waitcnt lgkmcnt(15)
    v_mfma_f32_16x16x32_bf16 v[108:111], v[44:47], v[12:15], v[108:111]
    ds_read_b64_tr_b16 v[82:83], v173 offset:15296
    v_mfma_f32_16x16x32_bf16 v[136:139], v[44:47], v[16:19], v[136:139]
    s_waitcnt lgkmcnt(0)
    s_barrier
    v_mfma_f32_16x16x32_bf16 v[84:87], v[56:59], v[48:51], v[84:87]
    ds_read_b128 v[12:15], v170 offset:49152
    ds_read_b64_tr_b16 v[20:21], v173 offset:17408
    v_mfma_f32_16x16x32_bf16 v[112:115], v[56:59], v[52:55], v[112:115]
    ds_read_b64_tr_b16 v[22:23], v173 offset:17472
    ds_read_b128 v[16:19], v170 offset:51200
    v_mfma_f32_16x16x32_bf16 v[88:91], v[60:63], v[48:51], v[88:91]
    ds_read_b64_tr_b16 v[24:25], v173 offset:19584
    v_mfma_f32_16x16x32_bf16 v[116:119], v[60:63], v[52:55], v[116:119]
    ds_read_b64_tr_b16 v[26:27], v173 offset:19648
    v_mfma_f32_16x16x32_bf16 v[92:95], v[64:67], v[48:51], v[92:95]
    ds_read_b64_tr_b16 v[28:29], v173 offset:21760
    v_mfma_f32_16x16x32_bf16 v[120:123], v[64:67], v[52:55], v[120:123]
    ds_read_b64_tr_b16 v[30:31], v173 offset:21824
    v_mfma_f32_16x16x32_bf16 v[96:99], v[68:71], v[48:51], v[96:99]
    ds_read_b64_tr_b16 v[32:33], v173 offset:23936
    v_mfma_f32_16x16x32_bf16 v[124:127], v[68:71], v[52:55], v[124:127]
    ds_read_b64_tr_b16 v[34:35], v173 offset:24000
    v_mfma_f32_16x16x32_bf16 v[100:103], v[72:75], v[48:51], v[100:103]
    ds_read_b64_tr_b16 v[36:37], v173 offset:26112
    v_mfma_f32_16x16x32_bf16 v[128:131], v[72:75], v[52:55], v[128:131]
    ds_read_b64_tr_b16 v[38:39], v173 offset:26176
    v_mfma_f32_16x16x32_bf16 v[104:107], v[76:79], v[48:51], v[104:107]
    ds_read_b64_tr_b16 v[40:41], v173 offset:28288
    v_mfma_f32_16x16x32_bf16 v[132:135], v[76:79], v[52:55], v[132:135]
    ds_read_b64_tr_b16 v[42:43], v173 offset:28352
    v_mfma_f32_16x16x32_bf16 v[108:111], v[80:83], v[48:51], v[108:111]
    ds_read_b64_tr_b16 v[44:45], v173 offset:30464
    v_mfma_f32_16x16x32_bf16 v[136:139], v[80:83], v[52:55], v[136:139]
    ds_read_b64_tr_b16 v[46:47], v173 offset:30528
    s_waitcnt lgkmcnt(13)
    v_mfma_f32_16x16x32_bf16 v[84:87], v[20:23], v[12:15], v[84:87]
    ds_read_b128 v[48:51], v171 offset:49152
    ds_read_b64_tr_b16 v[56:57], v173 offset:17920
    s_waitcnt lgkmcnt(14)
    v_mfma_f32_16x16x32_bf16 v[112:115], v[20:23], v[16:19], v[112:115]
    ds_read_b64_tr_b16 v[58:59], v173 offset:17984
    ds_read_b128 v[52:55], v171 offset:51200
    s_waitcnt lgkmcnt(14)
    v_mfma_f32_16x16x32_bf16 v[88:91], v[24:27], v[12:15], v[88:91]
    ds_read_b64_tr_b16 v[60:61], v173 offset:20096
    ds_read_b64_tr_b16 v[62:63], v173 offset:20160
    v_mfma_f32_16x16x32_bf16 v[116:119], v[24:27], v[16:19], v[116:119]
    ds_read_b64_tr_b16 v[64:65], v173 offset:22272
    s_waitcnt lgkmcnt(15)
    v_mfma_f32_16x16x32_bf16 v[92:95], v[28:31], v[12:15], v[92:95]
    ds_read_b64_tr_b16 v[66:67], v173 offset:22336
    v_mfma_f32_16x16x32_bf16 v[120:123], v[28:31], v[16:19], v[120:123]
    ds_read_b64_tr_b16 v[68:69], v173 offset:24448
    s_waitcnt lgkmcnt(15)
    v_mfma_f32_16x16x32_bf16 v[96:99], v[32:35], v[12:15], v[96:99]
    ds_read_b64_tr_b16 v[70:71], v173 offset:24512
    v_mfma_f32_16x16x32_bf16 v[124:127], v[32:35], v[16:19], v[124:127]
    ds_read_b64_tr_b16 v[72:73], v173 offset:26624
    s_waitcnt lgkmcnt(15)
    v_mfma_f32_16x16x32_bf16 v[100:103], v[36:39], v[12:15], v[100:103]
    ds_read_b64_tr_b16 v[74:75], v173 offset:26688
    v_mfma_f32_16x16x32_bf16 v[128:131], v[36:39], v[16:19], v[128:131]
    ds_read_b64_tr_b16 v[76:77], v173 offset:28800
    s_waitcnt lgkmcnt(15)
    v_mfma_f32_16x16x32_bf16 v[104:107], v[40:43], v[12:15], v[104:107]
    ds_read_b64_tr_b16 v[78:79], v173 offset:28864
    v_mfma_f32_16x16x32_bf16 v[132:135], v[40:43], v[16:19], v[132:135]
    ds_read_b64_tr_b16 v[80:81], v173 offset:32640
    s_waitcnt lgkmcnt(15)
    v_mfma_f32_16x16x32_bf16 v[108:111], v[44:47], v[12:15], v[108:111]
    ds_read_b64_tr_b16 v[82:83], v173 offset:32704
    v_mfma_f32_16x16x32_bf16 v[136:139], v[44:47], v[16:19], v[136:139]
    s_sub_u32 s48, s48, 1
    s_cmp_lg_u32 s48, 0
    s_waitcnt lgkmcnt(0)
    s_barrier
    s_cbranch_scc1 k4_kernel_cloop
    s_waitcnt vmcnt(0)
    v_mfma_f32_16x16x32_bf16 v[84:87], v[56:59], v[48:51], v[84:87]
    v_lshlrev_b32 v12, 16, v140
    v_and_b32 v13, s50, v140
    v_lshlrev_b32 v14, 16, v141
    v_and_b32 v15, s50, v141
    v_mfma_f32_16x16x32_bf16 v[112:115], v[56:59], v[52:55], v[112:115]
    v_lshlrev_b32 v16, 16, v142
    v_and_b32 v17, s50, v142
    v_lshlrev_b32 v18, 16, v143
    v_and_b32 v19, s50, v143
    v_mfma_f32_16x16x32_bf16 v[88:91], v[60:63], v[48:51], v[88:91]
    v_lshlrev_b32 v20, 16, v144
    v_and_b32 v21, s50, v144
    v_lshlrev_b32 v22, 16, v145
    v_and_b32 v23, s50, v145
    v_mfma_f32_16x16x32_bf16 v[116:119], v[60:63], v[52:55], v[116:119]
    v_lshlrev_b32 v24, 16, v146
    v_and_b32 v25, s50, v146
    v_lshlrev_b32 v26, 16, v147
    v_and_b32 v27, s50, v147
    v_mfma_f32_16x16x32_bf16 v[92:95], v[64:67], v[48:51], v[92:95]
    v_lshlrev_b32 v28, 16, v148
    v_and_b32 v29, s50, v148
    v_lshlrev_b32 v30, 16, v149
    v_and_b32 v31, s50, v149
    v_mfma_f32_16x16x32_bf16 v[120:123], v[64:67], v[52:55], v[120:123]
    v_lshlrev_b32 v32, 16, v150
    v_and_b32 v33, s50, v150
    v_lshlrev_b32 v34, 16, v151
    v_and_b32 v35, s50, v151
    v_mfma_f32_16x16x32_bf16 v[96:99], v[68:71], v[48:51], v[96:99]
    v_lshlrev_b32 v36, 16, v152
    v_and_b32 v37, s50, v152
    v_lshlrev_b32 v38, 16, v153
    v_and_b32 v39, s50, v153
    v_mfma_f32_16x16x32_bf16 v[124:127], v[68:71], v[52:55], v[124:127]
    v_lshlrev_b32 v40, 16, v154
    v_and_b32 v41, s50, v154
    v_lshlrev_b32 v42, 16, v155
    v_and_b32 v43, s50, v155
    v_mfma_f32_16x16x32_bf16 v[100:103], v[72:75], v[48:51], v[100:103]
    v_lshlrev_b32 v44, 16, v156
    v_and_b32 v45, s50, v156
    v_lshlrev_b32 v46, 16, v157
    v_and_b32 v47, s50, v157
    v_mfma_f32_16x16x32_bf16 v[128:131], v[72:75], v[52:55], v[128:131]
    v_mfma_f32_16x16x32_bf16 v[104:107], v[76:79], v[48:51], v[104:107]
    v_mfma_f32_16x16x32_bf16 v[132:135], v[76:79], v[52:55], v[132:135]
    v_mfma_f32_16x16x32_bf16 v[108:111], v[80:83], v[48:51], v[108:111]
    v_mfma_f32_16x16x32_bf16 v[136:139], v[80:83], v[52:55], v[136:139]
    v_pk_mul_f32 v[84:85], v[84:85], v[12:13]
    v_pk_mul_f32 v[86:87], v[86:87], v[14:15]
    v_cvt_pk_bf16_f32 v48, v84, v85
    v_cvt_pk_bf16_f32 v49, v86, v87
    v_pk_mul_f32 v[112:113], v[112:113], v[16:17]
    v_pk_mul_f32 v[114:115], v[114:115], v[18:19]
    v_cvt_pk_bf16_f32 v52, v112, v113
    v_cvt_pk_bf16_f32 v53, v114, v115
    v_pk_mul_f32 v[88:89], v[88:89], v[20:21]
    v_pk_mul_f32 v[90:91], v[90:91], v[22:23]
    v_cvt_pk_bf16_f32 v50, v88, v89
    v_cvt_pk_bf16_f32 v51, v90, v91
    buffer_store_dwordx4 v[48:51], v11, s[32:35], s20 offen offset:0 sc0 sc1
    v_pk_mul_f32 v[116:117], v[116:117], v[24:25]
    v_pk_mul_f32 v[118:119], v[118:119], v[26:27]
    v_cvt_pk_bf16_f32 v54, v116, v117
    v_cvt_pk_bf16_f32 v55, v118, v119
    buffer_store_dwordx4 v[52:55], v11, s[32:35], s20 offen offset:256 sc0 sc1
    v_pk_mul_f32 v[92:93], v[92:93], v[28:29]
    v_pk_mul_f32 v[94:95], v[94:95], v[30:31]
    v_cvt_pk_bf16_f32 v56, v92, v93
    v_cvt_pk_bf16_f32 v57, v94, v95
    v_pk_mul_f32 v[120:121], v[120:121], v[32:33]
    v_pk_mul_f32 v[122:123], v[122:123], v[34:35]
    v_cvt_pk_bf16_f32 v60, v120, v121
    v_cvt_pk_bf16_f32 v61, v122, v123
    v_pk_mul_f32 v[96:97], v[96:97], v[36:37]
    v_pk_mul_f32 v[98:99], v[98:99], v[38:39]
    v_cvt_pk_bf16_f32 v58, v96, v97
    v_cvt_pk_bf16_f32 v59, v98, v99
    s_add_u32 s20, s20, 131072
    buffer_store_dwordx4 v[56:59], v11, s[32:35], s20 offen offset:0 sc0 sc1
    v_pk_mul_f32 v[124:125], v[124:125], v[40:41]
    v_pk_mul_f32 v[126:127], v[126:127], v[42:43]
    v_cvt_pk_bf16_f32 v62, v124, v125
    v_cvt_pk_bf16_f32 v63, v126, v127
    buffer_store_dwordx4 v[60:63], v11, s[32:35], s20 offen offset:256 sc0 sc1
    v_pk_mul_f32 v[100:101], v[100:101], v[44:45]
    v_pk_mul_f32 v[102:103], v[102:103], v[46:47]
    v_cvt_pk_bf16_f32 v64, v100, v101
    v_cvt_pk_bf16_f32 v65, v102, v103
    v_lshlrev_b32 v12, 16, v158
    v_and_b32 v13, s50, v158
    v_lshlrev_b32 v14, 16, v159
    v_and_b32 v15, s50, v159
    v_pk_mul_f32 v[128:129], v[128:129], v[12:13]
    v_pk_mul_f32 v[130:131], v[130:131], v[14:15]
    v_cvt_pk_bf16_f32 v68, v128, v129
    v_cvt_pk_bf16_f32 v69, v130, v131
    v_lshlrev_b32 v16, 16, v160
    v_and_b32 v17, s50, v160
    v_lshlrev_b32 v18, 16, v161
    v_and_b32 v19, s50, v161
    v_pk_mul_f32 v[104:105], v[104:105], v[16:17]
    v_pk_mul_f32 v[106:107], v[106:107], v[18:19]
    v_cvt_pk_bf16_f32 v66, v104, v105
    v_cvt_pk_bf16_f32 v67, v106, v107
    s_add_u32 s20, s20, 131072
    buffer_store_dwordx4 v[64:67], v11, s[32:35], s20 offen offset:0 sc0 sc1
    v_lshlrev_b32 v20, 16, v162
    v_and_b32 v21, s50, v162
    v_lshlrev_b32 v22, 16, v163
    v_and_b32 v23, s50, v163
    v_pk_mul_f32 v[132:133], v[132:133], v[20:21]
    v_pk_mul_f32 v[134:135], v[134:135], v[22:23]
    v_cvt_pk_bf16_f32 v70, v132, v133
    v_cvt_pk_bf16_f32 v71, v134, v135
    buffer_store_dwordx4 v[68:71], v11, s[32:35], s20 offen offset:256 sc0 sc1
    v_lshlrev_b32 v24, 16, v164
    v_and_b32 v25, s50, v164
    v_lshlrev_b32 v26, 16, v165
    v_and_b32 v27, s50, v165
    v_pk_mul_f32 v[108:109], v[108:109], v[24:25]
    v_pk_mul_f32 v[110:111], v[110:111], v[26:27]
    v_cvt_pk_bf16_f32 v72, v108, v109
    v_cvt_pk_bf16_f32 v73, v110, v111
    buffer_store_dwordx2 v[72:73], v11, s[32:35], s22 offen offset:0
    v_lshlrev_b32 v28, 16, v166
    v_and_b32 v29, s50, v166
    v_lshlrev_b32 v30, 16, v167
    v_and_b32 v31, s50, v167
    v_pk_mul_f32 v[136:137], v[136:137], v[28:29]
    v_pk_mul_f32 v[138:139], v[138:139], v[30:31]
    v_cvt_pk_bf16_f32 v76, v136, v137
    v_cvt_pk_bf16_f32 v77, v138, v139
    buffer_store_dwordx2 v[76:77], v11, s[32:35], s22 offen offset:256
    s_endpgm
k4_kernel_prod:
    v_and_b32 v2, 63, v0
    v_lshrrev_b32 v3, 3, v2
    v_and_b32 v4, 7, v2
    s_sub_u32 s17, s16, 4
    s_lshl_b32 s18, s14, 7
    s_lshl_b32 s60, s17, 5
    s_add_u32 s60, s60, s18
    v_add_u32 v5, s60, v3
    s_mov_b32 s61, 4096
    v_mul_lo_u32 v5, v5, s61
    v_lshrrev_b32 v6, 4, v2
    v_xor_b32 v6, v6, v4
    v_lshl_add_u32 v8, v6, 4, v5
    v_xor_b32 v6, 4, v6
    v_lshl_add_u32 v9, v6, 4, v5
    v_add_u32 v10, 63488, v8
    v_add_u32 v11, 95232, v9
    v_add_u32 v9, 31744, v9
    s_mul_i32 s19, s17, 3
    s_add_u32 s20, s19, s13
    s_lshl_b32 s20, s20, 15
    v_lshlrev_b32 v5, 4, v2
    v_add_u32 v12, s20, v5
    v_add_u32 v13, 31680, v12
    v_add_u32 v14, 63360, v12
    s_and_b32 s20, s17, 1
    s_lshr_b32 s21, s17, 1
    s_add_u32 s22, s20, s12
    s_lshl_b32 s22, s22, 15
    s_lshl_b32 s23, s21, 9
    s_add_u32 s22, s22, s23
    v_add_u32 v15, s22, v5
    v_mov_b32 v6, 0x40000000
    v_cmp_gt_u32 vcc, 32, v2
    s_nop 1
    v_cndmask_b32 v15, v6, v15, vcc
    s_mul_i32 s40, s19, 1088
    s_add_u32 s44, s17, 12
    s_mul_i32 s44, s44, 1088
    s_lshl_b32 s43, s17, 12
    s_waitcnt lgkmcnt(0)
    s_mov_b32 s20, s8
    s_and_b32 s21, s9, 0xffff
    s_mov_b32 s22, 8388608
    s_mov_b32 s23, 0x00020000
    s_add_u32 s24, s4, 25165824
    s_addc_u32 s25, s5, 0
    s_and_b32 s25, s25, 0xffff
    s_mov_b32 s26, 7340032
    s_mov_b32 s27, 0x00020000
    v_lshlrev_b32 v16, 6, v2
    s_lshl_b32 s46, s2, 2
    s_add_u32 s46, s46, s17
    s_lshl_b32 s46, s46, 12
    s_mov_b32 s28, s50
    s_and_b32 s29, s51, 0xffff
    s_mov_b32 s30, 3670016
    s_mov_b32 s31, 0x00020000
    s_lshl_b32 s52, s2, 2
    s_add_u32 s52, s52, s17
    s_mul_i32 s52, s52, 3584
    s_add_u32 m0, s43, 0
    s_mov_b32 s41, 0
    buffer_load_dwordx4 v8, s[20:23], s41 offen offset:0 lds
    buffer_load_dwordx4 v9, s[20:23], s41 offen offset:1024 lds
    buffer_load_dwordx4 v10, s[20:23], s41 offen offset:2048 lds
    buffer_load_dwordx4 v11, s[20:23], s41 offen offset:3072 lds
    s_mov_b32 s42, 0
    s_add_u32 m0, s40, 65536
    s_nop 0
    buffer_load_dwordx4 v12, s[24:27], s42 offen offset:0 lds
    buffer_load_dwordx4 v13, s[24:27], s42 offen offset:1088 lds
    buffer_load_dwordx4 v14, s[24:27], s42 offen offset:2176 lds
    s_add_u32 m0, s44, 65536
    s_nop 0
    buffer_load_dwordx4 v15, s[24:27], s42 offen lds
    s_add_u32 m0, s43, 16384
    s_mov_b32 s41, 128
    buffer_load_dwordx4 v8, s[20:23], s41 offen offset:0 lds
    buffer_load_dwordx4 v9, s[20:23], s41 offen offset:1024 lds
    buffer_load_dwordx4 v10, s[20:23], s41 offen offset:2048 lds
    buffer_load_dwordx4 v11, s[20:23], s41 offen offset:3072 lds
    s_mov_b32 s42, 1024
    s_add_u32 m0, s40, 82944
    s_nop 0
    buffer_load_dwordx4 v12, s[24:27], s42 offen offset:0 lds
    buffer_load_dwordx4 v13, s[24:27], s42 offen offset:1088 lds
    buffer_load_dwordx4 v14, s[24:27], s42 offen offset:2176 lds
    s_add_u32 m0, s44, 82944
    s_nop 0
    buffer_load_dwordx4 v15, s[24:27], s42 offen lds
    s_waitcnt vmcnt(8)
    s_barrier
    s_add_u32 m0, s43, 32768
    s_mov_b32 s41, 256
    buffer_load_dwordx4 v8, s[20:23], s41 offen offset:0 lds
    buffer_load_dwordx4 v9, s[20:23], s41 offen offset:1024 lds
    buffer_load_dwordx4 v10, s[20:23], s41 offen offset:2048 lds
    buffer_load_dwordx4 v11, s[20:23], s41 offen offset:3072 lds
    s_mov_b32 s42, 2048
    s_add_u32 m0, s40, 100352
    s_nop 0
    buffer_load_dwordx4 v12, s[24:27], s42 offen offset:0 lds
    buffer_load_dwordx4 v13, s[24:27], s42 offen offset:1088 lds
    buffer_load_dwordx4 v14, s[24:27], s42 offen offset:2176 lds
    s_add_u32 m0, s44, 100352
    s_nop 0
    buffer_load_dwordx4 v15, s[24:27], s42 offen lds
    s_add_u32 m0, s43, 49152
    s_mov_b32 s41, 384
    buffer_load_dwordx4 v8, s[20:23], s41 offen offset:0 lds
    buffer_load_dwordx4 v9, s[20:23], s41 offen offset:1024 lds
    buffer_load_dwordx4 v10, s[20:23], s41 offen offset:2048 lds
    buffer_load_dwordx4 v11, s[20:23], s41 offen offset:3072 lds
    s_mov_b32 s42, 3072
    s_add_u32 m0, s40, 117760
    s_nop 0
    buffer_load_dwordx4 v12, s[24:27], s42 offen offset:0 lds
    buffer_load_dwordx4 v13, s[24:27], s42 offen offset:1088 lds
    buffer_load_dwordx4 v14, s[24:27], s42 offen offset:2176 lds
    s_add_u32 m0, s44, 117760
    s_nop 0
    buffer_load_dwordx4 v15, s[24:27], s42 offen lds
    s_buffer_load_dword s53, s[28:31], s52 offset:0
    s_buffer_load_dword s53, s[28:31], s52 offset:64
    s_waitcnt vmcnt(16)
    s_barrier
    s_add_u32 m0, s43, 0
    s_mov_b32 s41, 512
    buffer_load_dwordx4 v8, s[20:23], s41 offen offset:0 lds
    buffer_load_dwordx4 v9, s[20:23], s41 offen offset:1024 lds
    buffer_load_dwordx4 v10, s[20:23], s41 offen offset:2048 lds
    buffer_load_dwordx4 v11, s[20:23], s41 offen offset:3072 lds
    s_mov_b32 s42, 4096
    s_add_u32 m0, s40, 65536
    s_nop 0
    buffer_load_dwordx4 v12, s[24:27], s42 offen offset:0 lds
    buffer_load_dwordx4 v13, s[24:27], s42 offen offset:1088 lds
    buffer_load_dwordx4 v14, s[24:27], s42 offen offset:2176 lds
    s_add_u32 m0, s44, 65536
    s_nop 0
    buffer_load_dwordx4 v15, s[24:27], s42 offen lds
    s_buffer_load_dword s53, s[28:31], s52 offset:128
    s_buffer_load_dword s53, s[28:31], s52 offset:192
    s_waitcnt vmcnt(16)
    s_barrier
    s_add_u32 m0, s43, 16384
    s_mov_b32 s41, 640
    buffer_load_dwordx4 v8, s[20:23], s41 offen offset:0 lds
    buffer_load_dwordx4 v9, s[20:23], s41 offen offset:1024 lds
    buffer_load_dwordx4 v10, s[20:23], s41 offen offset:2048 lds
    buffer_load_dwordx4 v11, s[20:23], s41 offen offset:3072 lds
    s_mov_b32 s42, 5120
    s_add_u32 m0, s40, 82944
    s_nop 0
    buffer_load_dwordx4 v12, s[24:27], s42 offen offset:0 lds
    buffer_load_dwordx4 v13, s[24:27], s42 offen offset:1088 lds
    buffer_load_dwordx4 v14, s[24:27], s42 offen offset:2176 lds
    s_add_u32 m0, s44, 82944
    s_nop 0
    buffer_load_dwordx4 v15, s[24:27], s42 offen lds
    s_buffer_load_dword s53, s[28:31], s52 offset:256
    s_buffer_load_dword s53, s[28:31], s52 offset:320
    s_waitcnt vmcnt(16)
    s_barrier
    s_add_u32 m0, s43, 32768
    s_mov_b32 s41, 768
    buffer_load_dwordx4 v8, s[20:23], s41 offen offset:0 lds
    buffer_load_dwordx4 v9, s[20:23], s41 offen offset:1024 lds
    buffer_load_dwordx4 v10, s[20:23], s41 offen offset:2048 lds
    buffer_load_dwordx4 v11, s[20:23], s41 offen offset:3072 lds
    s_mov_b32 s42, 6144
    s_add_u32 m0, s40, 100352
    s_nop 0
    buffer_load_dwordx4 v12, s[24:27], s42 offen offset:0 lds
    buffer_load_dwordx4 v13, s[24:27], s42 offen offset:1088 lds
    buffer_load_dwordx4 v14, s[24:27], s42 offen offset:2176 lds
    s_add_u32 m0, s44, 100352
    s_nop 0
    buffer_load_dwordx4 v15, s[24:27], s42 offen lds
    s_buffer_load_dword s53, s[28:31], s52 offset:384
    s_buffer_load_dword s53, s[28:31], s52 offset:448
    s_waitcnt vmcnt(16)
    s_barrier
    s_add_u32 m0, s43, 49152
    s_mov_b32 s41, 896
    buffer_load_dwordx4 v8, s[20:23], s41 offen offset:0 lds
    buffer_load_dwordx4 v9, s[20:23], s41 offen offset:1024 lds
    buffer_load_dwordx4 v10, s[20:23], s41 offen offset:2048 lds
    buffer_load_dwordx4 v11, s[20:23], s41 offen offset:3072 lds
    s_mov_b32 s42, 7168
    s_add_u32 m0, s40, 117760
    s_nop 0
    buffer_load_dwordx4 v12, s[24:27], s42 offen offset:0 lds
    buffer_load_dwordx4 v13, s[24:27], s42 offen offset:1088 lds
    buffer_load_dwordx4 v14, s[24:27], s42 offen offset:2176 lds
    s_add_u32 m0, s44, 117760
    s_nop 0
    buffer_load_dwordx4 v15, s[24:27], s42 offen lds
    s_buffer_load_dword s53, s[28:31], s52 offset:512
    s_buffer_load_dword s53, s[28:31], s52 offset:576
    s_waitcnt vmcnt(16)
    s_barrier
    s_add_u32 m0, s43, 0
    s_mov_b32 s41, 1024
    buffer_load_dwordx4 v8, s[20:23], s41 offen offset:0 lds
    buffer_load_dwordx4 v9, s[20:23], s41 offen offset:1024 lds
    buffer_load_dwordx4 v10, s[20:23], s41 offen offset:2048 lds
    buffer_load_dwordx4 v11, s[20:23], s41 offen offset:3072 lds
    s_mov_b32 s42, 8192
    s_add_u32 m0, s40, 65536
    s_nop 0
    buffer_load_dwordx4 v12, s[24:27], s42 offen offset:0 lds
    buffer_load_dwordx4 v13, s[24:27], s42 offen offset:1088 lds
    buffer_load_dwordx4 v14, s[24:27], s42 offen offset:2176 lds
    s_add_u32 m0, s44, 65536
    s_nop 0
    buffer_load_dwordx4 v15, s[24:27], s42 offen lds
    s_buffer_load_dword s53, s[28:31], s52 offset:640
    s_buffer_load_dword s53, s[28:31], s52 offset:704
    s_waitcnt vmcnt(16)
    s_barrier
    s_add_u32 m0, s43, 16384
    s_mov_b32 s41, 1152
    buffer_load_dwordx4 v8, s[20:23], s41 offen offset:0 lds
    buffer_load_dwordx4 v9, s[20:23], s41 offen offset:1024 lds
    buffer_load_dwordx4 v10, s[20:23], s41 offen offset:2048 lds
    buffer_load_dwordx4 v11, s[20:23], s41 offen offset:3072 lds
    s_mov_b32 s42, 9216
    s_add_u32 m0, s40, 82944
    s_nop 0
    buffer_load_dwordx4 v12, s[24:27], s42 offen offset:0 lds
    buffer_load_dwordx4 v13, s[24:27], s42 offen offset:1088 lds
    buffer_load_dwordx4 v14, s[24:27], s42 offen offset:2176 lds
    s_add_u32 m0, s44, 82944
    s_nop 0
    buffer_load_dwordx4 v15, s[24:27], s42 offen lds
    s_buffer_load_dword s53, s[28:31], s52 offset:768
    s_buffer_load_dword s53, s[28:31], s52 offset:832
    s_waitcnt vmcnt(16)
    s_barrier
    s_add_u32 m0, s43, 32768
    s_mov_b32 s41, 1280
    buffer_load_dwordx4 v8, s[20:23], s41 offen offset:0 lds
    buffer_load_dwordx4 v9, s[20:23], s41 offen offset:1024 lds
    buffer_load_dwordx4 v10, s[20:23], s41 offen offset:2048 lds
    buffer_load_dwordx4 v11, s[20:23], s41 offen offset:3072 lds
    s_mov_b32 s42, 10240
    s_add_u32 m0, s40, 100352
    s_nop 0
    buffer_load_dwordx4 v12, s[24:27], s42 offen offset:0 lds
    buffer_load_dwordx4 v13, s[24:27], s42 offen offset:1088 lds
    buffer_load_dwordx4 v14, s[24:27], s42 offen offset:2176 lds
    s_add_u32 m0, s44, 100352
    s_nop 0
    buffer_load_dwordx4 v15, s[24:27], s42 offen lds
    s_buffer_load_dword s53, s[28:31], s52 offset:896
    s_buffer_load_dword s53, s[28:31], s52 offset:960
    s_waitcnt vmcnt(16)
    s_barrier
    s_add_u32 m0, s43, 49152
    s_mov_b32 s41, 1408
    buffer_load_dwordx4 v8, s[20:23], s41 offen offset:0 lds
    buffer_load_dwordx4 v9, s[20:23], s41 offen offset:1024 lds
    buffer_load_dwordx4 v10, s[20:23], s41 offen offset:2048 lds
    buffer_load_dwordx4 v11, s[20:23], s41 offen offset:3072 lds
    s_mov_b32 s42, 11264
    s_add_u32 m0, s40, 117760
    s_nop 0
    buffer_load_dwordx4 v12, s[24:27], s42 offen offset:0 lds
    buffer_load_dwordx4 v13, s[24:27], s42 offen offset:1088 lds
    buffer_load_dwordx4 v14, s[24:27], s42 offen offset:2176 lds
    s_add_u32 m0, s44, 117760
    s_nop 0
    buffer_load_dwordx4 v15, s[24:27], s42 offen lds
    s_buffer_load_dword s53, s[28:31], s52 offset:1024
    s_buffer_load_dword s53, s[28:31], s52 offset:1088
    s_waitcnt vmcnt(16)
    s_barrier
    s_add_u32 m0, s43, 0
    s_mov_b32 s41, 1536
    buffer_load_dwordx4 v8, s[20:23], s41 offen offset:0 lds
    buffer_load_dwordx4 v9, s[20:23], s41 offen offset:1024 lds
    buffer_load_dwordx4 v10, s[20:23], s41 offen offset:2048 lds
    buffer_load_dwordx4 v11, s[20:23], s41 offen offset:3072 lds
    s_mov_b32 s42, 12288
    s_add_u32 m0, s40, 65536
    s_nop 0
    buffer_load_dwordx4 v12, s[24:27], s42 offen offset:0 lds
    buffer_load_dwordx4 v13, s[24:27], s42 offen offset:1088 lds
    buffer_load_dwordx4 v14, s[24:27], s42 offen offset:2176 lds
    s_add_u32 m0, s44, 65536
    s_nop 0
    buffer_load_dwordx4 v15, s[24:27], s42 offen lds
    s_buffer_load_dword s53, s[28:31], s52 offset:1152
    s_buffer_load_dword s53, s[28:31], s52 offset:1216
    s_waitcnt vmcnt(16)
    s_barrier
    s_add_u32 m0, s43, 16384
    s_mov_b32 s41, 1664
    buffer_load_dwordx4 v8, s[20:23], s41 offen offset:0 lds
    buffer_load_dwordx4 v9, s[20:23], s41 offen offset:1024 lds
    buffer_load_dwordx4 v10, s[20:23], s41 offen offset:2048 lds
    buffer_load_dwordx4 v11, s[20:23], s41 offen offset:3072 lds
    s_mov_b32 s42, 13312
    s_add_u32 m0, s40, 82944
    s_nop 0
    buffer_load_dwordx4 v12, s[24:27], s42 offen offset:0 lds
    buffer_load_dwordx4 v13, s[24:27], s42 offen offset:1088 lds
    buffer_load_dwordx4 v14, s[24:27], s42 offen offset:2176 lds
    s_add_u32 m0, s44, 82944
    s_nop 0
    buffer_load_dwordx4 v15, s[24:27], s42 offen lds
    s_buffer_load_dword s53, s[28:31], s52 offset:1280
    s_buffer_load_dword s53, s[28:31], s52 offset:1344
    s_waitcnt vmcnt(16)
    s_barrier
    s_add_u32 m0, s43, 32768
    s_mov_b32 s41, 1792
    buffer_load_dwordx4 v8, s[20:23], s41 offen offset:0 lds
    buffer_load_dwordx4 v9, s[20:23], s41 offen offset:1024 lds
    buffer_load_dwordx4 v10, s[20:23], s41 offen offset:2048 lds
    buffer_load_dwordx4 v11, s[20:23], s41 offen offset:3072 lds
    s_mov_b32 s42, 14336
    s_add_u32 m0, s40, 100352
    s_nop 0
    buffer_load_dwordx4 v12, s[24:27], s42 offen offset:0 lds
    buffer_load_dwordx4 v13, s[24:27], s42 offen offset:1088 lds
    buffer_load_dwordx4 v14, s[24:27], s42 offen offset:2176 lds
    s_add_u32 m0, s44, 100352
    s_nop 0
    buffer_load_dwordx4 v15, s[24:27], s42 offen lds
    s_buffer_load_dword s53, s[28:31], s52 offset:1408
    s_buffer_load_dword s53, s[28:31], s52 offset:1472
    s_waitcnt vmcnt(16)
    s_barrier
    s_add_u32 m0, s43, 49152
    s_mov_b32 s41, 1920
    buffer_load_dwordx4 v8, s[20:23], s41 offen offset:0 lds
    buffer_load_dwordx4 v9, s[20:23], s41 offen offset:1024 lds
    buffer_load_dwordx4 v10, s[20:23], s41 offen offset:2048 lds
    buffer_load_dwordx4 v11, s[20:23], s41 offen offset:3072 lds
    s_mov_b32 s42, 15360
    s_add_u32 m0, s40, 117760
    s_nop 0
    buffer_load_dwordx4 v12, s[24:27], s42 offen offset:0 lds
    buffer_load_dwordx4 v13, s[24:27], s42 offen offset:1088 lds
    buffer_load_dwordx4 v14, s[24:27], s42 offen offset:2176 lds
    s_add_u32 m0, s44, 117760
    s_nop 0
    buffer_load_dwordx4 v15, s[24:27], s42 offen lds
    s_buffer_load_dword s53, s[28:31], s52 offset:1536
    s_buffer_load_dword s53, s[28:31], s52 offset:1600
    s_waitcnt vmcnt(16)
    s_barrier
    s_add_u32 m0, s43, 0
    s_mov_b32 s41, 2048
    buffer_load_dwordx4 v8, s[20:23], s41 offen offset:0 lds
    buffer_load_dwordx4 v9, s[20:23], s41 offen offset:1024 lds
    buffer_load_dwordx4 v10, s[20:23], s41 offen offset:2048 lds
    buffer_load_dwordx4 v11, s[20:23], s41 offen offset:3072 lds
    s_mov_b32 s42, 16384
    s_add_u32 m0, s40, 65536
    s_nop 0
    buffer_load_dwordx4 v12, s[24:27], s42 offen offset:0 lds
    buffer_load_dwordx4 v13, s[24:27], s42 offen offset:1088 lds
    buffer_load_dwordx4 v14, s[24:27], s42 offen offset:2176 lds
    s_add_u32 m0, s44, 65536
    s_nop 0
    buffer_load_dwordx4 v15, s[24:27], s42 offen lds
    s_buffer_load_dword s53, s[28:31], s52 offset:1664
    s_buffer_load_dword s53, s[28:31], s52 offset:1728
    s_waitcnt vmcnt(16)
    s_barrier
    s_add_u32 m0, s43, 16384
    s_mov_b32 s41, 2176
    buffer_load_dwordx4 v8, s[20:23], s41 offen offset:0 lds
    buffer_load_dwordx4 v9, s[20:23], s41 offen offset:1024 lds
    buffer_load_dwordx4 v10, s[20:23], s41 offen offset:2048 lds
    buffer_load_dwordx4 v11, s[20:23], s41 offen offset:3072 lds
    s_mov_b32 s42, 17408
    s_add_u32 m0, s40, 82944
    s_nop 0
    buffer_load_dwordx4 v12, s[24:27], s42 offen offset:0 lds
    buffer_load_dwordx4 v13, s[24:27], s42 offen offset:1088 lds
    buffer_load_dwordx4 v14, s[24:27], s42 offen offset:2176 lds
    s_add_u32 m0, s44, 82944
    s_nop 0
    buffer_load_dwordx4 v15, s[24:27], s42 offen lds
    s_buffer_load_dword s53, s[28:31], s52 offset:1792
    s_buffer_load_dword s53, s[28:31], s52 offset:1856
    s_waitcnt vmcnt(16)
    s_barrier
    s_add_u32 m0, s43, 32768
    s_mov_b32 s41, 2304
    buffer_load_dwordx4 v8, s[20:23], s41 offen offset:0 lds
    buffer_load_dwordx4 v9, s[20:23], s41 offen offset:1024 lds
    buffer_load_dwordx4 v10, s[20:23], s41 offen offset:2048 lds
    buffer_load_dwordx4 v11, s[20:23], s41 offen offset:3072 lds
    s_mov_b32 s42, 18432
    s_add_u32 m0, s40, 100352
    s_nop 0
    buffer_load_dwordx4 v12, s[24:27], s42 offen offset:0 lds
    buffer_load_dwordx4 v13, s[24:27], s42 offen offset:1088 lds
    buffer_load_dwordx4 v14, s[24:27], s42 offen offset:2176 lds
    s_add_u32 m0, s44, 100352
    s_nop 0
    buffer_load_dwordx4 v15, s[24:27], s42 offen lds
    s_buffer_load_dword s53, s[28:31], s52 offset:1920
    s_buffer_load_dword s53, s[28:31], s52 offset:1984
    s_waitcnt vmcnt(16)
    s_barrier
    s_add_u32 m0, s43, 49152
    s_mov_b32 s41, 2432
    buffer_load_dwordx4 v8, s[20:23], s41 offen offset:0 lds
    buffer_load_dwordx4 v9, s[20:23], s41 offen offset:1024 lds
    buffer_load_dwordx4 v10, s[20:23], s41 offen offset:2048 lds
    buffer_load_dwordx4 v11, s[20:23], s41 offen offset:3072 lds
    s_mov_b32 s42, 19456
    s_add_u32 m0, s40, 117760
    s_nop 0
    buffer_load_dwordx4 v12, s[24:27], s42 offen offset:0 lds
    buffer_load_dwordx4 v13, s[24:27], s42 offen offset:1088 lds
    buffer_load_dwordx4 v14, s[24:27], s42 offen offset:2176 lds
    s_add_u32 m0, s44, 117760
    s_nop 0
    buffer_load_dwordx4 v15, s[24:27], s42 offen lds
    s_buffer_load_dword s53, s[28:31], s52 offset:2048
    s_buffer_load_dword s53, s[28:31], s52 offset:2112
    s_waitcnt vmcnt(16)
    s_barrier
    s_add_u32 m0, s43, 0
    s_mov_b32 s41, 2560
    buffer_load_dwordx4 v8, s[20:23], s41 offen offset:0 lds
    buffer_load_dwordx4 v9, s[20:23], s41 offen offset:1024 lds
    buffer_load_dwordx4 v10, s[20:23], s41 offen offset:2048 lds
    buffer_load_dwordx4 v11, s[20:23], s41 offen offset:3072 lds
    s_mov_b32 s42, 20480
    s_add_u32 m0, s40, 65536
    s_nop 0
    buffer_load_dwordx4 v12, s[24:27], s42 offen offset:0 lds
    buffer_load_dwordx4 v13, s[24:27], s42 offen offset:1088 lds
    buffer_load_dwordx4 v14, s[24:27], s42 offen offset:2176 lds
    s_add_u32 m0, s44, 65536
    s_nop 0
    buffer_load_dwordx4 v15, s[24:27], s42 offen lds
    s_buffer_load_dword s53, s[28:31], s52 offset:2176
    s_buffer_load_dword s53, s[28:31], s52 offset:2240
    s_waitcnt vmcnt(16)
    s_barrier
    s_add_u32 m0, s43, 16384
    s_mov_b32 s41, 2688
    buffer_load_dwordx4 v8, s[20:23], s41 offen offset:0 lds
    buffer_load_dwordx4 v9, s[20:23], s41 offen offset:1024 lds
    buffer_load_dwordx4 v10, s[20:23], s41 offen offset:2048 lds
    buffer_load_dwordx4 v11, s[20:23], s41 offen offset:3072 lds
    s_mov_b32 s42, 21504
    s_add_u32 m0, s40, 82944
    s_nop 0
    buffer_load_dwordx4 v12, s[24:27], s42 offen offset:0 lds
    buffer_load_dwordx4 v13, s[24:27], s42 offen offset:1088 lds
    buffer_load_dwordx4 v14, s[24:27], s42 offen offset:2176 lds
    s_add_u32 m0, s44, 82944
    s_nop 0
    buffer_load_dwordx4 v15, s[24:27], s42 offen lds
    s_buffer_load_dword s53, s[28:31], s52 offset:2304
    s_buffer_load_dword s53, s[28:31], s52 offset:2368
    s_waitcnt vmcnt(16)
    s_barrier
    s_add_u32 m0, s43, 32768
    s_mov_b32 s41, 2816
    buffer_load_dwordx4 v8, s[20:23], s41 offen offset:0 lds
    buffer_load_dwordx4 v9, s[20:23], s41 offen offset:1024 lds
    buffer_load_dwordx4 v10, s[20:23], s41 offen offset:2048 lds
    buffer_load_dwordx4 v11, s[20:23], s41 offen offset:3072 lds
    s_mov_b32 s42, 22528
    s_add_u32 m0, s40, 100352
    s_nop 0
    buffer_load_dwordx4 v12, s[24:27], s42 offen offset:0 lds
    buffer_load_dwordx4 v13, s[24:27], s42 offen offset:1088 lds
    buffer_load_dwordx4 v14, s[24:27], s42 offen offset:2176 lds
    s_add_u32 m0, s44, 100352
    s_nop 0
    buffer_load_dwordx4 v15, s[24:27], s42 offen lds
    s_buffer_load_dword s53, s[28:31], s52 offset:2432
    s_buffer_load_dword s53, s[28:31], s52 offset:2496
    s_waitcnt vmcnt(16)
    s_barrier
    s_add_u32 m0, s43, 49152
    s_mov_b32 s41, 2944
    buffer_load_dwordx4 v8, s[20:23], s41 offen offset:0 lds
    buffer_load_dwordx4 v9, s[20:23], s41 offen offset:1024 lds
    buffer_load_dwordx4 v10, s[20:23], s41 offen offset:2048 lds
    buffer_load_dwordx4 v11, s[20:23], s41 offen offset:3072 lds
    s_mov_b32 s42, 23552
    s_add_u32 m0, s40, 117760
    s_nop 0
    buffer_load_dwordx4 v12, s[24:27], s42 offen offset:0 lds
    buffer_load_dwordx4 v13, s[24:27], s42 offen offset:1088 lds
    buffer_load_dwordx4 v14, s[24:27], s42 offen offset:2176 lds
    s_add_u32 m0, s44, 117760
    s_nop 0
    buffer_load_dwordx4 v15, s[24:27], s42 offen lds
    s_buffer_load_dword s53, s[28:31], s52 offset:2560
    s_buffer_load_dword s53, s[28:31], s52 offset:2624
    s_waitcnt vmcnt(16)
    s_barrier
    s_add_u32 m0, s43, 0
    s_mov_b32 s41, 3072
    buffer_load_dwordx4 v8, s[20:23], s41 offen offset:0 lds
    buffer_load_dwordx4 v9, s[20:23], s41 offen offset:1024 lds
    buffer_load_dwordx4 v10, s[20:23], s41 offen offset:2048 lds
    buffer_load_dwordx4 v11, s[20:23], s41 offen offset:3072 lds
    s_mov_b32 s42, 24576
    s_add_u32 m0, s40, 65536
    s_nop 0
    buffer_load_dwordx4 v12, s[24:27], s42 offen offset:0 lds
    buffer_load_dwordx4 v13, s[24:27], s42 offen offset:1088 lds
    buffer_load_dwordx4 v14, s[24:27], s42 offen offset:2176 lds
    s_add_u32 m0, s44, 65536
    s_nop 0
    buffer_load_dwordx4 v15, s[24:27], s42 offen lds
    s_buffer_load_dword s53, s[28:31], s52 offset:2688
    s_buffer_load_dword s53, s[28:31], s52 offset:2752
    s_waitcnt vmcnt(16)
    s_barrier
    s_add_u32 m0, s43, 16384
    s_mov_b32 s41, 3200
    buffer_load_dwordx4 v8, s[20:23], s41 offen offset:0 lds
    buffer_load_dwordx4 v9, s[20:23], s41 offen offset:1024 lds
    buffer_load_dwordx4 v10, s[20:23], s41 offen offset:2048 lds
    buffer_load_dwordx4 v11, s[20:23], s41 offen offset:3072 lds
    s_mov_b32 s42, 25600
    s_add_u32 m0, s40, 82944
    s_nop 0
    buffer_load_dwordx4 v12, s[24:27], s42 offen offset:0 lds
    buffer_load_dwordx4 v13, s[24:27], s42 offen offset:1088 lds
    buffer_load_dwordx4 v14, s[24:27], s42 offen offset:2176 lds
    s_add_u32 m0, s44, 82944
    s_nop 0
    buffer_load_dwordx4 v15, s[24:27], s42 offen lds
    s_buffer_load_dword s53, s[28:31], s52 offset:2816
    s_buffer_load_dword s53, s[28:31], s52 offset:2880
    s_waitcnt vmcnt(16)
    s_barrier
    s_add_u32 m0, s43, 32768
    s_mov_b32 s41, 3328
    buffer_load_dwordx4 v8, s[20:23], s41 offen offset:0 lds
    buffer_load_dwordx4 v9, s[20:23], s41 offen offset:1024 lds
    buffer_load_dwordx4 v10, s[20:23], s41 offen offset:2048 lds
    buffer_load_dwordx4 v11, s[20:23], s41 offen offset:3072 lds
    s_mov_b32 s42, 26624
    s_add_u32 m0, s40, 100352
    s_nop 0
    buffer_load_dwordx4 v12, s[24:27], s42 offen offset:0 lds
    buffer_load_dwordx4 v13, s[24:27], s42 offen offset:1088 lds
    buffer_load_dwordx4 v14, s[24:27], s42 offen offset:2176 lds
    s_add_u32 m0, s44, 100352
    s_nop 0
    buffer_load_dwordx4 v15, s[24:27], s42 offen lds
    s_buffer_load_dword s53, s[28:31], s52 offset:2944
    s_buffer_load_dword s53, s[28:31], s52 offset:3008
    s_waitcnt vmcnt(16)
    s_barrier
    s_add_u32 m0, s43, 49152
    s_mov_b32 s41, 3456
    buffer_load_dwordx4 v8, s[20:23], s41 offen offset:0 lds
    buffer_load_dwordx4 v9, s[20:23], s41 offen offset:1024 lds
    buffer_load_dwordx4 v10, s[20:23], s41 offen offset:2048 lds
    buffer_load_dwordx4 v11, s[20:23], s41 offen offset:3072 lds
    s_mov_b32 s42, 27648
    s_add_u32 m0, s40, 117760
    s_nop 0
    buffer_load_dwordx4 v12, s[24:27], s42 offen offset:0 lds
    buffer_load_dwordx4 v13, s[24:27], s42 offen offset:1088 lds
    buffer_load_dwordx4 v14, s[24:27], s42 offen offset:2176 lds
    s_add_u32 m0, s44, 117760
    s_nop 0
    buffer_load_dwordx4 v15, s[24:27], s42 offen lds
    s_buffer_load_dword s53, s[28:31], s52 offset:3072
    s_buffer_load_dword s53, s[28:31], s52 offset:3136
    s_waitcnt vmcnt(16)
    s_barrier
    s_add_u32 m0, s43, 0
    s_mov_b32 s41, 3584
    buffer_load_dwordx4 v8, s[20:23], s41 offen offset:0 lds
    buffer_load_dwordx4 v9, s[20:23], s41 offen offset:1024 lds
    buffer_load_dwordx4 v10, s[20:23], s41 offen offset:2048 lds
    buffer_load_dwordx4 v11, s[20:23], s41 offen offset:3072 lds
    s_mov_b32 s42, 28672
    s_add_u32 m0, s40, 65536
    s_nop 0
    buffer_load_dwordx4 v12, s[24:27], s42 offen offset:0 lds
    buffer_load_dwordx4 v13, s[24:27], s42 offen offset:1088 lds
    buffer_load_dwordx4 v14, s[24:27], s42 offen offset:2176 lds
    s_add_u32 m0, s44, 65536
    s_nop 0
    buffer_load_dwordx4 v15, s[24:27], s42 offen lds
    s_buffer_load_dword s53, s[28:31], s52 offset:3200
    s_buffer_load_dword s53, s[28:31], s52 offset:3264
    s_waitcnt vmcnt(16)
    s_barrier
    s_add_u32 m0, s43, 16384
    s_mov_b32 s41, 3712
    buffer_load_dwordx4 v8, s[20:23], s41 offen offset:0 lds
    buffer_load_dwordx4 v9, s[20:23], s41 offen offset:1024 lds
    buffer_load_dwordx4 v10, s[20:23], s41 offen offset:2048 lds
    buffer_load_dwordx4 v11, s[20:23], s41 offen offset:3072 lds
    s_mov_b32 s42, 29696
    s_add_u32 m0, s40, 82944
    s_nop 0
    buffer_load_dwordx4 v12, s[24:27], s42 offen offset:0 lds
    buffer_load_dwordx4 v13, s[24:27], s42 offen offset:1088 lds
    buffer_load_dwordx4 v14, s[24:27], s42 offen offset:2176 lds
    s_add_u32 m0, s44, 82944
    s_nop 0
    buffer_load_dwordx4 v15, s[24:27], s42 offen lds
    s_buffer_load_dword s53, s[28:31], s52 offset:3328
    s_buffer_load_dword s53, s[28:31], s52 offset:3392
    s_waitcnt vmcnt(16)
    s_barrier
    s_add_u32 m0, s43, 32768
    s_mov_b32 s41, 3840
    buffer_load_dwordx4 v8, s[20:23], s41 offen offset:0 lds
    buffer_load_dwordx4 v9, s[20:23], s41 offen offset:1024 lds
    buffer_load_dwordx4 v10, s[20:23], s41 offen offset:2048 lds
    buffer_load_dwordx4 v11, s[20:23], s41 offen offset:3072 lds
    s_mov_b32 s42, 30720
    s_add_u32 m0, s40, 100352
    s_nop 0
    buffer_load_dwordx4 v12, s[24:27], s42 offen offset:0 lds
    buffer_load_dwordx4 v13, s[24:27], s42 offen offset:1088 lds
    buffer_load_dwordx4 v14, s[24:27], s42 offen offset:2176 lds
    s_add_u32 m0, s44, 100352
    s_nop 0
    buffer_load_dwordx4 v15, s[24:27], s42 offen lds
    s_buffer_load_dword s53, s[28:31], s52 offset:3456
    s_buffer_load_dword s53, s[28:31], s52 offset:3520
    s_waitcnt vmcnt(16)
    s_barrier
    s_add_u32 m0, s43, 49152
    s_mov_b32 s41, 3968
    buffer_load_dwordx4 v8, s[20:23], s41 offen offset:0 lds
    buffer_load_dwordx4 v9, s[20:23], s41 offen offset:1024 lds
    buffer_load_dwordx4 v10, s[20:23], s41 offen offset:2048 lds
    buffer_load_dwordx4 v11, s[20:23], s41 offen offset:3072 lds
    s_mov_b32 s42, 31744
    s_add_u32 m0, s40, 117760
    s_nop 0
    buffer_load_dwordx4 v12, s[24:27], s42 offen offset:0 lds
    buffer_load_dwordx4 v13, s[24:27], s42 offen offset:1088 lds
    buffer_load_dwordx4 v14, s[24:27], s42 offen offset:2176 lds
    s_add_u32 m0, s44, 117760
    s_nop 0
    buffer_load_dwordx4 v15, s[24:27], s42 offen lds
    s_waitcnt vmcnt(16)
    s_barrier
    s_waitcnt vmcnt(8)
    s_getpc_b64 s[48:49]
pfc_11:
    s_add_u32 s48, s48, k5_kernel-pfc_11
    s_addc_u32 s49, s49, 0
    s_lshr_b32 s50, s2, 3
    s_lshl_b32 s50, s50, 2
    s_add_u32 s50, s50, s17
    s_lshl_b32 s50, s50, 8
    v_and_b32 v17, 3, v2
    v_lshlrev_b32 v17, 6, v17
    v_add_u32 v17, s50, v17
    v_min_u32 v17, k5_kernel_end-k5_kernel, v17
    global_load_dword v17, v17, s[48:49]
    s_barrier
    s_waitcnt vmcnt(1)
    s_barrier
    s_barrier
k4_kernel_end:
    s_endpgm
.text
.globl k5_kernel
.p2align 8
.type k5_kernel,@function
k5_kernel:
    s_cmp_ge_u32 s2, 256
    s_cbranch_scc1 k5_kernel_end
    v_lshrrev_b32 v1, 6, v0
    s_nop 0
    v_readfirstlane_b32 s16, v1
    s_load_dwordx2 s[4:5], s[0:1], 104
    s_load_dwordx2 s[8:9], s[0:1], 64
    s_load_dwordx2 s[10:11], s[0:1], 88
    s_and_b32 s3, s2, 7
    s_lshr_b32 s6, s2, 3
    s_and_b32 s14, s3, 1
    s_lshl_b32 s14, s14, 3
    s_and_b32 s7, s6, 7
    s_add_u32 s14, s14, s7
    s_lshr_b32 s15, s3, 1
    s_lshl_b32 s15, s15, 2
    s_lshr_b32 s7, s6, 3
    s_add_u32 s15, s15, s7
    s_cmp_ge_u32 s16, 4
    s_cbranch_scc1 k5_kernel_prod
    v_and_b32 v2, 63, v0
    v_and_b32 v3, 15, v0
    v_bfe_u32 v4, v0, 4, 2
    v_bfe_u32 v5, v0, 2, 2
    v_and_b32 v6, 3, v0
    s_lshr_b32 s17, s16, 1
    s_and_b32 s18, s16, 1
    v_lshlrev_b32 v10, 11, v4
    v_lshl_add_u32 v10, v3, 4, v10
    s_lshl_b32 s60, s17, 10
    v_add_u32 v10, s60, v10
    v_add_u32 v11, 65536, v10
    v_and_b32 v7, 1, v4
    v_lshl_add_u32 v12, v7, 4, v5
    v_lshrrev_b32 v7, 1, v4
    v_lshl_add_u32 v12, v7, 2, v12
    v_lshlrev_b32 v12, 7, v12
    v_lshl_add_u32 v12, v6, 3, v12
    v_lshrrev_b32 v7, 1, v5
    v_xor_b32 v7, s18, v7
    v_lshl_add_u32 v12, v7, 6, v12
    v_and_b32 v7, 1, v4
    v_lshl_add_u32 v12, v7, 5, v12
    v_add_u32 v12, 98304, v12
    v_xor_b32 v13, 32, v12
    v_lshlrev_b32 v128, 15, v4
    v_lshl_add_u32 v128, v3, 4, v128
    s_lshl_b32 s19, s15, 1
    s_add_u32 s19, s19, s18
    s_lshl_b32 s20, s14, 1
    s_add_u32 s20, s20, s17
    s_lshl_b32 s21, s19, 17
    s_lshl_b32 s22, s20, 10
    s_add_u32 s21, s21, s22
    v_and_b32 v7, 1, v4
    v_lshlrev_b32 v129, 5, v7
    v_lshrrev_b32 v7, 1, v4
    v_lshl_add_u32 v129, v7, 4, v129
    v_lshl_add_u32 v129, v3, 11, v129
    s_lshl_b32 s22, s20, 17
    s_lshl_b32 s23, s19, 6
    s_add_u32 s22, s22, s23
    v_lshlrev_b32 v130, 4, v4
    s_lshl_b32 s23, s19, 7
    v_mov_b32 v64, 0
    v_mov_b32 v65, 0
    v_mov_b32 v66, 0
    v_mov_b32 v67, 0
    v_mov_b32 v68, 0
    v_mov_b32 v69, 0
    v_mov_b32 v70, 0
    v_mov_b32 v71, 0
    v_mov_b32 v72, 0
    v_mov_b32 v73, 0
    v_mov_b32 v74, 0
    v_mov_b32 v75, 0
    v_mov_b32 v76, 0
    v_mov_b32 v77, 0
    v_mov_b32 v78, 0
    v_mov_b32 v79, 0
    v_mov_b32 v80, 0
    v_mov_b32 v81, 0
    v_mov_b32 v82, 0
    v_mov_b32 v83, 0
    v_mov_b32 v84, 0
    v_mov_b32 v85, 0
    v_mov_b32 v86, 0
    v_mov_b32 v87, 0
    v_mov_b32 v88, 0
    v_mov_b32 v89, 0
    v_mov_b32 v90, 0
    v_mov_b32 v91, 0
    v_mov_b32 v92, 0
    v_mov_b32 v93, 0
    v_mov_b32 v94, 0
    v_mov_b32 v95, 0
    v_mov_b32 v40, 0
    v_mov_b32 v41, 0
    v_mov_b32 v42, 0
    v_mov_b32 v43, 0
    v_mov_b32 v44, 0
    v_mov_b32 v45, 0
    v_mov_b32 v46, 0
    v_mov_b32 v47, 0
    v_mov_b32 v48, 0
    v_mov_b32 v49, 0
    v_mov_b32 v50, 0
    v_mov_b32 v51, 0
    v_mov_b32 v52, 0
    v_mov_b32 v53, 0
    v_mov_b32 v54, 0
    v_mov_b32 v55, 0
    v_mov_b32 v56, 0
    v_mov_b32 v57, 0
    v_mov_b32 v58, 0
    v_mov_b32 v59, 0
    v_mov_b32 v60, 0
    v_mov_b32 v61, 0
    v_mov_b32 v62, 0
    v_mov_b32 v63, 0
    s_waitcnt lgkmcnt(0)
    s_mov_b32 s24, s10
    s_and_b32 s25, s11, 0xffff
    s_mov_b32 s26, 4194304
    s_mov_b32 s27, 0x00020000
    s_mov_b32 s28, s4
    s_and_b32 s29, s5, 0xffff
    s_mov_b32 s30, 376832
    s_mov_b32 s31, 0x00020000
    s_add_u32 s36, s4, 13631488
    s_addc_u32 s37, s5, 0
    s_and_b32 s37, s37, 0xffff
    s_mov_b32 s38, 4194304
    s_mov_b32 s39, 0x00020000
    s_add_u32 s40, s4, 44040192
    s_addc_u32 s41, s5, 0
    s_and_b32 s41, s41, 0xffff
    s_mov_b32 s42, 4194304
    s_mov_b32 s43, 0x00020000
    s_mov_b32 s50, 0xffff0000
    s_mov_b32 s48, 1
    s_barrier
k5_kernel_cloop:
    v_mfma_f32_16x16x32_bf16 v[64:67], v[56:59], v[40:43], v[64:67]
    ds_read_b128 v[16:19], v10 offset:0
    v_mfma_f32_16x16x32_bf16 v[72:75], v[56:59], v[44:47], v[72:75]
    ds_read_b64_tr_b16 v[32:33], v12 offset:0
    v_mfma_f32_16x16x32_bf16 v[80:83], v[56:59], v[48:51], v[80:83]
    ds_read_b64_tr_b16 v[34:35], v12 offset:1024
    v_mfma_f32_16x16x32_bf16 v[88:91], v[56:59], v[52:55], v[88:91]
    ds_read_b128 v[20:23], v10 offset:256
    v_mfma_f32_16x16x32_bf16 v[68:71], v[60:63], v[40:43], v[68:71]
    ds_read_b128 v[24:27], v10 offset:512
    v_mfma_f32_16x16x32_bf16 v[76:79], v[60:63], v[44:47], v[76:79]
    ds_read_b128 v[28:31], v10 offset:768
    v_mfma_f32_16x16x32_bf16 v[84:87], v[60:63], v[48:51], v[84:87]
    ds_read_b64_tr_b16 v[36:37], v13 offset:0
    v_mfma_f32_16x16x32_bf16 v[92:95], v[60:63], v[52:55], v[92:95]
    ds_read_b64_tr_b16 v[38:39], v13 offset:1024
    s_waitcnt lgkmcnt(5)
    v_mfma_f32_16x16x32_bf16 v[64:67], v[32:35], v[16:19], v[64:67]
    ds_read_b128 v[40:43], v10 offset:8192
    ds_read_b64_tr_b16 v[56:57], v12 offset:4096
    s_waitcnt lgkmcnt(6)
    v_mfma_f32_16x16x32_bf16 v[72:75], v[32:35], v[20:23], v[72:75]
    ds_read_b64_tr_b16 v[58:59], v12 offset:5120
    s_waitcnt lgkmcnt(6)
    v_mfma_f32_16x16x32_bf16 v[80:83], v[32:35], v[24:27], v[80:83]
    ds_read_b128 v[44:47], v10 offset:8448
    s_waitcnt lgkmcnt(6)
    v_mfma_f32_16x16x32_bf16 v[88:91], v[32:35], v[28:31], v[88:91]
    ds_read_b128 v[48:51], v10 offset:8704
    s_waitcnt lgkmcnt(5)
    v_mfma_f32_16x16x32_bf16 v[68:71], v[36:39], v[16:19], v[68:71]
    ds_read_b128 v[52:55], v10 offset:8960
    v_mfma_f32_16x16x32_bf16 v[76:79], v[36:39], v[20:23], v[76:79]
    ds_read_b64_tr_b16 v[60:61], v13 offset:4096
    v_mfma_f32_16x16x32_bf16 v[84:87], v[36:39], v[24:27], v[84:87]
    ds_read_b64_tr_b16 v[62:63], v13 offset:5120
    v_mfma_f32_16x16x32_bf16 v[92:95], v[36:39], v[28:31], v[92:95]
    s_waitcnt lgkmcnt(0)
    s_barrier
    v_mfma_f32_16x16x32_bf16 v[64:67], v[56:59], v[40:43], v[64:67]
    ds_read_b128 v[16:19], v10 offset:16384
    v_mfma_f32_16x16x32_bf16 v[72:75], v[56:59], v[44:47], v[72:75]
    ds_read_b64_tr_b16 v[32:33], v12 offset:8192
    v_mfma_f32_16x16x32_bf16 v[80:83], v[56:59], v[48:51], v[80:83]
    ds_read_b64_tr_b16 v[34:35], v12 offset:9216
    v_mfma_f32_16x16x32_bf16 v[88:91], v[56:59], v[52:55], v[88:91]
    ds_read_b128 v[20:23], v10 offset:16640
    v_mfma_f32_16x16x32_bf16 v[68:71], v[60:63], v[40:43], v[68:71]
    ds_read_b128 v[24:27], v10 offset:16896
    v_mfma_f32_16x16x32_bf16 v[76:79], v[60:63], v[44:47], v[76:79]
    ds_read_b128 v[28:31], v10 offset:17152
    v_mfma_f32_16x16x32_bf16 v[84:87], v[60:63], v[48:51], v[84:87]
    ds_read_b64_tr_b16 v[36:37], v13 offset:8192
    v_mfma_f32_16x16x32_bf16 v[92:95], v[60:63], v[52:55], v[92:95]
    ds_read_b64_tr_b16 v[38:39], v13 offset:9216
    s_waitcnt lgkmcnt(5)
    v_mfma_f32_16x16x32_bf16 v[64:67], v[32:35], v[16:19], v[64:67]
    ds_read_b128 v[40:43], v10 offset:24576
    ds_read_b64_tr_b16 v[56:57], v12 offset:12288
    s_waitcnt lgkmcnt(6)
    v_mfma_f32_16x16x32_bf16 v[72:75], v[32:35], v[20:23], v[72:75]
    ds_read_b64_tr_b16 v[58:59], v12 offset:13312
    s_waitcnt lgkmcnt(6)
    v_mfma_f32_16x16x32_bf16 v[80:83], v[32:35], v[24:27], v[80:83]
    ds_read_b128 v[44:47], v10 offset:24832
    s_waitcnt lgkmcnt(6)
    v_mfma_f32_16x16x32_bf16 v[88:91], v[32:35], v[28:31], v[88:91]
    ds_read_b128 v[48:51], v10 offset:25088
    s_waitcnt lgkmcnt(5)
    v_mfma_f32_16x16x32_bf16 v[68:71], v[36:39], v[16:19], v[68:71]
    ds_read_b128 v[52:55], v10 offset:25344
    v_mfma_f32_16x16x32_bf16 v[76:79], v[36:39], v[20:23], v[76:79]
    ds_read_b64_tr_b16 v[60:61], v13 offset:12288
    v_mfma_f32_16x16x32_bf16 v[84:87], v[36:39], v[24:27], v[84:87]
    ds_read_b64_tr_b16 v[62:63], v13 offset:13312
    v_mfma_f32_16x16x32_bf16 v[92:95], v[36:39], v[28:31], v[92:95]
    s_waitcnt lgkmcnt(0)
    s_barrier
    v_mfma_f32_16x16x32_bf16 v[64:67], v[56:59], v[40:43], v[64:67]
    ds_read_b128 v[16:19], v10 offset:32768
    v_mfma_f32_16x16x32_bf16 v[72:75], v[56:59], v[44:47], v[72:75]
    ds_read_b64_tr_b16 v[32:33], v12 offset:16384
    v_mfma_f32_16x16x32_bf16 v[80:83], v[56:59], v[48:51], v[80:83]
    ds_read_b64_tr_b16 v[34:35], v12 offset:17408
    v_mfma_f32_16x16x32_bf16 v[88:91], v[56:59], v[52:55], v[88:91]
    ds_read_b128 v[20:23], v10 offset:33024
    v_mfma_f32_16x16x32_bf16 v[68:71], v[60:63], v[40:43], v[68:71]
    ds_read_b128 v[24:27], v10 offset:33280
    v_mfma_f32_16x16x32_bf16 v[76:79], v[60:63], v[44:47], v[76:79]
    ds_read_b128 v[28:31], v10 offset:33536
    v_mfma_f32_16x16x32_bf16 v[84:87], v[60:63], v[48:51], v[84:87]
    ds_read_b64_tr_b16 v[36:37], v13 offset:16384
    v_mfma_f32_16x16x32_bf16 v[92:95], v[60:63], v[52:55], v[92:95]
    ds_read_b64_tr_b16 v[38:39], v13 offset:17408
    s_waitcnt lgkmcnt(5)
    v_mfma_f32_16x16x32_bf16 v[64:67], v[32:35], v[16:19], v[64:67]
    ds_read_b128 v[40:43], v10 offset:40960
    ds_read_b64_tr_b16 v[56:57], v12 offset:20480
    s_waitcnt lgkmcnt(6)
    v_mfma_f32_16x16x32_bf16 v[72:75], v[32:35], v[20:23], v[72:75]
    ds_read_b64_tr_b16 v[58:59], v12 offset:21504
    s_waitcnt lgkmcnt(6)
    v_mfma_f32_16x16x32_bf16 v[80:83], v[32:35], v[24:27], v[80:83]
    ds_read_b128 v[44:47], v10 offset:41216
    s_waitcnt lgkmcnt(6)
    v_mfma_f32_16x16x32_bf16 v[88:91], v[32:35], v[28:31], v[88:91]
    ds_read_b128 v[48:51], v10 offset:41472
    s_waitcnt lgkmcnt(5)
    v_mfma_f32_16x16x32_bf16 v[68:71], v[36:39], v[16:19], v[68:71]
    ds_read_b128 v[52:55], v10 offset:41728
    v_mfma_f32_16x16x32_bf16 v[76:79], v[36:39], v[20:23], v[76:79]
    ds_read_b64_tr_b16 v[60:61], v13 offset:20480
    v_mfma_f32_16x16x32_bf16 v[84:87], v[36:39], v[24:27], v[84:87]
    ds_read_b64_tr_b16 v[62:63], v13 offset:21504
    v_mfma_f32_16x16x32_bf16 v[92:95], v[36:39], v[28:31], v[92:95]
    s_waitcnt lgkmcnt(0)
    s_barrier
    v_mfma_f32_16x16x32_bf16 v[64:67], v[56:59], v[40:43], v[64:67]
    ds_read_b128 v[16:19], v10 offset:49152
    v_mfma_f32_16x16x32_bf16 v[72:75], v[56:59], v[44:47], v[72:75]
    ds_read_b64_tr_b16 v[32:33], v12 offset:24576
    v_mfma_f32_16x16x32_bf16 v[80:83], v[56:59], v[48:51], v[80:83]
    ds_read_b64_tr_b16 v[34:35], v12 offset:25600
    v_mfma_f32_16x16x32_bf16 v[88:91], v[56:59], v[52:55], v[88:91]
    ds_read_b128 v[20:23], v10 offset:49408
    v_mfma_f32_16x16x32_bf16 v[68:71], v[60:63], v[40:43], v[68:71]
    ds_read_b128 v[24:27], v10 offset:49664
    v_mfma_f32_16x16x32_bf16 v[76:79], v[60:63], v[44:47], v[76:79]
    ds_read_b128 v[28:31], v10 offset:49920
    v_mfma_f32_16x16x32_bf16 v[84:87], v[60:63], v[48:51], v[84:87]
    ds_read_b64_tr_b16 v[36:37], v13 offset:24576
    v_mfma_f32_16x16x32_bf16 v[92:95], v[60:63], v[52:55], v[92:95]
    ds_read_b64_tr_b16 v[38:39], v13 offset:25600
    s_waitcnt lgkmcnt(5)
    v_mfma_f32_16x16x32_bf16 v[64:67], v[32:35], v[16:19], v[64:67]
    ds_read_b128 v[40:43], v10 offset:57344
    ds_read_b64_tr_b16 v[56:57], v12 offset:28672
    s_waitcnt lgkmcnt(6)
    v_mfma_f32_16x16x32_bf16 v[72:75], v[32:35], v[20:23], v[72:75]
    ds_read_b64_tr_b16 v[58:59], v12 offset:29696
    s_waitcnt lgkmcnt(6)
    v_mfma_f32_16x16x32_bf16 v[80:83], v[32:35], v[24:27], v[80:83]
    ds_read_b128 v[44:47], v10 offset:57600
    s_waitcnt lgkmcnt(6)
    v_mfma_f32_16x16x32_bf16 v[88:91], v[32:35], v[28:31], v[88:91]
    ds_read_b128 v[48:51], v10 offset:57856
    s_waitcnt lgkmcnt(5)
    v_mfma_f32_16x16x32_bf16 v[68:71], v[36:39], v[16:19], v[68:71]
    ds_read_b128 v[52:55], v10 offset:58112
    v_mfma_f32_16x16x32_bf16 v[76:79], v[36:39], v[20:23], v[76:79]
    ds_read_b64_tr_b16 v[60:61], v13 offset:28672
    v_mfma_f32_16x16x32_bf16 v[84:87], v[36:39], v[24:27], v[84:87]
    ds_read_b64_tr_b16 v[62:63], v13 offset:29696
    v_mfma_f32_16x16x32_bf16 v[92:95], v[36:39], v[28:31], v[92:95]
    s_waitcnt lgkmcnt(0)
    s_barrier
    v_mfma_f32_16x16x32_bf16 v[64:67], v[56:59], v[40:43], v[64:67]
    ds_read_b128 v[16:19], v11 offset:0
    v_mfma_f32_16x16x32_bf16 v[72:75], v[56:59], v[44:47], v[72:75]
    ds_read_b64_tr_b16 v[32:33], v12 offset:32768
    v_mfma_f32_16x16x32_bf16 v[80:83], v[56:59], v[48:51], v[80:83]
    ds_read_b64_tr_b16 v[34:35], v12 offset:33792
    v_mfma_f32_16x16x32_bf16 v[88:91], v[56:59], v[52:55], v[88:91]
    ds_read_b128 v[20:23], v11 offset:256
    v_mfma_f32_16x16x32_bf16 v[68:71], v[60:63], v[40:43], v[68:71]
    ds_read_b128 v[24:27], v11 offset:512
    v_mfma_f32_16x16x32_bf16 v[76:79], v[60:63], v[44:47], v[76:79]
    ds_read_b128 v[28:31], v11 offset:768
    v_mfma_f32_16x16x32_bf16 v[84:87], v[60:63], v[48:51], v[84:87]
    ds_read_b64_tr_b16 v[36:37], v13 offset:32768
    v_mfma_f32_16x16x32_bf16 v[92:95], v[60:63], v[52:55], v[92:95]
    ds_read_b64_tr_b16 v[38:39], v13 offset:33792
    s_waitcnt lgkmcnt(5)
    v_mfma_f32_16x16x32_bf16 v[64:67], v[32:35], v[16:19], v[64:67]
    ds_read_b128 v[40:43], v11 offset:8192
    ds_read_b64_tr_b16 v[56:57], v12 offset:36864
    s_waitcnt lgkmcnt(6)
    v_mfma_f32_16x16x32_bf16 v[72:75], v[32:35], v[20:23], v[72:75]
    ds_read_b64_tr_b16 v[58:59], v12 offset:37888
    s_waitcnt lgkmcnt(6)
    v_mfma_f32_16x16x32_bf16 v[80:83], v[32:35], v[24:27], v[80:83]
    ds_read_b128 v[44:47], v11 offset:8448
    s_waitcnt lgkmcnt(6)
    v_mfma_f32_16x16x32_bf16 v[88:91], v[32:35], v[28:31], v[88:91]
    ds_read_b128 v[48:51], v11 offset:8704
    s_waitcnt lgkmcnt(5)
    v_mfma_f32_16x16x32_bf16 v[68:71], v[36:39], v[16:19], v[68:71]
    ds_read_b128 v[52:55], v11 offset:8960
    v_mfma_f32_16x16x32_bf16 v[76:79], v[36:39], v[20:23], v[76:79]
    ds_read_b64_tr_b16 v[60:61], v13 offset:36864
    v_mfma_f32_16x16x32_bf16 v[84:87], v[36:39], v[24:27], v[84:87]
    ds_read_b64_tr_b16 v[62:63], v13 offset:37888
    v_mfma_f32_16x16x32_bf16 v[92:95], v[36:39], v[28:31], v[92:95]
    s_waitcnt lgkmcnt(0)
    s_barrier
    v_mfma_f32_16x16x32_bf16 v[64:67], v[56:59], v[40:43], v[64:67]
    ds_read_b128 v[16:19], v11 offset:16384
    v_mfma_f32_16x16x32_bf16 v[72:75], v[56:59], v[44:47], v[72:75]
    ds_read_b64_tr_b16 v[32:33], v12 offset:40960
    v_mfma_f32_16x16x32_bf16 v[80:83], v[56:59], v[48:51], v[80:83]
    ds_read_b64_tr_b16 v[34:35], v12 offset:41984
    v_mfma_f32_16x16x32_bf16 v[88:91], v[56:59], v[52:55], v[88:91]
    ds_read_b128 v[20:23], v11 offset:16640
    v_mfma_f32_16x16x32_bf16 v[68:71], v[60:63], v[40:43], v[68:71]
    ds_read_b128 v[24:27], v11 offset:16896
    v_mfma_f32_16x16x32_bf16 v[76:79], v[60:63], v[44:47], v[76:79]
    ds_read_b128 v[28:31], v11 offset:17152
    v_mfma_f32_16x16x32_bf16 v[84:87], v[60:63], v[48:51], v[84:87]
    ds_read_b64_tr_b16 v[36:37], v13 offset:40960
    v_mfma_f32_16x16x32_bf16 v[92:95], v[60:63], v[52:55], v[92:95]
    ds_read_b64_tr_b16 v[38:39], v13 offset:41984
    s_waitcnt lgkmcnt(5)
    v_mfma_f32_16x16x32_bf16 v[64:67], v[32:35], v[16:19], v[64:67]
    ds_read_b128 v[40:43], v11 offset:24576
    ds_read_b64_tr_b16 v[56:57], v12 offset:45056
    s_waitcnt lgkmcnt(6)
    v_mfma_f32_16x16x32_bf16 v[72:75], v[32:35], v[20:23], v[72:75]
    ds_read_b64_tr_b16 v[58:59], v12 offset:46080
    s_waitcnt lgkmcnt(6)
    v_mfma_f32_16x16x32_bf16 v[80:83], v[32:35], v[24:27], v[80:83]
    ds_read_b128 v[44:47], v11 offset:24832
    s_waitcnt lgkmcnt(6)
    v_mfma_f32_16x16x32_bf16 v[88:91], v[32:35], v[28:31], v[88:91]
    ds_read_b128 v[48:51], v11 offset:25088
    s_waitcnt lgkmcnt(5)
    v_mfma_f32_16x16x32_bf16 v[68:71], v[36:39], v[16:19], v[68:71]
    ds_read_b128 v[52:55], v11 offset:25344
    v_mfma_f32_16x16x32_bf16 v[76:79], v[36:39], v[20:23], v[76:79]
    ds_read_b64_tr_b16 v[60:61], v13 offset:45056
    v_mfma_f32_16x16x32_bf16 v[84:87], v[36:39], v[24:27], v[84:87]
    ds_read_b64_tr_b16 v[62:63], v13 offset:46080
    v_mfma_f32_16x16x32_bf16 v[92:95], v[36:39], v[28:31], v[92:95]
    s_waitcnt lgkmcnt(0)
    s_barrier
    v_mfma_f32_16x16x32_bf16 v[64:67], v[56:59], v[40:43], v[64:67]
    ds_read_b128 v[16:19], v10 offset:0
    v_mfma_f32_16x16x32_bf16 v[72:75], v[56:59], v[44:47], v[72:75]
    ds_read_b64_tr_b16 v[32:33], v12 offset:0
    v_mfma_f32_16x16x32_bf16 v[80:83], v[56:59], v[48:51], v[80:83]
    ds_read_b64_tr_b16 v[34:35], v12 offset:1024
    v_mfma_f32_16x16x32_bf16 v[88:91], v[56:59], v[52:55], v[88:91]
    ds_read_b128 v[20:23], v10 offset:256
    v_mfma_f32_16x16x32_bf16 v[68:71], v[60:63], v[40:43], v[68:71]
    ds_read_b128 v[24:27], v10 offset:512
    v_mfma_f32_16x16x32_bf16 v[76:79], v[60:63], v[44:47], v[76:79]
    ds_read_b128 v[28:31], v10 offset:768
    v_mfma_f32_16x16x32_bf16 v[84:87], v[60:63], v[48:51], v[84:87]
    ds_read_b64_tr_b16 v[36:37], v13 offset:0
    v_mfma_f32_16x16x32_bf16 v[92:95], v[60:63], v[52:55], v[92:95]
    ds_read_b64_tr_b16 v[38:39], v13 offset:1024
    s_waitcnt lgkmcnt(5)
    v_mfma_f32_16x16x32_bf16 v[64:67], v[32:35], v[16:19], v[64:67]
    ds_read_b128 v[40:43], v10 offset:8192
    ds_read_b64_tr_b16 v[56:57], v12 offset:4096
    s_waitcnt lgkmcnt(6)
    v_mfma_f32_16x16x32_bf16 v[72:75], v[32:35], v[20:23], v[72:75]
    ds_read_b64_tr_b16 v[58:59], v12 offset:5120
    s_waitcnt lgkmcnt(6)
    v_mfma_f32_16x16x32_bf16 v[80:83], v[32:35], v[24:27], v[80:83]
    ds_read_b128 v[44:47], v10 offset:8448
    s_waitcnt lgkmcnt(6)
    v_mfma_f32_16x16x32_bf16 v[88:91], v[32:35], v[28:31], v[88:91]
    ds_read_b128 v[48:51], v10 offset:8704
    s_waitcnt lgkmcnt(5)
    v_mfma_f32_16x16x32_bf16 v[68:71], v[36:39], v[16:19], v[68:71]
    ds_read_b128 v[52:55], v10 offset:8960
    v_mfma_f32_16x16x32_bf16 v[76:79], v[36:39], v[20:23], v[76:79]
    ds_read_b64_tr_b16 v[60:61], v13 offset:4096
    v_mfma_f32_16x16x32_bf16 v[84:87], v[36:39], v[24:27], v[84:87]
    ds_read_b64_tr_b16 v[62:63], v13 offset:5120
    v_mfma_f32_16x16x32_bf16 v[92:95], v[36:39], v[28:31], v[92:95]
    s_waitcnt lgkmcnt(0)
    s_barrier
    v_mfma_f32_16x16x32_bf16 v[64:67], v[56:59], v[40:43], v[64:67]
    ds_read_b128 v[16:19], v10 offset:16384
    v_mfma_f32_16x16x32_bf16 v[72:75], v[56:59], v[44:47], v[72:75]
    ds_read_b64_tr_b16 v[32:33], v12 offset:8192
    v_mfma_f32_16x16x32_bf16 v[80:83], v[56:59], v[48:51], v[80:83]
    ds_read_b64_tr_b16 v[34:35], v12 offset:9216
    v_mfma_f32_16x16x32_bf16 v[88:91], v[56:59], v[52:55], v[88:91]
    ds_read_b128 v[20:23], v10 offset:16640
    v_mfma_f32_16x16x32_bf16 v[68:71], v[60:63], v[40:43], v[68:71]
    ds_read_b128 v[24:27], v10 offset:16896
    v_mfma_f32_16x16x32_bf16 v[76:79], v[60:63], v[44:47], v[76:79]
    ds_read_b128 v[28:31], v10 offset:17152
    v_mfma_f32_16x16x32_bf16 v[84:87], v[60:63], v[48:51], v[84:87]
    ds_read_b64_tr_b16 v[36:37], v13 offset:8192
    v_mfma_f32_16x16x32_bf16 v[92:95], v[60:63], v[52:55], v[92:95]
    ds_read_b64_tr_b16 v[38:39], v13 offset:9216
    s_waitcnt lgkmcnt(5)
    v_mfma_f32_16x16x32_bf16 v[64:67], v[32:35], v[16:19], v[64:67]
    ds_read_b128 v[40:43], v10 offset:24576
    ds_read_b64_tr_b16 v[56:57], v12 offset:12288
    s_waitcnt lgkmcnt(6)
    v_mfma_f32_16x16x32_bf16 v[72:75], v[32:35], v[20:23], v[72:75]
    ds_read_b64_tr_b16 v[58:59], v12 offset:13312
    s_waitcnt lgkmcnt(6)
    v_mfma_f32_16x16x32_bf16 v[80:83], v[32:35], v[24:27], v[80:83]
    ds_read_b128 v[44:47], v10 offset:24832
    s_waitcnt lgkmcnt(6)
    v_mfma_f32_16x16x32_bf16 v[88:91], v[32:35], v[28:31], v[88:91]
    ds_read_b128 v[48:51], v10 offset:25088
    s_waitcnt lgkmcnt(5)
    v_mfma_f32_16x16x32_bf16 v[68:71], v[36:39], v[16:19], v[68:71]
    ds_read_b128 v[52:55], v10 offset:25344
    v_mfma_f32_16x16x32_bf16 v[76:79], v[36:39], v[20:23], v[76:79]
    ds_read_b64_tr_b16 v[60:61], v13 offset:12288
    v_mfma_f32_16x16x32_bf16 v[84:87], v[36:39], v[24:27], v[84:87]
    ds_read_b64_tr_b16 v[62:63], v13 offset:13312
    v_mfma_f32_16x16x32_bf16 v[92:95], v[36:39], v[28:31], v[92:95]
    s_waitcnt lgkmcnt(0)
    s_barrier
    v_mfma_f32_16x16x32_bf16 v[64:67], v[56:59], v[40:43], v[64:67]
    ds_read_b128 v[16:19], v10 offset:32768
    v_mfma_f32_16x16x32_bf16 v[72:75], v[56:59], v[44:47], v[72:75]
    ds_read_b64_tr_b16 v[32:33], v12 offset:16384
    v_mfma_f32_16x16x32_bf16 v[80:83], v[56:59], v[48:51], v[80:83]
    ds_read_b64_tr_b16 v[34:35], v12 offset:17408
    v_mfma_f32_16x16x32_bf16 v[88:91], v[56:59], v[52:55], v[88:91]
    ds_read_b128 v[20:23], v10 offset:33024
    v_mfma_f32_16x16x32_bf16 v[68:71], v[60:63], v[40:43], v[68:71]
    ds_read_b128 v[24:27], v10 offset:33280
    v_mfma_f32_16x16x32_bf16 v[76:79], v[60:63], v[44:47], v[76:79]
    ds_read_b128 v[28:31], v10 offset:33536
    v_mfma_f32_16x16x32_bf16 v[84:87], v[60:63], v[48:51], v[84:87]
    ds_read_b64_tr_b16 v[36:37], v13 offset:16384
    v_mfma_f32_16x16x32_bf16 v[92:95], v[60:63], v[52:55], v[92:95]
    ds_read_b64_tr_b16 v[38:39], v13 offset:17408
    s_waitcnt lgkmcnt(5)
    v_mfma_f32_16x16x32_bf16 v[64:67], v[32:35], v[16:19], v[64:67]
    ds_read_b128 v[40:43], v10 offset:40960
    ds_read_b64_tr_b16 v[56:57], v12 offset:20480
    s_waitcnt lgkmcnt(6)
    v_mfma_f32_16x16x32_bf16 v[72:75], v[32:35], v[20:23], v[72:75]
    ds_read_b64_tr_b16 v[58:59], v12 offset:21504
    s_waitcnt lgkmcnt(6)
    v_mfma_f32_16x16x32_bf16 v[80:83], v[32:35], v[24:27], v[80:83]
    ds_read_b128 v[44:47], v10 offset:41216
    s_waitcnt lgkmcnt(6)
    v_mfma_f32_16x16x32_bf16 v[88:91], v[32:35], v[28:31], v[88:91]
    ds_read_b128 v[48:51], v10 offset:41472
    s_waitcnt lgkmcnt(5)
    v_mfma_f32_16x16x32_bf16 v[68:71], v[36:39], v[16:19], v[68:71]
    ds_read_b128 v[52:55], v10 offset:41728
    v_mfma_f32_16x16x32_bf16 v[76:79], v[36:39], v[20:23], v[76:79]
    ds_read_b64_tr_b16 v[60:61], v13 offset:20480
    v_mfma_f32_16x16x32_bf16 v[84:87], v[36:39], v[24:27], v[84:87]
    ds_read_b64_tr_b16 v[62:63], v13 offset:21504
    v_mfma_f32_16x16x32_bf16 v[92:95], v[36:39], v[28:31], v[92:95]
    s_waitcnt lgkmcnt(0)
    s_barrier
    v_mfma_f32_16x16x32_bf16 v[64:67], v[56:59], v[40:43], v[64:67]
    ds_read_b128 v[16:19], v10 offset:49152
    v_mfma_f32_16x16x32_bf16 v[72:75], v[56:59], v[44:47], v[72:75]
    ds_read_b64_tr_b16 v[32:33], v12 offset:24576
    v_mfma_f32_16x16x32_bf16 v[80:83], v[56:59], v[48:51], v[80:83]
    ds_read_b64_tr_b16 v[34:35], v12 offset:25600
    v_mfma_f32_16x16x32_bf16 v[88:91], v[56:59], v[52:55], v[88:91]
    ds_read_b128 v[20:23], v10 offset:49408
    v_mfma_f32_16x16x32_bf16 v[68:71], v[60:63], v[40:43], v[68:71]
    ds_read_b128 v[24:27], v10 offset:49664
    v_mfma_f32_16x16x32_bf16 v[76:79], v[60:63], v[44:47], v[76:79]
    ds_read_b128 v[28:31], v10 offset:49920
    v_mfma_f32_16x16x32_bf16 v[84:87], v[60:63], v[48:51], v[84:87]
    ds_read_b64_tr_b16 v[36:37], v13 offset:24576
    v_mfma_f32_16x16x32_bf16 v[92:95], v[60:63], v[52:55], v[92:95]
    ds_read_b64_tr_b16 v[38:39], v13 offset:25600
    s_waitcnt lgkmcnt(5)
    v_mfma_f32_16x16x32_bf16 v[64:67], v[32:35], v[16:19], v[64:67]
    ds_read_b128 v[40:43], v10 offset:57344
    ds_read_b64_tr_b16 v[56:57], v12 offset:28672
    s_waitcnt lgkmcnt(6)
    v_mfma_f32_16x16x32_bf16 v[72:75], v[32:35], v[20:23], v[72:75]
    ds_read_b64_tr_b16 v[58:59], v12 offset:29696
    s_waitcnt lgkmcnt(6)
    v_mfma_f32_16x16x32_bf16 v[80:83], v[32:35], v[24:27], v[80:83]
    ds_read_b128 v[44:47], v10 offset:57600
    s_waitcnt lgkmcnt(6)
    v_mfma_f32_16x16x32_bf16 v[88:91], v[32:35], v[28:31], v[88:91]
    ds_read_b128 v[48:51], v10 offset:57856
    s_waitcnt lgkmcnt(5)
    v_mfma_f32_16x16x32_bf16 v[68:71], v[36:39], v[16:19], v[68:71]
    ds_read_b128 v[52:55], v10 offset:58112
    v_mfma_f32_16x16x32_bf16 v[76:79], v[36:39], v[20:23], v[76:79]
    ds_read_b64_tr_b16 v[60:61], v13 offset:28672
    v_mfma_f32_16x16x32_bf16 v[84:87], v[36:39], v[24:27], v[84:87]
    ds_read_b64_tr_b16 v[62:63], v13 offset:29696
    v_mfma_f32_16x16x32_bf16 v[92:95], v[36:39], v[28:31], v[92:95]
    s_waitcnt lgkmcnt(0)
    s_barrier
    v_mfma_f32_16x16x32_bf16 v[64:67], v[56:59], v[40:43], v[64:67]
    ds_read_b128 v[16:19], v11 offset:0
    v_mfma_f32_16x16x32_bf16 v[72:75], v[56:59], v[44:47], v[72:75]
    ds_read_b64_tr_b16 v[32:33], v12 offset:32768
    v_mfma_f32_16x16x32_bf16 v[80:83], v[56:59], v[48:51], v[80:83]
    ds_read_b64_tr_b16 v[34:35], v12 offset:33792
    v_mfma_f32_16x16x32_bf16 v[88:91], v[56:59], v[52:55], v[88:91]
    ds_read_b128 v[20:23], v11 offset:256
    v_mfma_f32_16x16x32_bf16 v[68:71], v[60:63], v[40:43], v[68:71]
    ds_read_b128 v[24:27], v11 offset:512
    v_mfma_f32_16x16x32_bf16 v[76:79], v[60:63], v[44:47], v[76:79]
    ds_read_b128 v[28:31], v11 offset:768
    v_mfma_f32_16x16x32_bf16 v[84:87], v[60:63], v[48:51], v[84:87]
    ds_read_b64_tr_b16 v[36:37], v13 offset:32768
    v_mfma_f32_16x16x32_bf16 v[92:95], v[60:63], v[52:55], v[92:95]
    ds_read_b64_tr_b16 v[38:39], v13 offset:33792
    s_waitcnt lgkmcnt(5)
    v_mfma_f32_16x16x32_bf16 v[64:67], v[32:35], v[16:19], v[64:67]
    ds_read_b128 v[40:43], v11 offset:8192
    ds_read_b64_tr_b16 v[56:57], v12 offset:36864
    s_waitcnt lgkmcnt(6)
    v_mfma_f32_16x16x32_bf16 v[72:75], v[32:35], v[20:23], v[72:75]
    ds_read_b64_tr_b16 v[58:59], v12 offset:37888
    s_waitcnt lgkmcnt(6)
    v_mfma_f32_16x16x32_bf16 v[80:83], v[32:35], v[24:27], v[80:83]
    ds_read_b128 v[44:47], v11 offset:8448
    s_waitcnt lgkmcnt(6)
    v_mfma_f32_16x16x32_bf16 v[88:91], v[32:35], v[28:31], v[88:91]
    ds_read_b128 v[48:51], v11 offset:8704
    s_waitcnt lgkmcnt(5)
    v_mfma_f32_16x16x32_bf16 v[68:71], v[36:39], v[16:19], v[68:71]
    ds_read_b128 v[52:55], v11 offset:8960
    v_mfma_f32_16x16x32_bf16 v[76:79], v[36:39], v[20:23], v[76:79]
    ds_read_b64_tr_b16 v[60:61], v13 offset:36864
    v_mfma_f32_16x16x32_bf16 v[84:87], v[36:39], v[24:27], v[84:87]
    ds_read_b64_tr_b16 v[62:63], v13 offset:37888
    v_mfma_f32_16x16x32_bf16 v[92:95], v[36:39], v[28:31], v[92:95]
    s_waitcnt lgkmcnt(0)
    s_barrier
    v_mfma_f32_16x16x32_bf16 v[64:67], v[56:59], v[40:43], v[64:67]
    ds_read_b128 v[16:19], v11 offset:16384
    v_mfma_f32_16x16x32_bf16 v[72:75], v[56:59], v[44:47], v[72:75]
    ds_read_b64_tr_b16 v[32:33], v12 offset:40960
    v_mfma_f32_16x16x32_bf16 v[80:83], v[56:59], v[48:51], v[80:83]
    ds_read_b64_tr_b16 v[34:35], v12 offset:41984
    v_mfma_f32_16x16x32_bf16 v[88:91], v[56:59], v[52:55], v[88:91]
    ds_read_b128 v[20:23], v11 offset:16640
    v_mfma_f32_16x16x32_bf16 v[68:71], v[60:63], v[40:43], v[68:71]
    ds_read_b128 v[24:27], v11 offset:16896
    v_mfma_f32_16x16x32_bf16 v[76:79], v[60:63], v[44:47], v[76:79]
    ds_read_b128 v[28:31], v11 offset:17152
    v_mfma_f32_16x16x32_bf16 v[84:87], v[60:63], v[48:51], v[84:87]
    ds_read_b64_tr_b16 v[36:37], v13 offset:40960
    v_mfma_f32_16x16x32_bf16 v[92:95], v[60:63], v[52:55], v[92:95]
    ds_read_b64_tr_b16 v[38:39], v13 offset:41984
    s_waitcnt lgkmcnt(5)
    v_mfma_f32_16x16x32_bf16 v[64:67], v[32:35], v[16:19], v[64:67]
    ds_read_b128 v[40:43], v11 offset:24576
    ds_read_b64_tr_b16 v[56:57], v12 offset:45056
    s_waitcnt lgkmcnt(6)
    v_mfma_f32_16x16x32_bf16 v[72:75], v[32:35], v[20:23], v[72:75]
    ds_read_b64_tr_b16 v[58:59], v12 offset:46080
    s_waitcnt lgkmcnt(6)
    v_mfma_f32_16x16x32_bf16 v[80:83], v[32:35], v[24:27], v[80:83]
    ds_read_b128 v[44:47], v11 offset:24832
    s_waitcnt lgkmcnt(6)
    v_mfma_f32_16x16x32_bf16 v[88:91], v[32:35], v[28:31], v[88:91]
    ds_read_b128 v[48:51], v11 offset:25088
    s_waitcnt lgkmcnt(5)
    v_mfma_f32_16x16x32_bf16 v[68:71], v[36:39], v[16:19], v[68:71]
    ds_read_b128 v[52:55], v11 offset:25344
    v_mfma_f32_16x16x32_bf16 v[76:79], v[36:39], v[20:23], v[76:79]
    ds_read_b64_tr_b16 v[60:61], v13 offset:45056
    v_mfma_f32_16x16x32_bf16 v[84:87], v[36:39], v[24:27], v[84:87]
    ds_read_b64_tr_b16 v[62:63], v13 offset:46080
    v_mfma_f32_16x16x32_bf16 v[92:95], v[36:39], v[28:31], v[92:95]
    s_waitcnt lgkmcnt(0)
    s_barrier
    v_mfma_f32_16x16x32_bf16 v[64:67], v[56:59], v[40:43], v[64:67]
    ds_read_b128 v[16:19], v10 offset:0
    v_mfma_f32_16x16x32_bf16 v[72:75], v[56:59], v[44:47], v[72:75]
    ds_read_b64_tr_b16 v[32:33], v12 offset:0
    v_mfma_f32_16x16x32_bf16 v[80:83], v[56:59], v[48:51], v[80:83]
    ds_read_b64_tr_b16 v[34:35], v12 offset:1024
    v_mfma_f32_16x16x32_bf16 v[88:91], v[56:59], v[52:55], v[88:91]
    ds_read_b128 v[20:23], v10 offset:256
    v_mfma_f32_16x16x32_bf16 v[68:71], v[60:63], v[40:43], v[68:71]
    ds_read_b128 v[24:27], v10 offset:512
    v_mfma_f32_16x16x32_bf16 v[76:79], v[60:63], v[44:47], v[76:79]
    ds_read_b128 v[28:31], v10 offset:768
    v_mfma_f32_16x16x32_bf16 v[84:87], v[60:63], v[48:51], v[84:87]
    ds_read_b64_tr_b16 v[36:37], v13 offset:0
    v_mfma_f32_16x16x32_bf16 v[92:95], v[60:63], v[52:55], v[92:95]
    ds_read_b64_tr_b16 v[38:39], v13 offset:1024
    s_waitcnt lgkmcnt(5)
    v_mfma_f32_16x16x32_bf16 v[64:67], v[32:35], v[16:19], v[64:67]
    ds_read_b128 v[40:43], v10 offset:8192
    ds_read_b64_tr_b16 v[56:57], v12 offset:4096
    s_waitcnt lgkmcnt(6)
    v_mfma_f32_16x16x32_bf16 v[72:75], v[32:35], v[20:23], v[72:75]
    ds_read_b64_tr_b16 v[58:59], v12 offset:5120
    s_waitcnt lgkmcnt(6)
    v_mfma_f32_16x16x32_bf16 v[80:83], v[32:35], v[24:27], v[80:83]
    ds_read_b128 v[44:47], v10 offset:8448
    s_waitcnt lgkmcnt(6)
    v_mfma_f32_16x16x32_bf16 v[88:91], v[32:35], v[28:31], v[88:91]
    ds_read_b128 v[48:51], v10 offset:8704
    s_waitcnt lgkmcnt(5)
    v_mfma_f32_16x16x32_bf16 v[68:71], v[36:39], v[16:19], v[68:71]
    ds_read_b128 v[52:55], v10 offset:8960
    v_mfma_f32_16x16x32_bf16 v[76:79], v[36:39], v[20:23], v[76:79]
    ds_read_b64_tr_b16 v[60:61], v13 offset:4096
    v_mfma_f32_16x16x32_bf16 v[84:87], v[36:39], v[24:27], v[84:87]
    ds_read_b64_tr_b16 v[62:63], v13 offset:5120
    v_mfma_f32_16x16x32_bf16 v[92:95], v[36:39], v[28:31], v[92:95]
    s_waitcnt lgkmcnt(0)
    s_barrier
    v_mfma_f32_16x16x32_bf16 v[64:67], v[56:59], v[40:43], v[64:67]
    ds_read_b128 v[16:19], v10 offset:16384
    v_mfma_f32_16x16x32_bf16 v[72:75], v[56:59], v[44:47], v[72:75]
    ds_read_b64_tr_b16 v[32:33], v12 offset:8192
    v_mfma_f32_16x16x32_bf16 v[80:83], v[56:59], v[48:51], v[80:83]
    ds_read_b64_tr_b16 v[34:35], v12 offset:9216
    v_mfma_f32_16x16x32_bf16 v[88:91], v[56:59], v[52:55], v[88:91]
    ds_read_b128 v[20:23], v10 offset:16640
    v_mfma_f32_16x16x32_bf16 v[68:71], v[60:63], v[40:43], v[68:71]
    ds_read_b128 v[24:27], v10 offset:16896
    v_mfma_f32_16x16x32_bf16 v[76:79], v[60:63], v[44:47], v[76:79]
    ds_read_b128 v[28:31], v10 offset:17152
    v_mfma_f32_16x16x32_bf16 v[84:87], v[60:63], v[48:51], v[84:87]
    ds_read_b64_tr_b16 v[36:37], v13 offset:8192
    v_mfma_f32_16x16x32_bf16 v[92:95], v[60:63], v[52:55], v[92:95]
    ds_read_b64_tr_b16 v[38:39], v13 offset:9216
    s_waitcnt lgkmcnt(5)
    v_mfma_f32_16x16x32_bf16 v[64:67], v[32:35], v[16:19], v[64:67]
    ds_read_b128 v[40:43], v10 offset:24576
    ds_read_b64_tr_b16 v[56:57], v12 offset:12288
    s_waitcnt lgkmcnt(6)
    v_mfma_f32_16x16x32_bf16 v[72:75], v[32:35], v[20:23], v[72:75]
    ds_read_b64_tr_b16 v[58:59], v12 offset:13312
    s_waitcnt lgkmcnt(6)
    v_mfma_f32_16x16x32_bf16 v[80:83], v[32:35], v[24:27], v[80:83]
    ds_read_b128 v[44:47], v10 offset:24832
    s_waitcnt lgkmcnt(6)
    v_mfma_f32_16x16x32_bf16 v[88:91], v[32:35], v[28:31], v[88:91]
    ds_read_b128 v[48:51], v10 offset:25088
    s_waitcnt lgkmcnt(5)
    v_mfma_f32_16x16x32_bf16 v[68:71], v[36:39], v[16:19], v[68:71]
    ds_read_b128 v[52:55], v10 offset:25344
    v_mfma_f32_16x16x32_bf16 v[76:79], v[36:39], v[20:23], v[76:79]
    ds_read_b64_tr_b16 v[60:61], v13 offset:12288
    v_mfma_f32_16x16x32_bf16 v[84:87], v[36:39], v[24:27], v[84:87]
    ds_read_b64_tr_b16 v[62:63], v13 offset:13312
    v_mfma_f32_16x16x32_bf16 v[92:95], v[36:39], v[28:31], v[92:95]
    s_waitcnt lgkmcnt(0)
    s_barrier
    v_mfma_f32_16x16x32_bf16 v[64:67], v[56:59], v[40:43], v[64:67]
    ds_read_b128 v[16:19], v10 offset:32768
    v_mfma_f32_16x16x32_bf16 v[72:75], v[56:59], v[44:47], v[72:75]
    ds_read_b64_tr_b16 v[32:33], v12 offset:16384
    v_mfma_f32_16x16x32_bf16 v[80:83], v[56:59], v[48:51], v[80:83]
    ds_read_b64_tr_b16 v[34:35], v12 offset:17408
    v_mfma_f32_16x16x32_bf16 v[88:91], v[56:59], v[52:55], v[88:91]
    ds_read_b128 v[20:23], v10 offset:33024
    v_mfma_f32_16x16x32_bf16 v[68:71], v[60:63], v[40:43], v[68:71]
    ds_read_b128 v[24:27], v10 offset:33280
    v_mfma_f32_16x16x32_bf16 v[76:79], v[60:63], v[44:47], v[76:79]
    ds_read_b128 v[28:31], v10 offset:33536
    v_mfma_f32_16x16x32_bf16 v[84:87], v[60:63], v[48:51], v[84:87]
    ds_read_b64_tr_b16 v[36:37], v13 offset:16384
    v_mfma_f32_16x16x32_bf16 v[92:95], v[60:63], v[52:55], v[92:95]
    ds_read_b64_tr_b16 v[38:39], v13 offset:17408
    s_waitcnt lgkmcnt(5)
    v_mfma_f32_16x16x32_bf16 v[64:67], v[32:35], v[16:19], v[64:67]
    ds_read_b128 v[40:43], v10 offset:40960
    ds_read_b64_tr_b16 v[56:57], v12 offset:20480
    s_waitcnt lgkmcnt(6)
    v_mfma_f32_16x16x32_bf16 v[72:75], v[32:35], v[20:23], v[72:75]
    ds_read_b64_tr_b16 v[58:59], v12 offset:21504
    s_waitcnt lgkmcnt(6)
    v_mfma_f32_16x16x32_bf16 v[80:83], v[32:35], v[24:27], v[80:83]
    ds_read_b128 v[44:47], v10 offset:41216
    s_waitcnt lgkmcnt(6)
    v_mfma_f32_16x16x32_bf16 v[88:91], v[32:35], v[28:31], v[88:91]
    ds_read_b128 v[48:51], v10 offset:41472
    s_waitcnt lgkmcnt(5)
    v_mfma_f32_16x16x32_bf16 v[68:71], v[36:39], v[16:19], v[68:71]
    ds_read_b128 v[52:55], v10 offset:41728
    v_mfma_f32_16x16x32_bf16 v[76:79], v[36:39], v[20:23], v[76:79]
    ds_read_b64_tr_b16 v[60:61], v13 offset:20480
    v_mfma_f32_16x16x32_bf16 v[84:87], v[36:39], v[24:27], v[84:87]
    ds_read_b64_tr_b16 v[62:63], v13 offset:21504
    v_mfma_f32_16x16x32_bf16 v[92:95], v[36:39], v[28:31], v[92:95]
    s_waitcnt lgkmcnt(0)
    s_barrier
    v_mfma_f32_16x16x32_bf16 v[64:67], v[56:59], v[40:43], v[64:67]
    ds_read_b128 v[16:19], v10 offset:49152
    v_mfma_f32_16x16x32_bf16 v[72:75], v[56:59], v[44:47], v[72:75]
    ds_read_b64_tr_b16 v[32:33], v12 offset:24576
    v_mfma_f32_16x16x32_bf16 v[80:83], v[56:59], v[48:51], v[80:83]
    ds_read_b64_tr_b16 v[34:35], v12 offset:25600
    v_mfma_f32_16x16x32_bf16 v[88:91], v[56:59], v[52:55], v[88:91]
    ds_read_b128 v[20:23], v10 offset:49408
    v_mfma_f32_16x16x32_bf16 v[68:71], v[60:63], v[40:43], v[68:71]
    ds_read_b128 v[24:27], v10 offset:49664
    v_mfma_f32_16x16x32_bf16 v[76:79], v[60:63], v[44:47], v[76:79]
    ds_read_b128 v[28:31], v10 offset:49920
    v_mfma_f32_16x16x32_bf16 v[84:87], v[60:63], v[48:51], v[84:87]
    ds_read_b64_tr_b16 v[36:37], v13 offset:24576
    v_mfma_f32_16x16x32_bf16 v[92:95], v[60:63], v[52:55], v[92:95]
    ds_read_b64_tr_b16 v[38:39], v13 offset:25600
    s_waitcnt lgkmcnt(5)
    v_mfma_f32_16x16x32_bf16 v[64:67], v[32:35], v[16:19], v[64:67]
    ds_read_b128 v[40:43], v10 offset:57344
    ds_read_b64_tr_b16 v[56:57], v12 offset:28672
    s_waitcnt lgkmcnt(6)
    v_mfma_f32_16x16x32_bf16 v[72:75], v[32:35], v[20:23], v[72:75]
    ds_read_b64_tr_b16 v[58:59], v12 offset:29696
    s_waitcnt lgkmcnt(6)
    v_mfma_f32_16x16x32_bf16 v[80:83], v[32:35], v[24:27], v[80:83]
    ds_read_b128 v[44:47], v10 offset:57600
    s_waitcnt lgkmcnt(6)
    v_mfma_f32_16x16x32_bf16 v[88:91], v[32:35], v[28:31], v[88:91]
    ds_read_b128 v[48:51], v10 offset:57856
    s_waitcnt lgkmcnt(5)
    v_mfma_f32_16x16x32_bf16 v[68:71], v[36:39], v[16:19], v[68:71]
    ds_read_b128 v[52:55], v10 offset:58112
    v_mfma_f32_16x16x32_bf16 v[76:79], v[36:39], v[20:23], v[76:79]
    ds_read_b64_tr_b16 v[60:61], v13 offset:28672
    v_mfma_f32_16x16x32_bf16 v[84:87], v[36:39], v[24:27], v[84:87]
    ds_read_b64_tr_b16 v[62:63], v13 offset:29696
    v_mfma_f32_16x16x32_bf16 v[92:95], v[36:39], v[28:31], v[92:95]
    s_waitcnt lgkmcnt(0)
    s_barrier
    v_mfma_f32_16x16x32_bf16 v[64:67], v[56:59], v[40:43], v[64:67]
    ds_read_b128 v[16:19], v11 offset:0
    v_mfma_f32_16x16x32_bf16 v[72:75], v[56:59], v[44:47], v[72:75]
    ds_read_b64_tr_b16 v[32:33], v12 offset:32768
    v_mfma_f32_16x16x32_bf16 v[80:83], v[56:59], v[48:51], v[80:83]
    ds_read_b64_tr_b16 v[34:35], v12 offset:33792
    v_mfma_f32_16x16x32_bf16 v[88:91], v[56:59], v[52:55], v[88:91]
    ds_read_b128 v[20:23], v11 offset:256
    v_mfma_f32_16x16x32_bf16 v[68:71], v[60:63], v[40:43], v[68:71]
    ds_read_b128 v[24:27], v11 offset:512
    v_mfma_f32_16x16x32_bf16 v[76:79], v[60:63], v[44:47], v[76:79]
    ds_read_b128 v[28:31], v11 offset:768
    v_mfma_f32_16x16x32_bf16 v[84:87], v[60:63], v[48:51], v[84:87]
    ds_read_b64_tr_b16 v[36:37], v13 offset:32768
    v_mfma_f32_16x16x32_bf16 v[92:95], v[60:63], v[52:55], v[92:95]
    ds_read_b64_tr_b16 v[38:39], v13 offset:33792
    s_waitcnt lgkmcnt(5)
    v_mfma_f32_16x16x32_bf16 v[64:67], v[32:35], v[16:19], v[64:67]
    ds_read_b128 v[40:43], v11 offset:8192
    ds_read_b64_tr_b16 v[56:57], v12 offset:36864
    s_waitcnt lgkmcnt(6)
    v_mfma_f32_16x16x32_bf16 v[72:75], v[32:35], v[20:23], v[72:75]
    ds_read_b64_tr_b16 v[58:59], v12 offset:37888
    s_waitcnt lgkmcnt(6)
    v_mfma_f32_16x16x32_bf16 v[80:83], v[32:35], v[24:27], v[80:83]
    ds_read_b128 v[44:47], v11 offset:8448
    s_waitcnt lgkmcnt(6)
    v_mfma_f32_16x16x32_bf16 v[88:91], v[32:35], v[28:31], v[88:91]
    ds_read_b128 v[48:51], v11 offset:8704
    s_waitcnt lgkmcnt(5)
    v_mfma_f32_16x16x32_bf16 v[68:71], v[36:39], v[16:19], v[68:71]
    ds_read_b128 v[52:55], v11 offset:8960
    v_mfma_f32_16x16x32_bf16 v[76:79], v[36:39], v[20:23], v[76:79]
    ds_read_b64_tr_b16 v[60:61], v13 offset:36864
    v_mfma_f32_16x16x32_bf16 v[84:87], v[36:39], v[24:27], v[84:87]
    ds_read_b64_tr_b16 v[62:63], v13 offset:37888
    v_mfma_f32_16x16x32_bf16 v[92:95], v[36:39], v[28:31], v[92:95]
    s_waitcnt lgkmcnt(0)
    s_barrier
    v_mfma_f32_16x16x32_bf16 v[64:67], v[56:59], v[40:43], v[64:67]
    ds_read_b128 v[16:19], v11 offset:16384
    v_mfma_f32_16x16x32_bf16 v[72:75], v[56:59], v[44:47], v[72:75]
    ds_read_b64_tr_b16 v[32:33], v12 offset:40960
    v_mfma_f32_16x16x32_bf16 v[80:83], v[56:59], v[48:51], v[80:83]
    ds_read_b64_tr_b16 v[34:35], v12 offset:41984
    v_mfma_f32_16x16x32_bf16 v[88:91], v[56:59], v[52:55], v[88:91]
    ds_read_b128 v[20:23], v11 offset:16640
    v_mfma_f32_16x16x32_bf16 v[68:71], v[60:63], v[40:43], v[68:71]
    ds_read_b128 v[24:27], v11 offset:16896
    v_mfma_f32_16x16x32_bf16 v[76:79], v[60:63], v[44:47], v[76:79]
    ds_read_b128 v[28:31], v11 offset:17152
    v_mfma_f32_16x16x32_bf16 v[84:87], v[60:63], v[48:51], v[84:87]
    ds_read_b64_tr_b16 v[36:37], v13 offset:40960
    v_mfma_f32_16x16x32_bf16 v[92:95], v[60:63], v[52:55], v[92:95]
    ds_read_b64_tr_b16 v[38:39], v13 offset:41984
    s_waitcnt lgkmcnt(5)
    v_mfma_f32_16x16x32_bf16 v[64:67], v[32:35], v[16:19], v[64:67]
    ds_read_b128 v[40:43], v11 offset:24576
    ds_read_b64_tr_b16 v[56:57], v12 offset:45056
    s_waitcnt lgkmcnt(6)
    v_mfma_f32_16x16x32_bf16 v[72:75], v[32:35], v[20:23], v[72:75]
    ds_read_b64_tr_b16 v[58:59], v12 offset:46080
    s_waitcnt lgkmcnt(6)
    v_mfma_f32_16x16x32_bf16 v[80:83], v[32:35], v[24:27], v[80:83]
    ds_read_b128 v[44:47], v11 offset:24832
    s_waitcnt lgkmcnt(6)
    v_mfma_f32_16x16x32_bf16 v[88:91], v[32:35], v[28:31], v[88:91]
    ds_read_b128 v[48:51], v11 offset:25088
    s_waitcnt lgkmcnt(5)
    v_mfma_f32_16x16x32_bf16 v[68:71], v[36:39], v[16:19], v[68:71]
    ds_read_b128 v[52:55], v11 offset:25344
    v_mfma_f32_16x16x32_bf16 v[76:79], v[36:39], v[20:23], v[76:79]
    ds_read_b64_tr_b16 v[60:61], v13 offset:45056
    v_mfma_f32_16x16x32_bf16 v[84:87], v[36:39], v[24:27], v[84:87]
    ds_read_b64_tr_b16 v[62:63], v13 offset:46080
    v_mfma_f32_16x16x32_bf16 v[92:95], v[36:39], v[28:31], v[92:95]
    s_waitcnt lgkmcnt(0)
    s_barrier
    v_mfma_f32_16x16x32_bf16 v[64:67], v[56:59], v[40:43], v[64:67]
    ds_read_b128 v[16:19], v10 offset:0
    v_mfma_f32_16x16x32_bf16 v[72:75], v[56:59], v[44:47], v[72:75]
    ds_read_b64_tr_b16 v[32:33], v12 offset:0
    v_mfma_f32_16x16x32_bf16 v[80:83], v[56:59], v[48:51], v[80:83]
    ds_read_b64_tr_b16 v[34:35], v12 offset:1024
    v_mfma_f32_16x16x32_bf16 v[88:91], v[56:59], v[52:55], v[88:91]
    ds_read_b128 v[20:23], v10 offset:256
    v_mfma_f32_16x16x32_bf16 v[68:71], v[60:63], v[40:43], v[68:71]
    ds_read_b128 v[24:27], v10 offset:512
    v_mfma_f32_16x16x32_bf16 v[76:79], v[60:63], v[44:47], v[76:79]
    ds_read_b128 v[28:31], v10 offset:768
    v_mfma_f32_16x16x32_bf16 v[84:87], v[60:63], v[48:51], v[84:87]
    ds_read_b64_tr_b16 v[36:37], v13 offset:0
    v_mfma_f32_16x16x32_bf16 v[92:95], v[60:63], v[52:55], v[92:95]
    ds_read_b64_tr_b16 v[38:39], v13 offset:1024
    s_waitcnt lgkmcnt(5)
    v_mfma_f32_16x16x32_bf16 v[64:67], v[32:35], v[16:19], v[64:67]
    ds_read_b128 v[40:43], v10 offset:8192
    ds_read_b64_tr_b16 v[56:57], v12 offset:4096
    s_waitcnt lgkmcnt(6)
    v_mfma_f32_16x16x32_bf16 v[72:75], v[32:35], v[20:23], v[72:75]
    ds_read_b64_tr_b16 v[58:59], v12 offset:5120
    s_waitcnt lgkmcnt(6)
    v_mfma_f32_16x16x32_bf16 v[80:83], v[32:35], v[24:27], v[80:83]
    ds_read_b128 v[44:47], v10 offset:8448
    s_waitcnt lgkmcnt(6)
    v_mfma_f32_16x16x32_bf16 v[88:91], v[32:35], v[28:31], v[88:91]
    ds_read_b128 v[48:51], v10 offset:8704
    s_waitcnt lgkmcnt(5)
    v_mfma_f32_16x16x32_bf16 v[68:71], v[36:39], v[16:19], v[68:71]
    ds_read_b128 v[52:55], v10 offset:8960
    v_mfma_f32_16x16x32_bf16 v[76:79], v[36:39], v[20:23], v[76:79]
    ds_read_b64_tr_b16 v[60:61], v13 offset:4096
    v_mfma_f32_16x16x32_bf16 v[84:87], v[36:39], v[24:27], v[84:87]
    ds_read_b64_tr_b16 v[62:63], v13 offset:5120
    v_mfma_f32_16x16x32_bf16 v[92:95], v[36:39], v[28:31], v[92:95]
    s_waitcnt lgkmcnt(0)
    s_barrier
    v_mfma_f32_16x16x32_bf16 v[64:67], v[56:59], v[40:43], v[64:67]
    ds_read_b128 v[16:19], v10 offset:16384
    v_mfma_f32_16x16x32_bf16 v[72:75], v[56:59], v[44:47], v[72:75]
    ds_read_b64_tr_b16 v[32:33], v12 offset:8192
    v_mfma_f32_16x16x32_bf16 v[80:83], v[56:59], v[48:51], v[80:83]
    ds_read_b64_tr_b16 v[34:35], v12 offset:9216
    v_mfma_f32_16x16x32_bf16 v[88:91], v[56:59], v[52:55], v[88:91]
    ds_read_b128 v[20:23], v10 offset:16640
    v_mfma_f32_16x16x32_bf16 v[68:71], v[60:63], v[40:43], v[68:71]
    ds_read_b128 v[24:27], v10 offset:16896
    v_mfma_f32_16x16x32_bf16 v[76:79], v[60:63], v[44:47], v[76:79]
    ds_read_b128 v[28:31], v10 offset:17152
    v_mfma_f32_16x16x32_bf16 v[84:87], v[60:63], v[48:51], v[84:87]
    ds_read_b64_tr_b16 v[36:37], v13 offset:8192
    v_mfma_f32_16x16x32_bf16 v[92:95], v[60:63], v[52:55], v[92:95]
    ds_read_b64_tr_b16 v[38:39], v13 offset:9216
    s_waitcnt lgkmcnt(5)
    v_mfma_f32_16x16x32_bf16 v[64:67], v[32:35], v[16:19], v[64:67]
    ds_read_b128 v[40:43], v10 offset:24576
    ds_read_b64_tr_b16 v[56:57], v12 offset:12288
    s_waitcnt lgkmcnt(6)
    v_mfma_f32_16x16x32_bf16 v[72:75], v[32:35], v[20:23], v[72:75]
    ds_read_b64_tr_b16 v[58:59], v12 offset:13312
    s_waitcnt lgkmcnt(6)
    v_mfma_f32_16x16x32_bf16 v[80:83], v[32:35], v[24:27], v[80:83]
    ds_read_b128 v[44:47], v10 offset:24832
    s_waitcnt lgkmcnt(6)
    v_mfma_f32_16x16x32_bf16 v[88:91], v[32:35], v[28:31], v[88:91]
    ds_read_b128 v[48:51], v10 offset:25088
    s_waitcnt lgkmcnt(5)
    v_mfma_f32_16x16x32_bf16 v[68:71], v[36:39], v[16:19], v[68:71]
    ds_read_b128 v[52:55], v10 offset:25344
    v_mfma_f32_16x16x32_bf16 v[76:79], v[36:39], v[20:23], v[76:79]
    ds_read_b64_tr_b16 v[60:61], v13 offset:12288
    v_mfma_f32_16x16x32_bf16 v[84:87], v[36:39], v[24:27], v[84:87]
    ds_read_b64_tr_b16 v[62:63], v13 offset:13312
    v_mfma_f32_16x16x32_bf16 v[92:95], v[36:39], v[28:31], v[92:95]
    s_waitcnt lgkmcnt(0)
    s_barrier
    v_mfma_f32_16x16x32_bf16 v[64:67], v[56:59], v[40:43], v[64:67]
    ds_read_b128 v[16:19], v10 offset:32768
    v_mfma_f32_16x16x32_bf16 v[72:75], v[56:59], v[44:47], v[72:75]
    ds_read_b64_tr_b16 v[32:33], v12 offset:16384
    v_mfma_f32_16x16x32_bf16 v[80:83], v[56:59], v[48:51], v[80:83]
    ds_read_b64_tr_b16 v[34:35], v12 offset:17408
    v_mfma_f32_16x16x32_bf16 v[88:91], v[56:59], v[52:55], v[88:91]
    ds_read_b128 v[20:23], v10 offset:33024
    v_mfma_f32_16x16x32_bf16 v[68:71], v[60:63], v[40:43], v[68:71]
    ds_read_b128 v[24:27], v10 offset:33280
    v_mfma_f32_16x16x32_bf16 v[76:79], v[60:63], v[44:47], v[76:79]
    ds_read_b128 v[28:31], v10 offset:33536
    v_mfma_f32_16x16x32_bf16 v[84:87], v[60:63], v[48:51], v[84:87]
    ds_read_b64_tr_b16 v[36:37], v13 offset:16384
    v_mfma_f32_16x16x32_bf16 v[92:95], v[60:63], v[52:55], v[92:95]
    ds_read_b64_tr_b16 v[38:39], v13 offset:17408
    s_waitcnt lgkmcnt(5)
    v_mfma_f32_16x16x32_bf16 v[64:67], v[32:35], v[16:19], v[64:67]
    ds_read_b128 v[40:43], v10 offset:40960
    ds_read_b64_tr_b16 v[56:57], v12 offset:20480
    s_waitcnt lgkmcnt(6)
    v_mfma_f32_16x16x32_bf16 v[72:75], v[32:35], v[20:23], v[72:75]
    ds_read_b64_tr_b16 v[58:59], v12 offset:21504
    s_waitcnt lgkmcnt(6)
    v_mfma_f32_16x16x32_bf16 v[80:83], v[32:35], v[24:27], v[80:83]
    ds_read_b128 v[44:47], v10 offset:41216
    s_waitcnt lgkmcnt(6)
    v_mfma_f32_16x16x32_bf16 v[88:91], v[32:35], v[28:31], v[88:91]
    ds_read_b128 v[48:51], v10 offset:41472
    s_waitcnt lgkmcnt(5)
    v_mfma_f32_16x16x32_bf16 v[68:71], v[36:39], v[16:19], v[68:71]
    ds_read_b128 v[52:55], v10 offset:41728
    v_mfma_f32_16x16x32_bf16 v[76:79], v[36:39], v[20:23], v[76:79]
    ds_read_b64_tr_b16 v[60:61], v13 offset:20480
    v_mfma_f32_16x16x32_bf16 v[84:87], v[36:39], v[24:27], v[84:87]
    ds_read_b64_tr_b16 v[62:63], v13 offset:21504
    v_mfma_f32_16x16x32_bf16 v[92:95], v[36:39], v[28:31], v[92:95]
    s_waitcnt lgkmcnt(0)
    s_barrier
    v_mfma_f32_16x16x32_bf16 v[64:67], v[56:59], v[40:43], v[64:67]
    ds_read_b128 v[16:19], v10 offset:49152
    v_mfma_f32_16x16x32_bf16 v[72:75], v[56:59], v[44:47], v[72:75]
    ds_read_b64_tr_b16 v[32:33], v12 offset:24576
    v_mfma_f32_16x16x32_bf16 v[80:83], v[56:59], v[48:51], v[80:83]
    ds_read_b64_tr_b16 v[34:35], v12 offset:25600
    v_mfma_f32_16x16x32_bf16 v[88:91], v[56:59], v[52:55], v[88:91]
    ds_read_b128 v[20:23], v10 offset:49408
    v_mfma_f32_16x16x32_bf16 v[68:71], v[60:63], v[40:43], v[68:71]
    ds_read_b128 v[24:27], v10 offset:49664
    v_mfma_f32_16x16x32_bf16 v[76:79], v[60:63], v[44:47], v[76:79]
    ds_read_b128 v[28:31], v10 offset:49920
    v_mfma_f32_16x16x32_bf16 v[84:87], v[60:63], v[48:51], v[84:87]
    ds_read_b64_tr_b16 v[36:37], v13 offset:24576
    v_mfma_f32_16x16x32_bf16 v[92:95], v[60:63], v[52:55], v[92:95]
    ds_read_b64_tr_b16 v[38:39], v13 offset:25600
    s_waitcnt lgkmcnt(5)
    v_mfma_f32_16x16x32_bf16 v[64:67], v[32:35], v[16:19], v[64:67]
    ds_read_b128 v[40:43], v10 offset:57344
    ds_read_b64_tr_b16 v[56:57], v12 offset:28672
    s_waitcnt lgkmcnt(6)
    v_mfma_f32_16x16x32_bf16 v[72:75], v[32:35], v[20:23], v[72:75]
    ds_read_b64_tr_b16 v[58:59], v12 offset:29696
    s_waitcnt lgkmcnt(6)
    v_mfma_f32_16x16x32_bf16 v[80:83], v[32:35], v[24:27], v[80:83]
    ds_read_b128 v[44:47], v10 offset:57600
    s_waitcnt lgkmcnt(6)
    v_mfma_f32_16x16x32_bf16 v[88:91], v[32:35], v[28:31], v[88:91]
    ds_read_b128 v[48:51], v10 offset:57856
    s_waitcnt lgkmcnt(5)
    v_mfma_f32_16x16x32_bf16 v[68:71], v[36:39], v[16:19], v[68:71]
    ds_read_b128 v[52:55], v10 offset:58112
    v_mfma_f32_16x16x32_bf16 v[76:79], v[36:39], v[20:23], v[76:79]
    ds_read_b64_tr_b16 v[60:61], v13 offset:28672
    v_mfma_f32_16x16x32_bf16 v[84:87], v[36:39], v[24:27], v[84:87]
    ds_read_b64_tr_b16 v[62:63], v13 offset:29696
    v_mfma_f32_16x16x32_bf16 v[92:95], v[36:39], v[28:31], v[92:95]
    s_waitcnt lgkmcnt(0)
    s_barrier
    v_mfma_f32_16x16x32_bf16 v[64:67], v[56:59], v[40:43], v[64:67]
    ds_read_b128 v[16:19], v11 offset:0
    v_mfma_f32_16x16x32_bf16 v[72:75], v[56:59], v[44:47], v[72:75]
    ds_read_b64_tr_b16 v[32:33], v12 offset:32768
    v_mfma_f32_16x16x32_bf16 v[80:83], v[56:59], v[48:51], v[80:83]
    ds_read_b64_tr_b16 v[34:35], v12 offset:33792
    v_mfma_f32_16x16x32_bf16 v[88:91], v[56:59], v[52:55], v[88:91]
    ds_read_b128 v[20:23], v11 offset:256
    v_mfma_f32_16x16x32_bf16 v[68:71], v[60:63], v[40:43], v[68:71]
    ds_read_b128 v[24:27], v11 offset:512
    v_mfma_f32_16x16x32_bf16 v[76:79], v[60:63], v[44:47], v[76:79]
    ds_read_b128 v[28:31], v11 offset:768
    v_mfma_f32_16x16x32_bf16 v[84:87], v[60:63], v[48:51], v[84:87]
    ds_read_b64_tr_b16 v[36:37], v13 offset:32768
    v_mfma_f32_16x16x32_bf16 v[92:95], v[60:63], v[52:55], v[92:95]
    ds_read_b64_tr_b16 v[38:39], v13 offset:33792
    s_waitcnt lgkmcnt(5)
    v_mfma_f32_16x16x32_bf16 v[64:67], v[32:35], v[16:19], v[64:67]
    ds_read_b128 v[40:43], v11 offset:8192
    ds_read_b64_tr_b16 v[56:57], v12 offset:36864
    s_waitcnt lgkmcnt(6)
    v_mfma_f32_16x16x32_bf16 v[72:75], v[32:35], v[20:23], v[72:75]
    ds_read_b64_tr_b16 v[58:59], v12 offset:37888
    s_waitcnt lgkmcnt(6)
    v_mfma_f32_16x16x32_bf16 v[80:83], v[32:35], v[24:27], v[80:83]
    ds_read_b128 v[44:47], v11 offset:8448
    s_waitcnt lgkmcnt(6)
    v_mfma_f32_16x16x32_bf16 v[88:91], v[32:35], v[28:31], v[88:91]
    ds_read_b128 v[48:51], v11 offset:8704
    s_waitcnt lgkmcnt(5)
    v_mfma_f32_16x16x32_bf16 v[68:71], v[36:39], v[16:19], v[68:71]
    ds_read_b128 v[52:55], v11 offset:8960
    v_mfma_f32_16x16x32_bf16 v[76:79], v[36:39], v[20:23], v[76:79]
    ds_read_b64_tr_b16 v[60:61], v13 offset:36864
    v_mfma_f32_16x16x32_bf16 v[84:87], v[36:39], v[24:27], v[84:87]
    ds_read_b64_tr_b16 v[62:63], v13 offset:37888
    v_mfma_f32_16x16x32_bf16 v[92:95], v[36:39], v[28:31], v[92:95]
    s_waitcnt lgkmcnt(0)
    s_barrier
    v_mfma_f32_16x16x32_bf16 v[64:67], v[56:59], v[40:43], v[64:67]
    ds_read_b128 v[16:19], v11 offset:16384
    v_mfma_f32_16x16x32_bf16 v[72:75], v[56:59], v[44:47], v[72:75]
    ds_read_b64_tr_b16 v[32:33], v12 offset:40960
    v_mfma_f32_16x16x32_bf16 v[80:83], v[56:59], v[48:51], v[80:83]
    ds_read_b64_tr_b16 v[34:35], v12 offset:41984
    v_mfma_f32_16x16x32_bf16 v[88:91], v[56:59], v[52:55], v[88:91]
    ds_read_b128 v[20:23], v11 offset:16640
    v_mfma_f32_16x16x32_bf16 v[68:71], v[60:63], v[40:43], v[68:71]
    ds_read_b128 v[24:27], v11 offset:16896
    v_mfma_f32_16x16x32_bf16 v[76:79], v[60:63], v[44:47], v[76:79]
    ds_read_b128 v[28:31], v11 offset:17152
    v_mfma_f32_16x16x32_bf16 v[84:87], v[60:63], v[48:51], v[84:87]
    ds_read_b64_tr_b16 v[36:37], v13 offset:40960
    v_mfma_f32_16x16x32_bf16 v[92:95], v[60:63], v[52:55], v[92:95]
    ds_read_b64_tr_b16 v[38:39], v13 offset:41984
    buffer_load_dwordx4 v[96:99], v128, s[40:43], s21 offen offset:0
    buffer_load_dwordx4 v[100:103], v128, s[40:43], s21 offen offset:256
    buffer_load_dwordx4 v[104:107], v128, s[40:43], s21 offen offset:512
    s_waitcnt lgkmcnt(5)
    v_mfma_f32_16x16x32_bf16 v[64:67], v[32:35], v[16:19], v[64:67]
    ds_read_b128 v[40:43], v11 offset:24576
    ds_read_b64_tr_b16 v[56:57], v12 offset:45056
    s_waitcnt lgkmcnt(6)
    v_mfma_f32_16x16x32_bf16 v[72:75], v[32:35], v[20:23], v[72:75]
    ds_read_b64_tr_b16 v[58:59], v12 offset:46080
    s_waitcnt lgkmcnt(6)
    v_mfma_f32_16x16x32_bf16 v[80:83], v[32:35], v[24:27], v[80:83]
    ds_read_b128 v[44:47], v11 offset:24832
    s_waitcnt lgkmcnt(6)
    v_mfma_f32_16x16x32_bf16 v[88:91], v[32:35], v[28:31], v[88:91]
    ds_read_b128 v[48:51], v11 offset:25088
    s_waitcnt lgkmcnt(5)
    v_mfma_f32_16x16x32_bf16 v[68:71], v[36:39], v[16:19], v[68:71]
    ds_read_b128 v[52:55], v11 offset:25344
    v_mfma_f32_16x16x32_bf16 v[76:79], v[36:39], v[20:23], v[76:79]
    ds_read_b64_tr_b16 v[60:61], v13 offset:45056
    v_mfma_f32_16x16x32_bf16 v[84:87], v[36:39], v[24:27], v[84:87]
    ds_read_b64_tr_b16 v[62:63], v13 offset:46080
    v_mfma_f32_16x16x32_bf16 v[92:95], v[36:39], v[28:31], v[92:95]
    buffer_load_dwordx4 v[108:111], v128, s[40:43], s21 offen offset:768
    s_add_u32 s49, s23, 372736
    buffer_load_dwordx4 v[112:115], v130, s[28:31], s49 offen offset:0
    buffer_load_dwordx4 v[116:119], v130, s[28:31], s49 offen offset:64
    s_add_u32 s49, s23, 16384
    buffer_load_dwordx4 v[120:123], v130, s[28:31], s49 offen offset:0
    buffer_load_dwordx4 v[124:127], v130, s[28:31], s49 offen offset:64
    s_waitcnt lgkmcnt(0)
    s_barrier
    v_mfma_f32_16x16x32_bf16 v[64:67], v[56:59], v[40:43], v[64:67]
    ds_read_b128 v[16:19], v10 offset:0
    v_mfma_f32_16x16x32_bf16 v[72:75], v[56:59], v[44:47], v[72:75]
    ds_read_b64_tr_b16 v[32:33], v12 offset:0
    v_mfma_f32_16x16x32_bf16 v[80:83], v[56:59], v[48:51], v[80:83]
    ds_read_b64_tr_b16 v[34:35], v12 offset:1024
    v_mfma_f32_16x16x32_bf16 v[88:91], v[56:59], v[52:55], v[88:91]
    ds_read_b128 v[20:23], v10 offset:256
    v_mfma_f32_16x16x32_bf16 v[68:71], v[60:63], v[40:43], v[68:71]
    ds_read_b128 v[24:27], v10 offset:512
    v_mfma_f32_16x16x32_bf16 v[76:79], v[60:63], v[44:47], v[76:79]
    ds_read_b128 v[28:31], v10 offset:768
    v_mfma_f32_16x16x32_bf16 v[84:87], v[60:63], v[48:51], v[84:87]
    ds_read_b64_tr_b16 v[36:37], v13 offset:0
    v_mfma_f32_16x16x32_bf16 v[92:95], v[60:63], v[52:55], v[92:95]
    ds_read_b64_tr_b16 v[38:39], v13 offset:1024
    s_waitcnt lgkmcnt(5)
    v_mfma_f32_16x16x32_bf16 v[64:67], v[32:35], v[16:19], v[64:67]
    ds_read_b128 v[40:43], v10 offset:8192
    ds_read_b64_tr_b16 v[56:57], v12 offset:4096
    s_waitcnt lgkmcnt(6)
    v_mfma_f32_16x16x32_bf16 v[72:75], v[32:35], v[20:23], v[72:75]
    ds_read_b64_tr_b16 v[58:59], v12 offset:5120
    s_waitcnt lgkmcnt(6)
    v_mfma_f32_16x16x32_bf16 v[80:83], v[32:35], v[24:27], v[80:83]
    ds_read_b128 v[44:47], v10 offset:8448
    s_waitcnt lgkmcnt(6)
    v_mfma_f32_16x16x32_bf16 v[88:91], v[32:35], v[28:31], v[88:91]
    ds_read_b128 v[48:51], v10 offset:8704
    s_waitcnt lgkmcnt(5)
    v_mfma_f32_16x16x32_bf16 v[68:71], v[36:39], v[16:19], v[68:71]
    ds_read_b128 v[52:55], v10 offset:8960
    v_mfma_f32_16x16x32_bf16 v[76:79], v[36:39], v[20:23], v[76:79]
    ds_read_b64_tr_b16 v[60:61], v13 offset:4096
    v_mfma_f32_16x16x32_bf16 v[84:87], v[36:39], v[24:27], v[84:87]
    ds_read_b64_tr_b16 v[62:63], v13 offset:5120
    v_mfma_f32_16x16x32_bf16 v[92:95], v[36:39], v[28:31], v[92:95]
    s_waitcnt lgkmcnt(0)
    s_barrier
    v_mfma_f32_16x16x32_bf16 v[64:67], v[56:59], v[40:43], v[64:67]
    ds_read_b128 v[16:19], v10 offset:16384
    v_mfma_f32_16x16x32_bf16 v[72:75], v[56:59], v[44:47], v[72:75]
    ds_read_b64_tr_b16 v[32:33], v12 offset:8192
    v_mfma_f32_16x16x32_bf16 v[80:83], v[56:59], v[48:51], v[80:83]
    ds_read_b64_tr_b16 v[34:35], v12 offset:9216
    v_mfma_f32_16x16x32_bf16 v[88:91], v[56:59], v[52:55], v[88:91]
    ds_read_b128 v[20:23], v10 offset:16640
    v_mfma_f32_16x16x32_bf16 v[68:71], v[60:63], v[40:43], v[68:71]
    ds_read_b128 v[24:27], v10 offset:16896
    v_mfma_f32_16x16x32_bf16 v[76:79], v[60:63], v[44:47], v[76:79]
    ds_read_b128 v[28:31], v10 offset:17152
    v_mfma_f32_16x16x32_bf16 v[84:87], v[60:63], v[48:51], v[84:87]
    ds_read_b64_tr_b16 v[36:37], v13 offset:8192
    v_mfma_f32_16x16x32_bf16 v[92:95], v[60:63], v[52:55], v[92:95]
    ds_read_b64_tr_b16 v[38:39], v13 offset:9216
    s_waitcnt lgkmcnt(5)
    v_mfma_f32_16x16x32_bf16 v[64:67], v[32:35], v[16:19], v[64:67]
    ds_read_b128 v[40:43], v10 offset:24576
    ds_read_b64_tr_b16 v[56:57], v12 offset:12288
    s_waitcnt lgkmcnt(6)
    v_mfma_f32_16x16x32_bf16 v[72:75], v[32:35], v[20:23], v[72:75]
    ds_read_b64_tr_b16 v[58:59], v12 offset:13312
    s_waitcnt lgkmcnt(6)
    v_mfma_f32_16x16x32_bf16 v[80:83], v[32:35], v[24:27], v[80:83]
    ds_read_b128 v[44:47], v10 offset:24832
    s_waitcnt lgkmcnt(6)
    v_mfma_f32_16x16x32_bf16 v[88:91], v[32:35], v[28:31], v[88:91]
    ds_read_b128 v[48:51], v10 offset:25088
    s_waitcnt lgkmcnt(5)
    v_mfma_f32_16x16x32_bf16 v[68:71], v[36:39], v[16:19], v[68:71]
    ds_read_b128 v[52:55], v10 offset:25344
    v_mfma_f32_16x16x32_bf16 v[76:79], v[36:39], v[20:23], v[76:79]
    ds_read_b64_tr_b16 v[60:61], v13 offset:12288
    v_mfma_f32_16x16x32_bf16 v[84:87], v[36:39], v[24:27], v[84:87]
    ds_read_b64_tr_b16 v[62:63], v13 offset:13312
    v_mfma_f32_16x16x32_bf16 v[92:95], v[36:39], v[28:31], v[92:95]
    s_waitcnt lgkmcnt(0)
    s_barrier
    v_mfma_f32_16x16x32_bf16 v[64:67], v[56:59], v[40:43], v[64:67]
    ds_read_b128 v[16:19], v10 offset:32768
    v_mfma_f32_16x16x32_bf16 v[72:75], v[56:59], v[44:47], v[72:75]
    ds_read_b64_tr_b16 v[32:33], v12 offset:16384
    v_mfma_f32_16x16x32_bf16 v[80:83], v[56:59], v[48:51], v[80:83]
    ds_read_b64_tr_b16 v[34:35], v12 offset:17408
    v_mfma_f32_16x16x32_bf16 v[88:91], v[56:59], v[52:55], v[88:91]
    ds_read_b128 v[20:23], v10 offset:33024
    v_mfma_f32_16x16x32_bf16 v[68:71], v[60:63], v[40:43], v[68:71]
    ds_read_b128 v[24:27], v10 offset:33280
    v_mfma_f32_16x16x32_bf16 v[76:79], v[60:63], v[44:47], v[76:79]
    ds_read_b128 v[28:31], v10 offset:33536
    v_mfma_f32_16x16x32_bf16 v[84:87], v[60:63], v[48:51], v[84:87]
    ds_read_b64_tr_b16 v[36:37], v13 offset:16384
    v_mfma_f32_16x16x32_bf16 v[92:95], v[60:63], v[52:55], v[92:95]
    ds_read_b64_tr_b16 v[38:39], v13 offset:17408
    s_waitcnt lgkmcnt(5)
    v_mfma_f32_16x16x32_bf16 v[64:67], v[32:35], v[16:19], v[64:67]
    ds_read_b128 v[40:43], v10 offset:40960
    ds_read_b64_tr_b16 v[56:57], v12 offset:20480
    s_waitcnt lgkmcnt(6)
    v_mfma_f32_16x16x32_bf16 v[72:75], v[32:35], v[20:23], v[72:75]
    ds_read_b64_tr_b16 v[58:59], v12 offset:21504
    s_waitcnt lgkmcnt(6)
    v_mfma_f32_16x16x32_bf16 v[80:83], v[32:35], v[24:27], v[80:83]
    ds_read_b128 v[44:47], v10 offset:41216
    s_waitcnt lgkmcnt(6)
    v_mfma_f32_16x16x32_bf16 v[88:91], v[32:35], v[28:31], v[88:91]
    ds_read_b128 v[48:51], v10 offset:41472
    s_waitcnt lgkmcnt(5)
    v_mfma_f32_16x16x32_bf16 v[68:71], v[36:39], v[16:19], v[68:71]
    ds_read_b128 v[52:55], v10 offset:41728
    v_mfma_f32_16x16x32_bf16 v[76:79], v[36:39], v[20:23], v[76:79]
    ds_read_b64_tr_b16 v[60:61], v13 offset:20480
    v_mfma_f32_16x16x32_bf16 v[84:87], v[36:39], v[24:27], v[84:87]
    ds_read_b64_tr_b16 v[62:63], v13 offset:21504
    v_mfma_f32_16x16x32_bf16 v[92:95], v[36:39], v[28:31], v[92:95]
    s_waitcnt lgkmcnt(0)
    s_barrier
    v_mfma_f32_16x16x32_bf16 v[64:67], v[56:59], v[40:43], v[64:67]
    ds_read_b128 v[16:19], v10 offset:49152
    v_mfma_f32_16x16x32_bf16 v[72:75], v[56:59], v[44:47], v[72:75]
    ds_read_b64_tr_b16 v[32:33], v12 offset:24576
    v_mfma_f32_16x16x32_bf16 v[80:83], v[56:59], v[48:51], v[80:83]
    ds_read_b64_tr_b16 v[34:35], v12 offset:25600
    v_mfma_f32_16x16x32_bf16 v[88:91], v[56:59], v[52:55], v[88:91]
    ds_read_b128 v[20:23], v10 offset:49408
    v_mfma_f32_16x16x32_bf16 v[68:71], v[60:63], v[40:43], v[68:71]
    ds_read_b128 v[24:27], v10 offset:49664
    v_mfma_f32_16x16x32_bf16 v[76:79], v[60:63], v[44:47], v[76:79]
    ds_read_b128 v[28:31], v10 offset:49920
    v_mfma_f32_16x16x32_bf16 v[84:87], v[60:63], v[48:51], v[84:87]
    ds_read_b64_tr_b16 v[36:37], v13 offset:24576
    v_mfma_f32_16x16x32_bf16 v[92:95], v[60:63], v[52:55], v[92:95]
    ds_read_b64_tr_b16 v[38:39], v13 offset:25600
    s_waitcnt lgkmcnt(5)
    v_mfma_f32_16x16x32_bf16 v[64:67], v[32:35], v[16:19], v[64:67]
    ds_read_b128 v[40:43], v10 offset:57344
    ds_read_b64_tr_b16 v[56:57], v12 offset:28672
    s_waitcnt lgkmcnt(6)
    v_mfma_f32_16x16x32_bf16 v[72:75], v[32:35], v[20:23], v[72:75]
    ds_read_b64_tr_b16 v[58:59], v12 offset:29696
    s_waitcnt lgkmcnt(6)
    v_mfma_f32_16x16x32_bf16 v[80:83], v[32:35], v[24:27], v[80:83]
    ds_read_b128 v[44:47], v10 offset:57600
    s_waitcnt lgkmcnt(6)
    v_mfma_f32_16x16x32_bf16 v[88:91], v[32:35], v[28:31], v[88:91]
    ds_read_b128 v[48:51], v10 offset:57856
    s_waitcnt lgkmcnt(5)
    v_mfma_f32_16x16x32_bf16 v[68:71], v[36:39], v[16:19], v[68:71]
    ds_read_b128 v[52:55], v10 offset:58112
    v_mfma_f32_16x16x32_bf16 v[76:79], v[36:39], v[20:23], v[76:79]
    ds_read_b64_tr_b16 v[60:61], v13 offset:28672
    v_mfma_f32_16x16x32_bf16 v[84:87], v[36:39], v[24:27], v[84:87]
    ds_read_b64_tr_b16 v[62:63], v13 offset:29696
    v_mfma_f32_16x16x32_bf16 v[92:95], v[36:39], v[28:31], v[92:95]
    s_sub_u32 s48, s48, 1
    s_cmp_lg_u32 s48, 0
    s_waitcnt lgkmcnt(0)
    s_barrier
    s_cbranch_scc1 k5_kernel_cloop
    s_waitcnt vmcnt(0)
    v_min3_f32 v7, |v120|, |v121|, |v122|
    v_min3_f32 v8, |v123|, |v124|, |v125|
    v_min3_f32 v7, v7, |v126|, |v127|
    v_min_f32 v7, v7, v8
    v_cmp_eq_f32 vcc, 0, v7
    s_nop 4
    s_cbranch_vccz k5_nz
    s_mov_b64 exec, vcc
    buffer_load_dwordx4 v[96:99], v128, s[36:39], s21 offen offset:0
    buffer_load_dwordx4 v[100:103], v128, s[36:39], s21 offen offset:256
    buffer_load_dwordx4 v[104:107], v128, s[36:39], s21 offen offset:512
    buffer_load_dwordx4 v[108:111], v128, s[36:39], s21 offen offset:768
    v_mov_b32 v120, 1.0
    v_mov_b32 v121, 1.0
    v_mov_b32 v122, 1.0
    v_mov_b32 v123, 1.0
    v_mov_b32 v124, 1.0
    v_mov_b32 v125, 1.0
    v_mov_b32 v126, 1.0
    v_mov_b32 v127, 1.0
    s_mov_b64 exec, -1
    s_waitcnt vmcnt(0)
k5_nz:
    v_mfma_f32_16x16x32_bf16 v[64:67], v[56:59], v[40:43], v[64:67]
    v_rcp_f32 v120, v120
    v_rcp_f32 v121, v121
    v_rcp_f32 v122, v122
    v_rcp_f32 v123, v123
    v_mfma_f32_16x16x32_bf16 v[72:75], v[56:59], v[44:47], v[72:75]
    v_rcp_f32 v124, v124
    v_rcp_f32 v125, v125
    v_rcp_f32 v126, v126
    v_rcp_f32 v127, v127
    v_mfma_f32_16x16x32_bf16 v[80:83], v[56:59], v[48:51], v[80:83]
    v_cvt_pk_bf16_f32 v113, v112, v113
    v_cvt_pk_bf16_f32 v115, v114, v115
    v_cvt_pk_bf16_f32 v117, v116, v117
    v_cvt_pk_bf16_f32 v119, v118, v119
    v_mfma_f32_16x16x32_bf16 v[88:91], v[56:59], v[52:55], v[88:91]
    v_lshlrev_b32 v112, 16, v113
    v_and_b32 v113, s50, v113
    v_lshlrev_b32 v114, 16, v115
    v_and_b32 v115, s50, v115
    v_mfma_f32_16x16x32_bf16 v[68:71], v[60:63], v[40:43], v[68:71]
    v_lshlrev_b32 v116, 16, v117
    v_and_b32 v117, s50, v117
    v_lshlrev_b32 v118, 16, v119
    v_and_b32 v119, s50, v119
    v_mfma_f32_16x16x32_bf16 v[76:79], v[60:63], v[44:47], v[76:79]
    v_lshlrev_b32 v16, 16, v96
    v_and_b32 v17, s50, v96
    v_lshlrev_b32 v18, 16, v97
    v_and_b32 v19, s50, v97
    v_mfma_f32_16x16x32_bf16 v[84:87], v[60:63], v[48:51], v[84:87]
    v_lshlrev_b32 v20, 16, v98
    v_and_b32 v21, s50, v98
    v_lshlrev_b32 v22, 16, v99
    v_and_b32 v23, s50, v99
    v_mfma_f32_16x16x32_bf16 v[92:95], v[60:63], v[52:55], v[92:95]
    v_lshlrev_b32 v24, 16, v100
    v_and_b32 v25, s50, v100
    v_lshlrev_b32 v26, 16, v101
    v_and_b32 v27, s50, v101
    v_lshlrev_b32 v28, 16, v102
    v_and_b32 v29, s50, v102
    v_lshlrev_b32 v30, 16, v103
    v_and_b32 v31, s50, v103
    v_pk_mul_f32 v[16:17], v[16:17], v[120:121]
    v_pk_mul_f32 v[18:19], v[18:19], v[122:123]
    v_pk_mul_f32 v[20:21], v[20:21], v[124:125]
    v_pk_mul_f32 v[22:23], v[22:23], v[126:127]
    v_pk_fma_f32 v[64:65], v[64:65], v[112:113], v[16:17]
    v_pk_fma_f32 v[66:67], v[66:67], v[114:115], v[18:19]
    v_pk_fma_f32 v[68:69], v[68:69], v[116:117], v[20:21]
    v_pk_fma_f32 v[70:71], v[70:71], v[118:119], v[22:23]
    v_cvt_pk_bf16_f32 v96, v64, v65
    v_cvt_pk_bf16_f32 v97, v66, v67
    v_cvt_pk_bf16_f32 v98, v68, v69
    v_cvt_pk_bf16_f32 v99, v70, v71
    s_nop 0
    v_permlane16_swap_b32 v96, v98
    v_permlane16_swap_b32 v97, v99
    s_add_u32 s49, s22, 0
    buffer_store_dwordx4 v[96:99], v129, s[24:27], s49 offen sc0 sc1
    v_pk_mul_f32 v[24:25], v[24:25], v[120:121]
    v_pk_mul_f32 v[26:27], v[26:27], v[122:123]
    v_pk_mul_f32 v[28:29], v[28:29], v[124:125]
    v_pk_mul_f32 v[30:31], v[30:31], v[126:127]
    v_pk_fma_f32 v[72:73], v[72:73], v[112:113], v[24:25]
    v_pk_fma_f32 v[74:75], v[74:75], v[114:115], v[26:27]
    v_pk_fma_f32 v[76:77], v[76:77], v[116:117], v[28:29]
    v_pk_fma_f32 v[78:79], v[78:79], v[118:119], v[30:31]
    v_cvt_pk_bf16_f32 v100, v72, v73
    v_cvt_pk_bf16_f32 v101, v74, v75
    v_cvt_pk_bf16_f32 v102, v76, v77
    v_cvt_pk_bf16_f32 v103, v78, v79
    s_nop 0
    v_permlane16_swap_b32 v100, v102
    v_permlane16_swap_b32 v101, v103
    s_add_u32 s49, s22, 32768
    buffer_store_dwordx4 v[100:103], v129, s[24:27], s49 offen sc0 sc1
    v_lshlrev_b32 v16, 16, v104
    v_and_b32 v17, s50, v104
    v_lshlrev_b32 v18, 16, v105
    v_and_b32 v19, s50, v105
    v_lshlrev_b32 v20, 16, v106
    v_and_b32 v21, s50, v106
    v_lshlrev_b32 v22, 16, v107
    v_and_b32 v23, s50, v107
    v_pk_mul_f32 v[16:17], v[16:17], v[120:121]
    v_pk_mul_f32 v[18:19], v[18:19], v[122:123]
    v_pk_mul_f32 v[20:21], v[20:21], v[124:125]
    v_pk_mul_f32 v[22:23], v[22:23], v[126:127]
    v_pk_fma_f32 v[80:81], v[80:81], v[112:113], v[16:17]
    v_pk_fma_f32 v[82:83], v[82:83], v[114:115], v[18:19]
    v_pk_fma_f32 v[84:85], v[84:85], v[116:117], v[20:21]
    v_pk_fma_f32 v[86:87], v[86:87], v[118:119], v[22:23]
    v_cvt_pk_bf16_f32 v104, v80, v81
    v_cvt_pk_bf16_f32 v105, v82, v83
    v_cvt_pk_bf16_f32 v106, v84, v85
    v_cvt_pk_bf16_f32 v107, v86, v87
    s_nop 0
    v_permlane16_swap_b32 v104, v106
    v_permlane16_swap_b32 v105, v107
    s_add_u32 s49, s22, 65536
    buffer_store_dwordx4 v[104:107], v129, s[24:27], s49 offen sc0 sc1
    v_lshlrev_b32 v24, 16, v108
    v_and_b32 v25, s50, v108
    v_lshlrev_b32 v26, 16, v109
    v_and_b32 v27, s50, v109
    v_lshlrev_b32 v28, 16, v110
    v_and_b32 v29, s50, v110
    v_lshlrev_b32 v30, 16, v111
    v_and_b32 v31, s50, v111
    v_pk_mul_f32 v[24:25], v[24:25], v[120:121]
    v_pk_mul_f32 v[26:27], v[26:27], v[122:123]
    v_pk_mul_f32 v[28:29], v[28:29], v[124:125]
    v_pk_mul_f32 v[30:31], v[30:31], v[126:127]
    v_pk_fma_f32 v[88:89], v[88:89], v[112:113], v[24:25]
    v_pk_fma_f32 v[90:91], v[90:91], v[114:115], v[26:27]
    v_pk_fma_f32 v[92:93], v[92:93], v[116:117], v[28:29]
    v_pk_fma_f32 v[94:95], v[94:95], v[118:119], v[30:31]
    v_cvt_pk_bf16_f32 v108, v88, v89
    v_cvt_pk_bf16_f32 v109, v90, v91
    v_cvt_pk_bf16_f32 v110, v92, v93
    v_cvt_pk_bf16_f32 v111, v94, v95
    s_nop 0
    v_permlane16_swap_b32 v108, v110
    v_permlane16_swap_b32 v109, v111
    s_add_u32 s49, s22, 98304
    buffer_store_dwordx4 v[108:111], v129, s[24:27], s49 offen sc0 sc1
    s_endpgm
k5_kernel_prod:
    v_and_b32 v2, 63, v0
    v_lshrrev_b32 v3, 3, v2
    v_and_b32 v4, 7, v2
    s_sub_u32 s17, s16, 4
    s_lshl_b32 s18, s14, 7
    s_lshl_b32 s60, s17, 16
    s_lshl_b32 s61, s18, 4
    s_add_u32 s60, s60, s61
    v_lshlrev_b32 v8, 4, v2
    v_add_u32 v8, s60, v8
    v_add_u32 v9, 30720, v8
    s_and_b32 s60, s15, 7
    s_lshl_b32 s19, s15, 7
    s_lshr_b32 s61, s15, 3
    s_mul_i32 s61, s61, 229376
    s_cmp_eq_u32 s60, 3
    s_mov_b32 s51, 2048
    s_cmov_b32 s51, 128
    s_cselect_b32 s19, s61, s19
    s_lshl_b32 s53, s51, 6
    s_lshl_b32 s60, s17, 4
    v_add_u32 v5, s60, v3
    v_mul_lo_u32 v10, v5, s51
    s_lshl_b32 s61, s51, 3
    s_sub_u32 s61, s61, 1024
    v_add_u32 v10, s19, v10
    v_bfe_u32 v6, v5, 1, 1
    v_lshlrev_b32 v6, 2, v6
    v_bfe_u32 v5, v5, 4, 1
    v_lshl_or_b32 v6, v5, 1, v6
    v_xor_b32 v6, v6, v4
    v_lshl_add_u32 v10, v6, 4, v10
    v_add_u32 v11, s61, v10
    s_lshl_b32 s40, s17, 11
    s_lshl_b32 s43, s17, 12
    s_waitcnt lgkmcnt(0)
    s_add_u32 s20, s4, 32505856
    s_addc_u32 s21, s5, 0
    s_and_b32 s21, s21, 0xffff
    s_mov_b32 s22, 7340032
    s_mov_b32 s23, 0x00020000
    s_add_u32 s24, s4, 56623104
    s_addc_u32 s25, s5, 0
    s_cmpk_eq_u32 s51, 128
    s_cselect_b32 s24, s24, s8
    s_cselect_b32 s25, s25, s9
    s_and_b32 s25, s25, 0xffff
    s_mov_b32 s26, 3670016
    s_mov_b32 s27, 0x00020000
    v_lshlrev_b32 v12, 6, v2
    s_lshl_b32 s46, s2, 2
    s_add_u32 s46, s46, s17
    s_lshl_b32 s46, s46, 12
    s_add_u32 m0, s43, 0
    s_mov_b32 s41, 0
    buffer_load_dwordx4 v8, s[20:23], s41 offen offset:0 lds
    buffer_load_dwordx4 v8, s[20:23], s41 offen offset:1024 lds
    buffer_load_dwordx4 v9, s[20:23], s41 offen offset:2048 lds
    buffer_load_dwordx4 v9, s[20:23], s41 offen offset:3072 lds
    s_mul_i32 s42, s53, 0
    s_add_u32 m0, s40, 98304
    s_nop 0
    buffer_load_dwordx4 v10, s[24:27], s42 offen offset:0 lds
    buffer_load_dwordx4 v11, s[24:27], s42 offen offset:1024 lds
    s_add_u32 m0, s43, 16384
    s_mov_b32 s41, 262144
    buffer_load_dwordx4 v8, s[20:23], s41 offen offset:0 lds
    buffer_load_dwordx4 v8, s[20:23], s41 offen offset:1024 lds
    buffer_load_dwordx4 v9, s[20:23], s41 offen offset:2048 lds
    buffer_load_dwordx4 v9, s[20:23], s41 offen offset:3072 lds
    s_mul_i32 s42, s53, 1
    s_add_u32 m0, s40, 106496
    s_nop 0
    buffer_load_dwordx4 v10, s[24:27], s42 offen offset:0 lds
    buffer_load_dwordx4 v11, s[24:27], s42 offen offset:1024 lds
    s_add_u32 m0, s43, 32768
    s_mov_b32 s41, 524288
    buffer_load_dwordx4 v8, s[20:23], s41 offen offset:0 lds
    buffer_load_dwordx4 v8, s[20:23], s41 offen offset:1024 lds
    buffer_load_dwordx4 v9, s[20:23], s41 offen offset:2048 lds
    buffer_load_dwordx4 v9, s[20:23], s41 offen offset:3072 lds
    s_mul_i32 s42, s53, 2
    s_add_u32 m0, s40, 114688
    s_nop 0
    buffer_load_dwordx4 v10, s[24:27], s42 offen offset:0 lds
    buffer_load_dwordx4 v11, s[24:27], s42 offen offset:1024 lds
    s_add_u32 m0, s43, 49152
    s_mov_b32 s41, 786432
    buffer_load_dwordx4 v8, s[20:23], s41 offen offset:0 lds
    buffer_load_dwordx4 v8, s[20:23], s41 offen offset:1024 lds
    buffer_load_dwordx4 v9, s[20:23], s41 offen offset:2048 lds
    buffer_load_dwordx4 v9, s[20:23], s41 offen offset:3072 lds
    s_mul_i32 s42, s53, 3
    s_add_u32 m0, s40, 122880
    s_nop 0
    buffer_load_dwordx4 v10, s[24:27], s42 offen offset:0 lds
    buffer_load_dwordx4 v11, s[24:27], s42 offen offset:1024 lds
    s_waitcnt vmcnt(18)
    s_barrier
    s_add_u32 m0, s43, 65536
    s_mov_b32 s41, 1048576
    buffer_load_dwordx4 v8, s[20:23], s41 offen offset:0 lds
    buffer_load_dwordx4 v8, s[20:23], s41 offen offset:1024 lds
    buffer_load_dwordx4 v9, s[20:23], s41 offen offset:2048 lds
    buffer_load_dwordx4 v9, s[20:23], s41 offen offset:3072 lds
    s_mul_i32 s42, s53, 4
    s_add_u32 m0, s40, 131072
    s_nop 0
    buffer_load_dwordx4 v10, s[24:27], s42 offen offset:0 lds
    buffer_load_dwordx4 v11, s[24:27], s42 offen offset:1024 lds
    s_add_u32 m0, s43, 81920
    s_mov_b32 s41, 1310720
    buffer_load_dwordx4 v8, s[20:23], s41 offen offset:0 lds
    buffer_load_dwordx4 v8, s[20:23], s41 offen offset:1024 lds
    buffer_load_dwordx4 v9, s[20:23], s41 offen offset:2048 lds
    buffer_load_dwordx4 v9, s[20:23], s41 offen offset:3072 lds
    s_mul_i32 s42, s53, 5
    s_add_u32 m0, s40, 139264
    s_nop 0
    buffer_load_dwordx4 v10, s[24:27], s42 offen offset:0 lds
    buffer_load_dwordx4 v11, s[24:27], s42 offen offset:1024 lds
    s_waitcnt vmcnt(24)
    s_barrier
    s_add_u32 m0, s43, 0
    s_mov_b32 s41, 1572864
    buffer_load_dwordx4 v8, s[20:23], s41 offen offset:0 lds
    buffer_load_dwordx4 v8, s[20:23], s41 offen offset:1024 lds
    buffer_load_dwordx4 v9, s[20:23], s41 offen offset:2048 lds
    buffer_load_dwordx4 v9, s[20:23], s41 offen offset:3072 lds
    s_mul_i32 s42, s53, 6
    s_add_u32 m0, s40, 98304
    s_nop 0
    buffer_load_dwordx4 v10, s[24:27], s42 offen offset:0 lds
    buffer_load_dwordx4 v11, s[24:27], s42 offen offset:1024 lds
    s_waitcnt vmcnt(24)
    s_barrier
    s_add_u32 m0, s43, 16384
    s_mov_b32 s41, 1835008
    buffer_load_dwordx4 v8, s[20:23], s41 offen offset:0 lds
    buffer_load_dwordx4 v8, s[20:23], s41 offen offset:1024 lds
    buffer_load_dwordx4 v9, s[20:23], s41 offen offset:2048 lds
    buffer_load_dwordx4 v9, s[20:23], s41 offen offset:3072 lds
    s_mul_i32 s42, s53, 7
    s_add_u32 m0, s40, 106496
    s_nop 0
    buffer_load_dwordx4 v10, s[24:27], s42 offen offset:0 lds
    buffer_load_dwordx4 v11, s[24:27], s42 offen offset:1024 lds
    s_waitcnt vmcnt(24)
    s_barrier
    s_add_u32 m0, s43, 32768
    s_mov_b32 s41, 2097152
    buffer_load_dwordx4 v8, s[20:23], s41 offen offset:0 lds
    buffer_load_dwordx4 v8, s[20:23], s41 offen offset:1024 lds
    buffer_load_dwordx4 v9, s[20:23], s41 offen offset:2048 lds
    buffer_load_dwordx4 v9, s[20:23], s41 offen offset:3072 lds
    s_mul_i32 s42, s53, 8
    s_add_u32 m0, s40, 114688
    s_nop 0
    buffer_load_dwordx4 v10, s[24:27], s42 offen offset:0 lds
    buffer_load_dwordx4 v11, s[24:27], s42 offen offset:1024 lds
    s_waitcnt vmcnt(24)
    s_barrier
    s_add_u32 m0, s43, 49152
    s_mov_b32 s41, 2359296
    buffer_load_dwordx4 v8, s[20:23], s41 offen offset:0 lds
    buffer_load_dwordx4 v8, s[20:23], s41 offen offset:1024 lds
    buffer_load_dwordx4 v9, s[20:23], s41 offen offset:2048 lds
    buffer_load_dwordx4 v9, s[20:23], s41 offen offset:3072 lds
    s_mul_i32 s42, s53, 9
    s_add_u32 m0, s40, 122880
    s_nop 0
    buffer_load_dwordx4 v10, s[24:27], s42 offen offset:0 lds
    buffer_load_dwordx4 v11, s[24:27], s42 offen offset:1024 lds
    s_waitcnt vmcnt(24)
    s_barrier
    s_add_u32 m0, s43, 65536
    s_mov_b32 s41, 2621440
    buffer_load_dwordx4 v8, s[20:23], s41 offen offset:0 lds
    buffer_load_dwordx4 v8, s[20:23], s41 offen offset:1024 lds
    buffer_load_dwordx4 v9, s[20:23], s41 offen offset:2048 lds
    buffer_load_dwordx4 v9, s[20:23], s41 offen offset:3072 lds
    s_mul_i32 s42, s53, 10
    s_add_u32 m0, s40, 131072
    s_nop 0
    buffer_load_dwordx4 v10, s[24:27], s42 offen offset:0 lds
    buffer_load_dwordx4 v11, s[24:27], s42 offen offset:1024 lds
    s_waitcnt vmcnt(24)
    s_barrier
    s_add_u32 m0, s43, 81920
    s_mov_b32 s41, 2883584
    buffer_load_dwordx4 v8, s[20:23], s41 offen offset:0 lds
    buffer_load_dwordx4 v8, s[20:23], s41 offen offset:1024 lds
    buffer_load_dwordx4 v9, s[20:23], s41 offen offset:2048 lds
    buffer_load_dwordx4 v9, s[20:23], s41 offen offset:3072 lds
    s_mul_i32 s42, s53, 11
    s_add_u32 m0, s40, 139264
    s_nop 0
    buffer_load_dwordx4 v10, s[24:27], s42 offen offset:0 lds
    buffer_load_dwordx4 v11, s[24:27], s42 offen offset:1024 lds
    s_waitcnt vmcnt(24)
    s_barrier
    s_add_u32 m0, s43, 0
    s_mov_b32 s41, 3145728
    buffer_load_dwordx4 v8, s[20:23], s41 offen offset:0 lds
    buffer_load_dwordx4 v8, s[20:23], s41 offen offset:1024 lds
    buffer_load_dwordx4 v9, s[20:23], s41 offen offset:2048 lds
    buffer_load_dwordx4 v9, s[20:23], s41 offen offset:3072 lds
    s_mul_i32 s42, s53, 12
    s_add_u32 m0, s40, 98304
    s_nop 0
    buffer_load_dwordx4 v10, s[24:27], s42 offen offset:0 lds
    buffer_load_dwordx4 v11, s[24:27], s42 offen offset:1024 lds
    s_waitcnt vmcnt(24)
    s_barrier
    s_add_u32 m0, s43, 16384
    s_mov_b32 s41, 3407872
    buffer_load_dwordx4 v8, s[20:23], s41 offen offset:0 lds
    buffer_load_dwordx4 v8, s[20:23], s41 offen offset:1024 lds
    buffer_load_dwordx4 v9, s[20:23], s41 offen offset:2048 lds
    buffer_load_dwordx4 v9, s[20:23], s41 offen offset:3072 lds
    s_mul_i32 s42, s53, 13
    s_add_u32 m0, s40, 106496
    s_nop 0
    buffer_load_dwordx4 v10, s[24:27], s42 offen offset:0 lds
    buffer_load_dwordx4 v11, s[24:27], s42 offen offset:1024 lds
    s_waitcnt vmcnt(24)
    s_barrier
    s_add_u32 m0, s43, 32768
    s_mov_b32 s41, 3670016
    buffer_load_dwordx4 v8, s[20:23], s41 offen offset:0 lds
    buffer_load_dwordx4 v8, s[20:23], s41 offen offset:1024 lds
    buffer_load_dwordx4 v9, s[20:23], s41 offen offset:2048 lds
    buffer_load_dwordx4 v9, s[20:23], s41 offen offset:3072 lds
    s_mul_i32 s42, s53, 14
    s_add_u32 m0, s40, 114688
    s_nop 0
    buffer_load_dwordx4 v10, s[24:27], s42 offen offset:0 lds
    buffer_load_dwordx4 v11, s[24:27], s42 offen offset:1024 lds
    s_waitcnt vmcnt(24)
    s_barrier
    s_add_u32 m0, s43, 49152
    s_mov_b32 s41, 3932160
    buffer_load_dwordx4 v8, s[20:23], s41 offen offset:0 lds
    buffer_load_dwordx4 v8, s[20:23], s41 offen offset:1024 lds
    buffer_load_dwordx4 v9, s[20:23], s41 offen offset:2048 lds
    buffer_load_dwordx4 v9, s[20:23], s41 offen offset:3072 lds
    s_mul_i32 s42, s53, 15
    s_add_u32 m0, s40, 122880
    s_nop 0
    buffer_load_dwordx4 v10, s[24:27], s42 offen offset:0 lds
    buffer_load_dwordx4 v11, s[24:27], s42 offen offset:1024 lds
    s_waitcnt vmcnt(24)
    s_barrier
    s_add_u32 m0, s43, 65536
    s_mov_b32 s41, 4194304
    buffer_load_dwordx4 v8, s[20:23], s41 offen offset:0 lds
    buffer_load_dwordx4 v8, s[20:23], s41 offen offset:1024 lds
    buffer_load_dwordx4 v9, s[20:23], s41 offen offset:2048 lds
    buffer_load_dwordx4 v9, s[20:23], s41 offen offset:3072 lds
    s_mul_i32 s42, s53, 16
    s_add_u32 m0, s40, 131072
    s_nop 0
    buffer_load_dwordx4 v10, s[24:27], s42 offen offset:0 lds
    buffer_load_dwordx4 v11, s[24:27], s42 offen offset:1024 lds
    s_waitcnt vmcnt(24)
    s_barrier
    s_add_u32 m0, s43, 81920
    s_mov_b32 s41, 4456448
    buffer_load_dwordx4 v8, s[20:23], s41 offen offset:0 lds
    buffer_load_dwordx4 v8, s[20:23], s41 offen offset:1024 lds
    buffer_load_dwordx4 v9, s[20:23], s41 offen offset:2048 lds
    buffer_load_dwordx4 v9, s[20:23], s41 offen offset:3072 lds
    s_mul_i32 s42, s53, 17
    s_add_u32 m0, s40, 139264
    s_nop 0
    buffer_load_dwordx4 v10, s[24:27], s42 offen offset:0 lds
    buffer_load_dwordx4 v11, s[24:27], s42 offen offset:1024 lds
    s_waitcnt vmcnt(24)
    s_barrier
    s_add_u32 m0, s43, 0
    s_mov_b32 s41, 4718592
    buffer_load_dwordx4 v8, s[20:23], s41 offen offset:0 lds
    buffer_load_dwordx4 v8, s[20:23], s41 offen offset:1024 lds
    buffer_load_dwordx4 v9, s[20:23], s41 offen offset:2048 lds
    buffer_load_dwordx4 v9, s[20:23], s41 offen offset:3072 lds
    s_mul_i32 s42, s53, 18
    s_add_u32 m0, s40, 98304
    s_nop 0
    buffer_load_dwordx4 v10, s[24:27], s42 offen offset:0 lds
    buffer_load_dwordx4 v11, s[24:27], s42 offen offset:1024 lds
    s_waitcnt vmcnt(24)
    s_barrier
    s_add_u32 m0, s43, 16384
    s_mov_b32 s41, 4980736
    buffer_load_dwordx4 v8, s[20:23], s41 offen offset:0 lds
    buffer_load_dwordx4 v8, s[20:23], s41 offen offset:1024 lds
    buffer_load_dwordx4 v9, s[20:23], s41 offen offset:2048 lds
    buffer_load_dwordx4 v9, s[20:23], s41 offen offset:3072 lds
    s_mul_i32 s42, s53, 19
    s_add_u32 m0, s40, 106496
    s_nop 0
    buffer_load_dwordx4 v10, s[24:27], s42 offen offset:0 lds
    buffer_load_dwordx4 v11, s[24:27], s42 offen offset:1024 lds
    s_waitcnt vmcnt(24)
    s_barrier
    s_add_u32 m0, s43, 32768
    s_mov_b32 s41, 5242880
    buffer_load_dwordx4 v8, s[20:23], s41 offen offset:0 lds
    buffer_load_dwordx4 v8, s[20:23], s41 offen offset:1024 lds
    buffer_load_dwordx4 v9, s[20:23], s41 offen offset:2048 lds
    buffer_load_dwordx4 v9, s[20:23], s41 offen offset:3072 lds
    s_mul_i32 s42, s53, 20
    s_add_u32 m0, s40, 114688
    s_nop 0
    buffer_load_dwordx4 v10, s[24:27], s42 offen offset:0 lds
    buffer_load_dwordx4 v11, s[24:27], s42 offen offset:1024 lds
    s_waitcnt vmcnt(24)
    s_barrier
    s_add_u32 m0, s43, 49152
    s_mov_b32 s41, 5505024
    buffer_load_dwordx4 v8, s[20:23], s41 offen offset:0 lds
    buffer_load_dwordx4 v8, s[20:23], s41 offen offset:1024 lds
    buffer_load_dwordx4 v9, s[20:23], s41 offen offset:2048 lds
    buffer_load_dwordx4 v9, s[20:23], s41 offen offset:3072 lds
    s_mul_i32 s42, s53, 21
    s_add_u32 m0, s40, 122880
    s_nop 0
    buffer_load_dwordx4 v10, s[24:27], s42 offen offset:0 lds
    buffer_load_dwordx4 v11, s[24:27], s42 offen offset:1024 lds
    s_waitcnt vmcnt(24)
    s_barrier
    s_add_u32 m0, s43, 65536
    s_mov_b32 s41, 5767168
    buffer_load_dwordx4 v8, s[20:23], s41 offen offset:0 lds
    buffer_load_dwordx4 v8, s[20:23], s41 offen offset:1024 lds
    buffer_load_dwordx4 v9, s[20:23], s41 offen offset:2048 lds
    buffer_load_dwordx4 v9, s[20:23], s41 offen offset:3072 lds
    s_mul_i32 s42, s53, 22
    s_add_u32 m0, s40, 131072
    s_nop 0
    buffer_load_dwordx4 v10, s[24:27], s42 offen offset:0 lds
    buffer_load_dwordx4 v11, s[24:27], s42 offen offset:1024 lds
    s_waitcnt vmcnt(24)
    s_barrier
    s_add_u32 m0, s43, 81920
    s_mov_b32 s41, 6029312
    buffer_load_dwordx4 v8, s[20:23], s41 offen offset:0 lds
    buffer_load_dwordx4 v8, s[20:23], s41 offen offset:1024 lds
    buffer_load_dwordx4 v9, s[20:23], s41 offen offset:2048 lds
    buffer_load_dwordx4 v9, s[20:23], s41 offen offset:3072 lds
    s_mul_i32 s42, s53, 23
    s_add_u32 m0, s40, 139264
    s_nop 0
    buffer_load_dwordx4 v10, s[24:27], s42 offen offset:0 lds
    buffer_load_dwordx4 v11, s[24:27], s42 offen offset:1024 lds
    s_waitcnt vmcnt(24)
    s_barrier
    s_add_u32 m0, s43, 0
    s_mov_b32 s41, 6291456
    buffer_load_dwordx4 v8, s[20:23], s41 offen offset:0 lds
    buffer_load_dwordx4 v8, s[20:23], s41 offen offset:1024 lds
    buffer_load_dwordx4 v9, s[20:23], s41 offen offset:2048 lds
    buffer_load_dwordx4 v9, s[20:23], s41 offen offset:3072 lds
    s_mul_i32 s42, s53, 24
    s_add_u32 m0, s40, 98304
    s_nop 0
    buffer_load_dwordx4 v10, s[24:27], s42 offen offset:0 lds
    buffer_load_dwordx4 v11, s[24:27], s42 offen offset:1024 lds
    s_waitcnt vmcnt(24)
    s_barrier
    s_add_u32 m0, s43, 16384
    s_mov_b32 s41, 6553600
    buffer_load_dwordx4 v8, s[20:23], s41 offen offset:0 lds
    buffer_load_dwordx4 v8, s[20:23], s41 offen offset:1024 lds
    buffer_load_dwordx4 v9, s[20:23], s41 offen offset:2048 lds
    buffer_load_dwordx4 v9, s[20:23], s41 offen offset:3072 lds
    s_mul_i32 s42, s53, 25
    s_add_u32 m0, s40, 106496
    s_nop 0
    buffer_load_dwordx4 v10, s[24:27], s42 offen offset:0 lds
    buffer_load_dwordx4 v11, s[24:27], s42 offen offset:1024 lds
    s_waitcnt vmcnt(24)
    s_barrier
    s_add_u32 m0, s43, 32768
    s_mov_b32 s41, 6815744
    buffer_load_dwordx4 v8, s[20:23], s41 offen offset:0 lds
    buffer_load_dwordx4 v8, s[20:23], s41 offen offset:1024 lds
    buffer_load_dwordx4 v9, s[20:23], s41 offen offset:2048 lds
    buffer_load_dwordx4 v9, s[20:23], s41 offen offset:3072 lds
    s_mul_i32 s42, s53, 26
    s_add_u32 m0, s40, 114688
    s_nop 0
    buffer_load_dwordx4 v10, s[24:27], s42 offen offset:0 lds
    buffer_load_dwordx4 v11, s[24:27], s42 offen offset:1024 lds
    s_waitcnt vmcnt(24)
    s_barrier
    s_add_u32 m0, s43, 49152
    s_mov_b32 s41, 7077888
    buffer_load_dwordx4 v8, s[20:23], s41 offen offset:0 lds
    buffer_load_dwordx4 v8, s[20:23], s41 offen offset:1024 lds
    buffer_load_dwordx4 v9, s[20:23], s41 offen offset:2048 lds
    buffer_load_dwordx4 v9, s[20:23], s41 offen offset:3072 lds
    s_mul_i32 s42, s53, 27
    s_add_u32 m0, s40, 122880
    s_nop 0
    buffer_load_dwordx4 v10, s[24:27], s42 offen offset:0 lds
    buffer_load_dwordx4 v11, s[24:27], s42 offen offset:1024 lds
    s_waitcnt vmcnt(24)
    s_barrier
    s_waitcnt vmcnt(18)
    s_barrier
    s_waitcnt vmcnt(12)
    s_barrier
    s_waitcnt vmcnt(6)
    s_barrier
    s_waitcnt vmcnt(0)
    s_barrier
    s_barrier
k5_kernel_end:
    s_endpgm
.section .rodata,"a"
.p2align 6
.amdhsa_kernel k0_kernel
  .amdhsa_next_free_vgpr 200
  .amdhsa_next_free_sgpr 102
  .amdhsa_accum_offset 200
  .amdhsa_group_segment_fixed_size 0
  .amdhsa_kernarg_size 112
  .amdhsa_user_sgpr_count 2
  .amdhsa_user_sgpr_kernarg_segment_ptr 1
  .amdhsa_system_sgpr_workgroup_id_x 1
  .amdhsa_float_denorm_mode_32 3
.end_amdhsa_kernel
.section .rodata,"a"
.p2align 6
.amdhsa_kernel k0b_kernel
  .amdhsa_next_free_vgpr 96
  .amdhsa_next_free_sgpr 102
  .amdhsa_accum_offset 96
  .amdhsa_group_segment_fixed_size 0
  .amdhsa_kernarg_size 112
  .amdhsa_user_sgpr_count 2
  .amdhsa_user_sgpr_kernarg_segment_ptr 1
  .amdhsa_system_sgpr_workgroup_id_x 1
  .amdhsa_float_denorm_mode_32 3
.end_amdhsa_kernel
.section .rodata,"a"
.p2align 6
.amdhsa_kernel k1_kernel
  .amdhsa_next_free_vgpr 232
  .amdhsa_next_free_sgpr 102
  .amdhsa_accum_offset 232
  .amdhsa_group_segment_fixed_size 0
  .amdhsa_kernarg_size 112
  .amdhsa_user_sgpr_count 2
  .amdhsa_user_sgpr_kernarg_segment_ptr 1
  .amdhsa_system_sgpr_workgroup_id_x 1
  .amdhsa_float_denorm_mode_32 3
.end_amdhsa_kernel
.section .rodata,"a"
.p2align 6
.amdhsa_kernel k1b_kernel
  .amdhsa_next_free_vgpr 128
  .amdhsa_next_free_sgpr 102
  .amdhsa_accum_offset 128
  .amdhsa_group_segment_fixed_size 0
  .amdhsa_kernarg_size 112
  .amdhsa_user_sgpr_count 2
  .amdhsa_user_sgpr_kernarg_segment_ptr 1
  .amdhsa_system_sgpr_workgroup_id_x 1
  .amdhsa_float_denorm_mode_32 3
.end_amdhsa_kernel
.section .rodata,"a"
.p2align 6
.amdhsa_kernel k2_kernel
  .amdhsa_next_free_vgpr 144
  .amdhsa_next_free_sgpr 102
  .amdhsa_accum_offset 144
  .amdhsa_group_segment_fixed_size 0
  .amdhsa_kernarg_size 112
  .amdhsa_user_sgpr_count 2
  .amdhsa_user_sgpr_kernarg_segment_ptr 1
  .amdhsa_system_sgpr_workgroup_id_x 1
  .amdhsa_float_denorm_mode_32 3
.end_amdhsa_kernel
.section .rodata,"a"
.p2align 6
.amdhsa_kernel k3_kernel
  .amdhsa_next_free_vgpr 256
  .amdhsa_next_free_sgpr 102
  .amdhsa_accum_offset 256
  .amdhsa_group_segment_fixed_size 0
  .amdhsa_kernarg_size 112
  .amdhsa_user_sgpr_count 2
  .amdhsa_user_sgpr_kernarg_segment_ptr 1
  .amdhsa_system_sgpr_workgroup_id_x 1
  .amdhsa_float_denorm_mode_32 3
.end_amdhsa_kernel
.section .rodata,"a"
.p2align 6
.amdhsa_kernel k4_kernel
  .amdhsa_next_free_vgpr 176
  .amdhsa_next_free_sgpr 102
  .amdhsa_accum_offset 176
  .amdhsa_group_segment_fixed_size 0
  .amdhsa_kernarg_size 112
  .amdhsa_user_sgpr_count 2
  .amdhsa_user_sgpr_kernarg_segment_ptr 1
  .amdhsa_system_sgpr_workgroup_id_x 1
  .amdhsa_float_denorm_mode_32 3
.end_amdhsa_kernel
.section .rodata,"a"
.p2align 6
.amdhsa_kernel k5_kernel
  .amdhsa_next_free_vgpr 144
  .amdhsa_next_free_sgpr 102
  .amdhsa_accum_offset 144
  .amdhsa_group_segment_fixed_size 0
  .amdhsa_kernarg_size 112
  .amdhsa_user_sgpr_count 2
  .amdhsa_user_sgpr_kernarg_segment_ptr 1
  .amdhsa_system_sgpr_workgroup_id_x 1
  .amdhsa_float_denorm_mode_32 3
.end_amdhsa_kernel
```
